```python
import torch

def _softmax(x, axis=-1):
    return torch.softmax(x, dim=axis)
def _gelu(x):
    return torch.nn.functional.gelu(x, approximate="tanh")
def _silu(x):
    return torch.nn.functional.silu(x)
def _sigmoid(x):
    return torch.sigmoid(x)
def _layernorm(x, axis=-1, eps=1e-5):
    m = x.mean(dim=axis, keepdim=True)
    v = x.var(dim=axis, keepdim=True, unbiased=False)
    return (x - m) / torch.sqrt(v + eps)
def _scatter_add(tgt, idx, src, axis=0):
    return tgt.clone().index_add_(axis, idx, src)
def _segment_sum(src, seg, n):
    out = torch.zeros((n,) + src.shape[1:], dtype=src.dtype)
    return out.index_add_(0, seg, src)
def _pad(x, pw):
    flat = tuple(v for pair in reversed(pw) for v in pair)
    return torch.nn.functional.pad(x, flat)

kernel_name = 'standalone__gqa_block_cached__near_ridge'

def setup_inputs():

    _w = (lambda a: (lambda t: t.to(torch.bfloat16) if t.is_floating_point() else t)(torch.as_tensor(a)))
    B, Sq, D = 16, 240, 640
    Hq, Hkv, Sk, Dh = 32, 32, 1024, 128
    assert Hq % Hkv == 0, (Hq, Hkv)
    return {
        "x": _w((lambda *s: torch.randn(*s, dtype=torch.bfloat16) * 0.8)(B, Sq, D)),
        "k_cache": _w((lambda *s: torch.randn(*s, dtype=torch.bfloat16) * 0.8)(B, Hkv, Sk, Dh)),
        "v_cache": _w((lambda *s: torch.randn(*s, dtype=torch.bfloat16) * 0.05)(B, Hkv, Sk, Dh)),
        "wq": _w((lambda *s: torch.randn(*s, dtype=torch.bfloat16) * 0.8)(D, Hq * Dh) * (D ** -0.5)),
        "wo": _w((lambda *s: torch.randn(*s, dtype=torch.bfloat16) * 0.05)(Hq * Dh, D) * ((Hq * Dh) ** -0.5)),
    }

def reference(x, k_cache, v_cache, wq, wo):
    B, Sq, D = x.shape
    Hq, Dh = 32, 128
    Hkv = k_cache.shape[1]
    rep = Hq // Hkv
    q = (lambda x, *d: x.permute(*d))((x @ wq).reshape(B, Sq, Hq, Dh), 0, 2, 1, 3)
    k = (lambda x, n, axis: torch.repeat_interleave(x, n, dim=axis))(k_cache, rep, axis=1)
    v = (lambda x, n, axis: torch.repeat_interleave(x, n, dim=axis))(v_cache, rep, axis=1)
    scores = torch.einsum("bhqd,bhkd->bhqk", q, k) * (Dh ** -0.5)
    p = _softmax(scores, axis=-1)
    o = torch.einsum("bhqk,bhkd->bhqd", p, v)
    return (lambda x, *d: x.permute(*d))(o, 0, 2, 1, 3).reshape(B, Sq, Hq * Dh) @ wo
```

```asm
; @launch grid=(256,1,1) block=(256,1,1) lds=163840
.amdgcn_target "amdgcn-amd-amdhsa--gfx950"
.text
.globl standalone__gqa_block_cached__near_ridge_kernel
.p2align 8
.type standalone__gqa_block_cached__near_ridge_kernel,@function
standalone__gqa_block_cached__near_ridge_kernel:
    s_cmp_ge_u32 s2, 256
    s_cbranch_scc1 L1_end
    s_load_dwordx4 s[20:23], s[0:1], 0
    s_load_dwordx4 s[24:27], s[0:1], 16
    s_load_dwordx2 s[28:29], s[0:1], 56
    s_load_dwordx4 s[88:91], s[0:1], 32
    s_load_dwordx2 s[92:93], s[0:1], 48
    v_lshrrev_b32 v21, 6, v0
    v_and_b32 v1, 63, v0
    v_readfirstlane_b32 s3, v21
    s_and_b32 s52, s2, 7
    s_lshr_b32 s53, s2, 3
    s_lshr_b32 s30, s52, 1
    s_lshl_b32 s30, s30, 2
    s_lshr_b32 s54, s53, 3
    s_add_u32 s30, s30, s54
    s_and_b32 s31, s52, 1
    s_lshl_b32 s31, s31, 3
    s_and_b32 s59, s53, 7
    s_add_u32 s31, s31, s59
    s_mul_i32 s34, s3, 4224
    s_and_b32 s55, s3, 1
    s_lshr_b32 s56, s3, 1
    s_getpc_b64 s[60:61]
L1_pc:
    s_sub_u32 s60, s60, L1_pc-standalone__gqa_block_cached__near_ridge_kernel
    s_subb_u32 s61, s61, 0
    s_mov_b32 s62, L1_fbs-standalone__gqa_block_cached__near_ridge_kernel
    s_mov_b32 s63, 0x20000
    s_lshl_b32 s64, s59, 13
    v_lshlrev_b32 v23, 5, v0
    v_add_u32 v23, s64, v23
    buffer_load_dword v96, v23, s[60:63], 0 offen
    s_add_u32 s57, s54, s59
    s_and_b32 s57, s57, 3
    s_mov_b32 s96, 0x86534210
    s_mov_b32 s97, 0x97
    s_cmp_eq_u32 s57, 1
    s_cselect_b32 s96, 0x76453201, s96
    s_cselect_b32 s97, 0x89, s97
    s_cmp_eq_u32 s57, 2
    s_cselect_b32 s96, 0x75643120, s96
    s_cselect_b32 s97, 0x98, s97
    s_cmp_eq_u32 s57, 3
    s_cselect_b32 s96, 0x67542310, s96
    s_cselect_b32 s97, 0x98, s97
    v_and_b32 v21, 15, v1
    v_lshrrev_b32 v22, 4, v1
    v_lshlrev_b32 v20, 4, v1
    v_and_b32 v23, 1, v22
    v_lshlrev_b32 v23, 17, v23
    v_lshrrev_b32 v24, 1, v22
    v_lshl_add_u32 v23, v24, 15, v23
    v_lshl_add_u32 v23, v21, 4, v23
    s_lshl_b32 s57, s55, 16
    s_lshl_b32 s33, s56, 8
    s_lshl_b32 s45, s56, 18
    v_add_u32 v10, s57, v23
    v_add_u32 v11, 7136, v10
    v_add_u32 v12, 14272, v10
    v_add_u32 v13, 21408, v10
    v_lshrrev_b32 v23, 3, v1
    v_mul_u32_u24 v23, 1280, v23
    v_and_b32 v24, 7, v1
    v_xor_b32 v24, v24, v22
    v_lshl_add_u32 v14, v24, 4, v23
    v_xor_b32 v24, 4, v24
    v_lshl_add_u32 v15, v24, 4, v23
    v_add_u32 v16, 18432, v14
    v_add_u32 v17, 27648, v15
    v_add_u32 v15, 9216, v15
    s_lshl_b32 s42, s3, 13
    s_add_u32 s42, s42, 101376
    s_mov_b32 s7, 0x20000
    s_mov_b32 s15, 0x20000
    s_lshl_b32 s57, s31, 9
    s_sub_u32 s6, 5242880, s57
    s_mul_i32 s58, s30, 240
    s_lshl_b32 s60, s3, 6
    s_add_u32 s58, s58, s60
    s_mul_i32 s58, s58, 1280
    s_sub_u32 s14, 4915200, s58
    s_waitcnt lgkmcnt(0)
    s_add_u32 s4, s26, s57
    s_addc_u32 s5, s27, 0
    s_add_u32 s12, s20, s58
    s_addc_u32 s13, s21, 0
    s_bfe_u32 s98, s96, 0x40000
    s_lshl_b32 s36, s98, 19
    s_add_u32 s36, s36, s45
    s_add_u32 m0, s34, 16896
    s_nop 0
    buffer_load_dwordx4 v10, s[4:7], s36 offen offset:0 lds
    buffer_load_dwordx4 v11, s[4:7], s36 offen offset:1056 lds
    buffer_load_dwordx4 v12, s[4:7], s36 offen offset:2112 lds
    buffer_load_dwordx4 v13, s[4:7], s36 offen offset:3168 lds
    s_bfe_u32 s98, s96, 0x40000
    s_lshl_b32 s40, s98, 7
    s_add_u32 s41, s40, 40960
    s_add_u32 m0, s42, 0
    s_nop 0
    buffer_load_dwordx4 v14, s[12:15], s40 offen offset:0 lds
    buffer_load_dwordx4 v15, s[12:15], s40 offen offset:1024 lds
    buffer_load_dwordx4 v16, s[12:15], s40 offen offset:2048 lds
    buffer_load_dwordx4 v17, s[12:15], s40 offen offset:3072 lds
    s_add_u32 m0, s42, 4096
    s_nop 0
    buffer_load_dwordx4 v14, s[12:15], s41 offen offset:0 lds
    buffer_load_dwordx4 v15, s[12:15], s41 offen offset:1024 lds
    s_cmp_eq_u32 s3, 3
    s_cbranch_scc1 L1_xa
    buffer_load_dwordx4 v16, s[12:15], s41 offen offset:2048 lds
    buffer_load_dwordx4 v17, s[12:15], s41 offen offset:3072 lds
L1_xa:
    s_lshl_b32 s57, s30, 5
    s_lshl_b32 s58, s31, 1
    s_add_u32 s57, s57, s58
    s_lshl_b32 s57, s57, 18
    s_cmp_ge_u32 s3, 2
    s_cselect_b32 s8, s24, s22
    s_cselect_b32 s9, s25, s23
    s_cselect_b32 s35, -8192, 0
    s_add_u32 s8, s8, s57
    s_addc_u32 s9, s9, 0
    s_sub_u32 s8, s8, 2400
    s_subb_u32 s9, s9, 0
    s_mov_b32 s10, 526688
    s_mov_b32 s11, 0x20000
    s_mul_i32 s57, s30, 61440
    s_mul_i32 s58, s31, 1974272
    s_add_u32 s57, s57, s58
    s_add_u32 s84, s28, s57
    s_addc_u32 s85, s29, 0
    s_lshl_b32 s58, s3, 14
    s_add_u32 s58, s58, 987136
    s_add_u32 s16, s84, s58
    s_addc_u32 s17, s85, 0
    s_mov_b32 s19, 0x20000
    s_lshl_b32 s58, s3, 14
    s_add_u32 s84, s84, s58
    s_addc_u32 s85, s85, 0
    s_add_u32 s58, s58, 113664
    s_cmp_eq_u32 s3, 3
    s_cselect_b32 s69, 101376, s58
    s_cselect_b32 s86, 3, 4
    s_lshl_b32 s86, s86, 12
    s_mov_b32 s18, s86
    s_add_u32 s37, s86, s69
    s_sub_u32 s84, s84, s69
    s_subb_u32 s85, s85, 0
    s_mov_b32 s87, 0x20000
    s_mov_b32 s32, 33792
    s_mov_b32 s43, 30720
    s_mov_b32 s99, 0
    s_mov_b32 s95, s14
    s_mul_i32 s100, s3, 2112
    s_add_u32 s100, s100, 84480
    s_mov_b32 s60, s88
    s_mov_b32 s61, s89
    s_mov_b32 s62, 5242880
    s_mov_b32 s63, 0x20000
    s_mov_b32 s46, 0x3e0293ee
    s_mov_b32 s47, 0x5d800000
    s_mov_b32 s48, 0
    s_mov_b32 s49, 4096
    s_mov_b32 s50, 8192
    s_mov_b32 s51, 12288
    v_lshlrev_b32 v23, 11, v22
    v_lshl_add_u32 v23, v21, 4, v23
    s_lshl_b32 s57, s55, 10
    v_add_u32 v9, s57, v23
    v_add_u32 v6, 2400, v9
    v_add_u32 v7, 1600, v9
    v_add_u32 v8, 800, v9
    v_and_b32 v23, 7, v21
    v_mul_u32_u24 v23, 1056, v23
    v_lshrrev_b32 v24, 3, v21
    v_lshl_add_u32 v23, v24, 8, v23
    v_lshl_add_u32 v2, v22, 4, v23
    v_bfe_u32 v23, v1, 2, 3
    v_mul_u32_u24 v23, 1056, v23
    v_lshrrev_b32 v24, 5, v1
    v_lshl_add_u32 v23, v24, 8, v23
    v_and_b32 v24, 3, v1
    v_lshl_add_u32 v3, v24, 3, v23
    v_add_u32 v5, 16896, v3
    v_lshrrev_b32 v23, 1, v21
    v_xor_b32 v23, v23, v22
    v_lshlrev_b32 v24, 7, v21
    v_add_u32 v24, s42, v24
    v_lshl_add_u32 v18, v23, 4, v24
    v_xor_b32 v23, 4, v23
    v_lshl_add_u32 v19, v23, 4, v24
    s_memrealtime s[52:53]
    s_mov_b32 s64, s92
    s_mov_b32 s65, s93
    s_or_b32 s57, s2, s3
    s_cmp_eq_u32 s57, 0
    s_cselect_b32 s66, 4, 0
    s_mov_b32 s67, 0x20000
    s_waitcnt lgkmcnt(0)
    s_or_b32 s57, s52, 1
    s_lshl_b32 s57, s57, 2
    v_mov_b32 v23, s57
    buffer_store_dword v23, v20, s[64:67], 0 offen sc1
    s_mov_b32 s66, 4
    v_lshrrev_b32 v23, 5, v1
    v_lshlrev_b32 v23, 8, v23
    v_lshl_add_u32 v23, v21, 4, v23
    v_and_b32 v24, 1, v22
    v_lshl_add_u32 v23, v24, 3, v23
    v_add_u32 v123, s69, v23
    s_bfe_u32 s98, s96, 0x40004
    s_lshl_b32 s36, s98, 19
    s_add_u32 s36, s36, s45
    s_add_u32 m0, s34, 84480
    s_nop 0
    buffer_load_dwordx4 v10, s[4:7], s36 offen offset:0 lds
    buffer_load_dwordx4 v11, s[4:7], s36 offen offset:1056 lds
    buffer_load_dwordx4 v12, s[4:7], s36 offen offset:2112 lds
    buffer_load_dwordx4 v13, s[4:7], s36 offen offset:3168 lds
    s_waitcnt vmcnt(4)
    s_barrier
    s_cmp_eq_u32 s3, 3
    s_cbranch_scc1 L1v3_go
L1v4_go:
    ds_read_b128 a[64:67], v18 offset:0
    ds_read_b64_tr_b16 a[0:1], v5 offset:0
    ds_read_b64_tr_b16 a[2:3], v5 offset:512
    ds_read_b128 a[80:83], v19 offset:0
    ds_read_b64_tr_b16 a[32:33], v5 offset:8448
    ds_read_b64_tr_b16 a[34:35], v5 offset:8960
    ds_read_b128 a[68:71], v18 offset:2048
    ds_read_b128 a[84:87], v19 offset:2048
    ds_read_b128 a[72:75], v18 offset:4096
    ds_read_b128 a[88:91], v19 offset:4096
    ds_read_b128 a[76:79], v18 offset:6144
    ds_read_b128 a[92:95], v19 offset:6144
    ds_read_b64_tr_b16 a[4:5], v5 offset:32
    ds_read_b64_tr_b16 a[6:7], v5 offset:544
    ds_read_b64_tr_b16 a[36:37], v5 offset:8480
    ds_read_b64_tr_b16 a[38:39], v5 offset:8992
    ds_read_b64_tr_b16 a[8:9], v5 offset:64
    ds_read_b64_tr_b16 a[10:11], v5 offset:576
    ds_read_b64_tr_b16 a[40:41], v5 offset:8512
    ds_read_b64_tr_b16 a[42:43], v5 offset:9024
    ds_read_b64_tr_b16 a[12:13], v5 offset:96
    ds_read_b64_tr_b16 a[14:15], v5 offset:608
    ds_read_b64_tr_b16 a[44:45], v5 offset:8544
    ds_read_b64_tr_b16 a[46:47], v5 offset:9056
    ds_read_b64_tr_b16 a[16:17], v5 offset:128
    ds_read_b64_tr_b16 a[18:19], v5 offset:640
    ds_read_b64_tr_b16 a[48:49], v5 offset:8576
    ds_read_b64_tr_b16 a[50:51], v5 offset:9088
    ds_read_b64_tr_b16 a[20:21], v5 offset:160
    ds_read_b64_tr_b16 a[22:23], v5 offset:672
    ds_read_b64_tr_b16 a[52:53], v5 offset:8608
    ds_read_b64_tr_b16 a[54:55], v5 offset:9120
    ds_read_b64_tr_b16 a[24:25], v5 offset:192
    ds_read_b64_tr_b16 a[26:27], v5 offset:704
    ds_read_b64_tr_b16 a[56:57], v5 offset:8640
    ds_read_b64_tr_b16 a[58:59], v5 offset:9152
    ds_read_b64_tr_b16 a[28:29], v5 offset:224
    ds_read_b64_tr_b16 a[30:31], v5 offset:736
    ds_read_b64_tr_b16 a[60:61], v5 offset:8672
    ds_read_b64_tr_b16 a[62:63], v5 offset:9184
    s_waitcnt lgkmcnt(15)
    v_mfma_f32_16x16x32_bf16 v[128:131], a[0:3], a[64:67], 0
    s_bfe_u32 s98, s96, 0x40004
    v_mfma_f32_16x16x32_bf16 v[128:131], a[32:35], a[80:83], v[128:131]
    s_lshl_b32 s40, s98, 7
    s_add_u32 s41, s40, 40960
    s_add_u32 m0, s42, 30720
    s_nop 0
    buffer_load_dwordx4 v14, s[12:15], s40 offen offset:0 lds
    v_mfma_f32_16x16x32_bf16 v[160:163], a[32:35], a[84:87], 0
    buffer_load_dwordx4 v15, s[12:15], s40 offen offset:1024 lds
    v_mfma_f32_16x16x32_bf16 v[160:163], a[0:3], a[68:71], v[160:163]
    buffer_load_dwordx4 v16, s[12:15], s40 offen offset:2048 lds
    v_mfma_f32_16x16x32_bf16 v[192:195], a[0:3], a[72:75], 0
    v_mfma_f32_16x16x32_bf16 v[192:195], a[32:35], a[88:91], v[192:195]
    buffer_load_dwordx4 v17, s[12:15], s40 offen offset:3072 lds
    v_mfma_f32_16x16x32_bf16 v[224:227], a[32:35], a[92:95], 0
    s_add_u32 m0, s42, 34816
    s_nop 0
    buffer_load_dwordx4 v14, s[12:15], s41 offen offset:0 lds
    v_mfma_f32_16x16x32_bf16 v[224:227], a[0:3], a[76:79], v[224:227]
    v_mfma_f32_16x16x32_bf16 v[132:135], a[4:7], a[64:67], 0
    buffer_load_dwordx4 v15, s[12:15], s41 offen offset:1024 lds
    v_mfma_f32_16x16x32_bf16 v[132:135], a[36:39], a[80:83], v[132:135]
    buffer_load_dwordx4 v16, s[12:15], s41 offen offset:2048 lds
    v_mfma_f32_16x16x32_bf16 v[164:167], a[36:39], a[84:87], 0
    buffer_load_dwordx4 v17, s[12:15], s41 offen offset:3072 lds
    v_mfma_f32_16x16x32_bf16 v[164:167], a[4:7], a[68:71], v[164:167]
    s_bfe_u32 s98, s96, 0x40008
    v_mfma_f32_16x16x32_bf16 v[196:199], a[4:7], a[72:75], 0
    s_lshl_b32 s36, s98, 19
    s_add_u32 s36, s36, s45
    s_add_u32 m0, s34, 0
    s_nop 0
    buffer_load_dwordx4 v10, s[4:7], s36 offen offset:0 lds
    v_mfma_f32_16x16x32_bf16 v[196:199], a[36:39], a[88:91], v[196:199]
    buffer_load_dwordx4 v11, s[4:7], s36 offen offset:1056 lds
    v_mfma_f32_16x16x32_bf16 v[228:231], a[36:39], a[92:95], 0
    v_mfma_f32_16x16x32_bf16 v[228:231], a[4:7], a[76:79], v[228:231]
    buffer_load_dwordx4 v12, s[4:7], s36 offen offset:2112 lds
    v_mfma_f32_16x16x32_bf16 v[136:139], a[8:11], a[64:67], 0
    buffer_load_dwordx4 v13, s[4:7], s36 offen offset:3168 lds
    v_mfma_f32_16x16x32_bf16 v[136:139], a[40:43], a[80:83], v[136:139]
    v_mfma_f32_16x16x32_bf16 v[168:171], a[40:43], a[84:87], 0
    v_add_u32 v5, 84480, v3
    v_mfma_f32_16x16x32_bf16 v[168:171], a[8:11], a[68:71], v[168:171]
    s_waitcnt vmcnt(12) lgkmcnt(0)
    v_mfma_f32_16x16x32_bf16 v[200:203], a[8:11], a[72:75], 0
    s_barrier
    v_mfma_f32_16x16x32_bf16 v[200:203], a[40:43], a[88:91], v[200:203]
    ds_read_b64_tr_b16 a[32:33], v5 offset:8448
    ds_read_b64_tr_b16 a[34:35], v5 offset:8960
    v_mfma_f32_16x16x32_bf16 v[232:235], a[40:43], a[92:95], 0
    ds_read_b64_tr_b16 a[0:1], v5 offset:0
    ds_read_b64_tr_b16 a[2:3], v5 offset:512
    v_mfma_f32_16x16x32_bf16 v[232:235], a[8:11], a[76:79], v[232:235]
    s_bfe_u32 s98, s96, 0x40008
    ds_read_b64_tr_b16 a[36:37], v5 offset:8480
    ds_read_b64_tr_b16 a[38:39], v5 offset:8992
    v_mfma_f32_16x16x32_bf16 v[140:143], a[12:15], a[64:67], 0
    s_lshl_b32 s40, s98, 7
    ds_read_b64_tr_b16 a[4:5], v5 offset:32
    ds_read_b64_tr_b16 a[6:7], v5 offset:544
    v_mfma_f32_16x16x32_bf16 v[140:143], a[44:47], a[80:83], v[140:143]
    s_add_u32 s41, s40, 40960
    ds_read_b64_tr_b16 a[40:41], v5 offset:8512
    ds_read_b64_tr_b16 a[42:43], v5 offset:9024
    v_mfma_f32_16x16x32_bf16 v[172:175], a[44:47], a[84:87], 0
    s_add_u32 m0, s42, 0
    ds_read_b64_tr_b16 a[8:9], v5 offset:64
    ds_read_b64_tr_b16 a[10:11], v5 offset:576
    v_mfma_f32_16x16x32_bf16 v[172:175], a[12:15], a[68:71], v[172:175]
    buffer_load_dwordx4 v14, s[12:15], s40 offen offset:0 lds
    v_mfma_f32_16x16x32_bf16 v[204:207], a[12:15], a[72:75], 0
    buffer_load_dwordx4 v15, s[12:15], s40 offen offset:1024 lds
    v_mfma_f32_16x16x32_bf16 v[204:207], a[44:47], a[88:91], v[204:207]
    buffer_load_dwordx4 v16, s[12:15], s40 offen offset:2048 lds
    v_mfma_f32_16x16x32_bf16 v[236:239], a[44:47], a[92:95], 0
    ds_read_b64_tr_b16 a[44:45], v5 offset:8544
    ds_read_b64_tr_b16 a[46:47], v5 offset:9056
    v_mfma_f32_16x16x32_bf16 v[236:239], a[12:15], a[76:79], v[236:239]
    ds_read_b64_tr_b16 a[12:13], v5 offset:96
    ds_read_b64_tr_b16 a[14:15], v5 offset:608
    v_mfma_f32_16x16x32_bf16 v[144:147], a[16:19], a[64:67], 0
    buffer_load_dwordx4 v17, s[12:15], s40 offen offset:3072 lds
    v_mfma_f32_16x16x32_bf16 v[144:147], a[48:51], a[80:83], v[144:147]
    v_mfma_f32_16x16x32_bf16 v[176:179], a[48:51], a[84:87], 0
    s_add_u32 m0, s42, 4096
    v_mfma_f32_16x16x32_bf16 v[176:179], a[16:19], a[68:71], v[176:179]
    buffer_load_dwordx4 v14, s[12:15], s41 offen offset:0 lds
    v_mfma_f32_16x16x32_bf16 v[208:211], a[16:19], a[72:75], 0
    v_mfma_f32_16x16x32_bf16 v[208:211], a[48:51], a[88:91], v[208:211]
    v_mfma_f32_16x16x32_bf16 v[240:243], a[48:51], a[92:95], 0
    ds_read_b64_tr_b16 a[48:49], v5 offset:8576
    ds_read_b64_tr_b16 a[50:51], v5 offset:9088
    v_mfma_f32_16x16x32_bf16 v[240:243], a[16:19], a[76:79], v[240:243]
    ds_read_b64_tr_b16 a[16:17], v5 offset:128
    ds_read_b64_tr_b16 a[18:19], v5 offset:640
    v_mfma_f32_16x16x32_bf16 v[148:151], a[20:23], a[64:67], 0
    buffer_load_dwordx4 v15, s[12:15], s41 offen offset:1024 lds
    v_mfma_f32_16x16x32_bf16 v[148:151], a[52:55], a[80:83], v[148:151]
    v_mfma_f32_16x16x32_bf16 v[180:183], a[52:55], a[84:87], 0
    buffer_load_dwordx4 v16, s[12:15], s41 offen offset:2048 lds
    v_mfma_f32_16x16x32_bf16 v[180:183], a[20:23], a[68:71], v[180:183]
    v_mfma_f32_16x16x32_bf16 v[212:215], a[20:23], a[72:75], 0
    v_mfma_f32_16x16x32_bf16 v[212:215], a[52:55], a[88:91], v[212:215]
    buffer_load_dwordx4 v17, s[12:15], s41 offen offset:3072 lds
    v_mfma_f32_16x16x32_bf16 v[244:247], a[52:55], a[92:95], 0
    s_waitcnt vmcnt(12)
    ds_read_b64_tr_b16 a[52:53], v5 offset:8608
    ds_read_b64_tr_b16 a[54:55], v5 offset:9120
    v_mfma_f32_16x16x32_bf16 v[244:247], a[20:23], a[76:79], v[244:247]
    ds_read_b64_tr_b16 a[20:21], v5 offset:160
    ds_read_b64_tr_b16 a[22:23], v5 offset:672
    v_mfma_f32_16x16x32_bf16 v[152:155], a[24:27], a[64:67], 0
    ds_read_b128 a[96:99], v18 offset:30720
    v_mfma_f32_16x16x32_bf16 v[152:155], a[56:59], a[80:83], v[152:155]
    ds_read_b128 a[112:115], v19 offset:30720
    v_mfma_f32_16x16x32_bf16 v[184:187], a[56:59], a[84:87], 0
    ds_read_b128 a[100:103], v18 offset:32768
    v_mfma_f32_16x16x32_bf16 v[184:187], a[24:27], a[68:71], v[184:187]
    ds_read_b128 a[116:119], v19 offset:32768
    v_mfma_f32_16x16x32_bf16 v[216:219], a[24:27], a[72:75], 0
    ds_read_b128 a[104:107], v18 offset:34816
    v_mfma_f32_16x16x32_bf16 v[216:219], a[56:59], a[88:91], v[216:219]
    ds_read_b128 a[120:123], v19 offset:34816
    v_mfma_f32_16x16x32_bf16 v[248:251], a[56:59], a[92:95], 0
    s_bfe_u32 s98, s96, 0x4000c
    ds_read_b64_tr_b16 a[56:57], v5 offset:8640
    ds_read_b64_tr_b16 a[58:59], v5 offset:9152
    v_mfma_f32_16x16x32_bf16 v[248:251], a[24:27], a[76:79], v[248:251]
    s_lshl_b32 s36, s98, 19
    ds_read_b64_tr_b16 a[24:25], v5 offset:192
    ds_read_b64_tr_b16 a[26:27], v5 offset:704
    v_mfma_f32_16x16x32_bf16 v[156:159], a[28:31], a[64:67], 0
    s_add_u32 s36, s36, s45
    ds_read_b128 a[108:111], v18 offset:36864
    v_mfma_f32_16x16x32_bf16 v[156:159], a[60:63], a[80:83], v[156:159]
    s_add_u32 m0, s34, 16896
    ds_read_b128 a[124:127], v19 offset:36864
    v_mfma_f32_16x16x32_bf16 v[188:191], a[60:63], a[84:87], 0
    buffer_load_dwordx4 v10, s[4:7], s36 offen offset:0 lds
    v_mfma_f32_16x16x32_bf16 v[188:191], a[28:31], a[68:71], v[188:191]
    buffer_load_dwordx4 v11, s[4:7], s36 offen offset:1056 lds
    v_mfma_f32_16x16x32_bf16 v[220:223], a[28:31], a[72:75], 0
    buffer_load_dwordx4 v12, s[4:7], s36 offen offset:2112 lds
    v_mfma_f32_16x16x32_bf16 v[220:223], a[60:63], a[88:91], v[220:223]
    buffer_load_dwordx4 v13, s[4:7], s36 offen offset:3168 lds
    v_mfma_f32_16x16x32_bf16 v[252:255], a[60:63], a[92:95], 0
    ds_read_b64_tr_b16 a[60:61], v5 offset:8672
    ds_read_b64_tr_b16 a[62:63], v5 offset:9184
    v_mfma_f32_16x16x32_bf16 v[252:255], a[28:31], a[76:79], v[252:255]
    s_waitcnt lgkmcnt(13)
    ds_read_b64_tr_b16 a[28:29], v5 offset:224
    ds_read_b64_tr_b16 a[30:31], v5 offset:736
    v_mfma_f32_16x16x32_bf16 v[128:131], a[0:3], a[96:99], v[128:131]
    s_waitcnt lgkmcnt(14)
    v_mfma_f32_16x16x32_bf16 v[128:131], a[32:35], a[112:115], v[128:131]
    s_waitcnt lgkmcnt(12)
    v_mfma_f32_16x16x32_bf16 v[160:163], a[32:35], a[116:119], v[160:163]
    v_mfma_f32_16x16x32_bf16 v[160:163], a[0:3], a[100:103], v[160:163]
    s_waitcnt lgkmcnt(11)
    v_mfma_f32_16x16x32_bf16 v[192:195], a[0:3], a[104:107], v[192:195]
    s_waitcnt lgkmcnt(10)
    v_mfma_f32_16x16x32_bf16 v[192:195], a[32:35], a[120:123], v[192:195]
    s_waitcnt lgkmcnt(4)
    v_mfma_f32_16x16x32_bf16 v[224:227], a[32:35], a[124:127], v[224:227]
    v_add_u32 v5, 0, v3
    v_mfma_f32_16x16x32_bf16 v[224:227], a[0:3], a[108:111], v[224:227]
    s_waitcnt vmcnt(12) lgkmcnt(0)
    v_mfma_f32_16x16x32_bf16 v[132:135], a[4:7], a[96:99], v[132:135]
    s_barrier
    v_mfma_f32_16x16x32_bf16 v[132:135], a[36:39], a[112:115], v[132:135]
    s_bfe_u32 s98, s96, 0x4000c
    ds_read_b64_tr_b16 a[32:33], v5 offset:8448
    ds_read_b64_tr_b16 a[34:35], v5 offset:8960
    v_mfma_f32_16x16x32_bf16 v[164:167], a[36:39], a[116:119], v[164:167]
    s_lshl_b32 s40, s98, 7
    ds_read_b64_tr_b16 a[0:1], v5 offset:0
    ds_read_b64_tr_b16 a[2:3], v5 offset:512
    v_mfma_f32_16x16x32_bf16 v[164:167], a[4:7], a[100:103], v[164:167]
    s_add_u32 s41, s40, 40960
    s_add_u32 m0, s42, 30720
    s_nop 0
    buffer_load_dwordx4 v14, s[12:15], s40 offen offset:0 lds
    v_mfma_f32_16x16x32_bf16 v[196:199], a[4:7], a[104:107], v[196:199]
    v_mfma_f32_16x16x32_bf16 v[196:199], a[36:39], a[120:123], v[196:199]
    v_mfma_f32_16x16x32_bf16 v[228:231], a[36:39], a[124:127], v[228:231]
    ds_read_b64_tr_b16 a[36:37], v5 offset:8480
    ds_read_b64_tr_b16 a[38:39], v5 offset:8992
    v_mfma_f32_16x16x32_bf16 v[228:231], a[4:7], a[108:111], v[228:231]
    ds_read_b64_tr_b16 a[4:5], v5 offset:32
    ds_read_b64_tr_b16 a[6:7], v5 offset:544
    v_mfma_f32_16x16x32_bf16 v[136:139], a[8:11], a[96:99], v[136:139]
    buffer_load_dwordx4 v15, s[12:15], s40 offen offset:1024 lds
    v_mfma_f32_16x16x32_bf16 v[136:139], a[40:43], a[112:115], v[136:139]
    v_mfma_f32_16x16x32_bf16 v[168:171], a[40:43], a[116:119], v[168:171]
    buffer_load_dwordx4 v16, s[12:15], s40 offen offset:2048 lds
    v_mfma_f32_16x16x32_bf16 v[168:171], a[8:11], a[100:103], v[168:171]
    v_mfma_f32_16x16x32_bf16 v[200:203], a[8:11], a[104:107], v[200:203]
    v_mfma_f32_16x16x32_bf16 v[200:203], a[40:43], a[120:123], v[200:203]
    v_mfma_f32_16x16x32_bf16 v[232:235], a[40:43], a[124:127], v[232:235]
    ds_read_b64_tr_b16 a[40:41], v5 offset:8512
    ds_read_b64_tr_b16 a[42:43], v5 offset:9024
    v_mfma_f32_16x16x32_bf16 v[232:235], a[8:11], a[108:111], v[232:235]
    ds_read_b64_tr_b16 a[8:9], v5 offset:64
    ds_read_b64_tr_b16 a[10:11], v5 offset:576
    v_mfma_f32_16x16x32_bf16 v[140:143], a[12:15], a[96:99], v[140:143]
    buffer_load_dwordx4 v17, s[12:15], s40 offen offset:3072 lds
    v_mfma_f32_16x16x32_bf16 v[140:143], a[44:47], a[112:115], v[140:143]
    s_add_u32 m0, s42, 34816
    v_mfma_f32_16x16x32_bf16 v[172:175], a[44:47], a[116:119], v[172:175]
    buffer_load_dwordx4 v14, s[12:15], s41 offen offset:0 lds
    v_mfma_f32_16x16x32_bf16 v[172:175], a[12:15], a[100:103], v[172:175]
    v_mfma_f32_16x16x32_bf16 v[204:207], a[12:15], a[104:107], v[204:207]
    v_mfma_f32_16x16x32_bf16 v[204:207], a[44:47], a[120:123], v[204:207]
    v_mfma_f32_16x16x32_bf16 v[236:239], a[44:47], a[124:127], v[236:239]
    ds_read_b64_tr_b16 a[44:45], v5 offset:8544
    ds_read_b64_tr_b16 a[46:47], v5 offset:9056
    v_mfma_f32_16x16x32_bf16 v[236:239], a[12:15], a[108:111], v[236:239]
    ds_read_b64_tr_b16 a[12:13], v5 offset:96
    ds_read_b64_tr_b16 a[14:15], v5 offset:608
    v_mfma_f32_16x16x32_bf16 v[144:147], a[16:19], a[96:99], v[144:147]
    buffer_load_dwordx4 v15, s[12:15], s41 offen offset:1024 lds
    v_mfma_f32_16x16x32_bf16 v[144:147], a[48:51], a[112:115], v[144:147]
    v_mfma_f32_16x16x32_bf16 v[176:179], a[48:51], a[116:119], v[176:179]
    buffer_load_dwordx4 v16, s[12:15], s41 offen offset:2048 lds
    v_mfma_f32_16x16x32_bf16 v[176:179], a[16:19], a[100:103], v[176:179]
    v_mfma_f32_16x16x32_bf16 v[208:211], a[16:19], a[104:107], v[208:211]
    v_mfma_f32_16x16x32_bf16 v[208:211], a[48:51], a[120:123], v[208:211]
    v_mfma_f32_16x16x32_bf16 v[240:243], a[48:51], a[124:127], v[240:243]
    ds_read_b64_tr_b16 a[48:49], v5 offset:8576
    ds_read_b64_tr_b16 a[50:51], v5 offset:9088
    v_mfma_f32_16x16x32_bf16 v[240:243], a[16:19], a[108:111], v[240:243]
    ds_read_b64_tr_b16 a[16:17], v5 offset:128
    ds_read_b64_tr_b16 a[18:19], v5 offset:640
    v_mfma_f32_16x16x32_bf16 v[148:151], a[20:23], a[96:99], v[148:151]
    buffer_load_dwordx4 v17, s[12:15], s41 offen offset:3072 lds
    v_mfma_f32_16x16x32_bf16 v[148:151], a[52:55], a[112:115], v[148:151]
    s_bfe_u32 s98, s96, 0x40010
    v_mfma_f32_16x16x32_bf16 v[180:183], a[52:55], a[116:119], v[180:183]
    s_lshl_b32 s36, s98, 19
    s_add_u32 s36, s36, s45
    s_add_u32 m0, s34, 84480
    s_nop 0
    buffer_load_dwordx4 v10, s[4:7], s36 offen offset:0 lds
    v_mfma_f32_16x16x32_bf16 v[180:183], a[20:23], a[100:103], v[180:183]
    v_mfma_f32_16x16x32_bf16 v[212:215], a[20:23], a[104:107], v[212:215]
    v_mfma_f32_16x16x32_bf16 v[212:215], a[52:55], a[120:123], v[212:215]
    v_mfma_f32_16x16x32_bf16 v[244:247], a[52:55], a[124:127], v[244:247]
    s_waitcnt vmcnt(13)
    ds_read_b64_tr_b16 a[52:53], v5 offset:8608
    ds_read_b64_tr_b16 a[54:55], v5 offset:9120
    v_mfma_f32_16x16x32_bf16 v[244:247], a[20:23], a[108:111], v[244:247]
    ds_read_b64_tr_b16 a[20:21], v5 offset:160
    ds_read_b64_tr_b16 a[22:23], v5 offset:672
    v_mfma_f32_16x16x32_bf16 v[152:155], a[24:27], a[96:99], v[152:155]
    ds_read_b128 a[64:67], v18 offset:0
    v_mfma_f32_16x16x32_bf16 v[152:155], a[56:59], a[112:115], v[152:155]
    ds_read_b128 a[80:83], v19 offset:0
    v_mfma_f32_16x16x32_bf16 v[184:187], a[56:59], a[116:119], v[184:187]
    ds_read_b128 a[68:71], v18 offset:2048
    v_mfma_f32_16x16x32_bf16 v[184:187], a[24:27], a[100:103], v[184:187]
    ds_read_b128 a[84:87], v19 offset:2048
    v_mfma_f32_16x16x32_bf16 v[216:219], a[24:27], a[104:107], v[216:219]
    ds_read_b128 a[72:75], v18 offset:4096
    v_mfma_f32_16x16x32_bf16 v[216:219], a[56:59], a[120:123], v[216:219]
    ds_read_b128 a[88:91], v19 offset:4096
    v_mfma_f32_16x16x32_bf16 v[248:251], a[56:59], a[124:127], v[248:251]
    ds_read_b64_tr_b16 a[56:57], v5 offset:8640
    ds_read_b64_tr_b16 a[58:59], v5 offset:9152
    v_mfma_f32_16x16x32_bf16 v[248:251], a[24:27], a[108:111], v[248:251]
    ds_read_b64_tr_b16 a[24:25], v5 offset:192
    ds_read_b64_tr_b16 a[26:27], v5 offset:704
    v_mfma_f32_16x16x32_bf16 v[156:159], a[28:31], a[96:99], v[156:159]
    ds_read_b128 a[76:79], v18 offset:6144
    v_mfma_f32_16x16x32_bf16 v[156:159], a[60:63], a[112:115], v[156:159]
    ds_read_b128 a[92:95], v19 offset:6144
    v_mfma_f32_16x16x32_bf16 v[188:191], a[60:63], a[116:119], v[188:191]
    buffer_load_dwordx4 v11, s[4:7], s36 offen offset:1056 lds
    v_mfma_f32_16x16x32_bf16 v[188:191], a[28:31], a[100:103], v[188:191]
    buffer_load_dwordx4 v12, s[4:7], s36 offen offset:2112 lds
    v_mfma_f32_16x16x32_bf16 v[220:223], a[28:31], a[104:107], v[220:223]
    buffer_load_dwordx4 v13, s[4:7], s36 offen offset:3168 lds
    v_mfma_f32_16x16x32_bf16 v[220:223], a[60:63], a[120:123], v[220:223]
    v_mfma_f32_16x16x32_bf16 v[252:255], a[60:63], a[124:127], v[252:255]
    ds_read_b64_tr_b16 a[60:61], v5 offset:8672
    ds_read_b64_tr_b16 a[62:63], v5 offset:9184
    v_mfma_f32_16x16x32_bf16 v[252:255], a[28:31], a[108:111], v[252:255]
    s_waitcnt lgkmcnt(13)
    ds_read_b64_tr_b16 a[28:29], v5 offset:224
    ds_read_b64_tr_b16 a[30:31], v5 offset:736
    v_mfma_f32_16x16x32_bf16 v[128:131], a[0:3], a[64:67], v[128:131]
    s_waitcnt lgkmcnt(14)
    v_mfma_f32_16x16x32_bf16 v[128:131], a[32:35], a[80:83], v[128:131]
    s_waitcnt lgkmcnt(12)
    v_mfma_f32_16x16x32_bf16 v[160:163], a[32:35], a[84:87], v[160:163]
    v_mfma_f32_16x16x32_bf16 v[160:163], a[0:3], a[68:71], v[160:163]
    s_waitcnt lgkmcnt(11)
    v_mfma_f32_16x16x32_bf16 v[192:195], a[0:3], a[72:75], v[192:195]
    s_waitcnt lgkmcnt(10)
    v_mfma_f32_16x16x32_bf16 v[192:195], a[32:35], a[88:91], v[192:195]
    s_waitcnt lgkmcnt(4)
    v_mfma_f32_16x16x32_bf16 v[224:227], a[32:35], a[92:95], v[224:227]
    v_add_u32 v5, 16896, v3
    v_mfma_f32_16x16x32_bf16 v[224:227], a[0:3], a[76:79], v[224:227]
    s_waitcnt vmcnt(12) lgkmcnt(0)
    v_mfma_f32_16x16x32_bf16 v[132:135], a[4:7], a[64:67], v[132:135]
    s_barrier
    v_mfma_f32_16x16x32_bf16 v[132:135], a[36:39], a[80:83], v[132:135]
    s_bfe_u32 s98, s96, 0x40010
    ds_read_b64_tr_b16 a[32:33], v5 offset:8448
    ds_read_b64_tr_b16 a[34:35], v5 offset:8960
    v_mfma_f32_16x16x32_bf16 v[164:167], a[36:39], a[84:87], v[164:167]
    s_lshl_b32 s40, s98, 7
    ds_read_b64_tr_b16 a[0:1], v5 offset:0
    ds_read_b64_tr_b16 a[2:3], v5 offset:512
    v_mfma_f32_16x16x32_bf16 v[164:167], a[4:7], a[68:71], v[164:167]
    s_add_u32 s41, s40, 40960
    s_add_u32 m0, s42, 0
    s_nop 0
    buffer_load_dwordx4 v14, s[12:15], s40 offen offset:0 lds
    v_mfma_f32_16x16x32_bf16 v[196:199], a[4:7], a[72:75], v[196:199]
    v_mfma_f32_16x16x32_bf16 v[196:199], a[36:39], a[88:91], v[196:199]
    v_mfma_f32_16x16x32_bf16 v[228:231], a[36:39], a[92:95], v[228:231]
    ds_read_b64_tr_b16 a[36:37], v5 offset:8480
    ds_read_b64_tr_b16 a[38:39], v5 offset:8992
    v_mfma_f32_16x16x32_bf16 v[228:231], a[4:7], a[76:79], v[228:231]
    ds_read_b64_tr_b16 a[4:5], v5 offset:32
    ds_read_b64_tr_b16 a[6:7], v5 offset:544
    v_mfma_f32_16x16x32_bf16 v[136:139], a[8:11], a[64:67], v[136:139]
    buffer_load_dwordx4 v15, s[12:15], s40 offen offset:1024 lds
    v_mfma_f32_16x16x32_bf16 v[136:139], a[40:43], a[80:83], v[136:139]
    v_mfma_f32_16x16x32_bf16 v[168:171], a[40:43], a[84:87], v[168:171]
    buffer_load_dwordx4 v16, s[12:15], s40 offen offset:2048 lds
    v_mfma_f32_16x16x32_bf16 v[168:171], a[8:11], a[68:71], v[168:171]
    v_mfma_f32_16x16x32_bf16 v[200:203], a[8:11], a[72:75], v[200:203]
    v_mfma_f32_16x16x32_bf16 v[200:203], a[40:43], a[88:91], v[200:203]
    v_mfma_f32_16x16x32_bf16 v[232:235], a[40:43], a[92:95], v[232:235]
    ds_read_b64_tr_b16 a[40:41], v5 offset:8512
    ds_read_b64_tr_b16 a[42:43], v5 offset:9024
    v_mfma_f32_16x16x32_bf16 v[232:235], a[8:11], a[76:79], v[232:235]
    ds_read_b64_tr_b16 a[8:9], v5 offset:64
    ds_read_b64_tr_b16 a[10:11], v5 offset:576
    v_mfma_f32_16x16x32_bf16 v[140:143], a[12:15], a[64:67], v[140:143]
    buffer_load_dwordx4 v17, s[12:15], s40 offen offset:3072 lds
    v_mfma_f32_16x16x32_bf16 v[140:143], a[44:47], a[80:83], v[140:143]
    s_add_u32 m0, s42, 4096
    v_mfma_f32_16x16x32_bf16 v[172:175], a[44:47], a[84:87], v[172:175]
    buffer_load_dwordx4 v14, s[12:15], s41 offen offset:0 lds
    v_mfma_f32_16x16x32_bf16 v[172:175], a[12:15], a[68:71], v[172:175]
    v_mfma_f32_16x16x32_bf16 v[204:207], a[12:15], a[72:75], v[204:207]
    v_mfma_f32_16x16x32_bf16 v[204:207], a[44:47], a[88:91], v[204:207]
    v_mfma_f32_16x16x32_bf16 v[236:239], a[44:47], a[92:95], v[236:239]
    ds_read_b64_tr_b16 a[44:45], v5 offset:8544
    ds_read_b64_tr_b16 a[46:47], v5 offset:9056
    v_mfma_f32_16x16x32_bf16 v[236:239], a[12:15], a[76:79], v[236:239]
    ds_read_b64_tr_b16 a[12:13], v5 offset:96
    ds_read_b64_tr_b16 a[14:15], v5 offset:608
    v_mfma_f32_16x16x32_bf16 v[144:147], a[16:19], a[64:67], v[144:147]
    buffer_load_dwordx4 v15, s[12:15], s41 offen offset:1024 lds
    v_mfma_f32_16x16x32_bf16 v[144:147], a[48:51], a[80:83], v[144:147]
    v_mfma_f32_16x16x32_bf16 v[176:179], a[48:51], a[84:87], v[176:179]
    buffer_load_dwordx4 v16, s[12:15], s41 offen offset:2048 lds
    v_mfma_f32_16x16x32_bf16 v[176:179], a[16:19], a[68:71], v[176:179]
    v_mfma_f32_16x16x32_bf16 v[208:211], a[16:19], a[72:75], v[208:211]
    v_mfma_f32_16x16x32_bf16 v[208:211], a[48:51], a[88:91], v[208:211]
    v_mfma_f32_16x16x32_bf16 v[240:243], a[48:51], a[92:95], v[240:243]
    ds_read_b64_tr_b16 a[48:49], v5 offset:8576
    ds_read_b64_tr_b16 a[50:51], v5 offset:9088
    v_mfma_f32_16x16x32_bf16 v[240:243], a[16:19], a[76:79], v[240:243]
    ds_read_b64_tr_b16 a[16:17], v5 offset:128
    ds_read_b64_tr_b16 a[18:19], v5 offset:640
    v_mfma_f32_16x16x32_bf16 v[148:151], a[20:23], a[64:67], v[148:151]
    buffer_load_dwordx4 v17, s[12:15], s41 offen offset:3072 lds
    v_mfma_f32_16x16x32_bf16 v[148:151], a[52:55], a[80:83], v[148:151]
    s_bfe_u32 s98, s96, 0x40014
    v_mfma_f32_16x16x32_bf16 v[180:183], a[52:55], a[84:87], v[180:183]
    s_lshl_b32 s36, s98, 19
    s_add_u32 s36, s36, s45
    s_add_u32 m0, s34, 0
    s_nop 0
    buffer_load_dwordx4 v10, s[4:7], s36 offen offset:0 lds
    v_mfma_f32_16x16x32_bf16 v[180:183], a[20:23], a[68:71], v[180:183]
    v_mfma_f32_16x16x32_bf16 v[212:215], a[20:23], a[72:75], v[212:215]
    v_mfma_f32_16x16x32_bf16 v[212:215], a[52:55], a[88:91], v[212:215]
    v_mfma_f32_16x16x32_bf16 v[244:247], a[52:55], a[92:95], v[244:247]
    s_waitcnt vmcnt(13)
    ds_read_b64_tr_b16 a[52:53], v5 offset:8608
    ds_read_b64_tr_b16 a[54:55], v5 offset:9120
    v_mfma_f32_16x16x32_bf16 v[244:247], a[20:23], a[76:79], v[244:247]
    ds_read_b64_tr_b16 a[20:21], v5 offset:160
    ds_read_b64_tr_b16 a[22:23], v5 offset:672
    v_mfma_f32_16x16x32_bf16 v[152:155], a[24:27], a[64:67], v[152:155]
    ds_read_b128 a[96:99], v18 offset:30720
    v_mfma_f32_16x16x32_bf16 v[152:155], a[56:59], a[80:83], v[152:155]
    ds_read_b128 a[112:115], v19 offset:30720
    v_mfma_f32_16x16x32_bf16 v[184:187], a[56:59], a[84:87], v[184:187]
    ds_read_b128 a[100:103], v18 offset:32768
    v_mfma_f32_16x16x32_bf16 v[184:187], a[24:27], a[68:71], v[184:187]
    ds_read_b128 a[116:119], v19 offset:32768
    v_mfma_f32_16x16x32_bf16 v[216:219], a[24:27], a[72:75], v[216:219]
    ds_read_b128 a[104:107], v18 offset:34816
    v_mfma_f32_16x16x32_bf16 v[216:219], a[56:59], a[88:91], v[216:219]
    ds_read_b128 a[120:123], v19 offset:34816
    v_mfma_f32_16x16x32_bf16 v[248:251], a[56:59], a[92:95], v[248:251]
    ds_read_b64_tr_b16 a[56:57], v5 offset:8640
    ds_read_b64_tr_b16 a[58:59], v5 offset:9152
    v_mfma_f32_16x16x32_bf16 v[248:251], a[24:27], a[76:79], v[248:251]
    ds_read_b64_tr_b16 a[24:25], v5 offset:192
    ds_read_b64_tr_b16 a[26:27], v5 offset:704
    v_mfma_f32_16x16x32_bf16 v[156:159], a[28:31], a[64:67], v[156:159]
    ds_read_b128 a[108:111], v18 offset:36864
    v_mfma_f32_16x16x32_bf16 v[156:159], a[60:63], a[80:83], v[156:159]
    ds_read_b128 a[124:127], v19 offset:36864
    v_mfma_f32_16x16x32_bf16 v[188:191], a[60:63], a[84:87], v[188:191]
    buffer_load_dwordx4 v11, s[4:7], s36 offen offset:1056 lds
    v_mfma_f32_16x16x32_bf16 v[188:191], a[28:31], a[68:71], v[188:191]
    buffer_load_dwordx4 v12, s[4:7], s36 offen offset:2112 lds
    v_mfma_f32_16x16x32_bf16 v[220:223], a[28:31], a[72:75], v[220:223]
    buffer_load_dwordx4 v13, s[4:7], s36 offen offset:3168 lds
    v_mfma_f32_16x16x32_bf16 v[220:223], a[60:63], a[88:91], v[220:223]
    v_mfma_f32_16x16x32_bf16 v[252:255], a[60:63], a[92:95], v[252:255]
    ds_read_b64_tr_b16 a[60:61], v5 offset:8672
    ds_read_b64_tr_b16 a[62:63], v5 offset:9184
    v_mfma_f32_16x16x32_bf16 v[252:255], a[28:31], a[76:79], v[252:255]
    s_waitcnt lgkmcnt(13)
    ds_read_b64_tr_b16 a[28:29], v5 offset:224
    ds_read_b64_tr_b16 a[30:31], v5 offset:736
    v_mfma_f32_16x16x32_bf16 v[128:131], a[0:3], a[96:99], v[128:131]
    s_waitcnt lgkmcnt(14)
    v_mfma_f32_16x16x32_bf16 v[128:131], a[32:35], a[112:115], v[128:131]
    s_waitcnt lgkmcnt(12)
    v_mfma_f32_16x16x32_bf16 v[160:163], a[32:35], a[116:119], v[160:163]
    v_mfma_f32_16x16x32_bf16 v[160:163], a[0:3], a[100:103], v[160:163]
    s_waitcnt lgkmcnt(11)
    v_mfma_f32_16x16x32_bf16 v[192:195], a[0:3], a[104:107], v[192:195]
    s_waitcnt lgkmcnt(10)
    v_mfma_f32_16x16x32_bf16 v[192:195], a[32:35], a[120:123], v[192:195]
    s_waitcnt lgkmcnt(4)
    v_mfma_f32_16x16x32_bf16 v[224:227], a[32:35], a[124:127], v[224:227]
    v_add_u32 v5, 84480, v3
    v_mfma_f32_16x16x32_bf16 v[224:227], a[0:3], a[108:111], v[224:227]
    s_waitcnt vmcnt(12) lgkmcnt(0)
    v_mfma_f32_16x16x32_bf16 v[132:135], a[4:7], a[96:99], v[132:135]
    s_barrier
    v_mfma_f32_16x16x32_bf16 v[132:135], a[36:39], a[112:115], v[132:135]
    s_bfe_u32 s98, s96, 0x40014
    ds_read_b64_tr_b16 a[32:33], v5 offset:8448
    ds_read_b64_tr_b16 a[34:35], v5 offset:8960
    v_mfma_f32_16x16x32_bf16 v[164:167], a[36:39], a[116:119], v[164:167]
    s_lshl_b32 s40, s98, 7
    ds_read_b64_tr_b16 a[0:1], v5 offset:0
    ds_read_b64_tr_b16 a[2:3], v5 offset:512
    v_mfma_f32_16x16x32_bf16 v[164:167], a[4:7], a[100:103], v[164:167]
    s_add_u32 s41, s40, 40960
    s_add_u32 m0, s42, 30720
    s_nop 0
    buffer_load_dwordx4 v14, s[12:15], s40 offen offset:0 lds
    v_mfma_f32_16x16x32_bf16 v[196:199], a[4:7], a[104:107], v[196:199]
    v_mfma_f32_16x16x32_bf16 v[196:199], a[36:39], a[120:123], v[196:199]
    v_mfma_f32_16x16x32_bf16 v[228:231], a[36:39], a[124:127], v[228:231]
    ds_read_b64_tr_b16 a[36:37], v5 offset:8480
    ds_read_b64_tr_b16 a[38:39], v5 offset:8992
    v_mfma_f32_16x16x32_bf16 v[228:231], a[4:7], a[108:111], v[228:231]
    ds_read_b64_tr_b16 a[4:5], v5 offset:32
    ds_read_b64_tr_b16 a[6:7], v5 offset:544
    v_mfma_f32_16x16x32_bf16 v[136:139], a[8:11], a[96:99], v[136:139]
    buffer_load_dwordx4 v15, s[12:15], s40 offen offset:1024 lds
    v_mfma_f32_16x16x32_bf16 v[136:139], a[40:43], a[112:115], v[136:139]
    v_mfma_f32_16x16x32_bf16 v[168:171], a[40:43], a[116:119], v[168:171]
    buffer_load_dwordx4 v16, s[12:15], s40 offen offset:2048 lds
    v_mfma_f32_16x16x32_bf16 v[168:171], a[8:11], a[100:103], v[168:171]
    v_mfma_f32_16x16x32_bf16 v[200:203], a[8:11], a[104:107], v[200:203]
    v_mfma_f32_16x16x32_bf16 v[200:203], a[40:43], a[120:123], v[200:203]
    v_mfma_f32_16x16x32_bf16 v[232:235], a[40:43], a[124:127], v[232:235]
    ds_read_b64_tr_b16 a[40:41], v5 offset:8512
    ds_read_b64_tr_b16 a[42:43], v5 offset:9024
    v_mfma_f32_16x16x32_bf16 v[232:235], a[8:11], a[108:111], v[232:235]
    ds_read_b64_tr_b16 a[8:9], v5 offset:64
    ds_read_b64_tr_b16 a[10:11], v5 offset:576
    v_mfma_f32_16x16x32_bf16 v[140:143], a[12:15], a[96:99], v[140:143]
    buffer_load_dwordx4 v17, s[12:15], s40 offen offset:3072 lds
    v_mfma_f32_16x16x32_bf16 v[140:143], a[44:47], a[112:115], v[140:143]
    s_add_u32 m0, s42, 34816
    v_mfma_f32_16x16x32_bf16 v[172:175], a[44:47], a[116:119], v[172:175]
    buffer_load_dwordx4 v14, s[12:15], s41 offen offset:0 lds
    v_mfma_f32_16x16x32_bf16 v[172:175], a[12:15], a[100:103], v[172:175]
    v_mfma_f32_16x16x32_bf16 v[204:207], a[12:15], a[104:107], v[204:207]
    v_mfma_f32_16x16x32_bf16 v[204:207], a[44:47], a[120:123], v[204:207]
    v_mfma_f32_16x16x32_bf16 v[236:239], a[44:47], a[124:127], v[236:239]
    ds_read_b64_tr_b16 a[44:45], v5 offset:8544
    ds_read_b64_tr_b16 a[46:47], v5 offset:9056
    v_mfma_f32_16x16x32_bf16 v[236:239], a[12:15], a[108:111], v[236:239]
    ds_read_b64_tr_b16 a[12:13], v5 offset:96
    ds_read_b64_tr_b16 a[14:15], v5 offset:608
    v_mfma_f32_16x16x32_bf16 v[144:147], a[16:19], a[96:99], v[144:147]
    buffer_load_dwordx4 v15, s[12:15], s41 offen offset:1024 lds
    v_mfma_f32_16x16x32_bf16 v[144:147], a[48:51], a[112:115], v[144:147]
    v_mfma_f32_16x16x32_bf16 v[176:179], a[48:51], a[116:119], v[176:179]
    buffer_load_dwordx4 v16, s[12:15], s41 offen offset:2048 lds
    v_mfma_f32_16x16x32_bf16 v[176:179], a[16:19], a[100:103], v[176:179]
    v_mfma_f32_16x16x32_bf16 v[208:211], a[16:19], a[104:107], v[208:211]
    v_mfma_f32_16x16x32_bf16 v[208:211], a[48:51], a[120:123], v[208:211]
    v_mfma_f32_16x16x32_bf16 v[240:243], a[48:51], a[124:127], v[240:243]
    ds_read_b64_tr_b16 a[48:49], v5 offset:8576
    ds_read_b64_tr_b16 a[50:51], v5 offset:9088
    v_mfma_f32_16x16x32_bf16 v[240:243], a[16:19], a[108:111], v[240:243]
    ds_read_b64_tr_b16 a[16:17], v5 offset:128
    ds_read_b64_tr_b16 a[18:19], v5 offset:640
    v_mfma_f32_16x16x32_bf16 v[148:151], a[20:23], a[96:99], v[148:151]
    buffer_load_dwordx4 v17, s[12:15], s41 offen offset:3072 lds
    v_mfma_f32_16x16x32_bf16 v[148:151], a[52:55], a[112:115], v[148:151]
    s_bfe_u32 s98, s96, 0x40018
    v_mfma_f32_16x16x32_bf16 v[180:183], a[52:55], a[116:119], v[180:183]
    s_lshl_b32 s36, s98, 19
    s_add_u32 s36, s36, s45
    s_add_u32 m0, s34, 16896
    s_nop 0
    buffer_load_dwordx4 v10, s[4:7], s36 offen offset:0 lds
    v_mfma_f32_16x16x32_bf16 v[180:183], a[20:23], a[100:103], v[180:183]
    v_mfma_f32_16x16x32_bf16 v[212:215], a[20:23], a[104:107], v[212:215]
    v_mfma_f32_16x16x32_bf16 v[212:215], a[52:55], a[120:123], v[212:215]
    v_mfma_f32_16x16x32_bf16 v[244:247], a[52:55], a[124:127], v[244:247]
    s_waitcnt vmcnt(13)
    ds_read_b64_tr_b16 a[52:53], v5 offset:8608
    ds_read_b64_tr_b16 a[54:55], v5 offset:9120
    v_mfma_f32_16x16x32_bf16 v[244:247], a[20:23], a[108:111], v[244:247]
    ds_read_b64_tr_b16 a[20:21], v5 offset:160
    ds_read_b64_tr_b16 a[22:23], v5 offset:672
    v_mfma_f32_16x16x32_bf16 v[152:155], a[24:27], a[96:99], v[152:155]
    ds_read_b128 a[64:67], v18 offset:0
    v_mfma_f32_16x16x32_bf16 v[152:155], a[56:59], a[112:115], v[152:155]
    ds_read_b128 a[80:83], v19 offset:0
    v_mfma_f32_16x16x32_bf16 v[184:187], a[56:59], a[116:119], v[184:187]
    ds_read_b128 a[68:71], v18 offset:2048
    v_mfma_f32_16x16x32_bf16 v[184:187], a[24:27], a[100:103], v[184:187]
    ds_read_b128 a[84:87], v19 offset:2048
    v_mfma_f32_16x16x32_bf16 v[216:219], a[24:27], a[104:107], v[216:219]
    ds_read_b128 a[72:75], v18 offset:4096
    v_mfma_f32_16x16x32_bf16 v[216:219], a[56:59], a[120:123], v[216:219]
    ds_read_b128 a[88:91], v19 offset:4096
    v_mfma_f32_16x16x32_bf16 v[248:251], a[56:59], a[124:127], v[248:251]
    ds_read_b64_tr_b16 a[56:57], v5 offset:8640
    ds_read_b64_tr_b16 a[58:59], v5 offset:9152
    v_mfma_f32_16x16x32_bf16 v[248:251], a[24:27], a[108:111], v[248:251]
    ds_read_b64_tr_b16 a[24:25], v5 offset:192
    ds_read_b64_tr_b16 a[26:27], v5 offset:704
    v_mfma_f32_16x16x32_bf16 v[156:159], a[28:31], a[96:99], v[156:159]
    ds_read_b128 a[76:79], v18 offset:6144
    v_mfma_f32_16x16x32_bf16 v[156:159], a[60:63], a[112:115], v[156:159]
    ds_read_b128 a[92:95], v19 offset:6144
    v_mfma_f32_16x16x32_bf16 v[188:191], a[60:63], a[116:119], v[188:191]
    buffer_load_dwordx4 v11, s[4:7], s36 offen offset:1056 lds
    v_mfma_f32_16x16x32_bf16 v[188:191], a[28:31], a[100:103], v[188:191]
    buffer_load_dwordx4 v12, s[4:7], s36 offen offset:2112 lds
    v_mfma_f32_16x16x32_bf16 v[220:223], a[28:31], a[104:107], v[220:223]
    buffer_load_dwordx4 v13, s[4:7], s36 offen offset:3168 lds
    v_mfma_f32_16x16x32_bf16 v[220:223], a[60:63], a[120:123], v[220:223]
    v_mfma_f32_16x16x32_bf16 v[252:255], a[60:63], a[124:127], v[252:255]
    ds_read_b64_tr_b16 a[60:61], v5 offset:8672
    ds_read_b64_tr_b16 a[62:63], v5 offset:9184
    v_mfma_f32_16x16x32_bf16 v[252:255], a[28:31], a[108:111], v[252:255]
    s_waitcnt lgkmcnt(13)
    ds_read_b64_tr_b16 a[28:29], v5 offset:224
    ds_read_b64_tr_b16 a[30:31], v5 offset:736
    v_mfma_f32_16x16x32_bf16 v[128:131], a[0:3], a[64:67], v[128:131]
    s_waitcnt lgkmcnt(14)
    v_mfma_f32_16x16x32_bf16 v[128:131], a[32:35], a[80:83], v[128:131]
    s_waitcnt lgkmcnt(12)
    v_mfma_f32_16x16x32_bf16 v[160:163], a[32:35], a[84:87], v[160:163]
    v_mfma_f32_16x16x32_bf16 v[160:163], a[0:3], a[68:71], v[160:163]
    s_waitcnt lgkmcnt(11)
    v_mfma_f32_16x16x32_bf16 v[192:195], a[0:3], a[72:75], v[192:195]
    s_waitcnt lgkmcnt(10)
    v_mfma_f32_16x16x32_bf16 v[192:195], a[32:35], a[88:91], v[192:195]
    s_waitcnt lgkmcnt(4)
    v_mfma_f32_16x16x32_bf16 v[224:227], a[32:35], a[92:95], v[224:227]
    v_add_u32 v5, 0, v3
    v_mfma_f32_16x16x32_bf16 v[224:227], a[0:3], a[76:79], v[224:227]
    s_waitcnt vmcnt(12) lgkmcnt(0)
    v_mfma_f32_16x16x32_bf16 v[132:135], a[4:7], a[64:67], v[132:135]
    s_barrier
    v_mfma_f32_16x16x32_bf16 v[132:135], a[36:39], a[80:83], v[132:135]
    s_bfe_u32 s98, s96, 0x40018
    ds_read_b64_tr_b16 a[32:33], v5 offset:8448
    ds_read_b64_tr_b16 a[34:35], v5 offset:8960
    v_mfma_f32_16x16x32_bf16 v[164:167], a[36:39], a[84:87], v[164:167]
    s_lshl_b32 s40, s98, 7
    ds_read_b64_tr_b16 a[0:1], v5 offset:0
    ds_read_b64_tr_b16 a[2:3], v5 offset:512
    v_mfma_f32_16x16x32_bf16 v[164:167], a[4:7], a[68:71], v[164:167]
    s_add_u32 s41, s40, 40960
    s_add_u32 m0, s42, 0
    s_nop 0
    buffer_load_dwordx4 v14, s[12:15], s40 offen offset:0 lds
    v_mfma_f32_16x16x32_bf16 v[196:199], a[4:7], a[72:75], v[196:199]
    v_mfma_f32_16x16x32_bf16 v[196:199], a[36:39], a[88:91], v[196:199]
    buffer_load_dwordx4 v15, s[12:15], s40 offen offset:1024 lds
    v_mfma_f32_16x16x32_bf16 v[228:231], a[36:39], a[92:95], v[228:231]
    ds_read_b64_tr_b16 a[36:37], v5 offset:8480
    ds_read_b64_tr_b16 a[38:39], v5 offset:8992
    v_mfma_f32_16x16x32_bf16 v[228:231], a[4:7], a[76:79], v[228:231]
    ds_read_b64_tr_b16 a[4:5], v5 offset:32
    ds_read_b64_tr_b16 a[6:7], v5 offset:544
    v_mfma_f32_16x16x32_bf16 v[136:139], a[8:11], a[64:67], v[136:139]
    buffer_load_dwordx4 v16, s[12:15], s40 offen offset:2048 lds
    v_mfma_f32_16x16x32_bf16 v[136:139], a[40:43], a[80:83], v[136:139]
    v_mfma_f32_16x16x32_bf16 v[168:171], a[40:43], a[84:87], v[168:171]
    v_mfma_f32_16x16x32_bf16 v[168:171], a[8:11], a[68:71], v[168:171]
    buffer_load_dwordx4 v17, s[12:15], s40 offen offset:3072 lds
    v_mfma_f32_16x16x32_bf16 v[200:203], a[8:11], a[72:75], v[200:203]
    v_mfma_f32_16x16x32_bf16 v[200:203], a[40:43], a[88:91], v[200:203]
    v_mfma_f32_16x16x32_bf16 v[232:235], a[40:43], a[92:95], v[232:235]
    ds_read_b64_tr_b16 a[40:41], v5 offset:8512
    ds_read_b64_tr_b16 a[42:43], v5 offset:9024
    v_mfma_f32_16x16x32_bf16 v[232:235], a[8:11], a[76:79], v[232:235]
    s_add_u32 m0, s42, 4096
    ds_read_b64_tr_b16 a[8:9], v5 offset:64
    ds_read_b64_tr_b16 a[10:11], v5 offset:576
    v_mfma_f32_16x16x32_bf16 v[140:143], a[12:15], a[64:67], v[140:143]
    buffer_load_dwordx4 v14, s[12:15], s41 offen offset:0 lds
    v_mfma_f32_16x16x32_bf16 v[140:143], a[44:47], a[80:83], v[140:143]
    v_mfma_f32_16x16x32_bf16 v[172:175], a[44:47], a[84:87], v[172:175]
    buffer_load_dwordx4 v15, s[12:15], s41 offen offset:1024 lds
    v_mfma_f32_16x16x32_bf16 v[172:175], a[12:15], a[68:71], v[172:175]
    v_mfma_f32_16x16x32_bf16 v[204:207], a[12:15], a[72:75], v[204:207]
    v_mfma_f32_16x16x32_bf16 v[204:207], a[44:47], a[88:91], v[204:207]
    buffer_load_dwordx4 v16, s[12:15], s41 offen offset:2048 lds
    v_mfma_f32_16x16x32_bf16 v[236:239], a[44:47], a[92:95], v[236:239]
    ds_read_b64_tr_b16 a[44:45], v5 offset:8544
    ds_read_b64_tr_b16 a[46:47], v5 offset:9056
    v_mfma_f32_16x16x32_bf16 v[236:239], a[12:15], a[76:79], v[236:239]
    ds_read_b64_tr_b16 a[12:13], v5 offset:96
    ds_read_b64_tr_b16 a[14:15], v5 offset:608
    v_mfma_f32_16x16x32_bf16 v[144:147], a[16:19], a[64:67], v[144:147]
    v_mfma_f32_16x16x32_bf16 v[144:147], a[48:51], a[80:83], v[144:147]
    buffer_load_dwordx4 v17, s[12:15], s41 offen offset:3072 lds
    v_mfma_f32_16x16x32_bf16 v[176:179], a[48:51], a[84:87], v[176:179]
    s_bfe_u32 s98, s96, 0x4001c
    v_mfma_f32_16x16x32_bf16 v[176:179], a[16:19], a[68:71], v[176:179]
    s_lshl_b32 s36, s98, 19
    v_mfma_f32_16x16x32_bf16 v[208:211], a[16:19], a[72:75], v[208:211]
    s_add_u32 s36, s36, s45
    s_add_u32 m0, s34, 84480
    s_nop 0
    buffer_load_dwordx4 v10, s[4:7], s36 offen offset:0 lds
    v_mfma_f32_16x16x32_bf16 v[208:211], a[48:51], a[88:91], v[208:211]
    v_mfma_f32_16x16x32_bf16 v[240:243], a[48:51], a[92:95], v[240:243]
    ds_read_b64_tr_b16 a[48:49], v5 offset:8576
    ds_read_b64_tr_b16 a[50:51], v5 offset:9088
    v_mfma_f32_16x16x32_bf16 v[240:243], a[16:19], a[76:79], v[240:243]
    ds_read_b64_tr_b16 a[16:17], v5 offset:128
    ds_read_b64_tr_b16 a[18:19], v5 offset:640
    v_mfma_f32_16x16x32_bf16 v[148:151], a[20:23], a[64:67], v[148:151]
    buffer_load_dwordx4 v11, s[4:7], s36 offen offset:1056 lds
    v_mfma_f32_16x16x32_bf16 v[148:151], a[52:55], a[80:83], v[148:151]
    v_mfma_f32_16x16x32_bf16 v[180:183], a[52:55], a[84:87], v[180:183]
    v_mfma_f32_16x16x32_bf16 v[180:183], a[20:23], a[68:71], v[180:183]
    buffer_load_dwordx4 v12, s[4:7], s36 offen offset:2112 lds
    v_mfma_f32_16x16x32_bf16 v[212:215], a[20:23], a[72:75], v[212:215]
    v_mfma_f32_16x16x32_bf16 v[212:215], a[52:55], a[88:91], v[212:215]
    v_mfma_f32_16x16x32_bf16 v[244:247], a[52:55], a[92:95], v[244:247]
    s_waitcnt vmcnt(15)
    ds_read_b64_tr_b16 a[52:53], v5 offset:8608
    ds_read_b64_tr_b16 a[54:55], v5 offset:9120
    v_mfma_f32_16x16x32_bf16 v[244:247], a[20:23], a[76:79], v[244:247]
    ds_read_b64_tr_b16 a[20:21], v5 offset:160
    ds_read_b64_tr_b16 a[22:23], v5 offset:672
    v_mfma_f32_16x16x32_bf16 v[152:155], a[24:27], a[64:67], v[152:155]
    ds_read_b128 a[96:99], v18 offset:30720
    v_mfma_f32_16x16x32_bf16 v[152:155], a[56:59], a[80:83], v[152:155]
    ds_read_b128 a[112:115], v19 offset:30720
    v_mfma_f32_16x16x32_bf16 v[184:187], a[56:59], a[84:87], v[184:187]
    ds_read_b128 a[100:103], v18 offset:32768
    v_mfma_f32_16x16x32_bf16 v[184:187], a[24:27], a[68:71], v[184:187]
    ds_read_b128 a[116:119], v19 offset:32768
    v_mfma_f32_16x16x32_bf16 v[216:219], a[24:27], a[72:75], v[216:219]
    ds_read_b128 a[104:107], v18 offset:34816
    v_mfma_f32_16x16x32_bf16 v[216:219], a[56:59], a[88:91], v[216:219]
    ds_read_b128 a[120:123], v19 offset:34816
    v_mfma_f32_16x16x32_bf16 v[248:251], a[56:59], a[92:95], v[248:251]
    ds_read_b64_tr_b16 a[56:57], v5 offset:8640
    ds_read_b64_tr_b16 a[58:59], v5 offset:9152
    v_mfma_f32_16x16x32_bf16 v[248:251], a[24:27], a[76:79], v[248:251]
    ds_read_b64_tr_b16 a[24:25], v5 offset:192
    ds_read_b64_tr_b16 a[26:27], v5 offset:704
    v_mfma_f32_16x16x32_bf16 v[156:159], a[28:31], a[64:67], v[156:159]
    ds_read_b128 a[108:111], v18 offset:36864
    v_mfma_f32_16x16x32_bf16 v[156:159], a[60:63], a[80:83], v[156:159]
    ds_read_b128 a[124:127], v19 offset:36864
    v_mfma_f32_16x16x32_bf16 v[188:191], a[60:63], a[84:87], v[188:191]
    buffer_load_dwordx4 v13, s[4:7], s36 offen offset:3168 lds
    v_mfma_f32_16x16x32_bf16 v[188:191], a[28:31], a[68:71], v[188:191]
    s_max_i32 s39, s35, 0
    s_min_i32 s38, s39, 524288
    s_add_i32 s35, s35, 8192
    s_add_u32 m0, s34, 33792
    s_nop 0
    buffer_load_dwordx4 v6, s[8:11], s38 offen offset:0 nt lds
    v_mfma_f32_16x16x32_bf16 v[220:223], a[28:31], a[72:75], v[220:223]
    buffer_load_dwordx4 v7, s[8:11], s38 offen offset:1056 nt lds
    v_mfma_f32_16x16x32_bf16 v[220:223], a[60:63], a[88:91], v[220:223]
    buffer_load_dwordx4 v8, s[8:11], s38 offen offset:2112 nt lds
    v_mfma_f32_16x16x32_bf16 v[252:255], a[60:63], a[92:95], v[252:255]
    ds_read_b64_tr_b16 a[60:61], v5 offset:8672
    ds_read_b64_tr_b16 a[62:63], v5 offset:9184
    v_mfma_f32_16x16x32_bf16 v[252:255], a[28:31], a[76:79], v[252:255]
    s_waitcnt lgkmcnt(13)
    ds_read_b64_tr_b16 a[28:29], v5 offset:224
    ds_read_b64_tr_b16 a[30:31], v5 offset:736
    buffer_load_dwordx4 v9, s[8:11], s38 offen offset:3168 nt lds
    v_mfma_f32_16x16x32_bf16 v[128:131], a[0:3], a[96:99], v[128:131]
    s_waitcnt lgkmcnt(14)
    v_mfma_f32_16x16x32_bf16 v[128:131], a[32:35], a[112:115], v[128:131]
    s_waitcnt lgkmcnt(12)
    v_mfma_f32_16x16x32_bf16 v[160:163], a[32:35], a[116:119], v[160:163]
    v_mfma_f32_16x16x32_bf16 v[160:163], a[0:3], a[100:103], v[160:163]
    s_waitcnt lgkmcnt(11)
    v_mfma_f32_16x16x32_bf16 v[192:195], a[0:3], a[104:107], v[192:195]
    s_waitcnt lgkmcnt(10)
    v_mfma_f32_16x16x32_bf16 v[192:195], a[32:35], a[120:123], v[192:195]
    s_waitcnt lgkmcnt(4)
    v_mfma_f32_16x16x32_bf16 v[224:227], a[32:35], a[124:127], v[224:227]
    v_add_u32 v5, 16896, v3
    v_mfma_f32_16x16x32_bf16 v[224:227], a[0:3], a[108:111], v[224:227]
    s_waitcnt vmcnt(16) lgkmcnt(0)
    v_mfma_f32_16x16x32_bf16 v[132:135], a[4:7], a[96:99], v[132:135]
    s_barrier
    v_mfma_f32_16x16x32_bf16 v[132:135], a[36:39], a[112:115], v[132:135]
    s_bfe_u32 s98, s96, 0x4001c
    ds_read_b64_tr_b16 a[32:33], v5 offset:8448
    ds_read_b64_tr_b16 a[34:35], v5 offset:8960
    v_mfma_f32_16x16x32_bf16 v[164:167], a[36:39], a[116:119], v[164:167]
    s_lshl_b32 s40, s98, 7
    ds_read_b64_tr_b16 a[0:1], v5 offset:0
    ds_read_b64_tr_b16 a[2:3], v5 offset:512
    v_mfma_f32_16x16x32_bf16 v[164:167], a[4:7], a[100:103], v[164:167]
    s_add_u32 s41, s40, 40960
    s_add_u32 m0, s42, 30720
    s_nop 0
    buffer_load_dwordx4 v14, s[12:15], s40 offen offset:0 lds
    v_mfma_f32_16x16x32_bf16 v[196:199], a[4:7], a[104:107], v[196:199]
    v_mfma_f32_16x16x32_bf16 v[196:199], a[36:39], a[120:123], v[196:199]
    buffer_load_dwordx4 v15, s[12:15], s40 offen offset:1024 lds
    v_mfma_f32_16x16x32_bf16 v[228:231], a[36:39], a[124:127], v[228:231]
    ds_read_b64_tr_b16 a[36:37], v5 offset:8480
    ds_read_b64_tr_b16 a[38:39], v5 offset:8992
    v_mfma_f32_16x16x32_bf16 v[228:231], a[4:7], a[108:111], v[228:231]
    ds_read_b64_tr_b16 a[4:5], v5 offset:32
    ds_read_b64_tr_b16 a[6:7], v5 offset:544
    v_mfma_f32_16x16x32_bf16 v[136:139], a[8:11], a[96:99], v[136:139]
    buffer_load_dwordx4 v16, s[12:15], s40 offen offset:2048 lds
    v_mfma_f32_16x16x32_bf16 v[136:139], a[40:43], a[112:115], v[136:139]
    v_mfma_f32_16x16x32_bf16 v[168:171], a[40:43], a[116:119], v[168:171]
    v_mfma_f32_16x16x32_bf16 v[168:171], a[8:11], a[100:103], v[168:171]
    buffer_load_dwordx4 v17, s[12:15], s40 offen offset:3072 lds
    v_mfma_f32_16x16x32_bf16 v[200:203], a[8:11], a[104:107], v[200:203]
    v_mfma_f32_16x16x32_bf16 v[200:203], a[40:43], a[120:123], v[200:203]
    v_mfma_f32_16x16x32_bf16 v[232:235], a[40:43], a[124:127], v[232:235]
    ds_read_b64_tr_b16 a[40:41], v5 offset:8512
    ds_read_b64_tr_b16 a[42:43], v5 offset:9024
    v_mfma_f32_16x16x32_bf16 v[232:235], a[8:11], a[108:111], v[232:235]
    s_add_u32 m0, s42, 34816
    ds_read_b64_tr_b16 a[8:9], v5 offset:64
    ds_read_b64_tr_b16 a[10:11], v5 offset:576
    v_mfma_f32_16x16x32_bf16 v[140:143], a[12:15], a[96:99], v[140:143]
    buffer_load_dwordx4 v14, s[12:15], s41 offen offset:0 lds
    v_mfma_f32_16x16x32_bf16 v[140:143], a[44:47], a[112:115], v[140:143]
    v_mfma_f32_16x16x32_bf16 v[172:175], a[44:47], a[116:119], v[172:175]
    buffer_load_dwordx4 v15, s[12:15], s41 offen offset:1024 lds
    v_mfma_f32_16x16x32_bf16 v[172:175], a[12:15], a[100:103], v[172:175]
    v_mfma_f32_16x16x32_bf16 v[204:207], a[12:15], a[104:107], v[204:207]
    v_mfma_f32_16x16x32_bf16 v[204:207], a[44:47], a[120:123], v[204:207]
    buffer_load_dwordx4 v16, s[12:15], s41 offen offset:2048 lds
    v_mfma_f32_16x16x32_bf16 v[236:239], a[44:47], a[124:127], v[236:239]
    ds_read_b64_tr_b16 a[44:45], v5 offset:8544
    ds_read_b64_tr_b16 a[46:47], v5 offset:9056
    v_mfma_f32_16x16x32_bf16 v[236:239], a[12:15], a[108:111], v[236:239]
    ds_read_b64_tr_b16 a[12:13], v5 offset:96
    ds_read_b64_tr_b16 a[14:15], v5 offset:608
    v_mfma_f32_16x16x32_bf16 v[144:147], a[16:19], a[96:99], v[144:147]
    v_mfma_f32_16x16x32_bf16 v[144:147], a[48:51], a[112:115], v[144:147]
    buffer_load_dwordx4 v17, s[12:15], s41 offen offset:3072 lds
    v_mfma_f32_16x16x32_bf16 v[176:179], a[48:51], a[116:119], v[176:179]
    s_bfe_u32 s98, s97, 0x40000
    v_mfma_f32_16x16x32_bf16 v[176:179], a[16:19], a[100:103], v[176:179]
    s_lshl_b32 s36, s98, 19
    v_mfma_f32_16x16x32_bf16 v[208:211], a[16:19], a[104:107], v[208:211]
    s_add_u32 s36, s36, s45
    s_add_u32 m0, s34, 0
    s_nop 0
    buffer_load_dwordx4 v10, s[4:7], s36 offen offset:0 lds
    v_mfma_f32_16x16x32_bf16 v[208:211], a[48:51], a[120:123], v[208:211]
    v_mfma_f32_16x16x32_bf16 v[240:243], a[48:51], a[124:127], v[240:243]
    ds_read_b64_tr_b16 a[48:49], v5 offset:8576
    ds_read_b64_tr_b16 a[50:51], v5 offset:9088
    v_mfma_f32_16x16x32_bf16 v[240:243], a[16:19], a[108:111], v[240:243]
    ds_read_b64_tr_b16 a[16:17], v5 offset:128
    ds_read_b64_tr_b16 a[18:19], v5 offset:640
    v_mfma_f32_16x16x32_bf16 v[148:151], a[20:23], a[96:99], v[148:151]
    buffer_load_dwordx4 v11, s[4:7], s36 offen offset:1056 lds
    v_mfma_f32_16x16x32_bf16 v[148:151], a[52:55], a[112:115], v[148:151]
    v_mfma_f32_16x16x32_bf16 v[180:183], a[52:55], a[116:119], v[180:183]
    v_mfma_f32_16x16x32_bf16 v[180:183], a[20:23], a[100:103], v[180:183]
    buffer_load_dwordx4 v12, s[4:7], s36 offen offset:2112 lds
    v_mfma_f32_16x16x32_bf16 v[212:215], a[20:23], a[104:107], v[212:215]
    v_mfma_f32_16x16x32_bf16 v[212:215], a[52:55], a[120:123], v[212:215]
    v_mfma_f32_16x16x32_bf16 v[244:247], a[52:55], a[124:127], v[244:247]
    s_waitcnt vmcnt(19)
    ds_read_b64_tr_b16 a[52:53], v5 offset:8608
    ds_read_b64_tr_b16 a[54:55], v5 offset:9120
    v_mfma_f32_16x16x32_bf16 v[244:247], a[20:23], a[108:111], v[244:247]
    ds_read_b64_tr_b16 a[20:21], v5 offset:160
    ds_read_b64_tr_b16 a[22:23], v5 offset:672
    v_mfma_f32_16x16x32_bf16 v[152:155], a[24:27], a[96:99], v[152:155]
    ds_read_b128 a[64:67], v18 offset:0
    v_mfma_f32_16x16x32_bf16 v[152:155], a[56:59], a[112:115], v[152:155]
    ds_read_b128 a[80:83], v19 offset:0
    v_mfma_f32_16x16x32_bf16 v[184:187], a[56:59], a[116:119], v[184:187]
    ds_read_b128 a[68:71], v18 offset:2048
    v_mfma_f32_16x16x32_bf16 v[184:187], a[24:27], a[100:103], v[184:187]
    ds_read_b128 a[84:87], v19 offset:2048
    v_mfma_f32_16x16x32_bf16 v[216:219], a[24:27], a[104:107], v[216:219]
    ds_read_b128 a[72:75], v18 offset:4096
    v_mfma_f32_16x16x32_bf16 v[216:219], a[56:59], a[120:123], v[216:219]
    ds_read_b128 a[88:91], v19 offset:4096
    v_mfma_f32_16x16x32_bf16 v[248:251], a[56:59], a[124:127], v[248:251]
    ds_read_b64_tr_b16 a[56:57], v5 offset:8640
    ds_read_b64_tr_b16 a[58:59], v5 offset:9152
    v_mfma_f32_16x16x32_bf16 v[248:251], a[24:27], a[108:111], v[248:251]
    ds_read_b64_tr_b16 a[24:25], v5 offset:192
    ds_read_b64_tr_b16 a[26:27], v5 offset:704
    v_mfma_f32_16x16x32_bf16 v[156:159], a[28:31], a[96:99], v[156:159]
    ds_read_b128 a[76:79], v18 offset:6144
    v_mfma_f32_16x16x32_bf16 v[156:159], a[60:63], a[112:115], v[156:159]
    ds_read_b128 a[92:95], v19 offset:6144
    v_mfma_f32_16x16x32_bf16 v[188:191], a[60:63], a[116:119], v[188:191]
    buffer_load_dwordx4 v13, s[4:7], s36 offen offset:3168 lds
    v_mfma_f32_16x16x32_bf16 v[188:191], a[28:31], a[100:103], v[188:191]
    s_max_i32 s39, s35, 0
    s_min_i32 s38, s39, 524288
    s_add_i32 s35, s35, 8192
    s_add_u32 m0, s34, 50688
    s_nop 0
    buffer_load_dwordx4 v6, s[8:11], s38 offen offset:0 nt lds
    v_mfma_f32_16x16x32_bf16 v[220:223], a[28:31], a[104:107], v[220:223]
    buffer_load_dwordx4 v7, s[8:11], s38 offen offset:1056 nt lds
    v_mfma_f32_16x16x32_bf16 v[220:223], a[60:63], a[120:123], v[220:223]
    buffer_load_dwordx4 v8, s[8:11], s38 offen offset:2112 nt lds
    v_mfma_f32_16x16x32_bf16 v[252:255], a[60:63], a[124:127], v[252:255]
    ds_read_b64_tr_b16 a[60:61], v5 offset:8672
    ds_read_b64_tr_b16 a[62:63], v5 offset:9184
    v_mfma_f32_16x16x32_bf16 v[252:255], a[28:31], a[108:111], v[252:255]
    s_waitcnt lgkmcnt(13)
    ds_read_b64_tr_b16 a[28:29], v5 offset:224
    ds_read_b64_tr_b16 a[30:31], v5 offset:736
    buffer_load_dwordx4 v9, s[8:11], s38 offen offset:3168 nt lds
    v_mfma_f32_16x16x32_bf16 v[128:131], a[0:3], a[64:67], v[128:131]
    s_waitcnt lgkmcnt(14)
    v_mfma_f32_16x16x32_bf16 v[128:131], a[32:35], a[80:83], v[128:131]
    s_waitcnt lgkmcnt(12)
    v_mfma_f32_16x16x32_bf16 v[160:163], a[32:35], a[84:87], v[160:163]
    v_mfma_f32_16x16x32_bf16 v[160:163], a[0:3], a[68:71], v[160:163]
    s_waitcnt lgkmcnt(11)
    v_mfma_f32_16x16x32_bf16 v[192:195], a[0:3], a[72:75], v[192:195]
    s_waitcnt lgkmcnt(10)
    v_mfma_f32_16x16x32_bf16 v[192:195], a[32:35], a[88:91], v[192:195]
    s_waitcnt lgkmcnt(4)
    v_mfma_f32_16x16x32_bf16 v[224:227], a[32:35], a[92:95], v[224:227]
    v_add_u32 v5, 84480, v3
    v_mfma_f32_16x16x32_bf16 v[224:227], a[0:3], a[76:79], v[224:227]
    s_waitcnt vmcnt(20) lgkmcnt(0)
    v_mfma_f32_16x16x32_bf16 v[132:135], a[4:7], a[64:67], v[132:135]
    s_barrier
    v_mfma_f32_16x16x32_bf16 v[132:135], a[36:39], a[80:83], v[132:135]
    s_bfe_u32 s98, s97, 0x40000
    ds_read_b64_tr_b16 a[32:33], v5 offset:8448
    ds_read_b64_tr_b16 a[34:35], v5 offset:8960
    v_mfma_f32_16x16x32_bf16 v[164:167], a[36:39], a[84:87], v[164:167]
    s_lshl_b32 s40, s98, 7
    ds_read_b64_tr_b16 a[0:1], v5 offset:0
    ds_read_b64_tr_b16 a[2:3], v5 offset:512
    v_mfma_f32_16x16x32_bf16 v[164:167], a[4:7], a[68:71], v[164:167]
    s_add_u32 s41, s40, 40960
    s_add_u32 m0, s42, 0
    s_nop 0
    buffer_load_dwordx4 v14, s[12:15], s40 offen offset:0 lds
    v_mfma_f32_16x16x32_bf16 v[196:199], a[4:7], a[72:75], v[196:199]
    v_mfma_f32_16x16x32_bf16 v[196:199], a[36:39], a[88:91], v[196:199]
    buffer_load_dwordx4 v15, s[12:15], s40 offen offset:1024 lds
    v_mfma_f32_16x16x32_bf16 v[228:231], a[36:39], a[92:95], v[228:231]
    ds_read_b64_tr_b16 a[36:37], v5 offset:8480
    ds_read_b64_tr_b16 a[38:39], v5 offset:8992
    v_mfma_f32_16x16x32_bf16 v[228:231], a[4:7], a[76:79], v[228:231]
    ds_read_b64_tr_b16 a[4:5], v5 offset:32
    ds_read_b64_tr_b16 a[6:7], v5 offset:544
    v_mfma_f32_16x16x32_bf16 v[136:139], a[8:11], a[64:67], v[136:139]
    buffer_load_dwordx4 v16, s[12:15], s40 offen offset:2048 lds
    v_mfma_f32_16x16x32_bf16 v[136:139], a[40:43], a[80:83], v[136:139]
    v_mfma_f32_16x16x32_bf16 v[168:171], a[40:43], a[84:87], v[168:171]
    v_mfma_f32_16x16x32_bf16 v[168:171], a[8:11], a[68:71], v[168:171]
    buffer_load_dwordx4 v17, s[12:15], s40 offen offset:3072 lds
    v_mfma_f32_16x16x32_bf16 v[200:203], a[8:11], a[72:75], v[200:203]
    v_mfma_f32_16x16x32_bf16 v[200:203], a[40:43], a[88:91], v[200:203]
    v_mfma_f32_16x16x32_bf16 v[232:235], a[40:43], a[92:95], v[232:235]
    ds_read_b64_tr_b16 a[40:41], v5 offset:8512
    ds_read_b64_tr_b16 a[42:43], v5 offset:9024
    v_mfma_f32_16x16x32_bf16 v[232:235], a[8:11], a[76:79], v[232:235]
    s_add_u32 m0, s42, 4096
    ds_read_b64_tr_b16 a[8:9], v5 offset:64
    ds_read_b64_tr_b16 a[10:11], v5 offset:576
    v_mfma_f32_16x16x32_bf16 v[140:143], a[12:15], a[64:67], v[140:143]
    buffer_load_dwordx4 v14, s[12:15], s41 offen offset:0 lds
    v_mfma_f32_16x16x32_bf16 v[140:143], a[44:47], a[80:83], v[140:143]
    v_mfma_f32_16x16x32_bf16 v[172:175], a[44:47], a[84:87], v[172:175]
    buffer_load_dwordx4 v15, s[12:15], s41 offen offset:1024 lds
    v_mfma_f32_16x16x32_bf16 v[172:175], a[12:15], a[68:71], v[172:175]
    v_mfma_f32_16x16x32_bf16 v[204:207], a[12:15], a[72:75], v[204:207]
    v_mfma_f32_16x16x32_bf16 v[204:207], a[44:47], a[88:91], v[204:207]
    buffer_load_dwordx4 v16, s[12:15], s41 offen offset:2048 lds
    v_mfma_f32_16x16x32_bf16 v[236:239], a[44:47], a[92:95], v[236:239]
    ds_read_b64_tr_b16 a[44:45], v5 offset:8544
    ds_read_b64_tr_b16 a[46:47], v5 offset:9056
    v_mfma_f32_16x16x32_bf16 v[236:239], a[12:15], a[76:79], v[236:239]
    ds_read_b64_tr_b16 a[12:13], v5 offset:96
    ds_read_b64_tr_b16 a[14:15], v5 offset:608
    v_mfma_f32_16x16x32_bf16 v[144:147], a[16:19], a[64:67], v[144:147]
    v_mfma_f32_16x16x32_bf16 v[144:147], a[48:51], a[80:83], v[144:147]
    buffer_load_dwordx4 v17, s[12:15], s41 offen offset:3072 lds
    v_mfma_f32_16x16x32_bf16 v[176:179], a[48:51], a[84:87], v[176:179]
    s_bfe_u32 s98, s97, 0x40004
    v_mfma_f32_16x16x32_bf16 v[176:179], a[16:19], a[68:71], v[176:179]
    s_lshl_b32 s36, s98, 19
    v_mfma_f32_16x16x32_bf16 v[208:211], a[16:19], a[72:75], v[208:211]
    s_add_u32 s36, s36, s45
    s_add_u32 m0, s34, 16896
    s_nop 0
    buffer_load_dwordx4 v10, s[4:7], s36 offen offset:0 lds
    v_mfma_f32_16x16x32_bf16 v[208:211], a[48:51], a[88:91], v[208:211]
    v_mfma_f32_16x16x32_bf16 v[240:243], a[48:51], a[92:95], v[240:243]
    ds_read_b64_tr_b16 a[48:49], v5 offset:8576
    ds_read_b64_tr_b16 a[50:51], v5 offset:9088
    v_mfma_f32_16x16x32_bf16 v[240:243], a[16:19], a[76:79], v[240:243]
    ds_read_b64_tr_b16 a[16:17], v5 offset:128
    ds_read_b64_tr_b16 a[18:19], v5 offset:640
    v_mfma_f32_16x16x32_bf16 v[148:151], a[20:23], a[64:67], v[148:151]
    buffer_load_dwordx4 v11, s[4:7], s36 offen offset:1056 lds
    v_mfma_f32_16x16x32_bf16 v[148:151], a[52:55], a[80:83], v[148:151]
    v_mfma_f32_16x16x32_bf16 v[180:183], a[52:55], a[84:87], v[180:183]
    v_mfma_f32_16x16x32_bf16 v[180:183], a[20:23], a[68:71], v[180:183]
    buffer_load_dwordx4 v12, s[4:7], s36 offen offset:2112 lds
    v_mfma_f32_16x16x32_bf16 v[212:215], a[20:23], a[72:75], v[212:215]
    v_mfma_f32_16x16x32_bf16 v[212:215], a[52:55], a[88:91], v[212:215]
    v_mfma_f32_16x16x32_bf16 v[244:247], a[52:55], a[92:95], v[244:247]
    s_waitcnt vmcnt(19)
    ds_read_b64_tr_b16 a[52:53], v5 offset:8608
    ds_read_b64_tr_b16 a[54:55], v5 offset:9120
    v_mfma_f32_16x16x32_bf16 v[244:247], a[20:23], a[76:79], v[244:247]
    ds_read_b64_tr_b16 a[20:21], v5 offset:160
    ds_read_b64_tr_b16 a[22:23], v5 offset:672
    v_mfma_f32_16x16x32_bf16 v[152:155], a[24:27], a[64:67], v[152:155]
    ds_read_b128 a[96:99], v18 offset:30720
    v_mfma_f32_16x16x32_bf16 v[152:155], a[56:59], a[80:83], v[152:155]
    ds_read_b128 a[112:115], v19 offset:30720
    v_mfma_f32_16x16x32_bf16 v[184:187], a[56:59], a[84:87], v[184:187]
    ds_read_b128 a[100:103], v18 offset:32768
    v_mfma_f32_16x16x32_bf16 v[184:187], a[24:27], a[68:71], v[184:187]
    ds_read_b128 a[116:119], v19 offset:32768
    v_mfma_f32_16x16x32_bf16 v[216:219], a[24:27], a[72:75], v[216:219]
    ds_read_b128 a[104:107], v18 offset:34816
    v_mfma_f32_16x16x32_bf16 v[216:219], a[56:59], a[88:91], v[216:219]
    ds_read_b128 a[120:123], v19 offset:34816
    v_mfma_f32_16x16x32_bf16 v[248:251], a[56:59], a[92:95], v[248:251]
    ds_read_b64_tr_b16 a[56:57], v5 offset:8640
    ds_read_b64_tr_b16 a[58:59], v5 offset:9152
    v_mfma_f32_16x16x32_bf16 v[248:251], a[24:27], a[76:79], v[248:251]
    ds_read_b64_tr_b16 a[24:25], v5 offset:192
    ds_read_b64_tr_b16 a[26:27], v5 offset:704
    v_mfma_f32_16x16x32_bf16 v[156:159], a[28:31], a[64:67], v[156:159]
    ds_read_b128 a[108:111], v18 offset:36864
    v_mfma_f32_16x16x32_bf16 v[156:159], a[60:63], a[80:83], v[156:159]
    ds_read_b128 a[124:127], v19 offset:36864
    v_mfma_f32_16x16x32_bf16 v[188:191], a[60:63], a[84:87], v[188:191]
    buffer_load_dwordx4 v13, s[4:7], s36 offen offset:3168 lds
    v_mfma_f32_16x16x32_bf16 v[188:191], a[28:31], a[68:71], v[188:191]
    s_max_i32 s39, s35, 0
    s_min_i32 s38, s39, 524288
    s_add_i32 s35, s35, 8192
    s_add_u32 m0, s34, 67584
    s_nop 0
    buffer_load_dwordx4 v6, s[8:11], s38 offen offset:0 nt lds
    v_mfma_f32_16x16x32_bf16 v[220:223], a[28:31], a[72:75], v[220:223]
    buffer_load_dwordx4 v7, s[8:11], s38 offen offset:1056 nt lds
    v_mfma_f32_16x16x32_bf16 v[220:223], a[60:63], a[88:91], v[220:223]
    buffer_load_dwordx4 v8, s[8:11], s38 offen offset:2112 nt lds
    v_mfma_f32_16x16x32_bf16 v[252:255], a[60:63], a[92:95], v[252:255]
    ds_read_b64_tr_b16 a[60:61], v5 offset:8672
    ds_read_b64_tr_b16 a[62:63], v5 offset:9184
    v_mfma_f32_16x16x32_bf16 v[252:255], a[28:31], a[76:79], v[252:255]
    s_waitcnt lgkmcnt(13)
    ds_read_b64_tr_b16 a[28:29], v5 offset:224
    ds_read_b64_tr_b16 a[30:31], v5 offset:736
    buffer_load_dwordx4 v9, s[8:11], s38 offen offset:3168 nt lds
    v_mfma_f32_16x16x32_bf16 v[128:131], a[0:3], a[96:99], v[128:131]
    s_waitcnt lgkmcnt(14)
    v_mfma_f32_16x16x32_bf16 v[128:131], a[32:35], a[112:115], v[128:131]
    s_waitcnt lgkmcnt(12)
    v_mfma_f32_16x16x32_bf16 v[160:163], a[32:35], a[116:119], v[160:163]
    v_mfma_f32_16x16x32_bf16 v[160:163], a[0:3], a[100:103], v[160:163]
    s_waitcnt lgkmcnt(11)
    v_mfma_f32_16x16x32_bf16 v[192:195], a[0:3], a[104:107], v[192:195]
    s_waitcnt lgkmcnt(10)
    v_mfma_f32_16x16x32_bf16 v[192:195], a[32:35], a[120:123], v[192:195]
    s_waitcnt lgkmcnt(4)
    v_mfma_f32_16x16x32_bf16 v[224:227], a[32:35], a[124:127], v[224:227]
    v_add_u32 v5, 0, v3
    v_mfma_f32_16x16x32_bf16 v[224:227], a[0:3], a[108:111], v[224:227]
    s_waitcnt vmcnt(20) lgkmcnt(0)
    v_mfma_f32_16x16x32_bf16 v[132:135], a[4:7], a[96:99], v[132:135]
    s_barrier
    v_mfma_f32_16x16x32_bf16 v[132:135], a[36:39], a[112:115], v[132:135]
    s_bfe_u32 s98, s97, 0x40004
    ds_read_b64_tr_b16 a[32:33], v5 offset:8448
    ds_read_b64_tr_b16 a[34:35], v5 offset:8960
    v_mfma_f32_16x16x32_bf16 v[164:167], a[36:39], a[116:119], v[164:167]
    s_lshl_b32 s40, s98, 7
    ds_read_b64_tr_b16 a[0:1], v5 offset:0
    ds_read_b64_tr_b16 a[2:3], v5 offset:512
    v_mfma_f32_16x16x32_bf16 v[164:167], a[4:7], a[100:103], v[164:167]
    s_add_u32 s41, s40, 40960
    s_add_u32 m0, s42, 30720
    s_nop 0
    buffer_load_dwordx4 v14, s[12:15], s40 offen offset:0 lds
    v_mfma_f32_16x16x32_bf16 v[196:199], a[4:7], a[104:107], v[196:199]
    v_mfma_f32_16x16x32_bf16 v[196:199], a[36:39], a[120:123], v[196:199]
    v_mfma_f32_16x16x32_bf16 v[228:231], a[36:39], a[124:127], v[228:231]
    ds_read_b64_tr_b16 a[36:37], v5 offset:8480
    ds_read_b64_tr_b16 a[38:39], v5 offset:8992
    v_mfma_f32_16x16x32_bf16 v[228:231], a[4:7], a[108:111], v[228:231]
    ds_read_b64_tr_b16 a[4:5], v5 offset:32
    ds_read_b64_tr_b16 a[6:7], v5 offset:544
    v_mfma_f32_16x16x32_bf16 v[136:139], a[8:11], a[96:99], v[136:139]
    buffer_load_dwordx4 v15, s[12:15], s40 offen offset:1024 lds
    v_mfma_f32_16x16x32_bf16 v[136:139], a[40:43], a[112:115], v[136:139]
    v_mfma_f32_16x16x32_bf16 v[168:171], a[40:43], a[116:119], v[168:171]
    buffer_load_dwordx4 v16, s[12:15], s40 offen offset:2048 lds
    v_mfma_f32_16x16x32_bf16 v[168:171], a[8:11], a[100:103], v[168:171]
    v_mfma_f32_16x16x32_bf16 v[200:203], a[8:11], a[104:107], v[200:203]
    v_mfma_f32_16x16x32_bf16 v[200:203], a[40:43], a[120:123], v[200:203]
    v_mfma_f32_16x16x32_bf16 v[232:235], a[40:43], a[124:127], v[232:235]
    ds_read_b64_tr_b16 a[40:41], v5 offset:8512
    ds_read_b64_tr_b16 a[42:43], v5 offset:9024
    v_mfma_f32_16x16x32_bf16 v[232:235], a[8:11], a[108:111], v[232:235]
    ds_read_b64_tr_b16 a[8:9], v5 offset:64
    ds_read_b64_tr_b16 a[10:11], v5 offset:576
    v_mfma_f32_16x16x32_bf16 v[140:143], a[12:15], a[96:99], v[140:143]
    buffer_load_dwordx4 v17, s[12:15], s40 offen offset:3072 lds
    v_mfma_f32_16x16x32_bf16 v[140:143], a[44:47], a[112:115], v[140:143]
    s_add_u32 m0, s42, 34816
    v_mfma_f32_16x16x32_bf16 v[172:175], a[44:47], a[116:119], v[172:175]
    buffer_load_dwordx4 v14, s[12:15], s41 offen offset:0 lds
    v_mfma_f32_16x16x32_bf16 v[172:175], a[12:15], a[100:103], v[172:175]
    v_mfma_f32_16x16x32_bf16 v[204:207], a[12:15], a[104:107], v[204:207]
    v_mfma_f32_16x16x32_bf16 v[204:207], a[44:47], a[120:123], v[204:207]
    v_mfma_f32_16x16x32_bf16 v[236:239], a[44:47], a[124:127], v[236:239]
    ds_read_b64_tr_b16 a[44:45], v5 offset:8544
    ds_read_b64_tr_b16 a[46:47], v5 offset:9056
    v_mfma_f32_16x16x32_bf16 v[236:239], a[12:15], a[108:111], v[236:239]
    ds_read_b64_tr_b16 a[12:13], v5 offset:96
    ds_read_b64_tr_b16 a[14:15], v5 offset:608
    v_mfma_f32_16x16x32_bf16 v[144:147], a[16:19], a[96:99], v[144:147]
    buffer_load_dwordx4 v15, s[12:15], s41 offen offset:1024 lds
    v_mfma_f32_16x16x32_bf16 v[144:147], a[48:51], a[112:115], v[144:147]
    v_mfma_f32_16x16x32_bf16 v[176:179], a[48:51], a[116:119], v[176:179]
    buffer_load_dwordx4 v16, s[12:15], s41 offen offset:2048 lds
    v_mfma_f32_16x16x32_bf16 v[176:179], a[16:19], a[100:103], v[176:179]
    v_mfma_f32_16x16x32_bf16 v[208:211], a[16:19], a[104:107], v[208:211]
    v_mfma_f32_16x16x32_bf16 v[208:211], a[48:51], a[120:123], v[208:211]
    v_mfma_f32_16x16x32_bf16 v[240:243], a[48:51], a[124:127], v[240:243]
    ds_read_b64_tr_b16 a[48:49], v5 offset:8576
    ds_read_b64_tr_b16 a[50:51], v5 offset:9088
    v_mfma_f32_16x16x32_bf16 v[240:243], a[16:19], a[108:111], v[240:243]
    ds_read_b64_tr_b16 a[16:17], v5 offset:128
    ds_read_b64_tr_b16 a[18:19], v5 offset:640
    v_mfma_f32_16x16x32_bf16 v[148:151], a[20:23], a[96:99], v[148:151]
    buffer_load_dwordx4 v17, s[12:15], s41 offen offset:3072 lds
    v_mfma_f32_16x16x32_bf16 v[148:151], a[52:55], a[112:115], v[148:151]
    s_bfe_u32 s98, s97, 0x40004
    v_mfma_f32_16x16x32_bf16 v[180:183], a[52:55], a[116:119], v[180:183]
    s_lshl_b32 s36, s98, 19
    s_add_u32 s36, s36, s45
    s_add_u32 s36, s36, 256
    s_add_u32 m0, s34, 84480
    s_nop 0
    buffer_load_dwordx4 v10, s[4:7], s36 offen offset:0 lds
    v_mfma_f32_16x16x32_bf16 v[180:183], a[20:23], a[100:103], v[180:183]
    v_mfma_f32_16x16x32_bf16 v[212:215], a[20:23], a[104:107], v[212:215]
    v_mfma_f32_16x16x32_bf16 v[212:215], a[52:55], a[120:123], v[212:215]
    v_mfma_f32_16x16x32_bf16 v[244:247], a[52:55], a[124:127], v[244:247]
    s_waitcnt vmcnt(17)
    ds_read_b64_tr_b16 a[52:53], v5 offset:8608
    ds_read_b64_tr_b16 a[54:55], v5 offset:9120
    v_mfma_f32_16x16x32_bf16 v[244:247], a[20:23], a[108:111], v[244:247]
    ds_read_b64_tr_b16 a[20:21], v5 offset:160
    ds_read_b64_tr_b16 a[22:23], v5 offset:672
    v_mfma_f32_16x16x32_bf16 v[152:155], a[24:27], a[96:99], v[152:155]
    ds_read_b128 a[64:67], v18 offset:0
    v_mfma_f32_16x16x32_bf16 v[152:155], a[56:59], a[112:115], v[152:155]
    ds_read_b128 a[80:83], v19 offset:0
    v_mfma_f32_16x16x32_bf16 v[184:187], a[56:59], a[116:119], v[184:187]
    ds_read_b128 a[68:71], v18 offset:2048
    v_mfma_f32_16x16x32_bf16 v[184:187], a[24:27], a[100:103], v[184:187]
    ds_read_b128 a[84:87], v19 offset:2048
    v_mfma_f32_16x16x32_bf16 v[216:219], a[24:27], a[104:107], v[216:219]
    ds_read_b128 a[72:75], v18 offset:4096
    v_mfma_f32_16x16x32_bf16 v[216:219], a[56:59], a[120:123], v[216:219]
    ds_read_b128 a[88:91], v19 offset:4096
    v_mfma_f32_16x16x32_bf16 v[248:251], a[56:59], a[124:127], v[248:251]
    ds_read_b64_tr_b16 a[56:57], v5 offset:8640
    ds_read_b64_tr_b16 a[58:59], v5 offset:9152
    v_mfma_f32_16x16x32_bf16 v[248:251], a[24:27], a[108:111], v[248:251]
    ds_read_b64_tr_b16 a[24:25], v5 offset:192
    ds_read_b64_tr_b16 a[26:27], v5 offset:704
    v_mfma_f32_16x16x32_bf16 v[156:159], a[28:31], a[96:99], v[156:159]
    ds_read_b128 a[76:79], v18 offset:6144
    v_mfma_f32_16x16x32_bf16 v[156:159], a[60:63], a[112:115], v[156:159]
    ds_read_b128 a[92:95], v19 offset:6144
    v_mfma_f32_16x16x32_bf16 v[188:191], a[60:63], a[116:119], v[188:191]
    buffer_load_dwordx4 v11, s[4:7], s36 offen offset:1056 lds
    v_mfma_f32_16x16x32_bf16 v[188:191], a[28:31], a[100:103], v[188:191]
    buffer_load_dwordx4 v12, s[4:7], s36 offen offset:2112 lds
    v_mfma_f32_16x16x32_bf16 v[220:223], a[28:31], a[104:107], v[220:223]
    buffer_load_dwordx4 v13, s[4:7], s36 offen offset:3168 lds
    v_mfma_f32_16x16x32_bf16 v[220:223], a[60:63], a[120:123], v[220:223]
    v_mfma_f32_16x16x32_bf16 v[252:255], a[60:63], a[124:127], v[252:255]
    ds_read_b64_tr_b16 a[60:61], v5 offset:8672
    ds_read_b64_tr_b16 a[62:63], v5 offset:9184
    v_mfma_f32_16x16x32_bf16 v[252:255], a[28:31], a[108:111], v[252:255]
    s_waitcnt lgkmcnt(13)
    ds_read_b64_tr_b16 a[28:29], v5 offset:224
    ds_read_b64_tr_b16 a[30:31], v5 offset:736
    v_mfma_f32_16x16x32_bf16 v[128:131], a[0:3], a[64:67], v[128:131]
    s_waitcnt lgkmcnt(14)
    v_mfma_f32_16x16x32_bf16 v[128:131], a[32:35], a[80:83], v[128:131]
    s_waitcnt lgkmcnt(12)
    v_mfma_f32_16x16x32_bf16 v[160:163], a[32:35], a[84:87], v[160:163]
    v_mfma_f32_16x16x32_bf16 v[160:163], a[0:3], a[68:71], v[160:163]
    s_waitcnt lgkmcnt(11)
    v_mfma_f32_16x16x32_bf16 v[192:195], a[0:3], a[72:75], v[192:195]
    s_waitcnt lgkmcnt(10)
    v_mfma_f32_16x16x32_bf16 v[192:195], a[32:35], a[88:91], v[192:195]
    s_waitcnt lgkmcnt(4)
    v_mfma_f32_16x16x32_bf16 v[224:227], a[32:35], a[92:95], v[224:227]
    v_add_u32 v5, 16896, v3
    v_mfma_f32_16x16x32_bf16 v[224:227], a[0:3], a[76:79], v[224:227]
    s_waitcnt vmcnt(16) lgkmcnt(0)
    v_mfma_f32_16x16x32_bf16 v[132:135], a[4:7], a[64:67], v[132:135]
    s_barrier
    v_mfma_f32_16x16x32_bf16 v[132:135], a[36:39], a[80:83], v[132:135]
    s_max_i32 s39, s35, 0
    ds_read_b64_tr_b16 a[32:33], v5 offset:8448
    ds_read_b64_tr_b16 a[34:35], v5 offset:8960
    v_mfma_f32_16x16x32_bf16 v[164:167], a[36:39], a[84:87], v[164:167]
    s_min_i32 s38, s39, 524288
    ds_read_b64_tr_b16 a[0:1], v5 offset:0
    ds_read_b64_tr_b16 a[2:3], v5 offset:512
    v_mfma_f32_16x16x32_bf16 v[164:167], a[4:7], a[68:71], v[164:167]
    s_add_i32 s35, s35, 8192
    s_add_u32 m0, s34, 0
    s_nop 0
    buffer_load_dwordx4 v6, s[8:11], s38 offen offset:0 nt lds
    v_mfma_f32_16x16x32_bf16 v[196:199], a[4:7], a[72:75], v[196:199]
    v_mfma_f32_16x16x32_bf16 v[196:199], a[36:39], a[88:91], v[196:199]
    v_mfma_f32_16x16x32_bf16 v[228:231], a[36:39], a[92:95], v[228:231]
    ds_read_b64_tr_b16 a[36:37], v5 offset:8480
    ds_read_b64_tr_b16 a[38:39], v5 offset:8992
    v_mfma_f32_16x16x32_bf16 v[228:231], a[4:7], a[76:79], v[228:231]
    ds_read_b64_tr_b16 a[4:5], v5 offset:32
    ds_read_b64_tr_b16 a[6:7], v5 offset:544
    v_mfma_f32_16x16x32_bf16 v[136:139], a[8:11], a[64:67], v[136:139]
    buffer_load_dwordx4 v7, s[8:11], s38 offen offset:1056 nt lds
    v_mfma_f32_16x16x32_bf16 v[136:139], a[40:43], a[80:83], v[136:139]
    v_mfma_f32_16x16x32_bf16 v[168:171], a[40:43], a[84:87], v[168:171]
    buffer_load_dwordx4 v8, s[8:11], s38 offen offset:2112 nt lds
    v_mfma_f32_16x16x32_bf16 v[168:171], a[8:11], a[68:71], v[168:171]
    v_mfma_f32_16x16x32_bf16 v[200:203], a[8:11], a[72:75], v[200:203]
    v_mfma_f32_16x16x32_bf16 v[200:203], a[40:43], a[88:91], v[200:203]
    v_mfma_f32_16x16x32_bf16 v[232:235], a[40:43], a[92:95], v[232:235]
    ds_read_b64_tr_b16 a[40:41], v5 offset:8512
    ds_read_b64_tr_b16 a[42:43], v5 offset:9024
    v_mfma_f32_16x16x32_bf16 v[232:235], a[8:11], a[76:79], v[232:235]
    ds_read_b64_tr_b16 a[8:9], v5 offset:64
    ds_read_b64_tr_b16 a[10:11], v5 offset:576
    v_mfma_f32_16x16x32_bf16 v[140:143], a[12:15], a[64:67], v[140:143]
    buffer_load_dwordx4 v9, s[8:11], s38 offen offset:3168 nt lds
    v_mfma_f32_16x16x32_bf16 v[140:143], a[44:47], a[80:83], v[140:143]
    v_mfma_f32_16x16x32_bf16 v[172:175], a[44:47], a[84:87], v[172:175]
    v_mfma_f32_16x16x32_bf16 v[172:175], a[12:15], a[68:71], v[172:175]
    v_mfma_f32_16x16x32_bf16 v[204:207], a[12:15], a[72:75], v[204:207]
    v_mfma_f32_16x16x32_bf16 v[204:207], a[44:47], a[88:91], v[204:207]
    v_mfma_f32_16x16x32_bf16 v[236:239], a[44:47], a[92:95], v[236:239]
    ds_read_b64_tr_b16 a[44:45], v5 offset:8544
    ds_read_b64_tr_b16 a[46:47], v5 offset:9056
    v_mfma_f32_16x16x32_bf16 v[236:239], a[12:15], a[76:79], v[236:239]
    ds_read_b64_tr_b16 a[12:13], v5 offset:96
    ds_read_b64_tr_b16 a[14:15], v5 offset:608
    v_mfma_f32_16x16x32_bf16 v[144:147], a[16:19], a[64:67], v[144:147]
    v_mfma_f32_16x16x32_bf16 v[144:147], a[48:51], a[80:83], v[144:147]
    v_mfma_f32_16x16x32_bf16 v[176:179], a[48:51], a[84:87], v[176:179]
    v_mfma_f32_16x16x32_bf16 v[176:179], a[16:19], a[68:71], v[176:179]
    v_mfma_f32_16x16x32_bf16 v[208:211], a[16:19], a[72:75], v[208:211]
    v_mfma_f32_16x16x32_bf16 v[208:211], a[48:51], a[88:91], v[208:211]
    v_mfma_f32_16x16x32_bf16 v[240:243], a[48:51], a[92:95], v[240:243]
    ds_read_b64_tr_b16 a[48:49], v5 offset:8576
    ds_read_b64_tr_b16 a[50:51], v5 offset:9088
    v_mfma_f32_16x16x32_bf16 v[240:243], a[16:19], a[76:79], v[240:243]
    ds_read_b64_tr_b16 a[16:17], v5 offset:128
    ds_read_b64_tr_b16 a[18:19], v5 offset:640
    v_mfma_f32_16x16x32_bf16 v[148:151], a[20:23], a[64:67], v[148:151]
    v_mfma_f32_16x16x32_bf16 v[148:151], a[52:55], a[80:83], v[148:151]
    v_mfma_f32_16x16x32_bf16 v[180:183], a[52:55], a[84:87], v[180:183]
    v_mfma_f32_16x16x32_bf16 v[180:183], a[20:23], a[68:71], v[180:183]
    v_mfma_f32_16x16x32_bf16 v[212:215], a[20:23], a[72:75], v[212:215]
    v_mfma_f32_16x16x32_bf16 v[212:215], a[52:55], a[88:91], v[212:215]
    v_mfma_f32_16x16x32_bf16 v[244:247], a[52:55], a[92:95], v[244:247]
    s_waitcnt vmcnt(8)
    ds_read_b64_tr_b16 a[52:53], v5 offset:8608
    ds_read_b64_tr_b16 a[54:55], v5 offset:9120
    v_mfma_f32_16x16x32_bf16 v[244:247], a[20:23], a[76:79], v[244:247]
    ds_read_b64_tr_b16 a[20:21], v5 offset:160
    ds_read_b64_tr_b16 a[22:23], v5 offset:672
    v_mfma_f32_16x16x32_bf16 v[152:155], a[24:27], a[64:67], v[152:155]
    ds_read_b128 a[96:99], v18 offset:30720
    v_mfma_f32_16x16x32_bf16 v[152:155], a[56:59], a[80:83], v[152:155]
    ds_read_b128 a[112:115], v19 offset:30720
    v_mfma_f32_16x16x32_bf16 v[184:187], a[56:59], a[84:87], v[184:187]
    ds_read_b128 a[100:103], v18 offset:32768
    v_mfma_f32_16x16x32_bf16 v[184:187], a[24:27], a[68:71], v[184:187]
    ds_read_b128 a[116:119], v19 offset:32768
    v_mfma_f32_16x16x32_bf16 v[216:219], a[24:27], a[72:75], v[216:219]
    ds_read_b128 a[104:107], v18 offset:34816
    v_mfma_f32_16x16x32_bf16 v[216:219], a[56:59], a[88:91], v[216:219]
    ds_read_b128 a[120:123], v19 offset:34816
    v_mfma_f32_16x16x32_bf16 v[248:251], a[56:59], a[92:95], v[248:251]
    ds_read_b64_tr_b16 a[56:57], v5 offset:8640
    ds_read_b64_tr_b16 a[58:59], v5 offset:9152
    v_mfma_f32_16x16x32_bf16 v[248:251], a[24:27], a[76:79], v[248:251]
    ds_read_b64_tr_b16 a[24:25], v5 offset:192
    ds_read_b64_tr_b16 a[26:27], v5 offset:704
    v_mfma_f32_16x16x32_bf16 v[156:159], a[28:31], a[64:67], v[156:159]
    ds_read_b128 a[108:111], v18 offset:36864
    v_mfma_f32_16x16x32_bf16 v[156:159], a[60:63], a[80:83], v[156:159]
    ds_read_b128 a[124:127], v19 offset:36864
    v_mfma_f32_16x16x32_bf16 v[188:191], a[60:63], a[84:87], v[188:191]
    v_mfma_f32_16x16x32_bf16 v[188:191], a[28:31], a[68:71], v[188:191]
    v_mfma_f32_16x16x32_bf16 v[220:223], a[28:31], a[72:75], v[220:223]
    v_mfma_f32_16x16x32_bf16 v[220:223], a[60:63], a[88:91], v[220:223]
    v_mfma_f32_16x16x32_bf16 v[252:255], a[60:63], a[92:95], v[252:255]
    ds_read_b64_tr_b16 a[60:61], v5 offset:8672
    ds_read_b64_tr_b16 a[62:63], v5 offset:9184
    v_mfma_f32_16x16x32_bf16 v[252:255], a[28:31], a[76:79], v[252:255]
    ds_read_b64_tr_b16 a[28:29], v5 offset:224
    ds_read_b64_tr_b16 a[30:31], v5 offset:736
    s_waitcnt lgkmcnt(15)
    v_mfma_f32_16x16x32_bf16 v[128:131], a[0:3], a[96:99], v[128:131]
    s_waitcnt vmcnt(4) lgkmcnt(0)
    s_barrier
    v_mfma_f32_16x16x32_bf16 v[128:131], a[32:35], a[112:115], v[128:131]
    s_max_i32 s39, s35, 0
    v_add_u32 v5, 84480, v3
    s_add_u32 m0, s34, 16896
    v_mfma_f32_16x16x32_bf16 v[132:135], a[36:39], a[112:115], v[132:135]
    s_min_i32 s38, s39, 524288
    buffer_load_dwordx4 v6, s[8:11], s38 offen offset:0 nt lds
    v_mfma_f32_16x16x32_bf16 v[132:135], a[4:7], a[96:99], v[132:135]
    s_bfe_u32 s98, s97, 0x40000
    s_lshl_b32 s36, s98, 19
    s_add_u32 s36, s36, s45
    v_mfma_f32_16x16x32_bf16 v[136:139], a[8:11], a[96:99], v[136:139]
    s_add_u32 s36, s36, 256
    v_add_u32 v4, 33792, v2
    v_mul_f32 v128, s46, v128
    v_mfma_f32_16x16x32_bf16 v[136:139], a[40:43], a[112:115], v[136:139]
    s_bfe_u32 s98, s96, 0x4001c
    v_mul_f32 v129, s46, v129
    v_mul_f32 v130, s46, v130
    v_mfma_f32_16x16x32_bf16 v[140:143], a[44:47], a[112:115], v[140:143]
    s_lshl_b32 s40, s98, 7
    buffer_load_dwordx4 v7, s[8:11], s38 offen offset:1056 nt lds
    v_mfma_f32_16x16x32_bf16 v[140:143], a[12:15], a[96:99], v[140:143]
    s_add_u32 s94, s32, s34
    v_mul_f32 v131, s46, v131
    v_mul_f32 v132, s46, v132
    v_mfma_f32_16x16x32_bf16 v[144:147], a[16:19], a[96:99], v[144:147]
    s_add_u32 s32, s32, 16896
    v_mul_f32 v133, s46, v133
    v_mul_f32 v134, s46, v134
    v_mfma_f32_16x16x32_bf16 v[144:147], a[48:51], a[112:115], v[144:147]
    s_cmp_ge_u32 s32, 84480
    s_cselect_b32 s32, 0, s32
    v_mul_f32 v135, s46, v135
    v_mfma_f32_16x16x32_bf16 v[148:151], a[52:55], a[112:115], v[148:151]
    s_add_i32 s35, s35, 8192
    buffer_load_dwordx4 v8, s[8:11], s38 offen offset:2112 nt lds
    v_mfma_f32_16x16x32_bf16 v[148:151], a[20:23], a[96:99], v[148:151]
    s_max_i32 s39, s35, 0
    v_cvt_pk_bf16_f32 v128, v128, v129
    v_cvt_pk_bf16_f32 v129, v130, v131
    v_mfma_f32_16x16x32_bf16 v[152:155], a[24:27], a[96:99], v[152:155]
    s_add_i32 s35, s35, 8192
    v_cvt_pk_bf16_f32 v130, v132, v133
    v_cvt_pk_bf16_f32 v131, v134, v135
    v_mfma_f32_16x16x32_bf16 v[152:155], a[56:59], a[112:115], v[152:155]
    s_lshl_b32 s57, s56, 16
    v_mul_f32 v136, s46, v136
    v_mul_f32 v137, s46, v137
    v_mfma_f32_16x16x32_bf16 v[156:159], a[60:63], a[112:115], v[156:159]
    s_mul_i32 s58, s55, 49152
    buffer_load_dwordx4 v9, s[8:11], s38 offen offset:3168 nt lds
    v_mfma_f32_16x16x32_bf16 v[156:159], a[28:31], a[96:99], v[156:159]
    s_add_u32 m0, s34, 84480
    v_mul_f32 v138, s46, v138
    v_mul_f32 v139, s46, v139
    v_mfma_f32_16x16x32_bf16 v[160:163], a[0:3], a[100:103], v[160:163]
    s_min_i32 s38, s39, 524288
    v_mul_f32 v140, s46, v140
    v_mul_f32 v141, s46, v141
    v_mfma_f32_16x16x32_bf16 v[160:163], a[32:35], a[116:119], v[160:163]
    s_max_i32 s39, s35, 0
    v_mul_f32 v142, s46, v142
    v_mul_f32 v143, s46, v143
    v_mfma_f32_16x16x32_bf16 v[164:167], a[36:39], a[116:119], v[164:167]
    s_sub_u32 s57, s57, s58
    v_permlane32_swap_b32 v128, v130
    v_permlane32_swap_b32 v129, v131
    v_mfma_f32_16x16x32_bf16 v[164:167], a[4:7], a[100:103], v[164:167]
    s_add_u32 s57, s57, 256
    v_cvt_pk_bf16_f32 v132, v136, v137
    v_cvt_pk_bf16_f32 v133, v138, v139
    v_mfma_f32_16x16x32_bf16 v[168:171], a[8:11], a[100:103], v[168:171]
    s_lshl_b32 s58, s2, 2
    v_cvt_pk_bf16_f32 v134, v140, v141
    v_cvt_pk_bf16_f32 v135, v142, v143
    v_mfma_f32_16x16x32_bf16 v[168:171], a[40:43], a[116:119], v[168:171]
    s_add_u32 s58, s58, s3
    v_mul_f32 v144, s46, v144
    v_mul_f32 v145, s46, v145
    v_mfma_f32_16x16x32_bf16 v[172:175], a[44:47], a[116:119], v[172:175]
    s_add_u32 s41, s40, 40960
    v_mul_f32 v160, s46, v160
    v_mul_f32 v161, s46, v161
    v_mfma_f32_16x16x32_bf16 v[172:175], a[12:15], a[100:103], v[172:175]
    s_lshl_b32 s96, s96, 4
    v_permlane16_swap_b32 v128, v130
    v_permlane16_swap_b32 v129, v131
    v_mfma_f32_16x16x32_bf16 v[176:179], a[16:19], a[100:103], v[176:179]
    s_mul_i32 s58, s58, 5120
    v_mul_f32 v146, s46, v146
    v_mul_f32 v147, s46, v147
    v_mfma_f32_16x16x32_bf16 v[176:179], a[48:51], a[116:119], v[176:179]
    s_add_i32 s35, s35, 8192
    v_mul_f32 v148, s46, v148
    v_mul_f32 v149, s46, v149
    v_mfma_f32_16x16x32_bf16 v[180:183], a[52:55], a[116:119], v[180:183]
    v_mul_f32 v150, s46, v150
    v_mul_f32 v151, s46, v151
    v_mfma_f32_16x16x32_bf16 v[180:183], a[20:23], a[100:103], v[180:183]
    v_cvt_pk_bf16_f32 v136, v144, v145
    v_permlane32_swap_b32 v132, v134
    v_mfma_f32_16x16x32_bf16 v[184:187], a[24:27], a[100:103], v[184:187]
    v_permlane32_swap_b32 v133, v135
    v_cvt_pk_bf16_f32 v144, v160, v161
    v_mfma_f32_16x16x32_bf16 v[184:187], a[56:59], a[116:119], v[184:187]
    v_cvt_pk_bf16_f32 v137, v146, v147
    v_cvt_pk_bf16_f32 v138, v148, v149
    v_mfma_f32_16x16x32_bf16 v[188:191], a[60:63], a[116:119], v[188:191]
    v_cvt_pk_bf16_f32 v139, v150, v151
    v_permlane16_swap_b32 v132, v134
    v_mfma_f32_16x16x32_bf16 v[188:191], a[28:31], a[100:103], v[188:191]
    v_permlane16_swap_b32 v133, v135
    v_mul_f32 v152, s46, v152
    v_mfma_f32_16x16x32_bf16 v[192:195], a[0:3], a[104:107], v[192:195]
    v_mul_f32 v153, s46, v153
    v_mul_f32 v154, s46, v154
    v_mfma_f32_16x16x32_bf16 v[192:195], a[32:35], a[120:123], v[192:195]
    v_mul_f32 v155, s46, v155
    v_mul_f32 v156, s46, v156
    v_mfma_f32_16x16x32_bf16 v[196:199], a[36:39], a[120:123], v[196:199]
    v_mul_f32 v157, s46, v157
    v_mul_f32 v158, s46, v158
    v_mfma_f32_16x16x32_bf16 v[196:199], a[4:7], a[104:107], v[196:199]
    v_mul_f32 v159, s46, v159
    v_permlane32_swap_b32 v136, v138
    v_mfma_f32_16x16x32_bf16 v[200:203], a[8:11], a[104:107], v[200:203]
    v_mul_f32 v192, s46, v192
    v_mul_f32 v193, s46, v193
    v_mfma_f32_16x16x32_bf16 v[200:203], a[40:43], a[120:123], v[200:203]
    v_mul_f32 v194, s46, v194
    v_mul_f32 v195, s46, v195
    v_mfma_f32_16x16x32_bf16 v[204:207], a[44:47], a[120:123], v[204:207]
    v_cvt_pk_bf16_f32 v160, v192, v193
    v_cvt_pk_bf16_f32 v161, v194, v195
    v_mfma_f32_16x16x32_bf16 v[204:207], a[12:15], a[104:107], v[204:207]
    v_permlane32_swap_b32 v137, v139
    v_cvt_pk_bf16_f32 v140, v152, v153
    v_mfma_f32_16x16x32_bf16 v[208:211], a[16:19], a[104:107], v[208:211]
    v_cvt_pk_bf16_f32 v141, v154, v155
    v_cvt_pk_bf16_f32 v142, v156, v157
    v_mfma_f32_16x16x32_bf16 v[208:211], a[48:51], a[120:123], v[208:211]
    v_cvt_pk_bf16_f32 v143, v158, v159
    v_permlane16_swap_b32 v136, v138
    v_mfma_f32_16x16x32_bf16 v[212:215], a[52:55], a[120:123], v[212:215]
    v_permlane16_swap_b32 v137, v139
    v_permlane32_swap_b32 v140, v142
    v_mfma_f32_16x16x32_bf16 v[212:215], a[20:23], a[104:107], v[212:215]
    v_permlane32_swap_b32 v141, v143
    v_permlane16_swap_b32 v140, v142
    v_mfma_f32_16x16x32_bf16 v[216:219], a[24:27], a[104:107], v[216:219]
    v_permlane16_swap_b32 v141, v143
    v_mul_f32 v162, s46, v162
    v_mfma_f32_16x16x32_bf16 v[216:219], a[56:59], a[120:123], v[216:219]
    v_mul_f32 v163, s46, v163
    v_mul_f32 v196, s46, v196
    v_mfma_f32_16x16x32_bf16 v[220:223], a[60:63], a[120:123], v[220:223]
    v_mul_f32 v197, s46, v197
    v_mul_f32 v198, s46, v198
    v_mfma_f32_16x16x32_bf16 v[220:223], a[28:31], a[104:107], v[220:223]
    v_mul_f32 v199, s46, v199
    v_cvt_pk_bf16_f32 v145, v162, v163
    v_mfma_f32_16x16x32_bf16 v[224:227], a[0:3], a[108:111], v[224:227]
    ds_read_b64_tr_b16 a[0:1], v5 offset:0
    ds_read_b64_tr_b16 a[2:3], v5 offset:512
    v_mfma_f32_16x16x32_bf16 v[224:227], a[32:35], a[124:127], v[224:227]
    ds_read_b64_tr_b16 a[32:33], v5 offset:8448
    ds_read_b64_tr_b16 a[34:35], v5 offset:8960
    v_mfma_f32_16x16x32_bf16 v[228:231], a[36:39], a[124:127], v[228:231]
    ds_read_b64_tr_b16 a[36:37], v5 offset:8480
    ds_read_b64_tr_b16 a[38:39], v5 offset:8992
    v_mfma_f32_16x16x32_bf16 v[228:231], a[4:7], a[108:111], v[228:231]
    ds_read_b64_tr_b16 a[4:5], v5 offset:32
    ds_read_b64_tr_b16 a[6:7], v5 offset:544
    v_mfma_f32_16x16x32_bf16 v[232:235], a[8:11], a[108:111], v[232:235]
    ds_read_b64_tr_b16 a[8:9], v5 offset:64
    ds_read_b64_tr_b16 a[10:11], v5 offset:576
    v_mfma_f32_16x16x32_bf16 v[232:235], a[40:43], a[124:127], v[232:235]
    ds_read_b64_tr_b16 a[40:41], v5 offset:8512
    ds_read_b64_tr_b16 a[42:43], v5 offset:9024
    v_mfma_f32_16x16x32_bf16 v[236:239], a[44:47], a[124:127], v[236:239]
    ds_read_b64_tr_b16 a[44:45], v5 offset:8544
    ds_read_b64_tr_b16 a[46:47], v5 offset:9056
    v_mfma_f32_16x16x32_bf16 v[236:239], a[12:15], a[108:111], v[236:239]
    ds_read_b64_tr_b16 a[12:13], v5 offset:96
    ds_read_b64_tr_b16 a[14:15], v5 offset:608
    v_mfma_f32_16x16x32_bf16 v[240:243], a[16:19], a[108:111], v[240:243]
    ds_read_b64_tr_b16 a[16:17], v5 offset:128
    ds_read_b64_tr_b16 a[18:19], v5 offset:640
    v_mfma_f32_16x16x32_bf16 v[240:243], a[48:51], a[124:127], v[240:243]
    ds_read_b64_tr_b16 a[48:49], v5 offset:8576
    ds_read_b64_tr_b16 a[50:51], v5 offset:9088
    v_mfma_f32_16x16x32_bf16 v[244:247], a[52:55], a[124:127], v[244:247]
    ds_read_b64_tr_b16 a[52:53], v5 offset:8608
    ds_read_b64_tr_b16 a[54:55], v5 offset:9120
    v_mfma_f32_16x16x32_bf16 v[244:247], a[20:23], a[108:111], v[244:247]
    ds_read_b64_tr_b16 a[20:21], v5 offset:160
    ds_read_b64_tr_b16 a[22:23], v5 offset:672
    v_mfma_f32_16x16x32_bf16 v[248:251], a[24:27], a[108:111], v[248:251]
    ds_read_b64_tr_b16 a[24:25], v5 offset:192
    ds_read_b64_tr_b16 a[26:27], v5 offset:704
    v_mfma_f32_16x16x32_bf16 v[248:251], a[56:59], a[124:127], v[248:251]
    ds_read_b64_tr_b16 a[56:57], v5 offset:8640
    ds_read_b64_tr_b16 a[58:59], v5 offset:9152
    v_mfma_f32_16x16x32_bf16 v[252:255], a[60:63], a[124:127], v[252:255]
    ds_read_b64_tr_b16 a[60:61], v5 offset:8672
    ds_read_b64_tr_b16 a[62:63], v5 offset:9184
    v_mfma_f32_16x16x32_bf16 v[252:255], a[28:31], a[108:111], v[252:255]
    s_waitcnt lgkmcnt(15)
    ds_read_b64_tr_b16 a[28:29], v5 offset:224
    ds_read_b64_tr_b16 a[30:31], v5 offset:736
    v_mfma_f32_16x16x32_bf16 a[128:131], a[0:3], a[96:99], 0
    v_cvt_pk_bf16_f32 v162, v196, v197
    v_cvt_pk_bf16_f32 v163, v198, v199
    v_mfma_f32_16x16x32_bf16 a[128:131], a[32:35], a[112:115], a[128:131]
    v_mul_f32 v164, s46, v164
    v_mul_f32 v165, s46, v165
    v_mfma_f32_16x16x32_bf16 a[160:163], a[32:35], a[116:119], 0
    v_mul_f32 v166, s46, v166
    v_mul_f32 v167, s46, v167
    v_mfma_f32_16x16x32_bf16 a[160:163], a[0:3], a[100:103], a[160:163]
    v_cvt_pk_bf16_f32 v146, v164, v165
    v_cvt_pk_bf16_f32 v147, v166, v167
    v_mfma_f32_16x16x32_bf16 a[192:195], a[0:3], a[104:107], 0
    v_mul_f32 v168, s46, v168
    v_mul_f32 v169, s46, v169
    v_mfma_f32_16x16x32_bf16 a[192:195], a[32:35], a[120:123], a[192:195]
    v_mul_f32 v170, s46, v170
    v_mul_f32 v171, s46, v171
    v_mfma_f32_16x16x32_bf16 a[224:227], a[32:35], a[124:127], 0
    v_mul_f32 v172, s46, v172
    v_mul_f32 v173, s46, v173
    v_mfma_f32_16x16x32_bf16 a[224:227], a[0:3], a[108:111], a[224:227]
    v_mul_f32 v174, s46, v174
    v_mul_f32 v175, s46, v175
    v_mfma_f32_16x16x32_bf16 a[132:135], a[4:7], a[96:99], 0
    s_waitcnt vmcnt(52) lgkmcnt(0)
    s_barrier
    v_mfma_f32_16x16x32_bf16 a[132:135], a[36:39], a[112:115], a[132:135]
    buffer_load_dwordx4 v10, s[4:7], s36 offen offset:0 lds
    v_mfma_f32_16x16x32_bf16 a[164:167], a[36:39], a[116:119], 0
    ds_read_b128 v[32:35], v4 offset:0
    ds_read_b128 v[36:39], v4 offset:64
    v_mfma_f32_16x16x32_bf16 a[164:167], a[4:7], a[100:103], a[164:167]
    ds_read_b128 v[40:43], v4 offset:128
    ds_read_b128 v[44:47], v4 offset:192
    v_mfma_f32_16x16x32_bf16 a[196:199], a[4:7], a[104:107], 0
    ds_read_b128 v[60:63], v4 offset:704
    ds_read_b128 v[56:59], v4 offset:640
    v_mfma_f32_16x16x32_bf16 a[196:199], a[36:39], a[120:123], a[196:199]
    buffer_load_dwordx4 v11, s[4:7], s36 offen offset:1056 lds
    v_mfma_f32_16x16x32_bf16 a[228:231], a[36:39], a[124:127], 0
    ds_read_b128 v[52:55], v4 offset:576
    ds_read_b128 v[48:51], v4 offset:512
    v_mfma_f32_16x16x32_bf16 a[228:231], a[4:7], a[108:111], a[228:231]
    v_permlane32_swap_b32 v144, v146
    v_permlane32_swap_b32 v145, v147
    v_mfma_f32_16x16x32_bf16 a[136:139], a[8:11], a[96:99], 0
    v_cvt_pk_bf16_f32 v148, v168, v169
    v_cvt_pk_bf16_f32 v149, v170, v171
    v_mfma_f32_16x16x32_bf16 a[136:139], a[40:43], a[112:115], a[136:139]
    buffer_load_dwordx4 v12, s[4:7], s36 offen offset:2112 lds
    v_mfma_f32_16x16x32_bf16 a[168:171], a[40:43], a[116:119], 0
    v_cvt_pk_bf16_f32 v150, v172, v173
    v_cvt_pk_bf16_f32 v151, v174, v175
    v_mfma_f32_16x16x32_bf16 a[168:171], a[8:11], a[100:103], a[168:171]
    v_permlane16_swap_b32 v144, v146
    v_permlane16_swap_b32 v145, v147
    v_mfma_f32_16x16x32_bf16 a[200:203], a[8:11], a[104:107], 0
    v_mul_f32 v176, s46, v176
    v_mul_f32 v177, s46, v177
    v_mfma_f32_16x16x32_bf16 a[200:203], a[40:43], a[120:123], a[200:203]
    buffer_load_dwordx4 v13, s[4:7], s36 offen offset:3168 lds
    v_mfma_f32_16x16x32_bf16 a[232:235], a[40:43], a[124:127], 0
    s_add_u32 m0, s42, 30720
    v_mul_f32 v178, s46, v178
    v_mul_f32 v179, s46, v179
    v_mfma_f32_16x16x32_bf16 a[232:235], a[8:11], a[108:111], a[232:235]
    s_add_u32 s42, s42, 30720
    v_mul_f32 v180, s46, v180
    v_mul_f32 v181, s46, v181
    v_mfma_f32_16x16x32_bf16 a[140:143], a[12:15], a[96:99], 0
    s_mov_b32 s33, s42
    v_mul_f32 v182, s46, v182
    v_mul_f32 v183, s46, v183
    v_mfma_f32_16x16x32_bf16 a[140:143], a[44:47], a[112:115], a[140:143]
    buffer_load_dwordx4 v14, s[12:15], s40 offen offset:0 lds
    v_mfma_f32_16x16x32_bf16 a[172:175], a[44:47], a[116:119], 0
    v_mul_f32 v200, s46, v200
    v_mul_f32 v201, s46, v201
    v_mfma_f32_16x16x32_bf16 a[172:175], a[12:15], a[100:103], a[172:175]
    v_mul_f32 v202, s46, v202
    v_mul_f32 v203, s46, v203
    v_mfma_f32_16x16x32_bf16 a[204:207], a[12:15], a[104:107], 0
    v_permlane32_swap_b32 v148, v150
    v_permlane32_swap_b32 v149, v151
    v_mfma_f32_16x16x32_bf16 a[204:207], a[44:47], a[120:123], a[204:207]
    buffer_load_dwordx4 v15, s[12:15], s40 offen offset:1024 lds
    v_mfma_f32_16x16x32_bf16 a[236:239], a[44:47], a[124:127], 0
    v_cvt_pk_bf16_f32 v152, v176, v177
    v_cvt_pk_bf16_f32 v153, v178, v179
    v_mfma_f32_16x16x32_bf16 a[236:239], a[12:15], a[108:111], a[236:239]
    v_cvt_pk_bf16_f32 v154, v180, v181
    v_cvt_pk_bf16_f32 v155, v182, v183
    v_mfma_f32_16x16x32_bf16 a[144:147], a[16:19], a[96:99], 0
    v_cvt_pk_bf16_f32 v164, v200, v201
    v_cvt_pk_bf16_f32 v165, v202, v203
    v_mfma_f32_16x16x32_bf16 a[144:147], a[48:51], a[112:115], a[144:147]
    buffer_load_dwordx4 v16, s[12:15], s40 offen offset:2048 lds
    v_mfma_f32_16x16x32_bf16 a[176:179], a[48:51], a[116:119], 0
    v_permlane16_swap_b32 v148, v150
    v_permlane16_swap_b32 v149, v151
    v_mfma_f32_16x16x32_bf16 a[176:179], a[16:19], a[100:103], a[176:179]
    v_mul_f32 v184, s46, v184
    v_mul_f32 v185, s46, v185
    v_mfma_f32_16x16x32_bf16 a[208:211], a[16:19], a[104:107], 0
    v_mul_f32 v186, s46, v186
    v_mul_f32 v187, s46, v187
    v_mfma_f32_16x16x32_bf16 a[208:211], a[48:51], a[120:123], a[208:211]
    buffer_load_dwordx4 v17, s[12:15], s40 offen offset:3072 lds
    v_mfma_f32_16x16x32_bf16 a[240:243], a[48:51], a[124:127], 0
    s_waitcnt vmcnt(44) lgkmcnt(0)
    s_barrier
    v_mfma_f32_16x16x32_bf16 a[240:243], a[16:19], a[108:111], a[240:243]
    s_mov_b32 m0, s94
    v_mul_f32 v188, s46, v188
    v_mul_f32 v189, s46, v189
    v_mfma_f32_16x16x32_bf16 a[148:151], a[20:23], a[96:99], 0
    s_add_u32 s94, s32, s34
    buffer_load_dwordx4 v6, s[8:11], s38 offen offset:0 nt lds
    v_mfma_f32_16x16x32_bf16 a[148:151], a[52:55], a[112:115], a[148:151]
    v_mul_f32 v190, s46, v190
    v_mul_f32 v191, s46, v191
    v_mfma_f32_16x16x32_bf16 a[180:183], a[52:55], a[116:119], 0
    v_permlane32_swap_b32 v152, v154
    v_permlane32_swap_b32 v153, v155
    v_mfma_f32_16x16x32_bf16 a[180:183], a[20:23], a[100:103], a[180:183]
    v_cvt_pk_bf16_f32 v156, v184, v185
    v_cvt_pk_bf16_f32 v157, v186, v187
    v_mfma_f32_16x16x32_bf16 a[212:215], a[20:23], a[104:107], 0
    buffer_load_dwordx4 v7, s[8:11], s38 offen offset:1056 nt lds
    v_mfma_f32_16x16x32_bf16 a[212:215], a[52:55], a[120:123], a[212:215]
    v_cvt_pk_bf16_f32 v158, v188, v189
    v_cvt_pk_bf16_f32 v159, v190, v191
    v_mfma_f32_16x16x32_bf16 a[244:247], a[52:55], a[124:127], 0
    v_permlane16_swap_b32 v152, v154
    v_permlane16_swap_b32 v153, v155
    v_mfma_f32_16x16x32_bf16 a[244:247], a[20:23], a[108:111], a[244:247]
    v_permlane32_swap_b32 v156, v158
    v_permlane32_swap_b32 v157, v159
    v_mfma_f32_16x16x32_bf16 a[152:155], a[24:27], a[96:99], 0
    buffer_load_dwordx4 v8, s[8:11], s38 offen offset:2112 nt lds
    v_mfma_f32_16x16x32_bf16 a[152:155], a[56:59], a[112:115], a[152:155]
    v_permlane16_swap_b32 v156, v158
    v_permlane16_swap_b32 v157, v159
    v_mfma_f32_16x16x32_bf16 a[184:187], a[56:59], a[116:119], 0
    v_mul_f32 v204, s46, v204
    v_mul_f32 v205, s46, v205
    v_mfma_f32_16x16x32_bf16 a[184:187], a[24:27], a[100:103], a[184:187]
    v_mul_f32 v206, s46, v206
    v_mul_f32 v207, s46, v207
    v_mfma_f32_16x16x32_bf16 a[216:219], a[24:27], a[104:107], 0
    buffer_load_dwordx4 v9, s[8:11], s38 offen offset:3168 nt lds
    v_mfma_f32_16x16x32_bf16 a[216:219], a[56:59], a[120:123], a[216:219]
    s_mov_b32 m0, s94
    v_cvt_pk_bf16_f32 v166, v204, v205
    v_cvt_pk_bf16_f32 v167, v206, v207
    v_mfma_f32_16x16x32_bf16 a[248:251], a[56:59], a[124:127], 0
    s_min_i32 s38, s39, 524288
    v_add_u32 v5, s32, v3
    v_permlane32_swap_b32 v160, v162
    v_mfma_f32_16x16x32_bf16 a[248:251], a[24:27], a[108:111], a[248:251]
    ds_read_b64_tr_b16 v[64:65], v5 offset:8448
    ds_read_b64_tr_b16 v[66:67], v5 offset:8960
    v_mfma_f32_16x16x32_bf16 a[156:159], a[28:31], a[96:99], 0
    ds_read_b64_tr_b16 v[68:69], v5 offset:8480
    ds_read_b64_tr_b16 v[70:71], v5 offset:8992
    v_mfma_f32_16x16x32_bf16 a[156:159], a[60:63], a[112:115], a[156:159]
    ds_read_b64_tr_b16 v[72:73], v5 offset:8512
    ds_read_b64_tr_b16 v[74:75], v5 offset:9024
    v_mfma_f32_16x16x32_bf16 a[188:191], a[60:63], a[116:119], 0
    ds_read_b64_tr_b16 v[76:77], v5 offset:8544
    ds_read_b64_tr_b16 v[78:79], v5 offset:9056
    v_mfma_f32_16x16x32_bf16 a[188:191], a[28:31], a[100:103], a[188:191]
    ds_read_b64_tr_b16 v[80:81], v5 offset:8576
    ds_read_b64_tr_b16 v[82:83], v5 offset:9088
    v_mfma_f32_16x16x32_bf16 a[220:223], a[28:31], a[104:107], 0
    ds_read_b64_tr_b16 v[84:85], v5 offset:8608
    ds_read_b64_tr_b16 v[86:87], v5 offset:9120
    v_mfma_f32_16x16x32_bf16 a[220:223], a[60:63], a[120:123], a[220:223]
    ds_read_b64_tr_b16 v[88:89], v5 offset:8640
    ds_read_b64_tr_b16 v[90:91], v5 offset:9152
    v_mfma_f32_16x16x32_bf16 a[252:255], a[60:63], a[124:127], 0
    ds_read_b64_tr_b16 v[92:93], v5 offset:8672
    ds_read_b64_tr_b16 v[94:95], v5 offset:9184
    v_mfma_f32_16x16x32_bf16 a[252:255], a[28:31], a[108:111], a[252:255]
    v_permlane32_swap_b32 v161, v163
    v_permlane16_swap_b32 v160, v162
    v_mfma_f32_16x16x32_bf16 v[192:195], v[32:35], v[128:131], 0
    v_permlane16_swap_b32 v161, v163
    v_mul_f32 v208, s46, v208
    v_mfma_f32_16x16x32_bf16 v[192:195], v[36:39], v[132:135], v[192:195]
    v_mul_f32 v209, s46, v209
    v_mul_f32 v210, s46, v210
    v_mfma_f32_16x16x32_bf16 v[192:195], v[40:43], v[136:139], v[192:195]
    v_mul_f32 v211, s46, v211
    v_mul_f32 v212, s46, v212
    v_mfma_f32_16x16x32_bf16 v[192:195], v[44:47], v[140:143], v[192:195]
    v_mul_f32 v213, s46, v213
    v_mul_f32 v214, s46, v214
    v_mfma_f32_16x16x32_bf16 v[196:199], v[60:63], v[140:143], 0
    v_mul_f32 v215, s46, v215
    v_permlane32_swap_b32 v164, v166
    v_mfma_f32_16x16x32_bf16 v[196:199], v[56:59], v[136:139], v[196:199]
    v_permlane32_swap_b32 v165, v167
    v_cvt_pk_bf16_f32 v168, v208, v209
    v_mfma_f32_16x16x32_bf16 v[196:199], v[52:55], v[132:135], v[196:199]
    v_cvt_pk_bf16_f32 v169, v210, v211
    v_cvt_pk_bf16_f32 v170, v212, v213
    v_mfma_f32_16x16x32_bf16 v[196:199], v[48:51], v[128:131], v[196:199]
    v_cvt_pk_bf16_f32 v171, v214, v215
    v_permlane16_swap_b32 v164, v166
    v_mfma_f32_16x16x32_bf16 v[200:203], v[32:35], v[144:147], 0
    v_permlane16_swap_b32 v165, v167
    v_mul_f32 v216, s46, v216
    v_mfma_f32_16x16x32_bf16 v[200:203], v[36:39], v[148:151], v[200:203]
    v_mul_f32 v217, s46, v217
    v_mul_f32 v218, s46, v218
    v_mfma_f32_16x16x32_bf16 v[200:203], v[40:43], v[152:155], v[200:203]
    v_mul_f32 v219, s46, v219
    v_mul_f32 v220, s46, v220
    v_mfma_f32_16x16x32_bf16 v[200:203], v[44:47], v[156:159], v[200:203]
    v_mul_f32 v221, s46, v221
    v_mul_f32 v222, s46, v222
    v_mfma_f32_16x16x32_bf16 v[204:207], v[60:63], v[156:159], 0
    v_mul_f32 v223, s46, v223
    v_mul_f32 v240, s46, v240
    v_mfma_f32_16x16x32_bf16 v[204:207], v[56:59], v[152:155], v[204:207]
    v_mul_f32 v241, s46, v241
    v_permlane32_swap_b32 v168, v170
    v_mfma_f32_16x16x32_bf16 v[204:207], v[52:55], v[148:151], v[204:207]
    v_permlane32_swap_b32 v169, v171
    v_cvt_pk_bf16_f32 v172, v216, v217
    v_mfma_f32_16x16x32_bf16 v[204:207], v[48:51], v[144:147], v[204:207]
    v_cvt_pk_bf16_f32 v173, v218, v219
    v_cvt_pk_bf16_f32 v174, v220, v221
    v_mfma_f32_16x16x32_bf16 v[208:211], v[32:35], v[160:163], 0
    v_cvt_pk_bf16_f32 v175, v222, v223
    v_cvt_pk_bf16_f32 v184, v240, v241
    v_mfma_f32_16x16x32_bf16 v[208:211], v[36:39], v[164:167], v[208:211]
    v_max3_f32 v240, v192, v193, v194
    v_permlane16_swap_b32 v168, v170
    v_permlane16_swap_b32 v169, v171
    v_permlane32_swap_b32 v172, v174
    v_permlane32_swap_b32 v173, v175
    v_mfma_f32_16x16x32_bf16 v[208:211], v[40:43], v[168:171], v[208:211]
    v_max3_f32 v241, v195, v196, v197
    v_max3_f32 v240, v240, v198, v199
    v_permlane16_swap_b32 v172, v174
    v_max_f32 v240, v240, v241
    v_permlane16_swap_b32 v173, v175
    v_mov_b32 v241, v240
    v_mul_f32 v224, s46, v224
    v_mfma_f32_16x16x32_bf16 v[208:211], v[44:47], v[172:175], v[208:211]
    v_permlane32_swap_b32 v240, v241
    v_mul_f32 v225, s46, v225
    v_mfma_f32_16x16x32_bf16 v[212:215], v[60:63], v[172:175], 0
    v_max_f32 v240, v240, v241
    v_mul_f32 v226, s46, v226
    v_mfma_f32_16x16x32_bf16 v[212:215], v[56:59], v[168:171], v[212:215]
    v_mov_b32 v241, v240
    v_mul_f32 v227, s46, v227
    v_mfma_f32_16x16x32_bf16 v[212:215], v[52:55], v[164:167], v[212:215]
    v_permlane16_swap_b32 v240, v241
    v_cvt_pk_bf16_f32 v176, v224, v225
    v_mfma_f32_16x16x32_bf16 v[212:215], v[48:51], v[160:163], v[212:215]
    s_waitcnt lgkmcnt(14)
    v_max_f32 v240, v240, v241
    v_cvt_pk_bf16_f32 v177, v226, v227
    v_sub_f32 v192, v192, v240
    v_sub_f32 v193, v193, v240
    v_sub_f32 v194, v194, v240
    v_sub_f32 v195, v195, v240
    v_sub_f32 v196, v196, v240
    v_sub_f32 v197, v197, v240
    v_sub_f32 v198, v198, v240
    v_sub_f32 v199, v199, v240
    v_exp_f32 v192, v192
    v_exp_f32 v193, v193
    v_exp_f32 v194, v194
    v_exp_f32 v195, v195
    v_exp_f32 v196, v196
    v_exp_f32 v197, v197
    v_exp_f32 v198, v198
    v_exp_f32 v199, v199
    v_cvt_pk_bf16_f32 v224, v192, v193
    v_cvt_pk_bf16_f32 v225, v194, v195
    v_cvt_pk_bf16_f32 v226, v196, v197
    v_cvt_pk_bf16_f32 v227, v198, v199
    v_mul_f32 v228, s46, v228
    v_mul_f32 v229, s46, v229
    v_mfma_f32_16x16x32_bf16 a[0:3], v[64:67], v[224:227], 0
    s_waitcnt lgkmcnt(12)
    v_mul_f32 v230, s46, v230
    v_mul_f32 v231, s46, v231
    v_mfma_f32_16x16x32_bf16 a[4:7], v[68:71], v[224:227], 0
    s_waitcnt lgkmcnt(10)
    v_cvt_pk_bf16_f32 v178, v228, v229
    v_cvt_pk_bf16_f32 v179, v230, v231
    v_mfma_f32_16x16x32_bf16 a[8:11], v[72:75], v[224:227], 0
    s_waitcnt lgkmcnt(8)
    v_mov_b32 v96, 0x3f803f80
    v_mov_b32 v97, 0x3f803f80
    v_mfma_f32_16x16x32_bf16 a[12:15], v[76:79], v[224:227], 0
    s_waitcnt lgkmcnt(6)
    v_mov_b32 v98, 0x3f803f80
    v_mov_b32 v99, 0x3f803f80
    v_mfma_f32_16x16x32_bf16 a[16:19], v[80:83], v[224:227], 0
    s_waitcnt lgkmcnt(4)
    v_mul_f32 v232, s46, v232
    v_mul_f32 v233, s46, v233
    v_mfma_f32_16x16x32_bf16 a[20:23], v[84:87], v[224:227], 0
    s_waitcnt lgkmcnt(2)
    v_mul_f32 v234, s46, v234
    v_mul_f32 v235, s46, v235
    v_mfma_f32_16x16x32_bf16 a[24:27], v[88:91], v[224:227], 0
    s_waitcnt lgkmcnt(0)
    v_mul_f32 v236, s46, v236
    v_mul_f32 v237, s46, v237
    v_mfma_f32_16x16x32_bf16 a[28:31], v[92:95], v[224:227], 0
    v_mul_f32 v238, s46, v238
    v_mul_f32 v239, s46, v239
    v_mfma_f32_16x16x32_bf16 v[100:103], v[96:99], v[224:227], 0
    v_permlane32_swap_b32 v176, v178
    v_permlane32_swap_b32 v177, v179
    v_cvt_pk_bf16_f32 v180, v232, v233
    v_cvt_pk_bf16_f32 v181, v234, v235
    v_cvt_pk_bf16_f32 v182, v236, v237
    v_cvt_pk_bf16_f32 v183, v238, v239
    v_permlane16_swap_b32 v176, v178
    v_permlane16_swap_b32 v177, v179
    v_mul_f32 v242, s46, v242
    v_mul_f32 v243, s46, v243
    v_mfma_f32_16x16x32_bf16 v[216:219], v[32:35], v[176:179], 0
    v_mul_f32 v244, s46, v244
    v_mul_f32 v245, s46, v245
    v_mul_f32 v246, s46, v246
    v_mul_f32 v247, s46, v247
    v_permlane32_swap_b32 v180, v182
    v_permlane32_swap_b32 v181, v183
    v_cvt_pk_bf16_f32 v185, v242, v243
    v_cvt_pk_bf16_f32 v186, v244, v245
    v_cvt_pk_bf16_f32 v187, v246, v247
    v_permlane16_swap_b32 v180, v182
    v_permlane16_swap_b32 v181, v183
    v_mul_f32 v248, s46, v248
    v_mul_f32 v249, s46, v249
    v_mfma_f32_16x16x32_bf16 v[216:219], v[36:39], v[180:183], v[216:219]
    v_mul_f32 v250, s46, v250
    v_mul_f32 v251, s46, v251
    v_mul_f32 v252, s46, v252
    v_mul_f32 v253, s46, v253
    v_mul_f32 v254, s46, v254
    v_mul_f32 v255, s46, v255
    v_permlane32_swap_b32 v184, v186
    v_permlane32_swap_b32 v185, v187
    v_cvt_pk_bf16_f32 v188, v248, v249
    v_cvt_pk_bf16_f32 v189, v250, v251
    v_cvt_pk_bf16_f32 v190, v252, v253
    v_cvt_pk_bf16_f32 v191, v254, v255
    v_max3_f32 v244, v200, v201, v202
    v_permlane16_swap_b32 v184, v186
    v_permlane16_swap_b32 v185, v187
    v_permlane32_swap_b32 v188, v190
    v_permlane32_swap_b32 v189, v191
    v_mfma_f32_16x16x32_bf16 v[216:219], v[40:43], v[184:187], v[216:219]
    v_max3_f32 v245, v203, v204, v205
    v_max3_f32 v244, v244, v206, v207
    v_permlane16_swap_b32 v188, v190
    v_max_f32 v244, v244, v245
    v_permlane16_swap_b32 v189, v191
    v_mov_b32 v245, v244
    v_add_u32 v4, s32, v2
    v_mfma_f32_16x16x32_bf16 v[216:219], v[44:47], v[188:191], v[216:219]
    s_add_u32 s32, s32, 16896
    ds_read_b128 v[32:35], v4 offset:0
    ds_read_b128 v[36:39], v4 offset:64
    v_mfma_f32_16x16x32_bf16 v[220:223], v[60:63], v[188:191], 0
    s_cmp_ge_u32 s32, 84480
    s_cselect_b32 s32, 0, s32
    ds_read_b128 v[40:43], v4 offset:128
    v_mfma_f32_16x16x32_bf16 v[220:223], v[56:59], v[184:187], v[220:223]
    ds_read_b128 v[44:47], v4 offset:192
    ds_read_b128 v[60:63], v4 offset:704
    v_mfma_f32_16x16x32_bf16 v[220:223], v[52:55], v[180:183], v[220:223]
    ds_read_b128 v[56:59], v4 offset:640
    ds_read_b128 v[52:55], v4 offset:576
    v_mfma_f32_16x16x32_bf16 v[220:223], v[48:51], v[176:179], v[220:223]
    ds_read_b128 v[48:51], v4 offset:512
    v_permlane32_swap_b32 v244, v245
    v_sub_f32 v241, 0, v240
    v_max_f32 v244, v244, v245
    v_sub_f32 v242, 0, v240
    v_mov_b32 v245, v244
    v_sub_f32 v243, 0, v240
    v_sub_f32 v240, 0, v240
    v_permlane16_swap_b32 v244, v245
    v_max3_f32 v248, v208, v209, v210
    v_max_f32 v244, v244, v245
    v_max3_f32 v249, v211, v212, v213
    v_sub_f32 v200, v200, v244
    v_sub_f32 v201, v201, v244
    v_sub_f32 v202, v202, v244
    v_sub_f32 v203, v203, v244
    v_sub_f32 v204, v204, v244
    v_sub_f32 v205, v205, v244
    v_sub_f32 v206, v206, v244
    v_sub_f32 v207, v207, v244
    v_exp_f32 v200, v200
    v_exp_f32 v201, v201
    v_exp_f32 v202, v202
    v_exp_f32 v203, v203
    v_exp_f32 v204, v204
    v_exp_f32 v205, v205
    v_exp_f32 v206, v206
    v_exp_f32 v207, v207
    v_cvt_pk_bf16_f32 v228, v200, v201
    v_cvt_pk_bf16_f32 v229, v202, v203
    v_cvt_pk_bf16_f32 v230, v204, v205
    v_cvt_pk_bf16_f32 v231, v206, v207
    v_max3_f32 v248, v248, v214, v215
    v_sub_f32 v245, 0, v244
    v_mfma_f32_16x16x32_bf16 a[32:35], v[64:67], v[228:231], 0
    s_waitcnt vmcnt(32) lgkmcnt(0)
    s_barrier
    v_mfma_f32_16x16x32_bf16 a[36:39], v[68:71], v[228:231], 0
    buffer_load_dwordx4 v6, s[8:11], s38 offen offset:0 nt lds
    v_mfma_f32_16x16x32_bf16 a[40:43], v[72:75], v[228:231], 0
    v_max_f32 v248, v248, v249
    v_sub_f32 v246, 0, v244
    v_mfma_f32_16x16x32_bf16 a[44:47], v[76:79], v[228:231], 0
    v_mov_b32 v249, v248
    v_sub_f32 v247, 0, v244
    v_mfma_f32_16x16x32_bf16 a[48:51], v[80:83], v[228:231], 0
    v_permlane32_swap_b32 v248, v249
    v_sub_f32 v244, 0, v244
    v_mfma_f32_16x16x32_bf16 a[52:55], v[84:87], v[228:231], 0
    buffer_load_dwordx4 v7, s[8:11], s38 offen offset:1056 nt lds
    v_mfma_f32_16x16x32_bf16 a[56:59], v[88:91], v[228:231], 0
    v_max_f32 v248, v248, v249
    v_max3_f32 v252, v216, v217, v218
    v_mfma_f32_16x16x32_bf16 a[60:63], v[92:95], v[228:231], 0
    v_mov_b32 v249, v248
    v_max3_f32 v253, v219, v220, v221
    v_mfma_f32_16x16x32_bf16 v[104:107], v[96:99], v[228:231], 0
    v_permlane16_swap_b32 v248, v249
    v_max3_f32 v252, v252, v222, v223
    v_mfma_f32_16x16x32_bf16 v[192:195], v[32:35], v[128:131], v[240:243]
    buffer_load_dwordx4 v8, s[8:11], s38 offen offset:2112 nt lds
    v_mfma_f32_16x16x32_bf16 v[192:195], v[36:39], v[132:135], v[192:195]
    v_max_f32 v248, v248, v249
    v_max_f32 v252, v252, v253
    v_mfma_f32_16x16x32_bf16 v[192:195], v[40:43], v[136:139], v[192:195]
    v_sub_f32 v208, v208, v248
    v_sub_f32 v209, v209, v248
    v_mfma_f32_16x16x32_bf16 v[192:195], v[44:47], v[140:143], v[192:195]
    v_sub_f32 v210, v210, v248
    v_sub_f32 v211, v211, v248
    v_mfma_f32_16x16x32_bf16 v[196:199], v[60:63], v[140:143], v[240:243]
    buffer_load_dwordx4 v9, s[8:11], s38 offen offset:3168 nt lds
    v_mfma_f32_16x16x32_bf16 v[196:199], v[56:59], v[136:139], v[196:199]
    v_sub_f32 v212, v212, v248
    v_sub_f32 v213, v213, v248
    v_mfma_f32_16x16x32_bf16 v[196:199], v[52:55], v[132:135], v[196:199]
    v_sub_f32 v214, v214, v248
    v_sub_f32 v215, v215, v248
    v_mfma_f32_16x16x32_bf16 v[196:199], v[48:51], v[128:131], v[196:199]
    v_exp_f32 v208, v208
    v_exp_f32 v209, v209
    v_exp_f32 v210, v210
    v_exp_f32 v211, v211
    v_exp_f32 v212, v212
    v_exp_f32 v213, v213
    v_exp_f32 v214, v214
    v_exp_f32 v215, v215
    v_cvt_pk_bf16_f32 v232, v208, v209
    v_cvt_pk_bf16_f32 v233, v210, v211
    v_cvt_pk_bf16_f32 v234, v212, v213
    v_cvt_pk_bf16_f32 v235, v214, v215
    v_mov_b32 v253, v252
    v_add_u32 v5, s32, v3
    v_mfma_f32_16x16x32_bf16 a[64:67], v[64:67], v[232:235], 0
    v_permlane32_swap_b32 v252, v253
    v_sub_f32 v249, 0, v248
    v_mfma_f32_16x16x32_bf16 a[68:71], v[68:71], v[232:235], 0
    v_max_f32 v252, v252, v253
    v_sub_f32 v250, 0, v248
    v_mfma_f32_16x16x32_bf16 a[72:75], v[72:75], v[232:235], 0
    v_mov_b32 v253, v252
    v_sub_f32 v251, 0, v248
    v_mfma_f32_16x16x32_bf16 a[76:79], v[76:79], v[232:235], 0
    v_permlane16_swap_b32 v252, v253
    v_sub_f32 v248, 0, v248
    v_mfma_f32_16x16x32_bf16 a[80:83], v[80:83], v[232:235], 0
    v_max_f32 v252, v252, v253
    v_add_u32 v4, s32, v2
    v_mfma_f32_16x16x32_bf16 a[84:87], v[84:87], v[232:235], 0
    v_sub_f32 v216, v216, v252
    v_sub_f32 v217, v217, v252
    v_mfma_f32_16x16x32_bf16 a[88:91], v[88:91], v[232:235], 0
    v_sub_f32 v218, v218, v252
    v_sub_f32 v219, v219, v252
    v_mfma_f32_16x16x32_bf16 a[92:95], v[92:95], v[232:235], 0
    v_sub_f32 v220, v220, v252
    v_sub_f32 v221, v221, v252
    v_mfma_f32_16x16x32_bf16 v[108:111], v[96:99], v[232:235], 0
    v_sub_f32 v222, v222, v252
    v_sub_f32 v223, v223, v252
    v_mfma_f32_16x16x32_bf16 v[200:203], v[32:35], v[144:147], v[244:247]
    v_exp_f32 v216, v216
    v_mfma_f32_16x16x32_bf16 v[200:203], v[36:39], v[148:151], v[200:203]
    v_exp_f32 v217, v217
    v_mfma_f32_16x16x32_bf16 v[200:203], v[40:43], v[152:155], v[200:203]
    v_exp_f32 v218, v218
    v_mfma_f32_16x16x32_bf16 v[200:203], v[44:47], v[156:159], v[200:203]
    v_exp_f32 v219, v219
    v_mfma_f32_16x16x32_bf16 v[204:207], v[60:63], v[156:159], v[244:247]
    v_exp_f32 v220, v220
    v_mfma_f32_16x16x32_bf16 v[204:207], v[56:59], v[152:155], v[204:207]
    v_exp_f32 v221, v221
    v_mfma_f32_16x16x32_bf16 v[204:207], v[52:55], v[148:151], v[204:207]
    v_exp_f32 v222, v222
    v_mfma_f32_16x16x32_bf16 v[204:207], v[48:51], v[144:147], v[204:207]
    v_exp_f32 v223, v223
    v_cvt_pk_bf16_f32 v236, v216, v217
    v_cvt_pk_bf16_f32 v237, v218, v219
    v_cvt_pk_bf16_f32 v238, v220, v221
    v_cvt_pk_bf16_f32 v239, v222, v223
    v_exp_f32 v192, v192
    s_nop 0
    v_mfma_f32_16x16x32_bf16 a[96:99], v[64:67], v[236:239], 0
    ds_read_b64_tr_b16 v[64:65], v5 offset:8448
    ds_read_b64_tr_b16 v[66:67], v5 offset:8960
    v_mfma_f32_16x16x32_bf16 a[100:103], v[68:71], v[236:239], 0
    ds_read_b64_tr_b16 v[68:69], v5 offset:8480
    ds_read_b64_tr_b16 v[70:71], v5 offset:8992
    v_mfma_f32_16x16x32_bf16 a[104:107], v[72:75], v[236:239], 0
    ds_read_b64_tr_b16 v[72:73], v5 offset:8512
    ds_read_b64_tr_b16 v[74:75], v5 offset:9024
    v_mfma_f32_16x16x32_bf16 a[108:111], v[76:79], v[236:239], 0
    ds_read_b64_tr_b16 v[76:77], v5 offset:8544
    ds_read_b64_tr_b16 v[78:79], v5 offset:9056
    v_mfma_f32_16x16x32_bf16 a[112:115], v[80:83], v[236:239], 0
    ds_read_b64_tr_b16 v[80:81], v5 offset:8576
    ds_read_b64_tr_b16 v[82:83], v5 offset:9088
    v_mfma_f32_16x16x32_bf16 a[116:119], v[84:87], v[236:239], 0
    ds_read_b64_tr_b16 v[84:85], v5 offset:8608
    ds_read_b64_tr_b16 v[86:87], v5 offset:9120
    v_mfma_f32_16x16x32_bf16 a[120:123], v[88:91], v[236:239], 0
    ds_read_b64_tr_b16 v[88:89], v5 offset:8640
    ds_read_b64_tr_b16 v[90:91], v5 offset:9152
    v_mfma_f32_16x16x32_bf16 a[124:127], v[92:95], v[236:239], 0
    ds_read_b64_tr_b16 v[92:93], v5 offset:8672
    ds_read_b64_tr_b16 v[94:95], v5 offset:9184
    v_mfma_f32_16x16x32_bf16 v[112:115], v[96:99], v[236:239], 0
    v_exp_f32 v193, v193
    v_mfma_f32_16x16x32_bf16 v[208:211], v[32:35], v[160:163], v[248:251]
    v_exp_f32 v194, v194
    v_mfma_f32_16x16x32_bf16 v[208:211], v[36:39], v[164:167], v[208:211]
    v_exp_f32 v195, v195
    v_mfma_f32_16x16x32_bf16 v[208:211], v[40:43], v[168:171], v[208:211]
    v_exp_f32 v196, v196
    v_mfma_f32_16x16x32_bf16 v[208:211], v[44:47], v[172:175], v[208:211]
    v_exp_f32 v197, v197
    v_mfma_f32_16x16x32_bf16 v[212:215], v[60:63], v[172:175], v[248:251]
    v_exp_f32 v198, v198
    v_mfma_f32_16x16x32_bf16 v[212:215], v[56:59], v[168:171], v[212:215]
    v_exp_f32 v199, v199
    v_mfma_f32_16x16x32_bf16 v[212:215], v[52:55], v[164:167], v[212:215]
    v_cvt_pk_bf16_f32 v224, v192, v193
    v_cvt_pk_bf16_f32 v225, v194, v195
    v_mfma_f32_16x16x32_bf16 v[212:215], v[48:51], v[160:163], v[212:215]
    s_waitcnt lgkmcnt(14)
    v_cvt_pk_bf16_f32 v226, v196, v197
    v_cvt_pk_bf16_f32 v227, v198, v199
    v_sub_f32 v253, 0, v252
    v_sub_f32 v254, 0, v252
    v_mfma_f32_16x16x32_bf16 a[0:3], v[64:67], v[224:227], a[0:3]
    s_waitcnt lgkmcnt(12)
    v_sub_f32 v255, 0, v252
    v_sub_f32 v252, 0, v252
    v_mfma_f32_16x16x32_bf16 a[4:7], v[68:71], v[224:227], a[4:7]
    s_waitcnt lgkmcnt(10)
    v_exp_f32 v200, v200
    v_mfma_f32_16x16x32_bf16 a[8:11], v[72:75], v[224:227], a[8:11]
    s_waitcnt lgkmcnt(8)
    v_exp_f32 v201, v201
    v_mfma_f32_16x16x32_bf16 a[12:15], v[76:79], v[224:227], a[12:15]
    s_waitcnt lgkmcnt(6)
    v_exp_f32 v202, v202
    v_mfma_f32_16x16x32_bf16 a[16:19], v[80:83], v[224:227], a[16:19]
    s_waitcnt lgkmcnt(4)
    v_exp_f32 v203, v203
    v_mfma_f32_16x16x32_bf16 a[20:23], v[84:87], v[224:227], a[20:23]
    s_waitcnt lgkmcnt(2)
    v_exp_f32 v204, v204
    v_mfma_f32_16x16x32_bf16 a[24:27], v[88:91], v[224:227], a[24:27]
    s_waitcnt lgkmcnt(0)
    v_exp_f32 v205, v205
    v_mfma_f32_16x16x32_bf16 a[28:31], v[92:95], v[224:227], a[28:31]
    v_exp_f32 v206, v206
    v_mfma_f32_16x16x32_bf16 v[100:103], v[96:99], v[224:227], v[100:103]
    v_exp_f32 v207, v207
    v_mfma_f32_16x16x32_bf16 v[216:219], v[32:35], v[176:179], v[252:255]
    ds_read_b128 v[32:35], v4 offset:0
    v_cvt_pk_bf16_f32 v228, v200, v201
    v_mfma_f32_16x16x32_bf16 v[216:219], v[36:39], v[180:183], v[216:219]
    ds_read_b128 v[36:39], v4 offset:64
    v_cvt_pk_bf16_f32 v229, v202, v203
    v_mfma_f32_16x16x32_bf16 v[216:219], v[40:43], v[184:187], v[216:219]
    ds_read_b128 v[40:43], v4 offset:128
    v_cvt_pk_bf16_f32 v230, v204, v205
    v_mfma_f32_16x16x32_bf16 v[216:219], v[44:47], v[188:191], v[216:219]
    ds_read_b128 v[44:47], v4 offset:192
    v_cvt_pk_bf16_f32 v231, v206, v207
    v_mfma_f32_16x16x32_bf16 v[220:223], v[60:63], v[188:191], v[252:255]
    ds_read_b128 v[60:63], v4 offset:704
    v_add_u32 v10, s57, v10
    v_mfma_f32_16x16x32_bf16 v[220:223], v[56:59], v[184:187], v[220:223]
    ds_read_b128 v[56:59], v4 offset:640
    v_add_u32 v11, s57, v11
    v_mfma_f32_16x16x32_bf16 v[220:223], v[52:55], v[180:183], v[220:223]
    s_bfe_u32 s57, s97, 0x40000
    ds_read_b128 v[52:55], v4 offset:576
    v_and_b32 v22, 7, v1
    v_mfma_f32_16x16x32_bf16 v[220:223], v[48:51], v[176:179], v[220:223]
    s_lshl_b32 s36, s57, 19
    ds_read_b128 v[48:51], v4 offset:512
    v_add_u32 v21, 84480, v3
    v_mfma_f32_16x16x32_bf16 a[32:35], v[64:67], v[228:231], a[32:35]
    v_exp_f32 v208, v208
    v_mfma_f32_16x16x32_bf16 a[36:39], v[68:71], v[228:231], a[36:39]
    v_exp_f32 v209, v209
    v_mfma_f32_16x16x32_bf16 a[40:43], v[72:75], v[228:231], a[40:43]
    v_exp_f32 v210, v210
    v_mfma_f32_16x16x32_bf16 a[44:47], v[76:79], v[228:231], a[44:47]
    v_exp_f32 v211, v211
    v_mfma_f32_16x16x32_bf16 a[48:51], v[80:83], v[228:231], a[48:51]
    v_exp_f32 v212, v212
    v_mfma_f32_16x16x32_bf16 a[52:55], v[84:87], v[228:231], a[52:55]
    v_exp_f32 v213, v213
    v_mfma_f32_16x16x32_bf16 a[56:59], v[88:91], v[228:231], a[56:59]
    v_exp_f32 v214, v214
    v_mfma_f32_16x16x32_bf16 a[60:63], v[92:95], v[228:231], a[60:63]
    v_exp_f32 v215, v215
    v_mfma_f32_16x16x32_bf16 v[104:107], v[96:99], v[228:231], v[104:107]
    v_mul_u32_u24 v22, 80, v22
    v_cvt_pk_bf16_f32 v232, v208, v209
    v_cvt_pk_bf16_f32 v233, v210, v211
    v_cvt_pk_bf16_f32 v234, v212, v213
    v_cvt_pk_bf16_f32 v235, v214, v215
    v_exp_f32 v216, v216
    v_exp_f32 v217, v217
    v_exp_f32 v218, v218
    v_exp_f32 v219, v219
    v_exp_f32 v220, v220
    v_exp_f32 v221, v221
    v_exp_f32 v222, v222
    s_mov_b32 s44, 0
    s_waitcnt lgkmcnt(0)
.p2align 6
L1v4_wloop:
    v_mfma_f32_16x16x32_bf16 v[192:195], v[32:35], v[128:131], v[240:243]
    s_waitcnt vmcnt(8) lgkmcnt(0)
    s_barrier
    v_mfma_f32_16x16x32_bf16 v[192:195], v[36:39], v[132:135], v[192:195]
    s_add_u32 s94, s32, s34
    ds_read_b128 v[116:119], v18 offset:0
    v_cvt_pk_bf16_f32 v236, v216, v217
    v_mfma_f32_16x16x32_bf16 v[192:195], v[40:43], v[136:139], v[192:195]
    s_add_u32 s32, s32, 16896
    ds_read_b128 v[124:127], v18 offset:2048
    v_cvt_pk_bf16_f32 v237, v218, v219
    v_mfma_f32_16x16x32_bf16 v[192:195], v[44:47], v[140:143], v[192:195]
    s_cmp_ge_u32 s32, 84480
    s_cselect_b32 s32, 0, s32
    ds_read_b128 v[28:31], v18 offset:4096
    v_mfma_f32_16x16x32_bf16 v[196:199], v[60:63], v[140:143], v[240:243]
    s_add_u32 m0, s100, 8448
    ds_read_b128 v[24:27], v18 offset:6144
    v_cvt_pk_bf16_f32 v238, v220, v221
    v_mfma_f32_16x16x32_bf16 v[196:199], v[56:59], v[136:139], v[196:199]
    s_add_u32 s36, s36, 262144
    buffer_load_dwordx4 v10, s[4:7], s36 offen offset:0 lds
    v_mfma_f32_16x16x32_bf16 v[196:199], v[52:55], v[132:135], v[196:199]
    s_max_i32 s39, s35, 0
    v_exp_f32 v223, v223
    v_mfma_f32_16x16x32_bf16 v[196:199], v[48:51], v[128:131], v[196:199]
    s_min_i32 s38, s39, 524288
    v_cvt_pk_bf16_f32 v239, v222, v223
    v_add_u32 v5, s32, v3
    v_mfma_f32_16x16x32_bf16 a[64:67], v[64:67], v[232:235], a[64:67]
    s_add_i32 s35, s35, 8192
    v_exp_f32 v192, v192
    v_mfma_f32_16x16x32_bf16 a[68:71], v[68:71], v[232:235], a[68:71]
    s_max_i32 s39, s35, 0
    v_exp_f32 v193, v193
    v_mfma_f32_16x16x32_bf16 a[72:75], v[72:75], v[232:235], a[72:75]
    s_sub_u32 s42, s42, s43
    v_exp_f32 v194, v194
    v_mfma_f32_16x16x32_bf16 a[76:79], v[76:79], v[232:235], a[76:79]
    s_add_i32 s35, s35, 8192
    v_exp_f32 v195, v195
    v_mfma_f32_16x16x32_bf16 a[80:83], v[80:83], v[232:235], a[80:83]
    v_exp_f32 v196, v196
    v_mfma_f32_16x16x32_bf16 a[84:87], v[84:87], v[232:235], a[84:87]
    buffer_load_dwordx4 v11, s[4:7], s36 offen offset:1056 lds
    v_mfma_f32_16x16x32_bf16 a[88:91], v[88:91], v[232:235], a[88:91]
    s_mov_b32 m0, s94
    v_exp_f32 v197, v197
    v_mfma_f32_16x16x32_bf16 a[92:95], v[92:95], v[232:235], a[92:95]
    s_lshl_b32 s36, s98, 19
    v_exp_f32 v198, v198
    v_mfma_f32_16x16x32_bf16 v[108:111], v[96:99], v[232:235], v[108:111]
    s_add_u32 s94, s32, s34
    v_exp_f32 v199, v199
    v_mfma_f32_16x16x32_bf16 v[200:203], v[32:35], v[144:147], v[244:247]
    s_lshr_b32 s98, s96, 28
    v_cvt_pk_bf16_f32 v224, v192, v193
    v_cvt_pk_bf16_f32 v225, v194, v195
    v_mfma_f32_16x16x32_bf16 v[200:203], v[36:39], v[148:151], v[200:203]
    s_lshl_b32 s40, s98, 7
    v_cvt_pk_bf16_f32 v226, v196, v197
    v_cvt_pk_bf16_f32 v227, v198, v199
    v_mfma_f32_16x16x32_bf16 v[200:203], v[40:43], v[152:155], v[200:203]
    s_lshl_b32 s96, s96, 4
    v_add_u32 v4, s32, v2
    s_add_u32 s32, s32, 16896
    v_mfma_f32_16x16x32_bf16 v[200:203], v[44:47], v[156:159], v[200:203]
    s_cmp_ge_u32 s32, 84480
    s_cselect_b32 s32, 0, s32
    v_add_u32 v18, s43, v18
    v_mfma_f32_16x16x32_bf16 v[204:207], v[60:63], v[156:159], v[244:247]
    buffer_load_dword v23, v22, s[60:63], s58 offen
    v_mfma_f32_16x16x32_bf16 v[204:207], v[56:59], v[152:155], v[204:207]
    s_add_u32 s58, s58, 640
    v_mfma_f32_16x16x32_bf16 v[204:207], v[52:55], v[148:151], v[204:207]
    v_exp_f32 v200, v200
    v_mfma_f32_16x16x32_bf16 v[204:207], v[48:51], v[144:147], v[204:207]
    v_exp_f32 v201, v201
    v_mfma_f32_16x16x32_bf16 a[96:99], v[64:67], v[236:239], a[96:99]
    ds_read_b64_tr_b16 v[64:65], v5 offset:8448
    ds_read_b64_tr_b16 v[66:67], v5 offset:8960
    v_mfma_f32_16x16x32_bf16 a[100:103], v[68:71], v[236:239], a[100:103]
    ds_read_b64_tr_b16 v[68:69], v5 offset:8480
    ds_read_b64_tr_b16 v[70:71], v5 offset:8992
    v_mfma_f32_16x16x32_bf16 a[104:107], v[72:75], v[236:239], a[104:107]
    ds_read_b64_tr_b16 v[72:73], v5 offset:8512
    ds_read_b64_tr_b16 v[74:75], v5 offset:9024
    v_mfma_f32_16x16x32_bf16 a[108:111], v[76:79], v[236:239], a[108:111]
    ds_read_b64_tr_b16 v[76:77], v5 offset:8544
    ds_read_b64_tr_b16 v[78:79], v5 offset:9056
    v_mfma_f32_16x16x32_bf16 a[112:115], v[80:83], v[236:239], a[112:115]
    ds_read_b64_tr_b16 v[80:81], v5 offset:8576
    ds_read_b64_tr_b16 v[82:83], v5 offset:9088
    v_mfma_f32_16x16x32_bf16 a[116:119], v[84:87], v[236:239], a[116:119]
    ds_read_b64_tr_b16 v[84:85], v5 offset:8608
    ds_read_b64_tr_b16 v[86:87], v5 offset:9120
    v_mfma_f32_16x16x32_bf16 a[120:123], v[88:91], v[236:239], a[120:123]
    ds_read_b64_tr_b16 v[88:89], v5 offset:8640
    ds_read_b64_tr_b16 v[90:91], v5 offset:9152
    v_mfma_f32_16x16x32_bf16 a[124:127], v[92:95], v[236:239], a[124:127]
    ds_read_b64_tr_b16 v[92:93], v5 offset:8672
    ds_read_b64_tr_b16 v[94:95], v5 offset:9184
    v_mfma_f32_16x16x32_bf16 v[112:115], v[96:99], v[236:239], v[112:115]
    buffer_load_dwordx4 v6, s[8:11], s38 offen offset:0 nt lds
    v_mfma_f32_16x16x32_bf16 v[208:211], v[32:35], v[160:163], v[248:251]
    v_exp_f32 v202, v202
    v_mfma_f32_16x16x32_bf16 v[208:211], v[36:39], v[164:167], v[208:211]
    v_exp_f32 v203, v203
    v_mfma_f32_16x16x32_bf16 v[208:211], v[40:43], v[168:171], v[208:211]
    v_exp_f32 v204, v204
    v_mfma_f32_16x16x32_bf16 v[208:211], v[44:47], v[172:175], v[208:211]
    v_exp_f32 v205, v205
    v_mfma_f32_16x16x32_bf16 v[212:215], v[60:63], v[172:175], v[248:251]
    v_exp_f32 v206, v206
    v_mfma_f32_16x16x32_bf16 v[212:215], v[56:59], v[168:171], v[212:215]
    v_exp_f32 v207, v207
    v_mfma_f32_16x16x32_bf16 v[212:215], v[52:55], v[164:167], v[212:215]
    v_cvt_pk_bf16_f32 v228, v200, v201
    v_cvt_pk_bf16_f32 v229, v202, v203
    v_mfma_f32_16x16x32_bf16 v[212:215], v[48:51], v[160:163], v[212:215]
    buffer_load_dwordx4 v7, s[8:11], s38 offen offset:1056 nt lds
    v_mfma_f32_16x16x32_bf16 v[216:219], v[32:35], v[176:179], v[252:255]
    ds_read_b64_tr_b16 v[32:33], v21 offset:0
    ds_read_b64_tr_b16 v[34:35], v21 offset:512
    v_mfma_f32_16x16x32_bf16 v[216:219], v[36:39], v[180:183], v[216:219]
    ds_read_b64_tr_b16 v[36:37], v21 offset:32
    ds_read_b64_tr_b16 v[38:39], v21 offset:544
    v_mfma_f32_16x16x32_bf16 v[216:219], v[40:43], v[184:187], v[216:219]
    ds_read_b64_tr_b16 v[40:41], v21 offset:64
    ds_read_b64_tr_b16 v[42:43], v21 offset:576
    v_mfma_f32_16x16x32_bf16 v[216:219], v[44:47], v[188:191], v[216:219]
    ds_read_b64_tr_b16 v[44:45], v21 offset:96
    ds_read_b64_tr_b16 v[46:47], v21 offset:608
    v_mfma_f32_16x16x32_bf16 v[220:223], v[60:63], v[188:191], v[252:255]
    ds_read_b64_tr_b16 v[60:61], v21 offset:224
    ds_read_b64_tr_b16 v[62:63], v21 offset:736
    v_mfma_f32_16x16x32_bf16 v[220:223], v[56:59], v[184:187], v[220:223]
    ds_read_b64_tr_b16 v[56:57], v21 offset:192
    ds_read_b64_tr_b16 v[58:59], v21 offset:704
    v_mfma_f32_16x16x32_bf16 v[220:223], v[52:55], v[180:183], v[220:223]
    ds_read_b64_tr_b16 v[52:53], v21 offset:160
    ds_read_b64_tr_b16 v[54:55], v21 offset:672
    v_mfma_f32_16x16x32_bf16 v[220:223], v[48:51], v[176:179], v[220:223]
    s_waitcnt lgkmcnt(15)
    ds_read_b64_tr_b16 v[48:49], v21 offset:128
    ds_read_b64_tr_b16 v[50:51], v21 offset:640
    v_mfma_f32_16x16x32_bf16 a[0:3], v[64:67], v[224:227], a[0:3]
    buffer_load_dwordx4 v8, s[8:11], s38 offen offset:2112 nt lds
    v_mfma_f32_16x16x32_bf16 a[4:7], v[68:71], v[224:227], a[4:7]
    v_cvt_pk_bf16_f32 v230, v204, v205
    v_cvt_pk_bf16_f32 v231, v206, v207
    v_mfma_f32_16x16x32_bf16 a[8:11], v[72:75], v[224:227], a[8:11]
    v_exp_f32 v208, v208
    v_mfma_f32_16x16x32_bf16 a[12:15], v[76:79], v[224:227], a[12:15]
    v_exp_f32 v209, v209
    v_mfma_f32_16x16x32_bf16 a[16:19], v[80:83], v[224:227], a[16:19]
    v_exp_f32 v210, v210
    v_mfma_f32_16x16x32_bf16 a[20:23], v[84:87], v[224:227], a[20:23]
    v_exp_f32 v211, v211
    v_mfma_f32_16x16x32_bf16 a[24:27], v[88:91], v[224:227], a[24:27]
    s_waitcnt lgkmcnt(15)
    v_exp_f32 v212, v212
    v_mfma_f32_16x16x32_bf16 a[28:31], v[92:95], v[224:227], a[28:31]
    v_exp_f32 v213, v213
    v_mfma_f32_16x16x32_bf16 v[100:103], v[96:99], v[224:227], v[100:103]
    s_waitcnt lgkmcnt(14)
    buffer_load_dwordx4 v9, s[8:11], s38 offen offset:3168 nt lds
    v_mfma_f32_16x16x32_bf16 a[128:131], v[32:35], v[116:119], a[128:131]
    s_add_u32 m0, s33, 4096
    v_exp_f32 v214, v214
    v_mfma_f32_16x16x32_bf16 a[160:163], v[32:35], v[124:127], a[160:163]
    s_min_i32 s38, s39, 524288
    v_exp_f32 v215, v215
    v_mfma_f32_16x16x32_bf16 a[192:195], v[32:35], v[28:31], a[192:195]
    s_cmp_lt_u32 s44, 7
    s_cselect_b32 s57, -1, 0
    s_cselect_b32 s33, s42, 163840
    v_mfma_f32_16x16x32_bf16 a[224:227], v[32:35], v[24:27], a[224:227]
    s_waitcnt lgkmcnt(12)
    s_add_u32 s44, s44, 1
    ds_read_b128 v[32:35], v4 offset:0
    v_cvt_pk_bf16_f32 v232, v208, v209
    v_mfma_f32_16x16x32_bf16 a[132:135], v[36:39], v[116:119], a[132:135]
    v_cvt_pk_bf16_f32 v233, v210, v211
    v_cvt_pk_bf16_f32 v234, v212, v213
    v_mfma_f32_16x16x32_bf16 a[164:167], v[36:39], v[124:127], a[164:167]
    v_cvt_pk_bf16_f32 v235, v214, v215
    v_add_u32 v5, s32, v3
    v_mfma_f32_16x16x32_bf16 a[196:199], v[36:39], v[28:31], a[196:199]
    v_exp_f32 v216, v216
    v_mfma_f32_16x16x32_bf16 a[228:231], v[36:39], v[24:27], a[228:231]
    s_waitcnt lgkmcnt(11)
    ds_read_b128 v[36:39], v4 offset:64
    v_mfma_f32_16x16x32_bf16 a[136:139], v[40:43], v[116:119], a[136:139]
    buffer_load_dwordx4 v14, s[12:15], s41 offen offset:0 lds
    v_mfma_f32_16x16x32_bf16 a[168:171], v[40:43], v[124:127], a[168:171]
    v_exp_f32 v217, v217
    v_mfma_f32_16x16x32_bf16 a[200:203], v[40:43], v[28:31], a[200:203]
    v_exp_f32 v218, v218
    v_mfma_f32_16x16x32_bf16 a[232:235], v[40:43], v[24:27], a[232:235]
    s_waitcnt lgkmcnt(10)
    ds_read_b128 v[40:43], v4 offset:128
    v_cvt_pk_bf16_f32 v236, v216, v217
    v_mfma_f32_16x16x32_bf16 a[140:143], v[44:47], v[116:119], a[140:143]
    v_exp_f32 v219, v219
    v_mfma_f32_16x16x32_bf16 a[172:175], v[44:47], v[124:127], a[172:175]
    v_exp_f32 v220, v220
    v_mfma_f32_16x16x32_bf16 a[204:207], v[44:47], v[28:31], a[204:207]
    v_exp_f32 v221, v221
    v_mfma_f32_16x16x32_bf16 a[236:239], v[44:47], v[24:27], a[236:239]
    s_waitcnt lgkmcnt(9)
    ds_read_b128 v[44:47], v4 offset:192
    v_cvt_pk_bf16_f32 v237, v218, v219
    v_mfma_f32_16x16x32_bf16 a[156:159], v[60:63], v[116:119], a[156:159]
    buffer_load_dwordx4 v15, s[12:15], s41 offen offset:1024 lds
    v_mfma_f32_16x16x32_bf16 a[188:191], v[60:63], v[124:127], a[188:191]
    v_exp_f32 v222, v222
    v_mfma_f32_16x16x32_bf16 a[220:223], v[60:63], v[28:31], a[220:223]
    v_exp_f32 v223, v223
    v_mfma_f32_16x16x32_bf16 a[252:255], v[60:63], v[24:27], a[252:255]
    s_waitcnt lgkmcnt(8)
    ds_read_b128 v[60:63], v4 offset:704
    v_cvt_pk_bf16_f32 v238, v220, v221
    v_mfma_f32_16x16x32_bf16 a[152:155], v[56:59], v[116:119], a[152:155]
    v_cvt_pk_bf16_f32 v239, v222, v223
    v_mfma_f32_16x16x32_bf16 a[184:187], v[56:59], v[124:127], a[184:187]
    v_mfma_f32_16x16x32_bf16 a[216:219], v[56:59], v[28:31], a[216:219]
    v_mfma_f32_16x16x32_bf16 a[248:251], v[56:59], v[24:27], a[248:251]
    s_waitcnt lgkmcnt(7)
    ds_read_b128 v[56:59], v4 offset:640
    v_mfma_f32_16x16x32_bf16 a[148:151], v[52:55], v[116:119], a[148:151]
    buffer_load_dwordx4 v16, s[12:15], s41 offen offset:2048 lds
    v_mfma_f32_16x16x32_bf16 a[180:183], v[52:55], v[124:127], a[180:183]
    v_mfma_f32_16x16x32_bf16 a[212:215], v[52:55], v[28:31], a[212:215]
    v_mfma_f32_16x16x32_bf16 a[244:247], v[52:55], v[24:27], a[244:247]
    s_waitcnt lgkmcnt(6)
    ds_read_b128 v[52:55], v4 offset:576
    v_mfma_f32_16x16x32_bf16 a[144:147], v[48:51], v[116:119], a[144:147]
    v_mfma_f32_16x16x32_bf16 a[176:179], v[48:51], v[124:127], a[176:179]
    v_mfma_f32_16x16x32_bf16 a[208:211], v[48:51], v[28:31], a[208:211]
    v_mfma_f32_16x16x32_bf16 a[240:243], v[48:51], v[24:27], a[240:243]
    ds_read_b128 v[48:51], v4 offset:512
    v_add_u32 v4, s32, v2
    v_mfma_f32_16x16x32_bf16 a[32:35], v[64:67], v[228:231], a[32:35]
    buffer_load_dwordx4 v17, s[12:15], s41 offen offset:3072 lds
    v_mfma_f32_16x16x32_bf16 a[36:39], v[68:71], v[228:231], a[36:39]
    s_add_u32 m0, s100, 0
    s_add_u32 s41, s40, 40960
    s_and_b32 s14, s95, s57
    v_mfma_f32_16x16x32_bf16 a[40:43], v[72:75], v[228:231], a[40:43]
    s_and_b32 s40, s40, s57
    s_and_b32 s41, s41, s57
    v_mfma_f32_16x16x32_bf16 a[44:47], v[76:79], v[228:231], a[44:47]
    v_mfma_f32_16x16x32_bf16 a[48:51], v[80:83], v[228:231], a[48:51]
    v_mfma_f32_16x16x32_bf16 a[52:55], v[84:87], v[228:231], a[52:55]
    v_mfma_f32_16x16x32_bf16 a[56:59], v[88:91], v[228:231], a[56:59]
    v_mfma_f32_16x16x32_bf16 a[60:63], v[92:95], v[228:231], a[60:63]
    v_mfma_f32_16x16x32_bf16 v[104:107], v[96:99], v[228:231], v[104:107]
    s_waitcnt vmcnt(9) lgkmcnt(0)
    s_barrier
    v_mfma_f32_16x16x32_bf16 v[192:195], v[32:35], v[128:131], v[240:243]
    ds_read_b128 v[116:119], v19 offset:0
    v_mfma_f32_16x16x32_bf16 v[192:195], v[36:39], v[132:135], v[192:195]
    ds_read_b128 v[124:127], v19 offset:2048
    v_mfma_f32_16x16x32_bf16 v[192:195], v[40:43], v[136:139], v[192:195]
    ds_read_b128 v[28:31], v19 offset:4096
    v_mfma_f32_16x16x32_bf16 v[192:195], v[44:47], v[140:143], v[192:195]
    ds_read_b128 v[24:27], v19 offset:6144
    v_add_u32 v19, s43, v19
    v_mfma_f32_16x16x32_bf16 v[196:199], v[60:63], v[140:143], v[240:243]
    s_sub_u32 s43, 0, s43
    buffer_load_dwordx4 v10, s[4:7], s36 offen offset:0 lds
    v_mfma_f32_16x16x32_bf16 v[196:199], v[56:59], v[136:139], v[196:199]
    s_cmp_lt_u32 s44, 9
    v_mfma_f32_16x16x32_bf16 v[196:199], v[52:55], v[132:135], v[196:199]
    v_exp_f32 v192, v192
    v_mfma_f32_16x16x32_bf16 v[196:199], v[48:51], v[128:131], v[196:199]
    v_exp_f32 v193, v193
    v_mfma_f32_16x16x32_bf16 a[64:67], v[64:67], v[232:235], a[64:67]
    v_exp_f32 v194, v194
    v_mfma_f32_16x16x32_bf16 a[68:71], v[68:71], v[232:235], a[68:71]
    v_exp_f32 v195, v195
    v_mfma_f32_16x16x32_bf16 a[72:75], v[72:75], v[232:235], a[72:75]
    v_cvt_pk_bf16_f32 v224, v192, v193
    v_cvt_pk_bf16_f32 v225, v194, v195
    v_mfma_f32_16x16x32_bf16 a[76:79], v[76:79], v[232:235], a[76:79]
    v_exp_f32 v196, v196
    v_mfma_f32_16x16x32_bf16 a[80:83], v[80:83], v[232:235], a[80:83]
    buffer_load_dwordx4 v11, s[4:7], s36 offen offset:1056 lds
    v_mfma_f32_16x16x32_bf16 a[84:87], v[84:87], v[232:235], a[84:87]
    s_mov_b32 m0, s94
    v_exp_f32 v197, v197
    v_mfma_f32_16x16x32_bf16 a[88:91], v[88:91], v[232:235], a[88:91]
    v_exp_f32 v198, v198
    v_mfma_f32_16x16x32_bf16 a[92:95], v[92:95], v[232:235], a[92:95]
    v_exp_f32 v199, v199
    v_mfma_f32_16x16x32_bf16 v[108:111], v[96:99], v[232:235], v[108:111]
    v_cvt_pk_bf16_f32 v226, v196, v197
    v_cvt_pk_bf16_f32 v227, v198, v199
    v_mfma_f32_16x16x32_bf16 v[200:203], v[32:35], v[144:147], v[244:247]
    v_mfma_f32_16x16x32_bf16 v[200:203], v[36:39], v[148:151], v[200:203]
    v_mfma_f32_16x16x32_bf16 v[200:203], v[40:43], v[152:155], v[200:203]
    v_mfma_f32_16x16x32_bf16 v[200:203], v[44:47], v[156:159], v[200:203]
    buffer_load_dwordx4 v6, s[8:11], s38 offen offset:0 nt lds
    v_mfma_f32_16x16x32_bf16 v[204:207], v[60:63], v[156:159], v[244:247]
    v_mfma_f32_16x16x32_bf16 v[204:207], v[56:59], v[152:155], v[204:207]
    v_mfma_f32_16x16x32_bf16 v[204:207], v[52:55], v[148:151], v[204:207]
    v_mfma_f32_16x16x32_bf16 v[204:207], v[48:51], v[144:147], v[204:207]
    v_mfma_f32_16x16x32_bf16 a[96:99], v[64:67], v[236:239], a[96:99]
    ds_read_b64_tr_b16 v[64:65], v5 offset:8448
    ds_read_b64_tr_b16 v[66:67], v5 offset:8960
    v_mfma_f32_16x16x32_bf16 a[100:103], v[68:71], v[236:239], a[100:103]
    ds_read_b64_tr_b16 v[68:69], v5 offset:8480
    ds_read_b64_tr_b16 v[70:71], v5 offset:8992
    v_mfma_f32_16x16x32_bf16 a[104:107], v[72:75], v[236:239], a[104:107]
    ds_read_b64_tr_b16 v[72:73], v5 offset:8512
    ds_read_b64_tr_b16 v[74:75], v5 offset:9024
    v_mfma_f32_16x16x32_bf16 a[108:111], v[76:79], v[236:239], a[108:111]
    ds_read_b64_tr_b16 v[76:77], v5 offset:8544
    ds_read_b64_tr_b16 v[78:79], v5 offset:9056
    v_mfma_f32_16x16x32_bf16 a[112:115], v[80:83], v[236:239], a[112:115]
    ds_read_b64_tr_b16 v[80:81], v5 offset:8576
    ds_read_b64_tr_b16 v[82:83], v5 offset:9088
    v_mfma_f32_16x16x32_bf16 a[116:119], v[84:87], v[236:239], a[116:119]
    ds_read_b64_tr_b16 v[84:85], v5 offset:8608
    ds_read_b64_tr_b16 v[86:87], v5 offset:9120
    v_mfma_f32_16x16x32_bf16 a[120:123], v[88:91], v[236:239], a[120:123]
    ds_read_b64_tr_b16 v[88:89], v5 offset:8640
    ds_read_b64_tr_b16 v[90:91], v5 offset:9152
    v_mfma_f32_16x16x32_bf16 a[124:127], v[92:95], v[236:239], a[124:127]
    ds_read_b64_tr_b16 v[92:93], v5 offset:8672
    ds_read_b64_tr_b16 v[94:95], v5 offset:9184
    v_mfma_f32_16x16x32_bf16 v[112:115], v[96:99], v[236:239], v[112:115]
    buffer_load_dwordx4 v7, s[8:11], s38 offen offset:1056 nt lds
    v_mfma_f32_16x16x32_bf16 v[208:211], v[32:35], v[160:163], v[248:251]
    v_exp_f32 v200, v200
    v_mfma_f32_16x16x32_bf16 v[208:211], v[36:39], v[164:167], v[208:211]
    v_exp_f32 v201, v201
    v_mfma_f32_16x16x32_bf16 v[208:211], v[40:43], v[168:171], v[208:211]
    v_exp_f32 v202, v202
    v_mfma_f32_16x16x32_bf16 v[208:211], v[44:47], v[172:175], v[208:211]
    v_exp_f32 v203, v203
    v_mfma_f32_16x16x32_bf16 v[212:215], v[60:63], v[172:175], v[248:251]
    v_exp_f32 v204, v204
    v_mfma_f32_16x16x32_bf16 v[212:215], v[56:59], v[168:171], v[212:215]
    v_exp_f32 v205, v205
    v_mfma_f32_16x16x32_bf16 v[212:215], v[52:55], v[164:167], v[212:215]
    v_exp_f32 v206, v206
    v_mfma_f32_16x16x32_bf16 v[212:215], v[48:51], v[160:163], v[212:215]
    buffer_load_dwordx4 v8, s[8:11], s38 offen offset:2112 nt lds
    v_mfma_f32_16x16x32_bf16 v[216:219], v[32:35], v[176:179], v[252:255]
    ds_read_b64_tr_b16 v[32:33], v21 offset:8448
    ds_read_b64_tr_b16 v[34:35], v21 offset:8960
    v_mfma_f32_16x16x32_bf16 v[216:219], v[36:39], v[180:183], v[216:219]
    ds_read_b64_tr_b16 v[36:37], v21 offset:8480
    ds_read_b64_tr_b16 v[38:39], v21 offset:8992
    v_mfma_f32_16x16x32_bf16 v[216:219], v[40:43], v[184:187], v[216:219]
    ds_read_b64_tr_b16 v[40:41], v21 offset:8512
    ds_read_b64_tr_b16 v[42:43], v21 offset:9024
    v_mfma_f32_16x16x32_bf16 v[216:219], v[44:47], v[188:191], v[216:219]
    ds_read_b64_tr_b16 v[44:45], v21 offset:8544
    ds_read_b64_tr_b16 v[46:47], v21 offset:9056
    v_mfma_f32_16x16x32_bf16 v[220:223], v[60:63], v[188:191], v[252:255]
    ds_read_b64_tr_b16 v[60:61], v21 offset:8672
    ds_read_b64_tr_b16 v[62:63], v21 offset:9184
    v_mfma_f32_16x16x32_bf16 v[220:223], v[56:59], v[184:187], v[220:223]
    ds_read_b64_tr_b16 v[56:57], v21 offset:8640
    ds_read_b64_tr_b16 v[58:59], v21 offset:9152
    v_mfma_f32_16x16x32_bf16 v[220:223], v[52:55], v[180:183], v[220:223]
    ds_read_b64_tr_b16 v[52:53], v21 offset:8608
    ds_read_b64_tr_b16 v[54:55], v21 offset:9120
    v_mfma_f32_16x16x32_bf16 v[220:223], v[48:51], v[176:179], v[220:223]
    s_waitcnt lgkmcnt(15)
    buffer_load_dwordx4 v9, s[8:11], s38 offen offset:3168 nt lds
    v_mfma_f32_16x16x32_bf16 a[0:3], v[64:67], v[224:227], a[0:3]
    s_mov_b32 m0, s33
    ds_read_b64_tr_b16 v[48:49], v21 offset:8576
    ds_read_b64_tr_b16 v[50:51], v21 offset:9088
    v_mfma_f32_16x16x32_bf16 a[4:7], v[68:71], v[224:227], a[4:7]
    v_exp_f32 v207, v207
    v_mfma_f32_16x16x32_bf16 a[8:11], v[72:75], v[224:227], a[8:11]
    v_cvt_pk_bf16_f32 v228, v200, v201
    v_cvt_pk_bf16_f32 v229, v202, v203
    v_mfma_f32_16x16x32_bf16 a[12:15], v[76:79], v[224:227], a[12:15]
    v_cvt_pk_bf16_f32 v230, v204, v205
    v_cvt_pk_bf16_f32 v231, v206, v207
    v_mfma_f32_16x16x32_bf16 a[16:19], v[80:83], v[224:227], a[16:19]
    v_exp_f32 v208, v208
    v_mfma_f32_16x16x32_bf16 a[20:23], v[84:87], v[224:227], a[20:23]
    v_exp_f32 v209, v209
    v_mfma_f32_16x16x32_bf16 a[24:27], v[88:91], v[224:227], a[24:27]
    s_waitcnt lgkmcnt(15)
    v_exp_f32 v210, v210
    v_mfma_f32_16x16x32_bf16 a[28:31], v[92:95], v[224:227], a[28:31]
    buffer_load_dwordx4 v14, s[12:15], s40 offen offset:0 lds
    v_mfma_f32_16x16x32_bf16 v[100:103], v[96:99], v[224:227], v[100:103]
    s_waitcnt lgkmcnt(14)
    v_exp_f32 v211, v211
    v_mfma_f32_16x16x32_bf16 a[128:131], v[32:35], v[116:119], a[128:131]
    v_exp_f32 v212, v212
    v_mfma_f32_16x16x32_bf16 a[160:163], v[32:35], v[124:127], a[160:163]
    v_exp_f32 v213, v213
    v_mfma_f32_16x16x32_bf16 a[192:195], v[32:35], v[28:31], a[192:195]
    v_exp_f32 v214, v214
    v_mfma_f32_16x16x32_bf16 a[224:227], v[32:35], v[24:27], a[224:227]
    s_waitcnt lgkmcnt(12)
    ds_read_b128 v[32:35], v4 offset:0
    v_cvt_pk_bf16_f32 v232, v208, v209
    v_mfma_f32_16x16x32_bf16 a[132:135], v[36:39], v[116:119], a[132:135]
    v_exp_f32 v215, v215
    v_mfma_f32_16x16x32_bf16 a[164:167], v[36:39], v[124:127], a[164:167]
    v_cvt_pk_bf16_f32 v233, v210, v211
    v_cvt_pk_bf16_f32 v234, v212, v213
    v_mfma_f32_16x16x32_bf16 a[196:199], v[36:39], v[28:31], a[196:199]
    buffer_load_dwordx4 v15, s[12:15], s40 offen offset:1024 lds
    v_mfma_f32_16x16x32_bf16 a[228:231], v[36:39], v[24:27], a[228:231]
    s_waitcnt lgkmcnt(11)
    ds_read_b128 v[36:39], v4 offset:64
    v_cvt_pk_bf16_f32 v235, v214, v215
    v_mfma_f32_16x16x32_bf16 a[136:139], v[40:43], v[116:119], a[136:139]
    v_exp_f32 v216, v216
    v_mfma_f32_16x16x32_bf16 a[168:171], v[40:43], v[124:127], a[168:171]
    v_exp_f32 v217, v217
    v_mfma_f32_16x16x32_bf16 a[200:203], v[40:43], v[28:31], a[200:203]
    v_exp_f32 v218, v218
    v_mfma_f32_16x16x32_bf16 a[232:235], v[40:43], v[24:27], a[232:235]
    s_waitcnt lgkmcnt(10)
    ds_read_b128 v[40:43], v4 offset:128
    v_mfma_f32_16x16x32_bf16 a[140:143], v[44:47], v[116:119], a[140:143]
    v_exp_f32 v219, v219
    v_mfma_f32_16x16x32_bf16 a[172:175], v[44:47], v[124:127], a[172:175]
    v_exp_f32 v220, v220
    v_mfma_f32_16x16x32_bf16 a[204:207], v[44:47], v[28:31], a[204:207]
    buffer_load_dwordx4 v16, s[12:15], s40 offen offset:2048 lds
    v_mfma_f32_16x16x32_bf16 a[236:239], v[44:47], v[24:27], a[236:239]
    s_waitcnt lgkmcnt(9)
    ds_read_b128 v[44:47], v4 offset:192
    v_mfma_f32_16x16x32_bf16 a[156:159], v[60:63], v[116:119], a[156:159]
    v_exp_f32 v221, v221
    v_mfma_f32_16x16x32_bf16 a[188:191], v[60:63], v[124:127], a[188:191]
    v_exp_f32 v222, v222
    v_mfma_f32_16x16x32_bf16 a[220:223], v[60:63], v[28:31], a[220:223]
    v_mfma_f32_16x16x32_bf16 a[252:255], v[60:63], v[24:27], a[252:255]
    s_waitcnt lgkmcnt(8)
    ds_read_b128 v[60:63], v4 offset:704
    v_mfma_f32_16x16x32_bf16 a[152:155], v[56:59], v[116:119], a[152:155]
    v_mfma_f32_16x16x32_bf16 a[184:187], v[56:59], v[124:127], a[184:187]
    v_mfma_f32_16x16x32_bf16 a[216:219], v[56:59], v[28:31], a[216:219]
    buffer_load_dwordx4 v17, s[12:15], s40 offen offset:3072 lds
    v_mfma_f32_16x16x32_bf16 a[248:251], v[56:59], v[24:27], a[248:251]
    s_waitcnt lgkmcnt(7)
    ds_read_b128 v[56:59], v4 offset:640
    v_mfma_f32_16x16x32_bf16 a[148:151], v[52:55], v[116:119], a[148:151]
    v_mfma_f32_16x16x32_bf16 a[180:183], v[52:55], v[124:127], a[180:183]
    v_mfma_f32_16x16x32_bf16 a[212:215], v[52:55], v[28:31], a[212:215]
    v_mfma_f32_16x16x32_bf16 a[244:247], v[52:55], v[24:27], a[244:247]
    s_waitcnt lgkmcnt(6)
    ds_read_b128 v[52:55], v4 offset:576
    v_mfma_f32_16x16x32_bf16 a[144:147], v[48:51], v[116:119], a[144:147]
    v_mfma_f32_16x16x32_bf16 a[176:179], v[48:51], v[124:127], a[176:179]
    v_mfma_f32_16x16x32_bf16 a[208:211], v[48:51], v[28:31], a[208:211]
    v_mfma_f32_16x16x32_bf16 a[240:243], v[48:51], v[24:27], a[240:243]
    ds_read_b128 v[48:51], v4 offset:512
    v_mfma_f32_16x16x32_bf16 a[32:35], v[64:67], v[228:231], a[32:35]
    v_mfma_f32_16x16x32_bf16 a[36:39], v[68:71], v[228:231], a[36:39]
    v_mfma_f32_16x16x32_bf16 a[40:43], v[72:75], v[228:231], a[40:43]
    v_mfma_f32_16x16x32_bf16 a[44:47], v[76:79], v[228:231], a[44:47]
    v_mfma_f32_16x16x32_bf16 a[48:51], v[80:83], v[228:231], a[48:51]
    v_mfma_f32_16x16x32_bf16 a[52:55], v[84:87], v[228:231], a[52:55]
    v_mfma_f32_16x16x32_bf16 a[56:59], v[88:91], v[228:231], a[56:59]
    v_mfma_f32_16x16x32_bf16 a[60:63], v[92:95], v[228:231], a[60:63]
    v_mfma_f32_16x16x32_bf16 v[104:107], v[96:99], v[228:231], v[104:107]
    s_waitcnt lgkmcnt(0)
    s_cbranch_scc1 L1v4_wloop
    s_mov_b32 s14, s95
    v_add_u32 v18, s69, v20
    v_add_u32 v19, s69, v20
    s_mov_b32 s44, 0
    s_mov_b32 s95, 0
    s_mov_b32 s96, 0
    s_mov_b32 s97, 0
.p2align 6
L1v4_aloop:
    v_mfma_f32_16x16x32_bf16 v[192:195], v[32:35], v[128:131], v[240:243]
    s_set_gpr_idx_on s96, gpr_idx(SRC0)
    v_accvgpr_read_b32 v116, a128
    v_accvgpr_read_b32 v117, a129
    v_accvgpr_read_b32 v118, a130
    v_accvgpr_read_b32 v119, a131
    s_set_gpr_idx_off
    v_mfma_f32_16x16x32_bf16 v[192:195], v[36:39], v[132:135], v[192:195]
    s_set_gpr_idx_on s96, gpr_idx(SRC0)
    v_accvgpr_read_b32 v124, a132
    v_accvgpr_read_b32 v125, a133
    v_accvgpr_read_b32 v126, a134
    v_accvgpr_read_b32 v127, a135
    s_set_gpr_idx_off
    v_mfma_f32_16x16x32_bf16 v[192:195], v[40:43], v[136:139], v[192:195]
    s_set_gpr_idx_on s96, gpr_idx(SRC0)
    v_accvgpr_read_b32 v28, a136
    v_accvgpr_read_b32 v29, a137
    v_accvgpr_read_b32 v30, a138
    v_accvgpr_read_b32 v31, a139
    s_set_gpr_idx_off
    v_mfma_f32_16x16x32_bf16 v[192:195], v[44:47], v[140:143], v[192:195]
    s_waitcnt vmcnt(12) lgkmcnt(0)
    s_barrier
    v_mfma_f32_16x16x32_bf16 v[196:199], v[60:63], v[140:143], v[240:243]
    s_add_u32 s94, s32, s34
    v_exp_f32 v223, v223
    v_mfma_f32_16x16x32_bf16 v[196:199], v[56:59], v[136:139], v[196:199]
    s_add_u32 s32, s32, 16896
    v_cvt_pk_bf16_f32 v236, v216, v217
    v_cvt_pk_bf16_f32 v237, v218, v219
    v_mfma_f32_16x16x32_bf16 v[196:199], v[52:55], v[132:135], v[196:199]
    s_cmp_ge_u32 s32, 84480
    s_cselect_b32 s32, 0, s32
    v_cvt_pk_bf16_f32 v238, v220, v221
    v_mfma_f32_16x16x32_bf16 v[196:199], v[48:51], v[128:131], v[196:199]
    s_mov_b32 m0, s94
    v_cvt_pk_bf16_f32 v239, v222, v223
    v_add_u32 v5, s32, v3
    v_mfma_f32_16x16x32_bf16 a[64:67], v[64:67], v[232:235], a[64:67]
    s_max_i32 s39, s35, 0
    s_min_i32 s38, s39, 524288
    v_add_u32 v4, s32, v2
    v_mfma_f32_16x16x32_bf16 a[68:71], v[68:71], v[232:235], a[68:71]
    s_add_u32 s95, s95, 3
    buffer_load_dwordx4 v6, s[8:11], s38 offen offset:0 nt lds
    v_mfma_f32_16x16x32_bf16 a[72:75], v[72:75], v[232:235], a[72:75]
    s_min_u32 s98, s95, 29
    v_exp_f32 v192, v192
    v_mfma_f32_16x16x32_bf16 a[76:79], v[76:79], v[232:235], a[76:79]
    s_lshl_b32 s96, s98, 2
    v_exp_f32 v193, v193
    v_mfma_f32_16x16x32_bf16 a[80:83], v[80:83], v[232:235], a[80:83]
    s_add_i32 s35, s35, 8192
    v_exp_f32 v194, v194
    v_mfma_f32_16x16x32_bf16 a[84:87], v[84:87], v[232:235], a[84:87]
    s_add_u32 s44, s44, 1
    v_exp_f32 v195, v195
    v_mfma_f32_16x16x32_bf16 a[88:91], v[88:91], v[232:235], a[88:91]
    v_exp_f32 v196, v196
    v_mfma_f32_16x16x32_bf16 a[92:95], v[92:95], v[232:235], a[92:95]
    v_exp_f32 v197, v197
    v_mfma_f32_16x16x32_bf16 v[108:111], v[96:99], v[232:235], v[108:111]
    v_exp_f32 v198, v198
    v_mfma_f32_16x16x32_bf16 v[200:203], v[32:35], v[144:147], v[244:247]
    v_exp_f32 v199, v199
    v_mfma_f32_16x16x32_bf16 v[200:203], v[36:39], v[148:151], v[200:203]
    v_cvt_pk_bf16_f32 v224, v192, v193
    v_cvt_pk_bf16_f32 v225, v194, v195
    v_mfma_f32_16x16x32_bf16 v[200:203], v[40:43], v[152:155], v[200:203]
    v_cvt_pk_bf16_f32 v226, v196, v197
    v_cvt_pk_bf16_f32 v227, v198, v199
    v_mfma_f32_16x16x32_bf16 v[200:203], v[44:47], v[156:159], v[200:203]
    v_mul_f32 v116, s46, v116
    v_mul_f32 v117, s46, v117
    v_mfma_f32_16x16x32_bf16 v[204:207], v[60:63], v[156:159], v[244:247]
    v_mul_f32 v118, s46, v118
    v_mul_f32 v119, s46, v119
    v_mfma_f32_16x16x32_bf16 v[204:207], v[56:59], v[152:155], v[204:207]
    buffer_load_dwordx4 v7, s[8:11], s38 offen offset:1056 nt lds
    v_mfma_f32_16x16x32_bf16 v[204:207], v[52:55], v[148:151], v[204:207]
    v_exp_f32 v200, v200
    v_mfma_f32_16x16x32_bf16 v[204:207], v[48:51], v[144:147], v[204:207]
    v_exp_f32 v201, v201
    v_mfma_f32_16x16x32_bf16 a[96:99], v[64:67], v[236:239], a[96:99]
    ds_read_b64_tr_b16 v[64:65], v5 offset:8448
    ds_read_b64_tr_b16 v[66:67], v5 offset:8960
    v_mfma_f32_16x16x32_bf16 a[100:103], v[68:71], v[236:239], a[100:103]
    ds_read_b64_tr_b16 v[68:69], v5 offset:8480
    ds_read_b64_tr_b16 v[70:71], v5 offset:8992
    v_mfma_f32_16x16x32_bf16 a[104:107], v[72:75], v[236:239], a[104:107]
    ds_read_b64_tr_b16 v[72:73], v5 offset:8512
    ds_read_b64_tr_b16 v[74:75], v5 offset:9024
    v_mfma_f32_16x16x32_bf16 a[108:111], v[76:79], v[236:239], a[108:111]
    ds_read_b64_tr_b16 v[76:77], v5 offset:8544
    ds_read_b64_tr_b16 v[78:79], v5 offset:9056
    v_mfma_f32_16x16x32_bf16 a[112:115], v[80:83], v[236:239], a[112:115]
    ds_read_b64_tr_b16 v[80:81], v5 offset:8576
    ds_read_b64_tr_b16 v[82:83], v5 offset:9088
    v_mfma_f32_16x16x32_bf16 a[116:119], v[84:87], v[236:239], a[116:119]
    ds_read_b64_tr_b16 v[84:85], v5 offset:8608
    ds_read_b64_tr_b16 v[86:87], v5 offset:9120
    v_mfma_f32_16x16x32_bf16 a[120:123], v[88:91], v[236:239], a[120:123]
    ds_read_b64_tr_b16 v[88:89], v5 offset:8640
    ds_read_b64_tr_b16 v[90:91], v5 offset:9152
    v_mfma_f32_16x16x32_bf16 a[124:127], v[92:95], v[236:239], a[124:127]
    ds_read_b64_tr_b16 v[92:93], v5 offset:8672
    ds_read_b64_tr_b16 v[94:95], v5 offset:9184
    v_mfma_f32_16x16x32_bf16 v[112:115], v[96:99], v[236:239], v[112:115]
    v_exp_f32 v202, v202
    v_mfma_f32_16x16x32_bf16 v[208:211], v[32:35], v[160:163], v[248:251]
    v_exp_f32 v203, v203
    v_mfma_f32_16x16x32_bf16 v[208:211], v[36:39], v[164:167], v[208:211]
    buffer_load_dwordx4 v8, s[8:11], s38 offen offset:2112 nt lds
    v_mfma_f32_16x16x32_bf16 v[208:211], v[40:43], v[168:171], v[208:211]
    v_exp_f32 v204, v204
    v_mfma_f32_16x16x32_bf16 v[208:211], v[44:47], v[172:175], v[208:211]
    v_exp_f32 v205, v205
    v_mfma_f32_16x16x32_bf16 v[212:215], v[60:63], v[172:175], v[248:251]
    v_exp_f32 v206, v206
    v_mfma_f32_16x16x32_bf16 v[212:215], v[56:59], v[168:171], v[212:215]
    v_exp_f32 v207, v207
    v_mfma_f32_16x16x32_bf16 v[212:215], v[52:55], v[164:167], v[212:215]
    v_cvt_pk_bf16_f32 v228, v200, v201
    v_cvt_pk_bf16_f32 v229, v202, v203
    v_mfma_f32_16x16x32_bf16 v[212:215], v[48:51], v[160:163], v[212:215]
    s_waitcnt lgkmcnt(14)
    v_cvt_pk_bf16_f32 v230, v204, v205
    v_cvt_pk_bf16_f32 v231, v206, v207
    v_mfma_f32_16x16x32_bf16 a[0:3], v[64:67], v[224:227], a[0:3]
    s_waitcnt lgkmcnt(12)
    v_mul_f32 v124, s46, v124
    v_mul_f32 v125, s46, v125
    v_mfma_f32_16x16x32_bf16 a[4:7], v[68:71], v[224:227], a[4:7]
    s_waitcnt lgkmcnt(10)
    v_mul_f32 v126, s46, v126
    v_mul_f32 v127, s46, v127
    v_mfma_f32_16x16x32_bf16 a[8:11], v[72:75], v[224:227], a[8:11]
    s_waitcnt lgkmcnt(8)
    v_mul_f32 v28, s46, v28
    v_mul_f32 v29, s46, v29
    v_mfma_f32_16x16x32_bf16 a[12:15], v[76:79], v[224:227], a[12:15]
    s_waitcnt lgkmcnt(6)
    v_mul_f32 v30, s46, v30
    v_mul_f32 v31, s46, v31
    v_mfma_f32_16x16x32_bf16 a[16:19], v[80:83], v[224:227], a[16:19]
    s_waitcnt lgkmcnt(4)
    v_exp_f32 v208, v208
    v_mfma_f32_16x16x32_bf16 a[20:23], v[84:87], v[224:227], a[20:23]
    s_waitcnt lgkmcnt(2)
    v_exp_f32 v209, v209
    v_mfma_f32_16x16x32_bf16 a[24:27], v[88:91], v[224:227], a[24:27]
    s_waitcnt lgkmcnt(0)
    buffer_load_dwordx4 v9, s[8:11], s38 offen offset:3168 nt lds
    v_mfma_f32_16x16x32_bf16 a[28:31], v[92:95], v[224:227], a[28:31]
    v_exp_f32 v210, v210
    v_mfma_f32_16x16x32_bf16 v[100:103], v[96:99], v[224:227], v[100:103]
    v_exp_f32 v211, v211
    v_mfma_f32_16x16x32_bf16 v[216:219], v[32:35], v[176:179], v[252:255]
    ds_read_b128 v[32:35], v4 offset:0
    v_add_u32 v122, s97, v123
    v_mfma_f32_16x16x32_bf16 v[216:219], v[36:39], v[180:183], v[216:219]
    s_lshl_b32 s97, s98, 9
    ds_read_b128 v[36:39], v4 offset:64
    v_cvt_pk_bf16_f32 v10, v116, v117
    v_mfma_f32_16x16x32_bf16 v[216:219], v[40:43], v[184:187], v[216:219]
    s_cmp_lt_u32 s44, 12
    ds_read_b128 v[40:43], v4 offset:128
    v_cvt_pk_bf16_f32 v11, v118, v119
    v_mfma_f32_16x16x32_bf16 v[216:219], v[44:47], v[188:191], v[216:219]
    ds_read_b128 v[44:47], v4 offset:192
    v_cvt_pk_bf16_f32 v12, v124, v125
    v_mfma_f32_16x16x32_bf16 v[220:223], v[60:63], v[188:191], v[252:255]
    ds_read_b128 v[60:63], v4 offset:704
    v_cvt_pk_bf16_f32 v13, v126, v127
    v_mfma_f32_16x16x32_bf16 v[220:223], v[56:59], v[184:187], v[220:223]
    ds_read_b128 v[56:59], v4 offset:640
    v_cvt_pk_bf16_f32 v14, v28, v29
    v_mfma_f32_16x16x32_bf16 v[220:223], v[52:55], v[180:183], v[220:223]
    ds_read_b128 v[52:55], v4 offset:576
    v_cvt_pk_bf16_f32 v15, v30, v31
    v_mfma_f32_16x16x32_bf16 v[220:223], v[48:51], v[176:179], v[220:223]
    ds_read_b128 v[48:51], v4 offset:512
    v_cvt_pk_bf16_f32 v232, v208, v209
    v_mfma_f32_16x16x32_bf16 a[32:35], v[64:67], v[228:231], a[32:35]
    ds_write_b64 v122, v[10:11] offset:0
    v_mfma_f32_16x16x32_bf16 a[36:39], v[68:71], v[228:231], a[36:39]
    ds_write_b64 v122, v[12:13] offset:512
    v_mfma_f32_16x16x32_bf16 a[40:43], v[72:75], v[228:231], a[40:43]
    ds_write_b64 v122, v[14:15] offset:1024
    v_mfma_f32_16x16x32_bf16 a[44:47], v[76:79], v[228:231], a[44:47]
    v_exp_f32 v212, v212
    v_mfma_f32_16x16x32_bf16 a[48:51], v[80:83], v[228:231], a[48:51]
    v_exp_f32 v213, v213
    v_mfma_f32_16x16x32_bf16 a[52:55], v[84:87], v[228:231], a[52:55]
    v_exp_f32 v214, v214
    v_mfma_f32_16x16x32_bf16 a[56:59], v[88:91], v[228:231], a[56:59]
    v_exp_f32 v215, v215
    v_mfma_f32_16x16x32_bf16 a[60:63], v[92:95], v[228:231], a[60:63]
    v_cvt_pk_bf16_f32 v233, v210, v211
    v_cvt_pk_bf16_f32 v234, v212, v213
    v_mfma_f32_16x16x32_bf16 v[104:107], v[96:99], v[228:231], v[104:107]
    v_cvt_pk_bf16_f32 v235, v214, v215
    v_exp_f32 v216, v216
    v_exp_f32 v217, v217
    v_exp_f32 v218, v218
    v_exp_f32 v219, v219
    v_exp_f32 v220, v220
    v_exp_f32 v221, v221
    v_exp_f32 v222, v222
    s_waitcnt lgkmcnt(0)
    s_cbranch_scc1 L1v4_aloop
    v_mfma_f32_16x16x32_bf16 a[64:67], v[64:67], v[232:235], a[64:67]
    s_add_u32 s94, s32, s34
    ds_read_b128 v[128:131], v18 offset:0
    ds_read_b128 v[132:135], v18 offset:1024
    v_mfma_f32_16x16x32_bf16 a[68:71], v[68:71], v[232:235], a[68:71]
    s_add_u32 s32, s32, 16896
    ds_read_b128 v[136:139], v18 offset:2048
    ds_read_b128 v[140:143], v18 offset:3072
    v_mfma_f32_16x16x32_bf16 a[72:75], v[72:75], v[232:235], a[72:75]
    s_cmp_ge_u32 s32, 84480
    s_cselect_b32 s32, 0, s32
    ds_read_b128 v[144:147], v18 offset:4096
    v_mfma_f32_16x16x32_bf16 a[76:79], v[76:79], v[232:235], a[76:79]
    s_mov_b32 m0, s94
    ds_read_b128 v[148:151], v18 offset:5120
    ds_read_b128 v[152:155], v18 offset:6144
    v_mfma_f32_16x16x32_bf16 a[80:83], v[80:83], v[232:235], a[80:83]
    s_max_i32 s39, s35, 0
    ds_read_b128 v[156:159], v18 offset:7168
    ds_read_b128 v[160:163], v18 offset:8192
    v_mfma_f32_16x16x32_bf16 a[84:87], v[84:87], v[232:235], a[84:87]
    s_min_i32 s38, s39, 524288
    ds_read_b128 v[164:167], v18 offset:9216
    ds_read_b128 v[168:171], v18 offset:10240
    v_mfma_f32_16x16x32_bf16 a[88:91], v[88:91], v[232:235], a[88:91]
    s_add_i32 s35, s35, 8192
    ds_read_b128 v[172:175], v18 offset:11264
    ds_read_b128 v[176:179], v18 offset:12288
    v_mfma_f32_16x16x32_bf16 a[92:95], v[92:95], v[232:235], a[92:95]
    s_max_i32 s39, s35, 0
    ds_read_b128 v[180:183], v18 offset:13312
    ds_read_b128 v[184:187], v18 offset:14336
    v_mfma_f32_16x16x32_bf16 v[108:111], v[96:99], v[232:235], v[108:111]
    ds_read_b128 v[188:191], v18 offset:15360
    v_exp_f32 v223, v223
    v_cvt_pk_bf16_f32 v236, v216, v217
    v_cvt_pk_bf16_f32 v237, v218, v219
    v_cvt_pk_bf16_f32 v238, v220, v221
    v_cvt_pk_bf16_f32 v239, v222, v223
    v_mov_b32 v23, 0
    v_add_u32 v5, s32, v3
    v_mfma_f32_16x16x32_bf16 a[96:99], v[64:67], v[236:239], a[96:99]
    s_add_u32 s94, s32, s34
    buffer_load_dword v0, v23, s[64:67], 0 offen
    v_mfma_f32_16x16x32_bf16 a[100:103], v[68:71], v[236:239], a[100:103]
    s_waitcnt vmcnt(13) lgkmcnt(0)
    s_barrier
    v_mfma_f32_16x16x32_bf16 a[104:107], v[72:75], v[236:239], a[104:107]
    s_add_i32 s35, s35, 8192
    ds_read_b64_tr_b16 v[64:65], v5 offset:8448
    ds_read_b64_tr_b16 v[66:67], v5 offset:8960
    v_mfma_f32_16x16x32_bf16 a[108:111], v[76:79], v[236:239], a[108:111]
    ds_read_b64_tr_b16 v[68:69], v5 offset:8480
    ds_read_b64_tr_b16 v[70:71], v5 offset:8992
    v_mfma_f32_16x16x32_bf16 a[112:115], v[80:83], v[236:239], a[112:115]
    ds_read_b64_tr_b16 v[72:73], v5 offset:8512
    ds_read_b64_tr_b16 v[74:75], v5 offset:9024
    v_mfma_f32_16x16x32_bf16 a[116:119], v[84:87], v[236:239], a[116:119]
    ds_read_b64_tr_b16 v[76:77], v5 offset:8544
    ds_read_b64_tr_b16 v[78:79], v5 offset:9056
    v_mfma_f32_16x16x32_bf16 a[120:123], v[88:91], v[236:239], a[120:123]
    ds_read_b64_tr_b16 v[80:81], v5 offset:8576
    ds_read_b64_tr_b16 v[82:83], v5 offset:9088
    v_mfma_f32_16x16x32_bf16 a[124:127], v[92:95], v[236:239], a[124:127]
    ds_read_b64_tr_b16 v[84:85], v5 offset:8608
    ds_read_b64_tr_b16 v[86:87], v5 offset:9120
    v_mfma_f32_16x16x32_bf16 v[112:115], v[96:99], v[236:239], v[112:115]
    ds_read_b64_tr_b16 v[88:89], v5 offset:8640
    ds_read_b64_tr_b16 v[90:91], v5 offset:9152
    v_mfma_f32_16x16x32_bf16 v[192:195], v[32:35], v[128:131], 0
    ds_read_b64_tr_b16 v[92:93], v5 offset:8672
    ds_read_b64_tr_b16 v[94:95], v5 offset:9184
    v_mfma_f32_16x16x32_bf16 v[192:195], v[36:39], v[132:135], v[192:195]
    buffer_load_dwordx4 v6, s[8:11], s38 offen offset:0 nt lds
    v_mfma_f32_16x16x32_bf16 v[192:195], v[40:43], v[136:139], v[192:195]
    v_rcp_f32 v24, v100
    v_mfma_f32_16x16x32_bf16 v[192:195], v[44:47], v[140:143], v[192:195]
    v_cmp_nlt_f32 s[52:53], v100, s47
    v_add_u32 v4, s32, v2
    v_mfma_f32_16x16x32_bf16 v[196:199], v[60:63], v[140:143], 0
    s_add_u32 s32, s32, 16896
    v_rcp_f32 v25, v104
    v_mfma_f32_16x16x32_bf16 v[196:199], v[56:59], v[136:139], v[196:199]
    s_cmp_ge_u32 s32, 101376
    s_cselect_b32 s32, 0, s32
    v_max3_f32 v240, v192, v193, v194
    v_mfma_f32_16x16x32_bf16 v[196:199], v[52:55], v[132:135], v[196:199]
    buffer_load_dwordx4 v7, s[8:11], s38 offen offset:1056 nt lds
    v_mfma_f32_16x16x32_bf16 v[196:199], v[48:51], v[128:131], v[196:199]
    v_cmp_nlt_f32 s[54:55], v104, s47
    v_cmp_nlt_f32 s[56:57], v108, s47
    v_mfma_f32_16x16x32_bf16 v[200:203], v[32:35], v[144:147], 0
    v_rcp_f32 v26, v108
    v_mfma_f32_16x16x32_bf16 v[200:203], v[36:39], v[148:151], v[200:203]
    s_or_b64 s[52:53], s[52:53], s[54:55]
    v_add_u32 v5, s32, v3
    v_cmp_nlt_f32 s[58:59], v112, s47
    v_mfma_f32_16x16x32_bf16 v[200:203], v[40:43], v[152:155], v[200:203]
    s_or_b64 s[52:53], s[52:53], s[56:57]
    buffer_load_dwordx4 v8, s[8:11], s38 offen offset:2112 nt lds
    v_mfma_f32_16x16x32_bf16 v[200:203], v[44:47], v[156:159], v[200:203]
    s_or_b64 s[52:53], s[52:53], s[58:59]
    s_cselect_b32 s54, 1, 0
    v_max3_f32 v241, v195, v196, v197
    v_mfma_f32_16x16x32_bf16 v[204:207], v[60:63], v[156:159], 0
    s_lshl_b32 s57, s3, 2
    v_max3_f32 v240, v240, v198, v199
    v_accvgpr_read_b32 v116, a0
    v_mfma_f32_16x16x32_bf16 v[204:207], v[56:59], v[152:155], v[204:207]
    s_or_b32 s99, s99, s54
    v_max_f32 v240, v240, v241
    v_max3_f32 v244, v200, v201, v202
    v_mfma_f32_16x16x32_bf16 v[204:207], v[52:55], v[148:151], v[204:207]
    s_add_u32 s57, s57, 162816
    buffer_load_dwordx4 v9, s[8:11], s38 offen offset:3168 nt lds
    v_mfma_f32_16x16x32_bf16 v[204:207], v[48:51], v[144:147], v[204:207]
    s_add_u32 m0, s34, 84480
    v_mov_b32 v241, v240
    s_min_i32 s38, s39, 524288
    v_mfma_f32_16x16x32_bf16 v[208:211], v[32:35], v[160:163], 0
    s_max_i32 s39, s35, 0
    v_permlane32_swap_b32 v240, v241
    v_accvgpr_read_b32 v117, a1
    v_mfma_f32_16x16x32_bf16 v[208:211], v[36:39], v[164:167], v[208:211]
    s_add_i32 s35, s35, 8192
    v_max_f32 v240, v240, v241
    v_max3_f32 v245, v203, v204, v205
    v_mfma_f32_16x16x32_bf16 v[208:211], v[40:43], v[168:171], v[208:211]
    buffer_load_dwordx4 v6, s[8:11], s38 offen offset:0 nt lds
    v_mfma_f32_16x16x32_bf16 v[208:211], v[44:47], v[172:175], v[208:211]
    v_mov_b32 v241, v240
    v_max3_f32 v244, v244, v206, v207
    v_mfma_f32_16x16x32_bf16 v[212:215], v[60:63], v[172:175], 0
    v_permlane16_swap_b32 v240, v241
    v_max_f32 v244, v244, v245
    v_mfma_f32_16x16x32_bf16 v[212:215], v[56:59], v[168:171], v[212:215]
    v_max_f32 v240, v240, v241
    v_mov_b32 v245, v244
    v_mfma_f32_16x16x32_bf16 v[212:215], v[52:55], v[164:167], v[212:215]
    buffer_load_dwordx4 v7, s[8:11], s38 offen offset:1056 nt lds
    v_mfma_f32_16x16x32_bf16 v[212:215], v[48:51], v[160:163], v[212:215]
    s_waitcnt lgkmcnt(14)
    v_sub_f32 v192, v192, v240
    v_sub_f32 v193, v193, v240
    v_sub_f32 v194, v194, v240
    v_sub_f32 v195, v195, v240
    v_sub_f32 v196, v196, v240
    v_sub_f32 v197, v197, v240
    v_sub_f32 v198, v198, v240
    v_sub_f32 v199, v199, v240
    v_exp_f32 v192, v192
    buffer_load_dwordx4 v8, s[8:11], s38 offen offset:2112 nt lds
    v_exp_f32 v193, v193
    v_exp_f32 v194, v194
    v_exp_f32 v195, v195
    v_exp_f32 v196, v196
    v_exp_f32 v197, v197
    v_exp_f32 v198, v198
    buffer_load_dwordx4 v9, s[8:11], s38 offen offset:3168 nt lds
    v_exp_f32 v199, v199
    v_cvt_pk_bf16_f32 v224, v192, v193
    v_cvt_pk_bf16_f32 v225, v194, v195
    v_cvt_pk_bf16_f32 v226, v196, v197
    v_cvt_pk_bf16_f32 v227, v198, v199
    v_permlane32_swap_b32 v244, v245
    v_sub_f32 v241, 0, v240
    v_mfma_f32_16x16x32_bf16 a[128:131], v[64:67], v[224:227], 0
    s_waitcnt lgkmcnt(12)
    s_mov_b32 m0, s94
    v_max_f32 v244, v244, v245
    v_sub_f32 v242, 0, v240
    v_mfma_f32_16x16x32_bf16 a[132:135], v[68:71], v[224:227], 0
    s_waitcnt lgkmcnt(10)
    s_min_i32 s38, s39, 524288
    v_mov_b32 v245, v244
    v_sub_f32 v243, 0, v240
    v_mfma_f32_16x16x32_bf16 a[136:139], v[72:75], v[224:227], 0
    s_waitcnt lgkmcnt(8)
    v_permlane16_swap_b32 v244, v245
    v_sub_f32 v240, 0, v240
    v_mfma_f32_16x16x32_bf16 a[140:143], v[76:79], v[224:227], 0
    s_waitcnt lgkmcnt(6)
    v_max_f32 v244, v244, v245
    v_max3_f32 v248, v208, v209, v210
    v_mfma_f32_16x16x32_bf16 a[144:147], v[80:83], v[224:227], 0
    s_waitcnt lgkmcnt(4)
    v_sub_f32 v200, v200, v244
    v_sub_f32 v201, v201, v244
    v_mfma_f32_16x16x32_bf16 a[148:151], v[84:87], v[224:227], 0
    s_waitcnt lgkmcnt(2)
    v_sub_f32 v202, v202, v244
    v_sub_f32 v203, v203, v244
    v_mfma_f32_16x16x32_bf16 a[152:155], v[88:91], v[224:227], 0
    s_waitcnt lgkmcnt(0)
    v_sub_f32 v204, v204, v244
    v_sub_f32 v205, v205, v244
    v_mfma_f32_16x16x32_bf16 a[156:159], v[92:95], v[224:227], 0
    v_sub_f32 v206, v206, v244
    v_sub_f32 v207, v207, v244
    v_mfma_f32_16x16x32_bf16 v[100:103], v[96:99], v[224:227], 0
    v_exp_f32 v200, v200
    v_mfma_f32_16x16x32_bf16 v[216:219], v[32:35], v[176:179], 0
    ds_read_b128 v[32:35], v4 offset:0
    v_max3_f32 v249, v211, v212, v213
    v_mfma_f32_16x16x32_bf16 v[216:219], v[36:39], v[180:183], v[216:219]
    ds_read_b128 v[36:39], v4 offset:64
    v_max3_f32 v248, v248, v214, v215
    v_mfma_f32_16x16x32_bf16 v[216:219], v[40:43], v[184:187], v[216:219]
    ds_read_b128 v[40:43], v4 offset:128
    v_max_f32 v248, v248, v249
    v_mfma_f32_16x16x32_bf16 v[216:219], v[44:47], v[188:191], v[216:219]
    ds_read_b128 v[44:47], v4 offset:192
    v_mov_b32 v249, v248
    v_mfma_f32_16x16x32_bf16 v[220:223], v[60:63], v[188:191], 0
    ds_read_b128 v[60:63], v4 offset:704
    v_permlane32_swap_b32 v248, v249
    v_mfma_f32_16x16x32_bf16 v[220:223], v[56:59], v[184:187], v[220:223]
    ds_read_b128 v[56:59], v4 offset:640
    v_max_f32 v248, v248, v249
    v_mfma_f32_16x16x32_bf16 v[220:223], v[52:55], v[180:183], v[220:223]
    ds_read_b128 v[52:55], v4 offset:576
    v_mov_b32 v249, v248
    v_mfma_f32_16x16x32_bf16 v[220:223], v[48:51], v[176:179], v[220:223]
    ds_read_b128 v[48:51], v4 offset:512
    v_exp_f32 v201, v201
    v_exp_f32 v202, v202
    v_exp_f32 v203, v203
    v_exp_f32 v204, v204
    v_exp_f32 v205, v205
    v_exp_f32 v206, v206
    v_exp_f32 v207, v207
    v_cvt_pk_bf16_f32 v228, v200, v201
    v_cvt_pk_bf16_f32 v229, v202, v203
    v_cvt_pk_bf16_f32 v230, v204, v205
    v_cvt_pk_bf16_f32 v231, v206, v207
    v_permlane16_swap_b32 v248, v249
    v_sub_f32 v245, 0, v244
    v_mfma_f32_16x16x32_bf16 a[160:163], v[64:67], v[228:231], 0
    v_max_f32 v248, v248, v249
    v_sub_f32 v246, 0, v244
    v_mfma_f32_16x16x32_bf16 a[164:167], v[68:71], v[228:231], 0
    v_sub_f32 v208, v208, v248
    v_sub_f32 v209, v209, v248
    v_mfma_f32_16x16x32_bf16 a[168:171], v[72:75], v[228:231], 0
    v_sub_f32 v210, v210, v248
    v_sub_f32 v211, v211, v248
    v_mfma_f32_16x16x32_bf16 a[172:175], v[76:79], v[228:231], 0
    v_sub_f32 v212, v212, v248
    v_sub_f32 v213, v213, v248
    v_mfma_f32_16x16x32_bf16 a[176:179], v[80:83], v[228:231], 0
    s_waitcnt vmcnt(17) lgkmcnt(0)
    s_barrier
    v_mfma_f32_16x16x32_bf16 a[180:183], v[84:87], v[228:231], 0
    buffer_load_dwordx4 v6, s[8:11], s38 offen offset:0 nt lds
    v_mfma_f32_16x16x32_bf16 a[184:187], v[88:91], v[228:231], 0
    v_sub_f32 v214, v214, v248
    v_sub_f32 v215, v215, v248
    v_mfma_f32_16x16x32_bf16 a[188:191], v[92:95], v[228:231], 0
    v_exp_f32 v208, v208
    v_mfma_f32_16x16x32_bf16 v[104:107], v[96:99], v[228:231], 0
    v_exp_f32 v209, v209
    v_mfma_f32_16x16x32_bf16 v[192:195], v[32:35], v[128:131], v[240:243]
    buffer_load_dwordx4 v7, s[8:11], s38 offen offset:1056 nt lds
    v_mfma_f32_16x16x32_bf16 v[192:195], v[36:39], v[132:135], v[192:195]
    v_exp_f32 v210, v210
    v_mfma_f32_16x16x32_bf16 v[192:195], v[40:43], v[136:139], v[192:195]
    v_exp_f32 v211, v211
    v_mfma_f32_16x16x32_bf16 v[192:195], v[44:47], v[140:143], v[192:195]
    v_exp_f32 v212, v212
    v_mfma_f32_16x16x32_bf16 v[196:199], v[60:63], v[140:143], v[240:243]
    buffer_load_dwordx4 v8, s[8:11], s38 offen offset:2112 nt lds
    v_mfma_f32_16x16x32_bf16 v[196:199], v[56:59], v[136:139], v[196:199]
    v_exp_f32 v213, v213
    v_mfma_f32_16x16x32_bf16 v[196:199], v[52:55], v[132:135], v[196:199]
    v_exp_f32 v214, v214
    v_mfma_f32_16x16x32_bf16 v[196:199], v[48:51], v[128:131], v[196:199]
    v_exp_f32 v215, v215
    buffer_load_dwordx4 v9, s[8:11], s38 offen offset:3168 nt lds
    v_cvt_pk_bf16_f32 v232, v208, v209
    v_cvt_pk_bf16_f32 v233, v210, v211
    v_cvt_pk_bf16_f32 v234, v212, v213
    v_cvt_pk_bf16_f32 v235, v214, v215
    v_sub_f32 v247, 0, v244
    v_sub_f32 v244, 0, v244
    v_mfma_f32_16x16x32_bf16 a[192:195], v[64:67], v[232:235], 0
    v_max3_f32 v252, v216, v217, v218
    v_max3_f32 v253, v219, v220, v221
    v_mfma_f32_16x16x32_bf16 a[196:199], v[68:71], v[232:235], 0
    v_max3_f32 v252, v252, v222, v223
    v_sub_f32 v249, 0, v248
    v_mfma_f32_16x16x32_bf16 a[200:203], v[72:75], v[232:235], 0
    v_max_f32 v252, v252, v253
    v_sub_f32 v250, 0, v248
    v_mfma_f32_16x16x32_bf16 a[204:207], v[76:79], v[232:235], 0
    v_mov_b32 v253, v252
    v_sub_f32 v251, 0, v248
    v_mfma_f32_16x16x32_bf16 a[208:211], v[80:83], v[232:235], 0
    v_permlane32_swap_b32 v252, v253
    v_sub_f32 v248, 0, v248
    v_mfma_f32_16x16x32_bf16 a[212:215], v[84:87], v[232:235], 0
    v_max_f32 v252, v252, v253
    v_add_u32 v4, s32, v2
    v_mfma_f32_16x16x32_bf16 a[216:219], v[88:91], v[232:235], 0
    v_mov_b32 v253, v252
    v_accvgpr_read_b32 v118, a2
    v_mfma_f32_16x16x32_bf16 a[220:223], v[92:95], v[232:235], 0
    v_permlane16_swap_b32 v252, v253
    v_accvgpr_read_b32 v119, a3
    v_mfma_f32_16x16x32_bf16 v[108:111], v[96:99], v[232:235], 0
    v_max_f32 v252, v252, v253
    v_mul_f32 v116, v24, v116
    v_mfma_f32_16x16x32_bf16 v[200:203], v[32:35], v[144:147], v[244:247]
    v_sub_f32 v216, v216, v252
    v_sub_f32 v217, v217, v252
    v_mfma_f32_16x16x32_bf16 v[200:203], v[36:39], v[148:151], v[200:203]
    v_sub_f32 v218, v218, v252
    v_sub_f32 v219, v219, v252
    v_mfma_f32_16x16x32_bf16 v[200:203], v[40:43], v[152:155], v[200:203]
    v_sub_f32 v220, v220, v252
    v_sub_f32 v221, v221, v252
    v_mfma_f32_16x16x32_bf16 v[200:203], v[44:47], v[156:159], v[200:203]
    v_sub_f32 v222, v222, v252
    v_sub_f32 v223, v223, v252
    v_mfma_f32_16x16x32_bf16 v[204:207], v[60:63], v[156:159], v[244:247]
    v_exp_f32 v216, v216
    v_mfma_f32_16x16x32_bf16 v[204:207], v[56:59], v[152:155], v[204:207]
    v_exp_f32 v217, v217
    v_mfma_f32_16x16x32_bf16 v[204:207], v[52:55], v[148:151], v[204:207]
    v_exp_f32 v218, v218
    v_mfma_f32_16x16x32_bf16 v[204:207], v[48:51], v[144:147], v[204:207]
    v_exp_f32 v219, v219
    v_exp_f32 v220, v220
    v_exp_f32 v221, v221
    v_exp_f32 v222, v222
    v_exp_f32 v223, v223
    v_cvt_pk_bf16_f32 v236, v216, v217
    v_cvt_pk_bf16_f32 v237, v218, v219
    v_cvt_pk_bf16_f32 v238, v220, v221
    v_cvt_pk_bf16_f32 v239, v222, v223
    v_rcp_f32 v27, v112
    s_nop 0
    v_mfma_f32_16x16x32_bf16 a[224:227], v[64:67], v[236:239], 0
    ds_read_b64_tr_b16 v[64:65], v5 offset:8448
    ds_read_b64_tr_b16 v[66:67], v5 offset:8960
    v_mfma_f32_16x16x32_bf16 a[228:231], v[68:71], v[236:239], 0
    ds_read_b64_tr_b16 v[68:69], v5 offset:8480
    ds_read_b64_tr_b16 v[70:71], v5 offset:8992
    v_mfma_f32_16x16x32_bf16 a[232:235], v[72:75], v[236:239], 0
    ds_read_b64_tr_b16 v[72:73], v5 offset:8512
    ds_read_b64_tr_b16 v[74:75], v5 offset:9024
    v_mfma_f32_16x16x32_bf16 a[236:239], v[76:79], v[236:239], 0
    ds_read_b64_tr_b16 v[76:77], v5 offset:8544
    ds_read_b64_tr_b16 v[78:79], v5 offset:9056
    v_mfma_f32_16x16x32_bf16 a[240:243], v[80:83], v[236:239], 0
    ds_read_b64_tr_b16 v[80:81], v5 offset:8576
    ds_read_b64_tr_b16 v[82:83], v5 offset:9088
    v_mfma_f32_16x16x32_bf16 a[244:247], v[84:87], v[236:239], 0
    ds_read_b64_tr_b16 v[84:85], v5 offset:8608
    ds_read_b64_tr_b16 v[86:87], v5 offset:9120
    v_mfma_f32_16x16x32_bf16 a[248:251], v[88:91], v[236:239], 0
    ds_read_b64_tr_b16 v[88:89], v5 offset:8640
    ds_read_b64_tr_b16 v[90:91], v5 offset:9152
    v_mfma_f32_16x16x32_bf16 a[252:255], v[92:95], v[236:239], 0
    ds_read_b64_tr_b16 v[92:93], v5 offset:8672
    ds_read_b64_tr_b16 v[94:95], v5 offset:9184
    v_mfma_f32_16x16x32_bf16 v[112:115], v[96:99], v[236:239], 0
    v_exp_f32 v192, v192
    v_mfma_f32_16x16x32_bf16 v[208:211], v[32:35], v[160:163], v[248:251]
    v_exp_f32 v193, v193
    v_mfma_f32_16x16x32_bf16 v[208:211], v[36:39], v[164:167], v[208:211]
    v_exp_f32 v194, v194
    v_mfma_f32_16x16x32_bf16 v[208:211], v[40:43], v[168:171], v[208:211]
    v_exp_f32 v195, v195
    v_mfma_f32_16x16x32_bf16 v[208:211], v[44:47], v[172:175], v[208:211]
    v_exp_f32 v196, v196
    v_mfma_f32_16x16x32_bf16 v[212:215], v[60:63], v[172:175], v[248:251]
    v_exp_f32 v197, v197
    v_mfma_f32_16x16x32_bf16 v[212:215], v[56:59], v[168:171], v[212:215]
    v_exp_f32 v198, v198
    v_mfma_f32_16x16x32_bf16 v[212:215], v[52:55], v[164:167], v[212:215]
    v_exp_f32 v199, v199
    v_mfma_f32_16x16x32_bf16 v[212:215], v[48:51], v[160:163], v[212:215]
    s_waitcnt lgkmcnt(14)
    v_cvt_pk_bf16_f32 v224, v192, v193
    v_cvt_pk_bf16_f32 v225, v194, v195
    v_cvt_pk_bf16_f32 v226, v196, v197
    v_cvt_pk_bf16_f32 v227, v198, v199
    v_sub_f32 v253, 0, v252
    v_sub_f32 v254, 0, v252
    v_mfma_f32_16x16x32_bf16 a[128:131], v[64:67], v[224:227], a[128:131]
    s_waitcnt lgkmcnt(12)
    v_sub_f32 v255, 0, v252
    v_sub_f32 v252, 0, v252
    v_mfma_f32_16x16x32_bf16 a[132:135], v[68:71], v[224:227], a[132:135]
    s_waitcnt lgkmcnt(10)
    v_exp_f32 v200, v200
    v_mfma_f32_16x16x32_bf16 a[136:139], v[72:75], v[224:227], a[136:139]
    s_waitcnt lgkmcnt(8)
    v_exp_f32 v201, v201
    v_mfma_f32_16x16x32_bf16 a[140:143], v[76:79], v[224:227], a[140:143]
    s_waitcnt lgkmcnt(6)
    v_exp_f32 v202, v202
    v_mfma_f32_16x16x32_bf16 a[144:147], v[80:83], v[224:227], a[144:147]
    s_waitcnt lgkmcnt(4)
    v_exp_f32 v203, v203
    v_mfma_f32_16x16x32_bf16 a[148:151], v[84:87], v[224:227], a[148:151]
    s_waitcnt lgkmcnt(2)
    v_exp_f32 v204, v204
    v_mfma_f32_16x16x32_bf16 a[152:155], v[88:91], v[224:227], a[152:155]
    s_waitcnt lgkmcnt(0)
    v_exp_f32 v205, v205
    v_mfma_f32_16x16x32_bf16 a[156:159], v[92:95], v[224:227], a[156:159]
    v_exp_f32 v206, v206
    v_mfma_f32_16x16x32_bf16 v[100:103], v[96:99], v[224:227], v[100:103]
    v_exp_f32 v207, v207
    v_mfma_f32_16x16x32_bf16 v[216:219], v[32:35], v[176:179], v[252:255]
    ds_read_b128 v[32:35], v4 offset:0
    v_cvt_pk_bf16_f32 v228, v200, v201
    v_mfma_f32_16x16x32_bf16 v[216:219], v[36:39], v[180:183], v[216:219]
    ds_read_b128 v[36:39], v4 offset:64
    v_cvt_pk_bf16_f32 v229, v202, v203
    v_mfma_f32_16x16x32_bf16 v[216:219], v[40:43], v[184:187], v[216:219]
    ds_read_b128 v[40:43], v4 offset:128
    v_cvt_pk_bf16_f32 v230, v204, v205
    v_mfma_f32_16x16x32_bf16 v[216:219], v[44:47], v[188:191], v[216:219]
    ds_read_b128 v[44:47], v4 offset:192
    v_cvt_pk_bf16_f32 v231, v206, v207
    v_mfma_f32_16x16x32_bf16 v[220:223], v[60:63], v[188:191], v[252:255]
    ds_read_b128 v[60:63], v4 offset:704
    v_mul_f32 v117, v24, v117
    v_mfma_f32_16x16x32_bf16 v[220:223], v[56:59], v[184:187], v[220:223]
    ds_read_b128 v[56:59], v4 offset:640
    v_mul_f32 v118, v24, v118
    v_mfma_f32_16x16x32_bf16 v[220:223], v[52:55], v[180:183], v[220:223]
    ds_read_b128 v[52:55], v4 offset:576
    v_mul_f32 v119, v24, v119
    v_mfma_f32_16x16x32_bf16 v[220:223], v[48:51], v[176:179], v[220:223]
    ds_read_b128 v[48:51], v4 offset:512
    v_cvt_pk_bf16_f32 v120, v116, v117
    v_mfma_f32_16x16x32_bf16 a[160:163], v[64:67], v[228:231], a[160:163]
    v_cvt_pk_bf16_f32 v121, v118, v119
    v_accvgpr_read_b32 v10, a4
    v_mfma_f32_16x16x32_bf16 a[164:167], v[68:71], v[228:231], a[164:167]
    ds_write_b64 v18, v[120:121] offset:0
    v_mfma_f32_16x16x32_bf16 a[168:171], v[72:75], v[228:231], a[168:171]
    v_accvgpr_read_b32 v11, a5
    v_accvgpr_read_b32 v12, a6
    v_mfma_f32_16x16x32_bf16 a[172:175], v[76:79], v[228:231], a[172:175]
    v_accvgpr_read_b32 v13, a7
    v_accvgpr_read_b32 v116, a8
    v_mfma_f32_16x16x32_bf16 a[176:179], v[80:83], v[228:231], a[176:179]
    v_accvgpr_read_b32 v117, a9
    v_accvgpr_read_b32 v118, a10
    v_mfma_f32_16x16x32_bf16 a[180:183], v[84:87], v[228:231], a[180:183]
    v_accvgpr_read_b32 v119, a11
    v_mul_f32 v10, v24, v10
    v_mfma_f32_16x16x32_bf16 a[184:187], v[88:91], v[228:231], a[184:187]
    v_mul_f32 v11, v24, v11
    v_mul_f32 v12, v24, v12
    v_mfma_f32_16x16x32_bf16 a[188:191], v[92:95], v[228:231], a[188:191]
    v_mul_f32 v13, v24, v13
    v_mul_f32 v116, v24, v116
    v_mfma_f32_16x16x32_bf16 v[104:107], v[96:99], v[228:231], v[104:107]
    v_mul_f32 v117, v24, v117
    v_mul_f32 v118, v24, v118
    v_mul_f32 v119, v24, v119
    v_cvt_pk_bf16_f32 v14, v10, v11
    v_cvt_pk_bf16_f32 v15, v12, v13
    v_cvt_pk_bf16_f32 v120, v116, v117
    ds_write_b64 v18, v[14:15] offset:8
    v_cvt_pk_bf16_f32 v121, v118, v119
    v_accvgpr_read_b32 v10, a12
    ds_write_b64 v18, v[120:121] offset:1024
    v_accvgpr_read_b32 v11, a13
    v_accvgpr_read_b32 v12, a14
    v_accvgpr_read_b32 v13, a15
    v_accvgpr_read_b32 v116, a16
    v_accvgpr_read_b32 v117, a17
    v_accvgpr_read_b32 v118, a18
    v_accvgpr_read_b32 v119, a19
    v_mul_f32 v10, v24, v10
    v_mul_f32 v11, v24, v11
    v_mul_f32 v12, v24, v12
    v_mul_f32 v13, v24, v13
    v_mul_f32 v116, v24, v116
    v_mul_f32 v117, v24, v117
    v_mul_f32 v118, v24, v118
    v_mul_f32 v119, v24, v119
    v_cvt_pk_bf16_f32 v14, v10, v11
    v_cvt_pk_bf16_f32 v15, v12, v13
    v_cvt_pk_bf16_f32 v120, v116, v117
    ds_write_b64 v18, v[14:15] offset:1032
    v_cvt_pk_bf16_f32 v121, v118, v119
    v_accvgpr_read_b32 v10, a20
    ds_write_b64 v18, v[120:121] offset:2048
    v_accvgpr_read_b32 v11, a21
    v_accvgpr_read_b32 v12, a22
    v_accvgpr_read_b32 v13, a23
    v_accvgpr_read_b32 v116, a24
    v_accvgpr_read_b32 v117, a25
    v_accvgpr_read_b32 v118, a26
    v_accvgpr_read_b32 v119, a27
    v_mul_f32 v10, v24, v10
    v_mul_f32 v11, v24, v11
    v_mul_f32 v12, v24, v12
    v_mul_f32 v13, v24, v13
    v_mul_f32 v116, v24, v116
    v_mul_f32 v117, v24, v117
    v_mul_f32 v118, v24, v118
    v_mul_f32 v119, v24, v119
    v_exp_f32 v208, v208
    v_exp_f32 v209, v209
    v_exp_f32 v210, v210
    v_exp_f32 v211, v211
    v_exp_f32 v212, v212
    v_exp_f32 v213, v213
    v_exp_f32 v214, v214
    v_exp_f32 v215, v215
    v_mov_b32 v21, s57
    v_mov_b32 v22, s99
    v_cvt_pk_bf16_f32 v14, v10, v11
    ds_write_b32 v21, v22
    v_cvt_pk_bf16_f32 v15, v12, v13
    v_cvt_pk_bf16_f32 v120, v116, v117
    ds_write_b64 v18, v[14:15] offset:2056
    v_cvt_pk_bf16_f32 v121, v118, v119
    v_cvt_pk_bf16_f32 v232, v208, v209
    ds_write_b64 v18, v[120:121] offset:3072
    v_cvt_pk_bf16_f32 v233, v210, v211
    v_cvt_pk_bf16_f32 v234, v212, v213
    v_cvt_pk_bf16_f32 v235, v214, v215
    v_exp_f32 v216, v216
    v_exp_f32 v217, v217
    v_exp_f32 v218, v218
    v_exp_f32 v219, v219
    v_exp_f32 v220, v220
    v_exp_f32 v221, v221
    v_exp_f32 v222, v222
    s_mov_b32 s44, 0
    s_mov_b32 s95, 7
    s_mov_b32 s96, 28
    s_mov_b32 s97, 3080
    s_waitcnt lgkmcnt(0)
.p2align 6
L1v4_bloop:
    v_mfma_f32_16x16x32_bf16 v[192:195], v[32:35], v[128:131], v[240:243]
    s_waitcnt vmcnt(16) lgkmcnt(0)
    v_exp_f32 v223, v223
    v_mfma_f32_16x16x32_bf16 v[192:195], v[36:39], v[132:135], v[192:195]
    s_barrier
    v_mfma_f32_16x16x32_bf16 v[192:195], v[40:43], v[136:139], v[192:195]
    s_add_u32 s94, s32, s34
    v_cvt_pk_bf16_f32 v236, v216, v217
    v_cvt_pk_bf16_f32 v237, v218, v219
    v_mfma_f32_16x16x32_bf16 v[192:195], v[44:47], v[140:143], v[192:195]
    s_add_u32 s32, s32, 16896
    v_cvt_pk_bf16_f32 v238, v220, v221
    v_cvt_pk_bf16_f32 v239, v222, v223
    v_mfma_f32_16x16x32_bf16 v[196:199], v[60:63], v[140:143], v[240:243]
    s_cmp_ge_u32 s32, 101376
    v_add_u32 v122, s97, v18
    v_mfma_f32_16x16x32_bf16 v[196:199], v[56:59], v[136:139], v[196:199]
    s_set_gpr_idx_on s96, gpr_idx(SRC0)
    v_accvgpr_read_b32 v116, a0
    v_accvgpr_read_b32 v117, a1
    s_set_gpr_idx_off
    v_mfma_f32_16x16x32_bf16 v[196:199], v[52:55], v[132:135], v[196:199]
    s_set_gpr_idx_on s96, gpr_idx(SRC0)
    v_accvgpr_read_b32 v118, a2
    v_accvgpr_read_b32 v119, a3
    s_set_gpr_idx_off
    v_mfma_f32_16x16x32_bf16 v[196:199], v[48:51], v[128:131], v[196:199]
    s_cselect_b32 s32, 0, s32
    v_mul_f32 v116, v24, v116
    v_mul_f32 v117, v24, v117
    v_mfma_f32_16x16x32_bf16 a[192:195], v[64:67], v[232:235], a[192:195]
    s_mov_b32 m0, s94
    v_add_u32 v5, s32, v3
    v_add_u32 v4, s32, v2
    v_mfma_f32_16x16x32_bf16 a[196:199], v[68:71], v[232:235], a[196:199]
    s_max_i32 s39, s35, 0
    v_mul_f32 v118, v24, v118
    v_mul_f32 v119, v24, v119
    v_mfma_f32_16x16x32_bf16 a[200:203], v[72:75], v[232:235], a[200:203]
    s_min_i32 s38, s39, 524288
    v_exp_f32 v192, v192
    v_mfma_f32_16x16x32_bf16 a[204:207], v[76:79], v[232:235], a[204:207]
    s_add_i32 s35, s35, 8192
    v_exp_f32 v193, v193
    v_mfma_f32_16x16x32_bf16 a[208:211], v[80:83], v[232:235], a[208:211]
    v_exp_f32 v194, v194
    v_mfma_f32_16x16x32_bf16 a[212:215], v[84:87], v[232:235], a[212:215]
    v_exp_f32 v195, v195
    v_mfma_f32_16x16x32_bf16 a[216:219], v[88:91], v[232:235], a[216:219]
    buffer_load_dwordx4 v6, s[8:11], s38 offen offset:0 nt lds
    v_mfma_f32_16x16x32_bf16 a[220:223], v[92:95], v[232:235], a[220:223]
    v_exp_f32 v196, v196
    v_mfma_f32_16x16x32_bf16 v[108:111], v[96:99], v[232:235], v[108:111]
    v_exp_f32 v197, v197
    v_mfma_f32_16x16x32_bf16 v[200:203], v[32:35], v[144:147], v[244:247]
    buffer_load_dwordx4 v7, s[8:11], s38 offen offset:1056 nt lds
    v_mfma_f32_16x16x32_bf16 v[200:203], v[36:39], v[148:151], v[200:203]
    v_exp_f32 v198, v198
    v_mfma_f32_16x16x32_bf16 v[200:203], v[40:43], v[152:155], v[200:203]
    v_exp_f32 v199, v199
    v_mfma_f32_16x16x32_bf16 v[200:203], v[44:47], v[156:159], v[200:203]
    buffer_load_dwordx4 v8, s[8:11], s38 offen offset:2112 nt lds
    v_mfma_f32_16x16x32_bf16 v[204:207], v[60:63], v[156:159], v[244:247]
    v_cvt_pk_bf16_f32 v224, v192, v193
    v_cvt_pk_bf16_f32 v225, v194, v195
    v_mfma_f32_16x16x32_bf16 v[204:207], v[56:59], v[152:155], v[204:207]
    v_cvt_pk_bf16_f32 v226, v196, v197
    v_cvt_pk_bf16_f32 v227, v198, v199
    v_mfma_f32_16x16x32_bf16 v[204:207], v[52:55], v[148:151], v[204:207]
    buffer_load_dwordx4 v9, s[8:11], s38 offen offset:3168 nt lds
    v_mfma_f32_16x16x32_bf16 v[204:207], v[48:51], v[144:147], v[204:207]
    v_cvt_pk_bf16_f32 v120, v116, v117
    v_cvt_pk_bf16_f32 v121, v118, v119
    v_mfma_f32_16x16x32_bf16 a[224:227], v[64:67], v[236:239], a[224:227]
    ds_read_b64_tr_b16 v[64:65], v5 offset:8448
    ds_read_b64_tr_b16 v[66:67], v5 offset:8960
    v_mfma_f32_16x16x32_bf16 a[228:231], v[68:71], v[236:239], a[228:231]
    s_add_u32 s95, s95, 1
    ds_read_b64_tr_b16 v[68:69], v5 offset:8480
    ds_read_b64_tr_b16 v[70:71], v5 offset:8992
    v_mfma_f32_16x16x32_bf16 a[232:235], v[72:75], v[236:239], a[232:235]
    s_min_u32 s98, s95, 31
    ds_read_b64_tr_b16 v[72:73], v5 offset:8512
    ds_read_b64_tr_b16 v[74:75], v5 offset:9024
    v_mfma_f32_16x16x32_bf16 a[236:239], v[76:79], v[236:239], a[236:239]
    s_lshl_b32 s96, s98, 2
    ds_read_b64_tr_b16 v[76:77], v5 offset:8544
    ds_read_b64_tr_b16 v[78:79], v5 offset:9056
    v_mfma_f32_16x16x32_bf16 a[240:243], v[80:83], v[236:239], a[240:243]
    s_lshr_b32 s97, s98, 1
    ds_read_b64_tr_b16 v[80:81], v5 offset:8576
    ds_read_b64_tr_b16 v[82:83], v5 offset:9088
    v_mfma_f32_16x16x32_bf16 a[244:247], v[84:87], v[236:239], a[244:247]
    s_lshl_b32 s97, s97, 10
    ds_read_b64_tr_b16 v[84:85], v5 offset:8608
    ds_read_b64_tr_b16 v[86:87], v5 offset:9120
    v_mfma_f32_16x16x32_bf16 a[248:251], v[88:91], v[236:239], a[248:251]
    s_and_b32 s98, s98, 1
    ds_read_b64_tr_b16 v[88:89], v5 offset:8640
    ds_read_b64_tr_b16 v[90:91], v5 offset:9152
    v_mfma_f32_16x16x32_bf16 a[252:255], v[92:95], v[236:239], a[252:255]
    s_lshl_b32 s98, s98, 3
    ds_read_b64_tr_b16 v[92:93], v5 offset:8672
    ds_read_b64_tr_b16 v[94:95], v5 offset:9184
    v_mfma_f32_16x16x32_bf16 v[112:115], v[96:99], v[236:239], v[112:115]
    s_add_u32 s97, s97, s98
    v_exp_f32 v200, v200
    v_mfma_f32_16x16x32_bf16 v[208:211], v[32:35], v[160:163], v[248:251]
    v_exp_f32 v201, v201
    v_mfma_f32_16x16x32_bf16 v[208:211], v[36:39], v[164:167], v[208:211]
    v_exp_f32 v202, v202
    v_mfma_f32_16x16x32_bf16 v[208:211], v[40:43], v[168:171], v[208:211]
    v_exp_f32 v203, v203
    v_mfma_f32_16x16x32_bf16 v[208:211], v[44:47], v[172:175], v[208:211]
    v_exp_f32 v204, v204
    v_mfma_f32_16x16x32_bf16 v[212:215], v[60:63], v[172:175], v[248:251]
    v_exp_f32 v205, v205
    v_mfma_f32_16x16x32_bf16 v[212:215], v[56:59], v[168:171], v[212:215]
    v_exp_f32 v206, v206
    v_mfma_f32_16x16x32_bf16 v[212:215], v[52:55], v[164:167], v[212:215]
    v_exp_f32 v207, v207
    v_mfma_f32_16x16x32_bf16 v[212:215], v[48:51], v[160:163], v[212:215]
    s_waitcnt lgkmcnt(14)
    v_cvt_pk_bf16_f32 v228, v200, v201
    v_cvt_pk_bf16_f32 v229, v202, v203
    v_mfma_f32_16x16x32_bf16 a[128:131], v[64:67], v[224:227], a[128:131]
    s_waitcnt lgkmcnt(12)
    v_cvt_pk_bf16_f32 v230, v204, v205
    v_cvt_pk_bf16_f32 v231, v206, v207
    v_mfma_f32_16x16x32_bf16 a[132:135], v[68:71], v[224:227], a[132:135]
    s_waitcnt lgkmcnt(10)
    ds_write_b64 v122, v[120:121]
    v_mfma_f32_16x16x32_bf16 a[136:139], v[72:75], v[224:227], a[136:139]
    s_waitcnt lgkmcnt(9)
    v_exp_f32 v208, v208
    v_mfma_f32_16x16x32_bf16 a[140:143], v[76:79], v[224:227], a[140:143]
    s_waitcnt lgkmcnt(7)
    v_exp_f32 v209, v209
    v_mfma_f32_16x16x32_bf16 a[144:147], v[80:83], v[224:227], a[144:147]
    s_waitcnt lgkmcnt(5)
    v_exp_f32 v210, v210
    v_mfma_f32_16x16x32_bf16 a[148:151], v[84:87], v[224:227], a[148:151]
    s_waitcnt lgkmcnt(3)
    v_exp_f32 v211, v211
    v_mfma_f32_16x16x32_bf16 a[152:155], v[88:91], v[224:227], a[152:155]
    s_waitcnt lgkmcnt(1)
    v_exp_f32 v212, v212
    v_mfma_f32_16x16x32_bf16 a[156:159], v[92:95], v[224:227], a[156:159]
    v_exp_f32 v213, v213
    v_mfma_f32_16x16x32_bf16 v[100:103], v[96:99], v[224:227], v[100:103]
    v_exp_f32 v214, v214
    v_mfma_f32_16x16x32_bf16 v[216:219], v[32:35], v[176:179], v[252:255]
    ds_read_b128 v[32:35], v4 offset:0
    v_cvt_pk_bf16_f32 v232, v208, v209
    v_mfma_f32_16x16x32_bf16 v[216:219], v[36:39], v[180:183], v[216:219]
    ds_read_b128 v[36:39], v4 offset:64
    v_cvt_pk_bf16_f32 v233, v210, v211
    v_mfma_f32_16x16x32_bf16 v[216:219], v[40:43], v[184:187], v[216:219]
    ds_read_b128 v[40:43], v4 offset:128
    v_cvt_pk_bf16_f32 v234, v212, v213
    v_mfma_f32_16x16x32_bf16 v[216:219], v[44:47], v[188:191], v[216:219]
    ds_read_b128 v[44:47], v4 offset:192
    v_mfma_f32_16x16x32_bf16 v[220:223], v[60:63], v[188:191], v[252:255]
    ds_read_b128 v[60:63], v4 offset:704
    v_mfma_f32_16x16x32_bf16 v[220:223], v[56:59], v[184:187], v[220:223]
    ds_read_b128 v[56:59], v4 offset:640
    v_mfma_f32_16x16x32_bf16 v[220:223], v[52:55], v[180:183], v[220:223]
    ds_read_b128 v[52:55], v4 offset:576
    v_mfma_f32_16x16x32_bf16 v[220:223], v[48:51], v[176:179], v[220:223]
    ds_read_b128 v[48:51], v4 offset:512
    v_mfma_f32_16x16x32_bf16 a[160:163], v[64:67], v[228:231], a[160:163]
    v_exp_f32 v215, v215
    v_mfma_f32_16x16x32_bf16 a[164:167], v[68:71], v[228:231], a[164:167]
    v_cvt_pk_bf16_f32 v235, v214, v215
    v_mfma_f32_16x16x32_bf16 a[168:171], v[72:75], v[228:231], a[168:171]
    v_exp_f32 v216, v216
    v_mfma_f32_16x16x32_bf16 a[172:175], v[76:79], v[228:231], a[172:175]
    s_and_b32 s98, s95, 7
    v_exp_f32 v217, v217
    v_mfma_f32_16x16x32_bf16 a[176:179], v[80:83], v[228:231], a[176:179]
    s_cbranch_scc0 L1v4_rot
L1v4_rotb:
    v_exp_f32 v218, v218
    v_mfma_f32_16x16x32_bf16 a[180:183], v[84:87], v[228:231], a[180:183]
    v_exp_f32 v219, v219
    v_mfma_f32_16x16x32_bf16 a[184:187], v[88:91], v[228:231], a[184:187]
    s_add_u32 s44, s44, 1
    v_exp_f32 v220, v220
    v_mfma_f32_16x16x32_bf16 a[188:191], v[92:95], v[228:231], a[188:191]
    s_cmp_lt_u32 s44, 25
    v_exp_f32 v221, v221
    v_mfma_f32_16x16x32_bf16 v[104:107], v[96:99], v[228:231], v[104:107]
    s_waitcnt lgkmcnt(0)
    v_exp_f32 v222, v222
    s_cbranch_scc1 L1v4_bloop
    s_mov_b32 s44, 0
L1v4_non:
    v_readfirstlane_b32 s69, v0
    s_nop 3
    s_cmp_eq_u32 s69, 0
    s_cbranch_scc1 L1v4_nons
L1v4_nong:
    s_mov_b32 s44, 0
    s_getpc_b64 s[4:5]
L1v4_pc2:
    s_mov_b32 s6, L1_fbs-L1v4_pc2
    s_mov_b32 s7, 0x20000
    s_lshl_b32 s57, s3, 11
    s_add_u32 s57, s57, L2_start-L1v4_pc2
    v_lshl_add_u32 v21, v20, 1, s57
    buffer_load_dword v22, v21, s[4:7], 0 offen
    s_bfe_u32 s57, s2, 0x20003
    s_lshl_b32 s57, s57, 11
    v_lshl_add_u32 v21, v20, 1, s57
    buffer_load_dword v22, v21, s[4:7], 0 offen
.p2align 4
L1v4_dloop:
    v_mfma_f32_16x16x32_bf16 v[192:195], v[32:35], v[128:131], v[240:243]
    s_waitcnt vmcnt(16) lgkmcnt(0)
    v_exp_f32 v223, v223
    v_mfma_f32_16x16x32_bf16 v[192:195], v[36:39], v[132:135], v[192:195]
    s_barrier
    v_mfma_f32_16x16x32_bf16 v[192:195], v[40:43], v[136:139], v[192:195]
    v_cvt_pk_bf16_f32 v236, v216, v217
    v_cvt_pk_bf16_f32 v237, v218, v219
    v_mfma_f32_16x16x32_bf16 v[192:195], v[44:47], v[140:143], v[192:195]
    s_add_u32 s32, s32, 16896
    v_cvt_pk_bf16_f32 v238, v220, v221
    v_cvt_pk_bf16_f32 v239, v222, v223
    v_mfma_f32_16x16x32_bf16 v[196:199], v[60:63], v[140:143], v[240:243]
    s_cmp_ge_u32 s32, 101376
    v_mfma_f32_16x16x32_bf16 v[196:199], v[56:59], v[136:139], v[196:199]
    ds_read_b128 v[124:127], v19 offset:0
    ds_read_b128 v[28:31], v19 offset:1024
    v_mfma_f32_16x16x32_bf16 v[196:199], v[52:55], v[132:135], v[196:199]
    ds_read_b128 v[10:13], v19 offset:2048
    ds_read_b128 v[14:17], v19 offset:3072
    v_mfma_f32_16x16x32_bf16 v[196:199], v[48:51], v[128:131], v[196:199]
    s_cselect_b32 s32, 0, s32
    v_mfma_f32_16x16x32_bf16 a[192:195], v[64:67], v[232:235], a[192:195]
    s_cmp_lt_u32 s44, 4
    v_add_u32 v5, s32, v3
    v_add_u32 v4, s32, v2
    v_mfma_f32_16x16x32_bf16 a[196:199], v[68:71], v[232:235], a[196:199]
    s_cselect_b32 s86, s37, 0
    v_mfma_f32_16x16x32_bf16 a[200:203], v[72:75], v[232:235], a[200:203]
    v_exp_f32 v192, v192
    v_mfma_f32_16x16x32_bf16 a[204:207], v[76:79], v[232:235], a[204:207]
    v_exp_f32 v193, v193
    v_mfma_f32_16x16x32_bf16 a[208:211], v[80:83], v[232:235], a[208:211]
    s_cmp_lt_u32 s44, 3
    v_exp_f32 v194, v194
    v_mfma_f32_16x16x32_bf16 a[212:215], v[84:87], v[232:235], a[212:215]
    s_cselect_b32 s68, 4096, 0
    v_exp_f32 v195, v195
    v_mfma_f32_16x16x32_bf16 a[216:219], v[88:91], v[232:235], a[216:219]
    s_waitcnt lgkmcnt(3)
    buffer_store_dwordx4 v[124:127], v19, s[84:87], 0 offen offset:0 sc1
    v_mfma_f32_16x16x32_bf16 a[220:223], v[92:95], v[232:235], a[220:223]
    v_exp_f32 v196, v196
    v_mfma_f32_16x16x32_bf16 v[108:111], v[96:99], v[232:235], v[108:111]
    v_exp_f32 v197, v197
    v_mfma_f32_16x16x32_bf16 v[200:203], v[32:35], v[144:147], v[244:247]
    s_waitcnt lgkmcnt(2)
    buffer_store_dwordx4 v[28:31], v19, s[84:87], 0 offen offset:1024 sc1
    v_mfma_f32_16x16x32_bf16 v[200:203], v[36:39], v[148:151], v[200:203]
    v_exp_f32 v198, v198
    v_mfma_f32_16x16x32_bf16 v[200:203], v[40:43], v[152:155], v[200:203]
    v_exp_f32 v199, v199
    v_mfma_f32_16x16x32_bf16 v[200:203], v[44:47], v[156:159], v[200:203]
    s_waitcnt lgkmcnt(1)
    buffer_store_dwordx4 v[10:13], v19, s[84:87], 0 offen offset:2048 sc1
    v_mfma_f32_16x16x32_bf16 v[204:207], v[60:63], v[156:159], v[244:247]
    v_cvt_pk_bf16_f32 v224, v192, v193
    v_cvt_pk_bf16_f32 v225, v194, v195
    v_mfma_f32_16x16x32_bf16 v[204:207], v[56:59], v[152:155], v[204:207]
    v_cvt_pk_bf16_f32 v226, v196, v197
    v_cvt_pk_bf16_f32 v227, v198, v199
    v_mfma_f32_16x16x32_bf16 v[204:207], v[52:55], v[148:151], v[204:207]
    s_waitcnt lgkmcnt(0)
    buffer_store_dwordx4 v[14:17], v19, s[84:87], 0 offen offset:3072 sc1
    v_mfma_f32_16x16x32_bf16 v[204:207], v[48:51], v[144:147], v[204:207]
    v_mfma_f32_16x16x32_bf16 a[224:227], v[64:67], v[236:239], a[224:227]
    ds_read_b64_tr_b16 v[64:65], v5 offset:8448
    ds_read_b64_tr_b16 v[66:67], v5 offset:8960
    v_mfma_f32_16x16x32_bf16 a[228:231], v[68:71], v[236:239], a[228:231]
    ds_read_b64_tr_b16 v[68:69], v5 offset:8480
    ds_read_b64_tr_b16 v[70:71], v5 offset:8992
    v_mfma_f32_16x16x32_bf16 a[232:235], v[72:75], v[236:239], a[232:235]
    ds_read_b64_tr_b16 v[72:73], v5 offset:8512
    ds_read_b64_tr_b16 v[74:75], v5 offset:9024
    v_mfma_f32_16x16x32_bf16 a[236:239], v[76:79], v[236:239], a[236:239]
    ds_read_b64_tr_b16 v[76:77], v5 offset:8544
    ds_read_b64_tr_b16 v[78:79], v5 offset:9056
    v_mfma_f32_16x16x32_bf16 a[240:243], v[80:83], v[236:239], a[240:243]
    ds_read_b64_tr_b16 v[80:81], v5 offset:8576
    ds_read_b64_tr_b16 v[82:83], v5 offset:9088
    v_mfma_f32_16x16x32_bf16 a[244:247], v[84:87], v[236:239], a[244:247]
    ds_read_b64_tr_b16 v[84:85], v5 offset:8608
    ds_read_b64_tr_b16 v[86:87], v5 offset:9120
    v_mfma_f32_16x16x32_bf16 a[248:251], v[88:91], v[236:239], a[248:251]
    ds_read_b64_tr_b16 v[88:89], v5 offset:8640
    ds_read_b64_tr_b16 v[90:91], v5 offset:9152
    v_mfma_f32_16x16x32_bf16 a[252:255], v[92:95], v[236:239], a[252:255]
    ds_read_b64_tr_b16 v[92:93], v5 offset:8672
    ds_read_b64_tr_b16 v[94:95], v5 offset:9184
    v_mfma_f32_16x16x32_bf16 v[112:115], v[96:99], v[236:239], v[112:115]
    v_exp_f32 v200, v200
    v_mfma_f32_16x16x32_bf16 v[208:211], v[32:35], v[160:163], v[248:251]
    v_exp_f32 v201, v201
    v_mfma_f32_16x16x32_bf16 v[208:211], v[36:39], v[164:167], v[208:211]
    v_exp_f32 v202, v202
    v_mfma_f32_16x16x32_bf16 v[208:211], v[40:43], v[168:171], v[208:211]
    v_exp_f32 v203, v203
    v_mfma_f32_16x16x32_bf16 v[208:211], v[44:47], v[172:175], v[208:211]
    v_exp_f32 v204, v204
    v_mfma_f32_16x16x32_bf16 v[212:215], v[60:63], v[172:175], v[248:251]
    v_exp_f32 v205, v205
    v_mfma_f32_16x16x32_bf16 v[212:215], v[56:59], v[168:171], v[212:215]
    v_exp_f32 v206, v206
    v_mfma_f32_16x16x32_bf16 v[212:215], v[52:55], v[164:167], v[212:215]
    v_exp_f32 v207, v207
    v_mfma_f32_16x16x32_bf16 v[212:215], v[48:51], v[160:163], v[212:215]
    s_waitcnt lgkmcnt(14)
    v_cvt_pk_bf16_f32 v228, v200, v201
    v_cvt_pk_bf16_f32 v229, v202, v203
    v_mfma_f32_16x16x32_bf16 a[128:131], v[64:67], v[224:227], a[128:131]
    s_waitcnt lgkmcnt(12)
    v_cvt_pk_bf16_f32 v230, v204, v205
    v_cvt_pk_bf16_f32 v231, v206, v207
    v_mfma_f32_16x16x32_bf16 a[132:135], v[68:71], v[224:227], a[132:135]
    s_waitcnt lgkmcnt(10)
    v_mfma_f32_16x16x32_bf16 a[136:139], v[72:75], v[224:227], a[136:139]
    s_waitcnt lgkmcnt(8)
    v_exp_f32 v208, v208
    v_mfma_f32_16x16x32_bf16 a[140:143], v[76:79], v[224:227], a[140:143]
    s_waitcnt lgkmcnt(6)
    v_exp_f32 v209, v209
    v_mfma_f32_16x16x32_bf16 a[144:147], v[80:83], v[224:227], a[144:147]
    s_waitcnt lgkmcnt(4)
    v_exp_f32 v210, v210
    v_mfma_f32_16x16x32_bf16 a[148:151], v[84:87], v[224:227], a[148:151]
    s_waitcnt lgkmcnt(2)
    v_exp_f32 v211, v211
    v_mfma_f32_16x16x32_bf16 a[152:155], v[88:91], v[224:227], a[152:155]
    s_waitcnt lgkmcnt(0)
    v_exp_f32 v212, v212
    v_mfma_f32_16x16x32_bf16 a[156:159], v[92:95], v[224:227], a[156:159]
    v_exp_f32 v213, v213
    v_mfma_f32_16x16x32_bf16 v[100:103], v[96:99], v[224:227], v[100:103]
    v_exp_f32 v214, v214
    v_mfma_f32_16x16x32_bf16 v[216:219], v[32:35], v[176:179], v[252:255]
    ds_read_b128 v[32:35], v4 offset:0
    v_cvt_pk_bf16_f32 v232, v208, v209
    v_mfma_f32_16x16x32_bf16 v[216:219], v[36:39], v[180:183], v[216:219]
    ds_read_b128 v[36:39], v4 offset:64
    v_cvt_pk_bf16_f32 v233, v210, v211
    v_mfma_f32_16x16x32_bf16 v[216:219], v[40:43], v[184:187], v[216:219]
    ds_read_b128 v[40:43], v4 offset:128
    v_cvt_pk_bf16_f32 v234, v212, v213
    v_mfma_f32_16x16x32_bf16 v[216:219], v[44:47], v[188:191], v[216:219]
    ds_read_b128 v[44:47], v4 offset:192
    v_mfma_f32_16x16x32_bf16 v[220:223], v[60:63], v[188:191], v[252:255]
    ds_read_b128 v[60:63], v4 offset:704
    v_mfma_f32_16x16x32_bf16 v[220:223], v[56:59], v[184:187], v[220:223]
    ds_read_b128 v[56:59], v4 offset:640
    v_mfma_f32_16x16x32_bf16 v[220:223], v[52:55], v[180:183], v[220:223]
    ds_read_b128 v[52:55], v4 offset:576
    v_mfma_f32_16x16x32_bf16 v[220:223], v[48:51], v[176:179], v[220:223]
    ds_read_b128 v[48:51], v4 offset:512
    v_mfma_f32_16x16x32_bf16 a[160:163], v[64:67], v[228:231], a[160:163]
    v_exp_f32 v215, v215
    v_mfma_f32_16x16x32_bf16 a[164:167], v[68:71], v[228:231], a[164:167]
    v_cvt_pk_bf16_f32 v235, v214, v215
    v_mfma_f32_16x16x32_bf16 a[168:171], v[72:75], v[228:231], a[168:171]
    v_exp_f32 v216, v216
    v_mfma_f32_16x16x32_bf16 a[172:175], v[76:79], v[228:231], a[172:175]
    v_exp_f32 v217, v217
    v_mfma_f32_16x16x32_bf16 a[176:179], v[80:83], v[228:231], a[176:179]
    v_exp_f32 v218, v218
    v_mfma_f32_16x16x32_bf16 a[180:183], v[84:87], v[228:231], a[180:183]
    v_exp_f32 v219, v219
    v_mfma_f32_16x16x32_bf16 a[184:187], v[88:91], v[228:231], a[184:187]
    s_add_u32 s44, s44, 1
    v_exp_f32 v220, v220
    v_mfma_f32_16x16x32_bf16 a[188:191], v[92:95], v[228:231], a[188:191]
    s_cmp_lt_u32 s44, 4
    v_exp_f32 v221, v221
    v_add_u32 v19, s68, v19
    v_mfma_f32_16x16x32_bf16 v[104:107], v[96:99], v[228:231], v[104:107]
    s_waitcnt lgkmcnt(0)
    v_exp_f32 v222, v222
    s_cbranch_scc1 L1v4_dloop
    v_mfma_f32_16x16x32_bf16 v[192:195], v[32:35], v[128:131], v[240:243]
    s_waitcnt vmcnt(16) lgkmcnt(0)
    s_barrier
    v_mfma_f32_16x16x32_bf16 v[192:195], v[36:39], v[132:135], v[192:195]
    s_add_u32 s32, s32, 16896
    v_exp_f32 v223, v223
    v_mfma_f32_16x16x32_bf16 v[192:195], v[40:43], v[136:139], v[192:195]
    s_cmp_ge_u32 s32, 101376
    s_cselect_b32 s32, 0, s32
    v_cvt_pk_bf16_f32 v236, v216, v217
    v_mfma_f32_16x16x32_bf16 v[192:195], v[44:47], v[140:143], v[192:195]
    s_lshr_b32 s98, s2, 3
    v_cvt_pk_bf16_f32 v237, v218, v219
    v_cvt_pk_bf16_f32 v238, v220, v221
    v_mfma_f32_16x16x32_bf16 v[196:199], v[60:63], v[140:143], v[240:243]
    s_mul_i32 s95, s98, 52
    v_cvt_pk_bf16_f32 v239, v222, v223
    v_add_u32 v5, s32, v3
    v_mfma_f32_16x16x32_bf16 v[196:199], v[56:59], v[136:139], v[196:199]
    s_lshr_b32 s95, s95, 8
    v_exp_f32 v192, v192
    v_mfma_f32_16x16x32_bf16 v[196:199], v[52:55], v[132:135], v[196:199]
    s_bfe_u32 s94, s2, 0x20001
    v_exp_f32 v193, v193
    v_mfma_f32_16x16x32_bf16 v[196:199], v[48:51], v[128:131], v[196:199]
    s_mul_i32 s97, s95, 5
    v_exp_f32 v194, v194
    v_mfma_f32_16x16x32_bf16 a[192:195], v[64:67], v[232:235], a[192:195]
    s_sub_u32 s97, s98, s97
    v_exp_f32 v195, v195
    v_mfma_f32_16x16x32_bf16 a[196:199], v[68:71], v[232:235], a[196:199]
    s_mul_i32 s96, s94, 6
    v_cvt_pk_bf16_f32 v224, v192, v193
    v_cvt_pk_bf16_f32 v225, v194, v195
    v_mfma_f32_16x16x32_bf16 a[200:203], v[72:75], v[232:235], a[200:203]
    s_lshl_b32 s94, s97, 8
    v_exp_f32 v196, v196
    v_mfma_f32_16x16x32_bf16 a[204:207], v[76:79], v[232:235], a[204:207]
    s_add_u32 s84, s88, s94
    s_addc_u32 s85, s89, 0
    s_sub_u32 s86, 5242880, s94
    v_mfma_f32_16x16x32_bf16 a[208:211], v[80:83], v[232:235], a[208:211]
    s_add_u32 s96, s96, s95
    v_exp_f32 v197, v197
    v_mfma_f32_16x16x32_bf16 a[212:215], v[84:87], v[232:235], a[212:215]
    s_lshr_b32 s94, s3, 1
    v_exp_f32 v198, v198
    v_mfma_f32_16x16x32_bf16 a[216:219], v[88:91], v[232:235], a[216:219]
    s_mul_i32 s94, s94, 30720
    v_exp_f32 v199, v199
    v_mfma_f32_16x16x32_bf16 a[220:223], v[92:95], v[232:235], a[220:223]
    s_mul_i32 s95, s3, 5120
    v_cvt_pk_bf16_f32 v226, v196, v197
    v_cvt_pk_bf16_f32 v227, v198, v199
    v_mfma_f32_16x16x32_bf16 v[108:111], v[96:99], v[232:235], v[108:111]
    s_mul_i32 s34, s3, 4224
    v_lshrrev_b32 v143, 4, v1
    s_add_u32 s94, s94, s95
    v_mfma_f32_16x16x32_bf16 v[200:203], v[32:35], v[144:147], v[244:247]
    s_and_b32 s58, s2, 1
    v_mul_u32_u24 v143, 9984, v143
    s_add_u32 m0, 0, s34
    v_mfma_f32_16x16x32_bf16 v[200:203], v[36:39], v[148:151], v[200:203]
    s_mov_b32 s87, 0x20000
    v_add3_u32 v128, v143, v20, s94
    s_mul_i32 s37, s58, 2621440
    v_mfma_f32_16x16x32_bf16 v[200:203], v[40:43], v[152:155], v[200:203]
    s_add_u32 s44, s37, 81920
    buffer_load_dwordx4 v128, s[84:87], s37 offen offset:0 lds
    v_mfma_f32_16x16x32_bf16 v[200:203], v[44:47], v[156:159], v[200:203]
    s_add_u32 s20, s37, 327680
    v_add_u32 v129, 224, v128
    v_add_u32 v130, 448, v128
    v_mfma_f32_16x16x32_bf16 v[204:207], v[60:63], v[156:159], v[244:247]
    s_add_u32 s92, s37, 409600
    v_add_u32 v131, 672, v128
    v_mov_b32 v21, 162816
    v_mfma_f32_16x16x32_bf16 v[204:207], v[56:59], v[152:155], v[204:207]
    s_bfe_u32 s60, s30, 0x10001
    buffer_load_dwordx4 v129, s[84:87], s37 offen offset:1056 lds
    v_mfma_f32_16x16x32_bf16 v[204:207], v[52:55], v[148:151], v[204:207]
    s_lshr_b32 s61, s30, 2
    ds_read_b128 v[124:127], v21
    s_mul_i32 s60, s60, 15360
    v_mfma_f32_16x16x32_bf16 v[204:207], v[48:51], v[144:147], v[204:207]
    s_lshl_b32 s61, s61, 8
    v_exp_f32 v200, v200
    v_mfma_f32_16x16x32_bf16 a[224:227], v[64:67], v[236:239], a[224:227]
    s_add_u32 s60, s60, s61
    ds_read_b64_tr_b16 v[64:65], v5 offset:8448
    ds_read_b64_tr_b16 v[66:67], v5 offset:8960
    v_mfma_f32_16x16x32_bf16 a[228:231], v[68:71], v[236:239], a[228:231]
    s_and_b32 s61, s30, 1
    ds_read_b64_tr_b16 v[68:69], v5 offset:8480
    ds_read_b64_tr_b16 v[70:71], v5 offset:8992
    v_mfma_f32_16x16x32_bf16 a[232:235], v[72:75], v[236:239], a[232:235]
    s_lshl_b32 s61, s61, 4
    ds_read_b64_tr_b16 v[72:73], v5 offset:8512
    ds_read_b64_tr_b16 v[74:75], v5 offset:9024
    v_mfma_f32_16x16x32_bf16 a[236:239], v[76:79], v[236:239], a[236:239]
    s_add_u32 s61, s61, s31
    ds_read_b64_tr_b16 v[76:77], v5 offset:8544
    ds_read_b64_tr_b16 v[78:79], v5 offset:9056
    v_mfma_f32_16x16x32_bf16 a[240:243], v[80:83], v[236:239], a[240:243]
    s_lshl_b32 s61, s61, 2
    ds_read_b64_tr_b16 v[80:81], v5 offset:8576
    ds_read_b64_tr_b16 v[82:83], v5 offset:9088
    v_mfma_f32_16x16x32_bf16 a[244:247], v[84:87], v[236:239], a[244:247]
    s_add_u32 s60, s60, s61
    ds_read_b64_tr_b16 v[84:85], v5 offset:8608
    ds_read_b64_tr_b16 v[86:87], v5 offset:9120
    v_mfma_f32_16x16x32_bf16 a[248:251], v[88:91], v[236:239], a[248:251]
    s_add_u32 s65, s69, 1
    ds_read_b64_tr_b16 v[88:89], v5 offset:8640
    ds_read_b64_tr_b16 v[90:91], v5 offset:9152
    v_mfma_f32_16x16x32_bf16 a[252:255], v[92:95], v[236:239], a[252:255]
    s_add_u32 s40, s28, 32505856
    s_addc_u32 s41, s29, 0
    ds_read_b64_tr_b16 v[92:93], v5 offset:8672
    v_mfma_f32_16x16x32_bf16 v[112:115], v[96:99], v[236:239], v[112:115]
    s_mov_b32 s43, 0x20000
    ds_read_b64_tr_b16 v[94:95], v5 offset:9184
    s_waitcnt lgkmcnt(15)
    v_or3_b32 v124, v124, v125, v126
    v_mfma_f32_16x16x32_bf16 v[208:211], v[32:35], v[160:163], v[248:251]
    s_lshl_b32 s66, s2, 7
    buffer_load_dwordx4 v130, s[84:87], s37 offen offset:2112 lds
    v_mfma_f32_16x16x32_bf16 v[208:211], v[36:39], v[164:167], v[208:211]
    s_add_u32 s66, s66, 32505856
    v_exp_f32 v201, v201
    v_mfma_f32_16x16x32_bf16 v[208:211], v[40:43], v[168:171], v[208:211]
    s_add_u32 s4, s28, s66
    s_addc_u32 s5, s29, 0
    v_cvt_pk_bf16_f32 v228, v200, v201
    v_mfma_f32_16x16x32_bf16 v[208:211], v[44:47], v[172:175], v[208:211]
    s_mul_i32 s66, s96, 43
    buffer_load_dwordx4 v131, s[84:87], s37 offen offset:3168 lds
    v_mfma_f32_16x16x32_bf16 v[212:215], v[60:63], v[172:175], v[248:251]
    s_add_u32 m0, 37376, s34
    v_exp_f32 v202, v202
    v_mfma_f32_16x16x32_bf16 v[212:215], v[56:59], v[168:171], v[212:215]
    s_lshr_b32 s66, s66, 7
    v_exp_f32 v203, v203
    v_mfma_f32_16x16x32_bf16 v[212:215], v[52:55], v[164:167], v[212:215]
    s_mul_i32 s66, s66, 3
    buffer_load_dwordx4 v128, s[84:87], s44 offen offset:0 lds
    v_mfma_f32_16x16x32_bf16 v[212:215], v[48:51], v[160:163], v[212:215]
    s_waitcnt lgkmcnt(14)
    s_sub_u32 s66, s96, s66
    v_exp_f32 v204, v204
    v_mfma_f32_16x16x32_bf16 a[128:131], v[64:67], v[224:227], a[128:131]
    s_waitcnt lgkmcnt(12)
    s_and_b32 s67, s66, 1
    v_exp_f32 v205, v205
    v_mfma_f32_16x16x32_bf16 a[132:135], v[68:71], v[224:227], a[132:135]
    s_waitcnt lgkmcnt(10)
    s_lshl_b32 s67, s67, 6
    buffer_load_dwordx4 v129, s[84:87], s44 offen offset:1056 lds
    v_mfma_f32_16x16x32_bf16 a[136:139], v[72:75], v[224:227], a[136:139]
    s_waitcnt lgkmcnt(8)
    s_lshl_b32 s62, s58, 5
    v_exp_f32 v206, v206
    v_mfma_f32_16x16x32_bf16 a[140:143], v[76:79], v[224:227], a[140:143]
    s_waitcnt lgkmcnt(6)
    s_add_u32 s67, s67, 28
    v_exp_f32 v207, v207
    v_mfma_f32_16x16x32_bf16 a[144:147], v[80:83], v[224:227], a[144:147]
    s_waitcnt lgkmcnt(4)
    s_add_u32 s63, s67, s62
    buffer_load_dwordx4 v130, s[84:87], s44 offen offset:2112 lds
    v_mfma_f32_16x16x32_bf16 a[148:151], v[84:87], v[224:227], a[148:151]
    s_waitcnt lgkmcnt(2)
    s_lshr_b32 s66, s66, 1
    v_cvt_pk_bf16_f32 v229, v202, v203
    v_cvt_pk_bf16_f32 v230, v204, v205
    v_mfma_f32_16x16x32_bf16 a[152:155], v[88:91], v[224:227], a[152:155]
    s_waitcnt lgkmcnt(0)
    s_lshl_b32 s66, s66, 6
    v_cvt_pk_bf16_f32 v231, v206, v207
    v_or_b32 v124, v124, v127
    v_mfma_f32_16x16x32_bf16 a[156:159], v[92:95], v[224:227], a[156:159]
    s_mov_b32 s52, 0
    buffer_load_dwordx4 v131, s[84:87], s44 offen offset:3168 lds
    v_mfma_f32_16x16x32_bf16 v[100:103], v[96:99], v[224:227], v[100:103]
    s_add_u32 m0, 74752, s34
    v_exp_f32 v208, v208
    v_mfma_f32_16x16x32_bf16 v[216:219], v[32:35], v[176:179], v[252:255]
    s_mov_b32 s57, 0
    v_exp_f32 v209, v209
    v_mfma_f32_16x16x32_bf16 v[216:219], v[36:39], v[180:183], v[216:219]
    s_mul_i32 s38, s3, 5120
    buffer_load_dwordx4 v128, s[84:87], s20 offen offset:0 lds
    v_mfma_f32_16x16x32_bf16 v[216:219], v[40:43], v[184:187], v[216:219]
    s_mul_i32 s39, s58, 15794176
    v_exp_f32 v210, v210
    v_mfma_f32_16x16x32_bf16 v[216:219], v[44:47], v[188:191], v[216:219]
    s_mov_b32 s55, 12
    v_exp_f32 v211, v211
    v_mfma_f32_16x16x32_bf16 v[220:223], v[60:63], v[188:191], v[252:255]
    s_mov_b32 s6, 128
    buffer_load_dwordx4 v129, s[84:87], s20 offen offset:1056 lds
    v_mfma_f32_16x16x32_bf16 v[220:223], v[56:59], v[184:187], v[220:223]
    s_mov_b32 s7, 0x20000
    v_exp_f32 v212, v212
    v_mfma_f32_16x16x32_bf16 v[220:223], v[52:55], v[180:183], v[220:223]
    s_add_u32 s38, s38, 16896
    v_exp_f32 v213, v213
    v_mfma_f32_16x16x32_bf16 v[220:223], v[48:51], v[176:179], v[220:223]
    s_mov_b32 s10, 30642176
    buffer_load_dwordx4 v130, s[84:87], s20 offen offset:2112 lds
    v_mfma_f32_16x16x32_bf16 a[160:163], v[64:67], v[228:231], a[160:163]
    s_mov_b32 s11, 0x20000
    v_exp_f32 v214, v214
    v_mfma_f32_16x16x32_bf16 a[164:167], v[68:71], v[228:231], a[164:167]
    s_add_u32 s59, s39, 2048
    v_exp_f32 v215, v215
    v_mfma_f32_16x16x32_bf16 a[168:171], v[72:75], v[228:231], a[168:171]
    s_add_u32 s21, s39, 1974272
    buffer_load_dwordx4 v131, s[84:87], s20 offen offset:3168 lds
    v_mfma_f32_16x16x32_bf16 a[172:175], v[76:79], v[228:231], a[172:175]
    s_add_u32 m0, 112128, s34
    v_cvt_pk_bf16_f32 v232, v208, v209
    v_cvt_pk_bf16_f32 v233, v210, v211
    v_mfma_f32_16x16x32_bf16 a[176:179], v[80:83], v[228:231], a[176:179]
    s_add_u32 s93, s39, 1976320
    v_cvt_pk_bf16_f32 v234, v212, v213
    v_cvt_pk_bf16_f32 v235, v214, v215
    v_mfma_f32_16x16x32_bf16 a[180:183], v[84:87], v[228:231], a[180:183]
    s_mov_b32 s101, 1
    buffer_load_dwordx4 v128, s[84:87], s92 offen offset:0 lds
    v_mfma_f32_16x16x32_bf16 a[184:187], v[88:91], v[228:231], a[184:187]
    v_exp_f32 v216, v216
    v_mfma_f32_16x16x32_bf16 a[188:191], v[92:95], v[228:231], a[188:191]
    v_exp_f32 v217, v217
    v_mfma_f32_16x16x32_bf16 v[104:107], v[96:99], v[228:231], v[104:107]
    buffer_load_dwordx4 v129, s[84:87], s92 offen offset:1056 lds
    v_mfma_f32_16x16x32_bf16 a[192:195], v[64:67], v[232:235], a[192:195]
    v_exp_f32 v218, v218
    v_mfma_f32_16x16x32_bf16 a[196:199], v[68:71], v[232:235], a[196:199]
    v_exp_f32 v219, v219
    v_mfma_f32_16x16x32_bf16 a[200:203], v[72:75], v[232:235], a[200:203]
    buffer_load_dwordx4 v130, s[84:87], s92 offen offset:2112 lds
    v_mfma_f32_16x16x32_bf16 a[204:207], v[76:79], v[232:235], a[204:207]
    v_exp_f32 v220, v220
    v_mfma_f32_16x16x32_bf16 a[208:211], v[80:83], v[232:235], a[208:211]
    v_exp_f32 v221, v221
    v_mfma_f32_16x16x32_bf16 a[212:215], v[84:87], v[232:235], a[212:215]
    buffer_load_dwordx4 v131, s[84:87], s92 offen offset:3168 lds
    v_mfma_f32_16x16x32_bf16 a[216:219], v[88:91], v[232:235], a[216:219]
    v_exp_f32 v222, v222
    v_mfma_f32_16x16x32_bf16 a[220:223], v[92:95], v[232:235], a[220:223]
    v_exp_f32 v223, v223
    v_mfma_f32_16x16x32_bf16 v[108:111], v[96:99], v[232:235], v[108:111]
    s_cmp_eq_u32 s58, 0
    s_cselect_b32 s56, 4, 20
    s_cselect_b32 s35, 14, 18
    s_cselect_b32 s45, -12, 2
    v_cvt_pk_bf16_f32 v236, v216, v217
    v_cvt_pk_bf16_f32 v237, v218, v219
    v_cvt_pk_bf16_f32 v238, v220, v221
    v_cvt_pk_bf16_f32 v239, v222, v223
    v_lshrrev_b32 v23, 1, v1
    v_and_b32 v0, 1, v1
    v_mfma_f32_16x16x32_bf16 a[224:227], v[64:67], v[236:239], a[224:227]
    s_add_u32 s68, s52, s56
    v_readfirstlane_b32 s100, v124
    v_lshlrev_b32 v23, 10, v23
    v_mfma_f32_16x16x32_bf16 a[228:231], v[68:71], v[236:239], a[228:231]
    s_and_b32 s95, s68, 1
    v_lshlrev_b32 v0, 7, v0
    v_cmp_gt_u32 vcc, 30, v1
    v_mfma_f32_16x16x32_bf16 a[232:235], v[72:75], v[236:239], a[232:235]
    s_or_b32 s64, s100, s3
    v_add3_u32 v23, v23, v0, s60
    v_mov_b32 v0, 0x100000
    v_mfma_f32_16x16x32_bf16 a[236:239], v[76:79], v[236:239], a[236:239]
    s_cmp_eq_u32 s64, 0
    s_cselect_b32 s42, 30720, 0
    v_mov_b32 v22, s65
    v_mfma_f32_16x16x32_bf16 a[240:243], v[80:83], v[236:239], a[240:243]
    s_sub_u32 s68, s68, s95
    v_cndmask_b32 v23, v0, v23, vcc
    v_accvgpr_read_b32 v116, a128
    v_mfma_f32_16x16x32_bf16 a[244:247], v[84:87], v[236:239], a[244:247]
    s_add_u32 s68, s68, s57
    v_rcp_f32 v24, v100
    v_mfma_f32_16x16x32_bf16 a[248:251], v[88:91], v[236:239], a[248:251]
    s_mul_i32 s94, s68, 987136
    v_accvgpr_read_b32 v117, a129
    v_accvgpr_read_b32 v118, a130
    v_mfma_f32_16x16x32_bf16 a[252:255], v[92:95], v[236:239], a[252:255]
    s_lshl_b32 s68, s68, 1
    v_accvgpr_read_b32 v119, a131
    v_accvgpr_read_b32 v120, a132
    v_mfma_f32_16x16x32_bf16 v[112:115], v[96:99], v[236:239], v[112:115]
    s_add_u32 s68, s68, s95
    v_accvgpr_read_b32 v121, a133
    v_accvgpr_read_b32 v122, a134
    v_accvgpr_read_b32 v123, a135
    v_accvgpr_read_b32 v10, a136
    v_accvgpr_read_b32 v11, a137
    v_accvgpr_read_b32 v12, a138
    v_accvgpr_read_b32 v13, a139
    v_accvgpr_read_b32 v14, a140
    s_waitcnt vmcnt(16) lgkmcnt(0)
    s_barrier
    buffer_store_dword v22, v23, s[40:43], 0 offen sc1
    v_accvgpr_read_b32 v15, a141
    v_accvgpr_read_b32 v16, a142
    v_accvgpr_read_b32 v17, a143
    v_mul_f32 v116, v24, v116
    v_mul_f32 v117, v24, v117
    v_mul_f32 v118, v24, v118
    v_mul_f32 v119, v24, v119
    v_mul_f32 v120, v24, v120
    v_mul_f32 v121, v24, v121
    v_mul_f32 v122, v24, v122
    v_mul_f32 v123, v24, v123
    v_mul_f32 v10, v24, v10
    v_mul_f32 v11, v24, v11
    v_mul_f32 v12, v24, v12
    v_mul_f32 v13, v24, v13
    v_mul_f32 v14, v24, v14
    v_mul_f32 v15, v24, v15
    v_mul_f32 v16, v24, v16
    v_mul_f32 v17, v24, v17
    v_cvt_pk_bf16_f32 v32, v116, v117
    v_cvt_pk_bf16_f32 v33, v118, v119
    v_cvt_pk_bf16_f32 v34, v120, v121
    v_cvt_pk_bf16_f32 v35, v122, v123
    v_cvt_pk_bf16_f32 v36, v10, v11
    buffer_store_dwordx4 v[32:35], v20, s[16:19], s48 offen offset:0 sc1
    v_cvt_pk_bf16_f32 v37, v12, v13
    v_cvt_pk_bf16_f32 v38, v14, v15
    v_cvt_pk_bf16_f32 v39, v16, v17
    v_accvgpr_read_b32 v116, a144
    buffer_store_dwordx4 v[36:39], v20, s[16:19], s48 offen offset:1024 sc1
    v_accvgpr_read_b32 v117, a145
    v_accvgpr_read_b32 v118, a146
    v_accvgpr_read_b32 v119, a147
    v_accvgpr_read_b32 v120, a148
    v_accvgpr_read_b32 v121, a149
    v_accvgpr_read_b32 v122, a150
    v_accvgpr_read_b32 v123, a151
    v_accvgpr_read_b32 v10, a152
    v_accvgpr_read_b32 v11, a153
    v_accvgpr_read_b32 v12, a154
    v_accvgpr_read_b32 v13, a155
    v_accvgpr_read_b32 v14, a156
    v_accvgpr_read_b32 v15, a157
    v_accvgpr_read_b32 v16, a158
    v_accvgpr_read_b32 v17, a159
    v_mul_f32 v116, v24, v116
    v_mul_f32 v117, v24, v117
    v_mul_f32 v118, v24, v118
    v_mul_f32 v119, v24, v119
    v_mul_f32 v120, v24, v120
    v_mul_f32 v121, v24, v121
    v_mul_f32 v122, v24, v122
    v_mul_f32 v123, v24, v123
    v_mul_f32 v10, v24, v10
    v_mul_f32 v11, v24, v11
    v_mul_f32 v12, v24, v12
    v_mul_f32 v13, v24, v13
    v_mul_f32 v14, v24, v14
    v_mul_f32 v15, v24, v15
    v_mul_f32 v16, v24, v16
    v_mul_f32 v17, v24, v17
    v_rcp_f32 v25, v104
    v_cvt_pk_bf16_f32 v40, v116, v117
    v_cvt_pk_bf16_f32 v41, v118, v119
    v_cvt_pk_bf16_f32 v42, v120, v121
    v_cvt_pk_bf16_f32 v43, v122, v123
    v_cvt_pk_bf16_f32 v44, v10, v11
    buffer_store_dwordx4 v[40:43], v20, s[16:19], s48 offen offset:2048 sc1
    v_cvt_pk_bf16_f32 v45, v12, v13
    v_cvt_pk_bf16_f32 v46, v14, v15
    v_cvt_pk_bf16_f32 v47, v16, v17
    v_accvgpr_read_b32 v116, a160
    buffer_store_dwordx4 v[44:47], v20, s[16:19], s48 offen offset:3072 sc1
    v_accvgpr_read_b32 v117, a161
    v_accvgpr_read_b32 v118, a162
    v_accvgpr_read_b32 v119, a163
    v_accvgpr_read_b32 v120, a164
    v_accvgpr_read_b32 v121, a165
    v_accvgpr_read_b32 v122, a166
    v_accvgpr_read_b32 v123, a167
    v_accvgpr_read_b32 v10, a168
    v_accvgpr_read_b32 v11, a169
    v_accvgpr_read_b32 v12, a170
    v_accvgpr_read_b32 v13, a171
    v_accvgpr_read_b32 v14, a172
    v_accvgpr_read_b32 v15, a173
    v_accvgpr_read_b32 v16, a174
    v_accvgpr_read_b32 v17, a175
    v_mul_f32 v116, v25, v116
    v_mul_f32 v117, v25, v117
    v_mul_f32 v118, v25, v118
    v_mul_f32 v119, v25, v119
    v_mul_f32 v120, v25, v120
    v_mul_f32 v121, v25, v121
    v_mul_f32 v122, v25, v122
    v_mul_f32 v123, v25, v123
    v_mul_f32 v10, v25, v10
    v_mul_f32 v11, v25, v11
    v_mul_f32 v12, v25, v12
    v_mul_f32 v13, v25, v13
    v_mul_f32 v14, v25, v14
    v_mul_f32 v15, v25, v15
    v_mul_f32 v16, v25, v16
    v_mul_f32 v17, v25, v17
    v_cvt_pk_bf16_f32 v48, v116, v117
    v_cvt_pk_bf16_f32 v49, v118, v119
    v_cvt_pk_bf16_f32 v50, v120, v121
    v_cvt_pk_bf16_f32 v51, v122, v123
    v_cvt_pk_bf16_f32 v52, v10, v11
    buffer_store_dwordx4 v[48:51], v20, s[16:19], s49 offen offset:0 sc1
    v_cvt_pk_bf16_f32 v53, v12, v13
    v_cvt_pk_bf16_f32 v54, v14, v15
    v_cvt_pk_bf16_f32 v55, v16, v17
    v_accvgpr_read_b32 v116, a176
    buffer_store_dwordx4 v[52:55], v20, s[16:19], s49 offen offset:1024 sc1
    v_accvgpr_read_b32 v117, a177
    v_accvgpr_read_b32 v118, a178
    v_accvgpr_read_b32 v119, a179
    v_accvgpr_read_b32 v120, a180
    v_accvgpr_read_b32 v121, a181
    v_accvgpr_read_b32 v122, a182
    v_accvgpr_read_b32 v123, a183
    v_accvgpr_read_b32 v10, a184
    v_accvgpr_read_b32 v11, a185
    v_accvgpr_read_b32 v12, a186
    v_accvgpr_read_b32 v13, a187
    v_accvgpr_read_b32 v14, a188
    v_accvgpr_read_b32 v15, a189
    v_accvgpr_read_b32 v16, a190
    v_accvgpr_read_b32 v17, a191
    v_and_b32 v141, 31, v1
    v_mul_f32 v116, v25, v116
    v_mul_f32 v117, v25, v117
    v_mul_f32 v118, v25, v118
    v_mul_f32 v119, v25, v119
    v_mul_f32 v120, v25, v120
    v_mul_f32 v121, v25, v121
    v_mul_f32 v122, v25, v122
    v_mul_f32 v123, v25, v123
    v_mul_f32 v10, v25, v10
    v_mul_f32 v11, v25, v11
    v_mul_f32 v12, v25, v12
    v_mul_f32 v13, v25, v13
    v_mul_f32 v14, v25, v14
    v_mul_f32 v15, v25, v15
    v_mul_f32 v16, v25, v16
    v_mul_f32 v17, v25, v17
    v_lshlrev_b32 v141, 2, v141
    v_rcp_f32 v26, v108
    v_cvt_pk_bf16_f32 v56, v116, v117
    v_cvt_pk_bf16_f32 v57, v118, v119
    v_cvt_pk_bf16_f32 v58, v120, v121
    v_cvt_pk_bf16_f32 v59, v122, v123
    v_cvt_pk_bf16_f32 v60, v10, v11
    buffer_store_dwordx4 v[56:59], v20, s[16:19], s49 offen offset:2048 sc1
    v_cvt_pk_bf16_f32 v61, v12, v13
    v_cvt_pk_bf16_f32 v62, v14, v15
    v_cvt_pk_bf16_f32 v63, v16, v17
    v_accvgpr_read_b32 v116, a192
    buffer_store_dwordx4 v[60:63], v20, s[16:19], s49 offen offset:3072 sc1
    v_accvgpr_read_b32 v117, a193
    v_accvgpr_read_b32 v118, a194
    v_accvgpr_read_b32 v119, a195
    v_accvgpr_read_b32 v120, a196
    v_accvgpr_read_b32 v121, a197
    v_accvgpr_read_b32 v122, a198
    v_accvgpr_read_b32 v123, a199
    v_accvgpr_read_b32 v10, a200
    v_accvgpr_read_b32 v11, a201
    v_accvgpr_read_b32 v12, a202
    v_accvgpr_read_b32 v13, a203
    v_accvgpr_read_b32 v14, a204
    v_accvgpr_read_b32 v15, a205
    v_accvgpr_read_b32 v16, a206
    v_accvgpr_read_b32 v17, a207
    v_and_b32 v159, s63, v141
    v_mul_f32 v116, v26, v116
    v_mul_f32 v117, v26, v117
    v_mul_f32 v118, v26, v118
    v_mul_f32 v119, v26, v119
    v_mul_f32 v120, v26, v120
    v_mul_f32 v121, v26, v121
    v_mul_f32 v122, v26, v122
    v_mul_f32 v123, v26, v123
    v_mul_f32 v10, v26, v10
    v_mul_f32 v11, v26, v11
    v_mul_f32 v12, v26, v12
    v_mul_f32 v13, v26, v13
    v_mul_f32 v14, v26, v14
    v_mul_f32 v15, v26, v15
    v_mul_f32 v16, v26, v16
    v_mul_f32 v17, v26, v17
    v_or_b32 v159, s66, v159
    v_cvt_pk_bf16_f32 v64, v116, v117
    v_cvt_pk_bf16_f32 v65, v118, v119
    v_cvt_pk_bf16_f32 v66, v120, v121
    v_cvt_pk_bf16_f32 v67, v122, v123
    v_cvt_pk_bf16_f32 v68, v10, v11
    buffer_store_dwordx4 v[64:67], v20, s[16:19], s50 offen offset:0 sc1
    v_cvt_pk_bf16_f32 v69, v12, v13
    v_cvt_pk_bf16_f32 v70, v14, v15
    v_cvt_pk_bf16_f32 v71, v16, v17
    v_or_b32 v141, s62, v159
    buffer_store_dwordx4 v[68:71], v20, s[16:19], s50 offen offset:1024 sc1
    s_mul_i32 s66, s96, 40960
    v_accvgpr_read_b32 v116, a208
    v_accvgpr_read_b32 v117, a209
    v_accvgpr_read_b32 v118, a210
    v_accvgpr_read_b32 v119, a211
    v_accvgpr_read_b32 v120, a212
    v_accvgpr_read_b32 v121, a213
    v_accvgpr_read_b32 v122, a214
    v_accvgpr_read_b32 v123, a215
    v_accvgpr_read_b32 v10, a216
    v_accvgpr_read_b32 v11, a217
    v_accvgpr_read_b32 v12, a218
    v_accvgpr_read_b32 v13, a219
    v_accvgpr_read_b32 v14, a220
    v_accvgpr_read_b32 v15, a221
    v_accvgpr_read_b32 v16, a222
    v_accvgpr_read_b32 v17, a223
    s_and_b32 s62, s3, 1
    s_lshr_b32 s63, s3, 1
    s_add_u32 s8, s28, s66
    s_addc_u32 s9, s29, 0
    s_mul_i32 s66, s62, 20480
    s_lshl_b32 s67, s63, 10
    v_mul_f32 v116, v26, v116
    v_mul_f32 v117, v26, v117
    v_mul_f32 v118, v26, v118
    v_mul_f32 v119, v26, v119
    v_mul_f32 v120, v26, v120
    v_mul_f32 v121, v26, v121
    v_mul_f32 v122, v26, v122
    v_mul_f32 v123, v26, v123
    v_mul_f32 v10, v26, v10
    v_mul_f32 v11, v26, v11
    v_mul_f32 v12, v26, v12
    v_mul_f32 v13, v26, v13
    v_mul_f32 v14, v26, v14
    v_mul_f32 v15, v26, v15
    v_mul_f32 v16, v26, v16
    v_mul_f32 v17, v26, v17
    s_add_u32 s66, s66, s67
    v_add_u32 v132, s66, v20
    v_rcp_f32 v27, v112
    v_cvt_pk_bf16_f32 v72, v116, v117
    v_cvt_pk_bf16_f32 v73, v118, v119
    v_cvt_pk_bf16_f32 v74, v120, v121
    v_cvt_pk_bf16_f32 v75, v122, v123
    v_cvt_pk_bf16_f32 v76, v10, v11
    buffer_store_dwordx4 v[72:75], v20, s[16:19], s50 offen offset:2048 sc1
    v_cvt_pk_bf16_f32 v77, v12, v13
    v_cvt_pk_bf16_f32 v78, v14, v15
    v_cvt_pk_bf16_f32 v79, v16, v17
    s_lshl_b32 s66, s62, 7
    buffer_store_dwordx4 v[76:79], v20, s[16:19], s50 offen offset:3072 sc1
    s_mul_i32 s67, s63, 5120
    v_accvgpr_read_b32 v116, a224
    v_accvgpr_read_b32 v117, a225
    v_accvgpr_read_b32 v118, a226
    v_accvgpr_read_b32 v119, a227
    v_accvgpr_read_b32 v120, a228
    v_accvgpr_read_b32 v121, a229
    v_accvgpr_read_b32 v122, a230
    v_accvgpr_read_b32 v123, a231
    v_accvgpr_read_b32 v10, a232
    v_accvgpr_read_b32 v11, a233
    v_accvgpr_read_b32 v12, a234
    v_accvgpr_read_b32 v13, a235
    v_accvgpr_read_b32 v14, a236
    v_accvgpr_read_b32 v15, a237
    v_accvgpr_read_b32 v16, a238
    v_accvgpr_read_b32 v17, a239
    s_add_u32 s67, s67, 16896
    v_cmp_nlt_f32 s[60:61], v100, s47
    v_cmp_nlt_f32 s[62:63], v104, s47
    v_add_u32 v136, s66, v3
    v_add_u32 v138, s66, v3
    v_add_u32 v137, s67, v20
    v_add_u32 v139, s67, v20
    v_cmp_nlt_f32 s[64:65], v108, s47
    v_mul_f32 v116, v27, v116
    v_mul_f32 v117, v27, v117
    v_mul_f32 v118, v27, v118
    v_mul_f32 v119, v27, v119
    v_mul_f32 v120, v27, v120
    v_mul_f32 v121, v27, v121
    v_mul_f32 v122, v27, v122
    v_mul_f32 v123, v27, v123
    v_mul_f32 v10, v27, v10
    v_mul_f32 v11, v27, v11
    v_mul_f32 v12, v27, v12
    v_mul_f32 v13, v27, v13
    v_mul_f32 v14, v27, v14
    v_mul_f32 v15, v27, v15
    v_mul_f32 v16, v27, v16
    v_mul_f32 v17, v27, v17
    v_cmp_nlt_f32 s[66:67], v112, s47
    v_cvt_pk_bf16_f32 v80, v116, v117
    v_cvt_pk_bf16_f32 v81, v118, v119
    v_cvt_pk_bf16_f32 v82, v120, v121
    v_cvt_pk_bf16_f32 v83, v122, v123
    v_cvt_pk_bf16_f32 v84, v10, v11
    v_cvt_pk_bf16_f32 v85, v12, v13
    v_cvt_pk_bf16_f32 v86, v14, v15
    v_cvt_pk_bf16_f32 v87, v16, v17
    v_accvgpr_read_b32 v116, a240
    v_accvgpr_read_b32 v117, a241
    v_accvgpr_read_b32 v118, a242
    v_accvgpr_read_b32 v119, a243
    v_accvgpr_read_b32 v120, a244
    v_accvgpr_read_b32 v121, a245
    v_accvgpr_read_b32 v122, a246
    v_accvgpr_read_b32 v123, a247
    v_accvgpr_read_b32 v10, a248
    v_accvgpr_read_b32 v11, a249
    v_accvgpr_read_b32 v12, a250
    v_accvgpr_read_b32 v13, a251
    v_accvgpr_read_b32 v14, a252
    v_accvgpr_read_b32 v15, a253
    v_accvgpr_read_b32 v16, a254
    v_accvgpr_read_b32 v17, a255
    s_or_b64 s[60:61], s[60:61], s[62:63]
    s_or_b64 s[60:61], s[60:61], s[64:65]
    v_mul_f32 v116, v27, v116
    v_mul_f32 v117, v27, v117
    v_mul_f32 v118, v27, v118
    v_mul_f32 v119, v27, v119
    v_mul_f32 v120, v27, v120
    v_mul_f32 v121, v27, v121
    v_mul_f32 v122, v27, v122
    v_mul_f32 v123, v27, v123
    v_mul_f32 v10, v27, v10
    v_mul_f32 v11, v27, v11
    v_mul_f32 v12, v27, v12
    v_mul_f32 v13, v27, v13
    v_mul_f32 v14, v27, v14
    v_mul_f32 v15, v27, v15
    v_mul_f32 v16, v27, v16
    v_mul_f32 v17, v27, v17
    s_lshl_b32 s95, s95, 11
    s_add_u32 s52, s52, 1
    s_or_b64 s[60:61], s[60:61], s[66:67]
    s_cselect_b32 s62, 2, 0
    v_add_u32 v133, 3072, v132
    v_add_u32 v134, 6144, v132
    v_add_u32 v135, 9216, v132
    v_add_u32 v147, 16384, v132
    s_mul_i32 s33, s68, 81920
    s_add_u32 s36, s94, s95
    s_cmp_eq_u32 s52, 12
    s_cselect_b32 s57, 1, s57
    s_cselect_b32 s56, s45, s56
    s_or_b32 s99, s99, s62
    v_cvt_pk_bf16_f32 v88, v116, v117
    v_cvt_pk_bf16_f32 v89, v118, v119
    v_cvt_pk_bf16_f32 v90, v120, v121
    v_cvt_pk_bf16_f32 v91, v122, v123
    v_cvt_pk_bf16_f32 v92, v10, v11
    v_cvt_pk_bf16_f32 v93, v12, v13
    v_cvt_pk_bf16_f32 v94, v14, v15
    v_cvt_pk_bf16_f32 v95, v16, v17
    s_cmp_lg_u32 s99, 0
    s_cbranch_scc1 L1_fbs
    s_branch L2_start
L1v4_rot:
    v_mov_b32 v24, v25
    v_mov_b32 v25, v26
    v_mov_b32 v26, v27
    s_branch L1v4_rotb
L1v4_nons:
    s_add_u32 s44, s44, 1
    s_cmp_ge_u32 s44, 0x80000
    s_cbranch_scc1 L1v4_nong
    buffer_load_dword v0, v23, s[64:67], 0 offen sc1
    s_waitcnt vmcnt(0)
    s_branch L1v4_non
L1v3_go:
    ds_read_b128 a[64:67], v18 offset:0
    ds_read_b64_tr_b16 a[0:1], v5 offset:0
    ds_read_b64_tr_b16 a[2:3], v5 offset:512
    ds_read_b128 a[80:83], v19 offset:0
    ds_read_b64_tr_b16 a[32:33], v5 offset:8448
    ds_read_b64_tr_b16 a[34:35], v5 offset:8960
    ds_read_b128 a[68:71], v18 offset:2048
    ds_read_b128 a[84:87], v19 offset:2048
    ds_read_b128 a[72:75], v18 offset:4096
    ds_read_b128 a[88:91], v19 offset:4096
    ds_read_b64_tr_b16 a[4:5], v5 offset:32
    ds_read_b64_tr_b16 a[6:7], v5 offset:544
    ds_read_b64_tr_b16 a[36:37], v5 offset:8480
    ds_read_b64_tr_b16 a[38:39], v5 offset:8992
    ds_read_b64_tr_b16 a[8:9], v5 offset:64
    ds_read_b64_tr_b16 a[10:11], v5 offset:576
    ds_read_b64_tr_b16 a[40:41], v5 offset:8512
    ds_read_b64_tr_b16 a[42:43], v5 offset:9024
    ds_read_b64_tr_b16 a[12:13], v5 offset:96
    ds_read_b64_tr_b16 a[14:15], v5 offset:608
    ds_read_b64_tr_b16 a[44:45], v5 offset:8544
    ds_read_b64_tr_b16 a[46:47], v5 offset:9056
    ds_read_b64_tr_b16 a[16:17], v5 offset:128
    ds_read_b64_tr_b16 a[18:19], v5 offset:640
    ds_read_b64_tr_b16 a[48:49], v5 offset:8576
    ds_read_b64_tr_b16 a[50:51], v5 offset:9088
    ds_read_b64_tr_b16 a[20:21], v5 offset:160
    ds_read_b64_tr_b16 a[22:23], v5 offset:672
    ds_read_b64_tr_b16 a[52:53], v5 offset:8608
    ds_read_b64_tr_b16 a[54:55], v5 offset:9120
    ds_read_b64_tr_b16 a[24:25], v5 offset:192
    ds_read_b64_tr_b16 a[26:27], v5 offset:704
    ds_read_b64_tr_b16 a[56:57], v5 offset:8640
    ds_read_b64_tr_b16 a[58:59], v5 offset:9152
    ds_read_b64_tr_b16 a[28:29], v5 offset:224
    ds_read_b64_tr_b16 a[30:31], v5 offset:736
    ds_read_b64_tr_b16 a[60:61], v5 offset:8672
    ds_read_b64_tr_b16 a[62:63], v5 offset:9184
    s_waitcnt lgkmcnt(15)
    v_mfma_f32_16x16x32_bf16 v[128:131], a[0:3], a[64:67], 0
    s_bfe_u32 s98, s96, 0x40004
    v_mfma_f32_16x16x32_bf16 v[128:131], a[32:35], a[80:83], v[128:131]
    s_lshl_b32 s40, s98, 7
    s_add_u32 s41, s40, 40960
    s_add_u32 m0, s42, 30720
    s_nop 0
    buffer_load_dwordx4 v14, s[12:15], s40 offen offset:0 lds
    v_mfma_f32_16x16x32_bf16 v[160:163], a[32:35], a[84:87], 0
    buffer_load_dwordx4 v15, s[12:15], s40 offen offset:1024 lds
    v_mfma_f32_16x16x32_bf16 v[160:163], a[0:3], a[68:71], v[160:163]
    buffer_load_dwordx4 v16, s[12:15], s40 offen offset:2048 lds
    v_mfma_f32_16x16x32_bf16 v[192:195], a[0:3], a[72:75], 0
    buffer_load_dwordx4 v17, s[12:15], s40 offen offset:3072 lds
    v_mfma_f32_16x16x32_bf16 v[192:195], a[32:35], a[88:91], v[192:195]
    s_add_u32 m0, s42, 34816
    s_nop 0
    buffer_load_dwordx4 v14, s[12:15], s41 offen offset:0 lds
    v_mfma_f32_16x16x32_bf16 v[132:135], a[4:7], a[64:67], 0
    v_mfma_f32_16x16x32_bf16 v[132:135], a[36:39], a[80:83], v[132:135]
    buffer_load_dwordx4 v15, s[12:15], s41 offen offset:1024 lds
    v_mfma_f32_16x16x32_bf16 v[164:167], a[36:39], a[84:87], 0
    s_bfe_u32 s98, s96, 0x40008
    s_lshl_b32 s36, s98, 19
    s_add_u32 s36, s36, s45
    s_add_u32 m0, s34, 0
    s_nop 0
    buffer_load_dwordx4 v10, s[4:7], s36 offen offset:0 lds
    v_mfma_f32_16x16x32_bf16 v[164:167], a[4:7], a[68:71], v[164:167]
    buffer_load_dwordx4 v11, s[4:7], s36 offen offset:1056 lds
    v_mfma_f32_16x16x32_bf16 v[196:199], a[4:7], a[72:75], 0
    buffer_load_dwordx4 v12, s[4:7], s36 offen offset:2112 lds
    v_mfma_f32_16x16x32_bf16 v[196:199], a[36:39], a[88:91], v[196:199]
    buffer_load_dwordx4 v13, s[4:7], s36 offen offset:3168 lds
    v_mfma_f32_16x16x32_bf16 v[136:139], a[8:11], a[64:67], 0
    v_mfma_f32_16x16x32_bf16 v[136:139], a[40:43], a[80:83], v[136:139]
    v_add_u32 v5, 84480, v3
    v_mfma_f32_16x16x32_bf16 v[168:171], a[40:43], a[84:87], 0
    s_waitcnt vmcnt(10) lgkmcnt(0)
    v_mfma_f32_16x16x32_bf16 v[168:171], a[8:11], a[68:71], v[168:171]
    s_barrier
    v_mfma_f32_16x16x32_bf16 v[200:203], a[8:11], a[72:75], 0
    ds_read_b64_tr_b16 a[0:1], v5 offset:0
    ds_read_b64_tr_b16 a[2:3], v5 offset:512
    v_mfma_f32_16x16x32_bf16 v[200:203], a[40:43], a[88:91], v[200:203]
    ds_read_b64_tr_b16 a[32:33], v5 offset:8448
    ds_read_b64_tr_b16 a[34:35], v5 offset:8960
    v_mfma_f32_16x16x32_bf16 v[140:143], a[12:15], a[64:67], 0
    ds_read_b64_tr_b16 a[4:5], v5 offset:32
    ds_read_b64_tr_b16 a[6:7], v5 offset:544
    v_mfma_f32_16x16x32_bf16 v[140:143], a[44:47], a[80:83], v[140:143]
    ds_read_b64_tr_b16 a[36:37], v5 offset:8480
    ds_read_b64_tr_b16 a[38:39], v5 offset:8992
    v_mfma_f32_16x16x32_bf16 v[172:175], a[44:47], a[84:87], 0
    s_bfe_u32 s98, s96, 0x40008
    ds_read_b64_tr_b16 a[8:9], v5 offset:64
    ds_read_b64_tr_b16 a[10:11], v5 offset:576
    v_mfma_f32_16x16x32_bf16 v[172:175], a[12:15], a[68:71], v[172:175]
    s_lshl_b32 s40, s98, 7
    ds_read_b64_tr_b16 a[40:41], v5 offset:8512
    ds_read_b64_tr_b16 a[42:43], v5 offset:9024
    v_mfma_f32_16x16x32_bf16 v[204:207], a[12:15], a[72:75], 0
    s_add_u32 s41, s40, 40960
    ds_read_b64_tr_b16 a[12:13], v5 offset:96
    ds_read_b64_tr_b16 a[14:15], v5 offset:608
    v_mfma_f32_16x16x32_bf16 v[204:207], a[44:47], a[88:91], v[204:207]
    s_add_u32 m0, s42, 0
    ds_read_b64_tr_b16 a[44:45], v5 offset:8544
    ds_read_b64_tr_b16 a[46:47], v5 offset:9056
    v_mfma_f32_16x16x32_bf16 v[144:147], a[16:19], a[64:67], 0
    buffer_load_dwordx4 v14, s[12:15], s40 offen offset:0 lds
    v_mfma_f32_16x16x32_bf16 v[144:147], a[48:51], a[80:83], v[144:147]
    buffer_load_dwordx4 v15, s[12:15], s40 offen offset:1024 lds
    v_mfma_f32_16x16x32_bf16 v[176:179], a[48:51], a[84:87], 0
    buffer_load_dwordx4 v16, s[12:15], s40 offen offset:2048 lds
    v_mfma_f32_16x16x32_bf16 v[176:179], a[16:19], a[68:71], v[176:179]
    buffer_load_dwordx4 v17, s[12:15], s40 offen offset:3072 lds
    v_mfma_f32_16x16x32_bf16 v[208:211], a[16:19], a[72:75], 0
    ds_read_b64_tr_b16 a[16:17], v5 offset:128
    ds_read_b64_tr_b16 a[18:19], v5 offset:640
    v_mfma_f32_16x16x32_bf16 v[208:211], a[48:51], a[88:91], v[208:211]
    s_add_u32 m0, s42, 4096
    ds_read_b64_tr_b16 a[48:49], v5 offset:8576
    ds_read_b64_tr_b16 a[50:51], v5 offset:9088
    v_mfma_f32_16x16x32_bf16 v[148:151], a[20:23], a[64:67], 0
    buffer_load_dwordx4 v14, s[12:15], s41 offen offset:0 lds
    v_mfma_f32_16x16x32_bf16 v[148:151], a[52:55], a[80:83], v[148:151]
    v_mfma_f32_16x16x32_bf16 v[180:183], a[52:55], a[84:87], 0
    s_waitcnt vmcnt(9)
    buffer_load_dwordx4 v15, s[12:15], s41 offen offset:1024 lds
    v_mfma_f32_16x16x32_bf16 v[180:183], a[20:23], a[68:71], v[180:183]
    ds_read_b128 a[96:99], v18 offset:30720
    v_mfma_f32_16x16x32_bf16 v[212:215], a[20:23], a[72:75], 0
    ds_read_b64_tr_b16 a[20:21], v5 offset:160
    ds_read_b64_tr_b16 a[22:23], v5 offset:672
    v_mfma_f32_16x16x32_bf16 v[212:215], a[52:55], a[88:91], v[212:215]
    ds_read_b64_tr_b16 a[52:53], v5 offset:8608
    ds_read_b64_tr_b16 a[54:55], v5 offset:9120
    v_mfma_f32_16x16x32_bf16 v[152:155], a[24:27], a[64:67], 0
    ds_read_b128 a[112:115], v19 offset:30720
    v_mfma_f32_16x16x32_bf16 v[152:155], a[56:59], a[80:83], v[152:155]
    ds_read_b128 a[100:103], v18 offset:32768
    v_mfma_f32_16x16x32_bf16 v[184:187], a[56:59], a[84:87], 0
    ds_read_b128 a[116:119], v19 offset:32768
    v_mfma_f32_16x16x32_bf16 v[184:187], a[24:27], a[68:71], v[184:187]
    s_bfe_u32 s98, s96, 0x4000c
    ds_read_b128 a[104:107], v18 offset:34816
    v_mfma_f32_16x16x32_bf16 v[216:219], a[24:27], a[72:75], 0
    s_lshl_b32 s36, s98, 19
    ds_read_b64_tr_b16 a[24:25], v5 offset:192
    ds_read_b64_tr_b16 a[26:27], v5 offset:704
    v_mfma_f32_16x16x32_bf16 v[216:219], a[56:59], a[88:91], v[216:219]
    s_add_u32 s36, s36, s45
    ds_read_b64_tr_b16 a[56:57], v5 offset:8640
    ds_read_b64_tr_b16 a[58:59], v5 offset:9152
    v_mfma_f32_16x16x32_bf16 v[156:159], a[28:31], a[64:67], 0
    s_add_u32 m0, s34, 16896
    ds_read_b128 a[120:123], v19 offset:34816
    v_mfma_f32_16x16x32_bf16 v[156:159], a[60:63], a[80:83], v[156:159]
    buffer_load_dwordx4 v10, s[4:7], s36 offen offset:0 lds
    v_mfma_f32_16x16x32_bf16 v[188:191], a[60:63], a[84:87], 0
    buffer_load_dwordx4 v11, s[4:7], s36 offen offset:1056 lds
    v_mfma_f32_16x16x32_bf16 v[188:191], a[28:31], a[68:71], v[188:191]
    buffer_load_dwordx4 v12, s[4:7], s36 offen offset:2112 lds
    v_mfma_f32_16x16x32_bf16 v[220:223], a[28:31], a[72:75], 0
    ds_read_b64_tr_b16 a[28:29], v5 offset:224
    ds_read_b64_tr_b16 a[30:31], v5 offset:736
    v_mfma_f32_16x16x32_bf16 v[220:223], a[60:63], a[88:91], v[220:223]
    s_waitcnt lgkmcnt(15)
    ds_read_b64_tr_b16 a[60:61], v5 offset:8672
    ds_read_b64_tr_b16 a[62:63], v5 offset:9184
    buffer_load_dwordx4 v13, s[4:7], s36 offen offset:3168 lds
    v_mfma_f32_16x16x32_bf16 v[128:131], a[0:3], a[96:99], v[128:131]
    s_waitcnt lgkmcnt(12)
    v_mfma_f32_16x16x32_bf16 v[128:131], a[32:35], a[112:115], v[128:131]
    s_waitcnt lgkmcnt(10)
    v_mfma_f32_16x16x32_bf16 v[160:163], a[32:35], a[116:119], v[160:163]
    v_mfma_f32_16x16x32_bf16 v[160:163], a[0:3], a[100:103], v[160:163]
    s_waitcnt lgkmcnt(9)
    v_mfma_f32_16x16x32_bf16 v[192:195], a[0:3], a[104:107], v[192:195]
    s_waitcnt lgkmcnt(4)
    v_mfma_f32_16x16x32_bf16 v[192:195], a[32:35], a[120:123], v[192:195]
    v_mfma_f32_16x16x32_bf16 v[132:135], a[4:7], a[96:99], v[132:135]
    v_add_u32 v5, 0, v3
    v_mfma_f32_16x16x32_bf16 v[132:135], a[36:39], a[112:115], v[132:135]
    s_waitcnt vmcnt(10) lgkmcnt(0)
    v_mfma_f32_16x16x32_bf16 v[164:167], a[36:39], a[116:119], v[164:167]
    s_barrier
    v_mfma_f32_16x16x32_bf16 v[164:167], a[4:7], a[100:103], v[164:167]
    s_bfe_u32 s98, s96, 0x4000c
    ds_read_b64_tr_b16 a[0:1], v5 offset:0
    ds_read_b64_tr_b16 a[2:3], v5 offset:512
    v_mfma_f32_16x16x32_bf16 v[196:199], a[4:7], a[104:107], v[196:199]
    s_lshl_b32 s40, s98, 7
    ds_read_b64_tr_b16 a[32:33], v5 offset:8448
    ds_read_b64_tr_b16 a[34:35], v5 offset:8960
    v_mfma_f32_16x16x32_bf16 v[196:199], a[36:39], a[120:123], v[196:199]
    s_add_u32 s41, s40, 40960
    ds_read_b64_tr_b16 a[4:5], v5 offset:32
    ds_read_b64_tr_b16 a[6:7], v5 offset:544
    v_mfma_f32_16x16x32_bf16 v[136:139], a[8:11], a[96:99], v[136:139]
    s_add_u32 m0, s42, 30720
    ds_read_b64_tr_b16 a[36:37], v5 offset:8480
    ds_read_b64_tr_b16 a[38:39], v5 offset:8992
    v_mfma_f32_16x16x32_bf16 v[136:139], a[40:43], a[112:115], v[136:139]
    buffer_load_dwordx4 v14, s[12:15], s40 offen offset:0 lds
    v_mfma_f32_16x16x32_bf16 v[168:171], a[40:43], a[116:119], v[168:171]
    buffer_load_dwordx4 v15, s[12:15], s40 offen offset:1024 lds
    v_mfma_f32_16x16x32_bf16 v[168:171], a[8:11], a[100:103], v[168:171]
    v_mfma_f32_16x16x32_bf16 v[200:203], a[8:11], a[104:107], v[200:203]
    ds_read_b64_tr_b16 a[8:9], v5 offset:64
    ds_read_b64_tr_b16 a[10:11], v5 offset:576
    v_mfma_f32_16x16x32_bf16 v[200:203], a[40:43], a[120:123], v[200:203]
    ds_read_b64_tr_b16 a[40:41], v5 offset:8512
    ds_read_b64_tr_b16 a[42:43], v5 offset:9024
    v_mfma_f32_16x16x32_bf16 v[140:143], a[12:15], a[96:99], v[140:143]
    buffer_load_dwordx4 v16, s[12:15], s40 offen offset:2048 lds
    v_mfma_f32_16x16x32_bf16 v[140:143], a[44:47], a[112:115], v[140:143]
    buffer_load_dwordx4 v17, s[12:15], s40 offen offset:3072 lds
    v_mfma_f32_16x16x32_bf16 v[172:175], a[44:47], a[116:119], v[172:175]
    v_mfma_f32_16x16x32_bf16 v[172:175], a[12:15], a[100:103], v[172:175]
    v_mfma_f32_16x16x32_bf16 v[204:207], a[12:15], a[104:107], v[204:207]
    ds_read_b64_tr_b16 a[12:13], v5 offset:96
    ds_read_b64_tr_b16 a[14:15], v5 offset:608
    v_mfma_f32_16x16x32_bf16 v[204:207], a[44:47], a[120:123], v[204:207]
    s_add_u32 m0, s42, 34816
    ds_read_b64_tr_b16 a[44:45], v5 offset:8544
    ds_read_b64_tr_b16 a[46:47], v5 offset:9056
    v_mfma_f32_16x16x32_bf16 v[144:147], a[16:19], a[96:99], v[144:147]
    buffer_load_dwordx4 v14, s[12:15], s41 offen offset:0 lds
    v_mfma_f32_16x16x32_bf16 v[144:147], a[48:51], a[112:115], v[144:147]
    buffer_load_dwordx4 v15, s[12:15], s41 offen offset:1024 lds
    v_mfma_f32_16x16x32_bf16 v[176:179], a[48:51], a[116:119], v[176:179]
    s_bfe_u32 s98, s96, 0x40010
    v_mfma_f32_16x16x32_bf16 v[176:179], a[16:19], a[100:103], v[176:179]
    s_lshl_b32 s36, s98, 19
    v_mfma_f32_16x16x32_bf16 v[208:211], a[16:19], a[104:107], v[208:211]
    s_add_u32 s36, s36, s45
    ds_read_b64_tr_b16 a[16:17], v5 offset:128
    ds_read_b64_tr_b16 a[18:19], v5 offset:640
    v_mfma_f32_16x16x32_bf16 v[208:211], a[48:51], a[120:123], v[208:211]
    s_add_u32 m0, s34, 84480
    ds_read_b64_tr_b16 a[48:49], v5 offset:8576
    ds_read_b64_tr_b16 a[50:51], v5 offset:9088
    v_mfma_f32_16x16x32_bf16 v[148:151], a[20:23], a[96:99], v[148:151]
    buffer_load_dwordx4 v10, s[4:7], s36 offen offset:0 lds
    v_mfma_f32_16x16x32_bf16 v[148:151], a[52:55], a[112:115], v[148:151]
    buffer_load_dwordx4 v11, s[4:7], s36 offen offset:1056 lds
    v_mfma_f32_16x16x32_bf16 v[180:183], a[52:55], a[116:119], v[180:183]
    s_waitcnt vmcnt(12)
    v_mfma_f32_16x16x32_bf16 v[180:183], a[20:23], a[100:103], v[180:183]
    ds_read_b128 a[64:67], v18 offset:0
    v_mfma_f32_16x16x32_bf16 v[212:215], a[20:23], a[104:107], v[212:215]
    ds_read_b64_tr_b16 a[20:21], v5 offset:160
    ds_read_b64_tr_b16 a[22:23], v5 offset:672
    v_mfma_f32_16x16x32_bf16 v[212:215], a[52:55], a[120:123], v[212:215]
    ds_read_b64_tr_b16 a[52:53], v5 offset:8608
    ds_read_b64_tr_b16 a[54:55], v5 offset:9120
    v_mfma_f32_16x16x32_bf16 v[152:155], a[24:27], a[96:99], v[152:155]
    ds_read_b128 a[80:83], v19 offset:0
    v_mfma_f32_16x16x32_bf16 v[152:155], a[56:59], a[112:115], v[152:155]
    ds_read_b128 a[68:71], v18 offset:2048
    v_mfma_f32_16x16x32_bf16 v[184:187], a[56:59], a[116:119], v[184:187]
    ds_read_b128 a[84:87], v19 offset:2048
    v_mfma_f32_16x16x32_bf16 v[184:187], a[24:27], a[100:103], v[184:187]
    ds_read_b128 a[72:75], v18 offset:4096
    v_mfma_f32_16x16x32_bf16 v[216:219], a[24:27], a[104:107], v[216:219]
    ds_read_b64_tr_b16 a[24:25], v5 offset:192
    ds_read_b64_tr_b16 a[26:27], v5 offset:704
    v_mfma_f32_16x16x32_bf16 v[216:219], a[56:59], a[120:123], v[216:219]
    ds_read_b64_tr_b16 a[56:57], v5 offset:8640
    ds_read_b64_tr_b16 a[58:59], v5 offset:9152
    v_mfma_f32_16x16x32_bf16 v[156:159], a[28:31], a[96:99], v[156:159]
    ds_read_b128 a[88:91], v19 offset:4096
    v_mfma_f32_16x16x32_bf16 v[156:159], a[60:63], a[112:115], v[156:159]
    buffer_load_dwordx4 v12, s[4:7], s36 offen offset:2112 lds
    v_mfma_f32_16x16x32_bf16 v[188:191], a[60:63], a[116:119], v[188:191]
    buffer_load_dwordx4 v13, s[4:7], s36 offen offset:3168 lds
    v_mfma_f32_16x16x32_bf16 v[188:191], a[28:31], a[100:103], v[188:191]
    v_mfma_f32_16x16x32_bf16 v[220:223], a[28:31], a[104:107], v[220:223]
    ds_read_b64_tr_b16 a[28:29], v5 offset:224
    ds_read_b64_tr_b16 a[30:31], v5 offset:736
    v_mfma_f32_16x16x32_bf16 v[220:223], a[60:63], a[120:123], v[220:223]
    s_waitcnt lgkmcnt(15)
    ds_read_b64_tr_b16 a[60:61], v5 offset:8672
    ds_read_b64_tr_b16 a[62:63], v5 offset:9184
    v_mfma_f32_16x16x32_bf16 v[128:131], a[0:3], a[64:67], v[128:131]
    s_waitcnt lgkmcnt(12)
    v_mfma_f32_16x16x32_bf16 v[128:131], a[32:35], a[80:83], v[128:131]
    s_waitcnt lgkmcnt(10)
    v_mfma_f32_16x16x32_bf16 v[160:163], a[32:35], a[84:87], v[160:163]
    v_mfma_f32_16x16x32_bf16 v[160:163], a[0:3], a[68:71], v[160:163]
    s_waitcnt lgkmcnt(9)
    v_mfma_f32_16x16x32_bf16 v[192:195], a[0:3], a[72:75], v[192:195]
    s_waitcnt lgkmcnt(4)
    v_mfma_f32_16x16x32_bf16 v[192:195], a[32:35], a[88:91], v[192:195]
    v_mfma_f32_16x16x32_bf16 v[132:135], a[4:7], a[64:67], v[132:135]
    v_add_u32 v5, 16896, v3
    v_mfma_f32_16x16x32_bf16 v[132:135], a[36:39], a[80:83], v[132:135]
    s_waitcnt vmcnt(10) lgkmcnt(0)
    v_mfma_f32_16x16x32_bf16 v[164:167], a[36:39], a[84:87], v[164:167]
    s_barrier
    v_mfma_f32_16x16x32_bf16 v[164:167], a[4:7], a[68:71], v[164:167]
    s_bfe_u32 s98, s96, 0x40010
    ds_read_b64_tr_b16 a[0:1], v5 offset:0
    ds_read_b64_tr_b16 a[2:3], v5 offset:512
    v_mfma_f32_16x16x32_bf16 v[196:199], a[4:7], a[72:75], v[196:199]
    s_lshl_b32 s40, s98, 7
    ds_read_b64_tr_b16 a[32:33], v5 offset:8448
    ds_read_b64_tr_b16 a[34:35], v5 offset:8960
    v_mfma_f32_16x16x32_bf16 v[196:199], a[36:39], a[88:91], v[196:199]
    s_add_u32 s41, s40, 40960
    ds_read_b64_tr_b16 a[4:5], v5 offset:32
    ds_read_b64_tr_b16 a[6:7], v5 offset:544
    v_mfma_f32_16x16x32_bf16 v[136:139], a[8:11], a[64:67], v[136:139]
    s_add_u32 m0, s42, 0
    ds_read_b64_tr_b16 a[36:37], v5 offset:8480
    ds_read_b64_tr_b16 a[38:39], v5 offset:8992
    v_mfma_f32_16x16x32_bf16 v[136:139], a[40:43], a[80:83], v[136:139]
    buffer_load_dwordx4 v14, s[12:15], s40 offen offset:0 lds
    v_mfma_f32_16x16x32_bf16 v[168:171], a[40:43], a[84:87], v[168:171]
    buffer_load_dwordx4 v15, s[12:15], s40 offen offset:1024 lds
    v_mfma_f32_16x16x32_bf16 v[168:171], a[8:11], a[68:71], v[168:171]
    v_mfma_f32_16x16x32_bf16 v[200:203], a[8:11], a[72:75], v[200:203]
    ds_read_b64_tr_b16 a[8:9], v5 offset:64
    ds_read_b64_tr_b16 a[10:11], v5 offset:576
    v_mfma_f32_16x16x32_bf16 v[200:203], a[40:43], a[88:91], v[200:203]
    ds_read_b64_tr_b16 a[40:41], v5 offset:8512
    ds_read_b64_tr_b16 a[42:43], v5 offset:9024
    v_mfma_f32_16x16x32_bf16 v[140:143], a[12:15], a[64:67], v[140:143]
    buffer_load_dwordx4 v16, s[12:15], s40 offen offset:2048 lds
    v_mfma_f32_16x16x32_bf16 v[140:143], a[44:47], a[80:83], v[140:143]
    buffer_load_dwordx4 v17, s[12:15], s40 offen offset:3072 lds
    v_mfma_f32_16x16x32_bf16 v[172:175], a[44:47], a[84:87], v[172:175]
    v_mfma_f32_16x16x32_bf16 v[172:175], a[12:15], a[68:71], v[172:175]
    v_mfma_f32_16x16x32_bf16 v[204:207], a[12:15], a[72:75], v[204:207]
    ds_read_b64_tr_b16 a[12:13], v5 offset:96
    ds_read_b64_tr_b16 a[14:15], v5 offset:608
    v_mfma_f32_16x16x32_bf16 v[204:207], a[44:47], a[88:91], v[204:207]
    s_add_u32 m0, s42, 4096
    ds_read_b64_tr_b16 a[44:45], v5 offset:8544
    ds_read_b64_tr_b16 a[46:47], v5 offset:9056
    v_mfma_f32_16x16x32_bf16 v[144:147], a[16:19], a[64:67], v[144:147]
    buffer_load_dwordx4 v14, s[12:15], s41 offen offset:0 lds
    v_mfma_f32_16x16x32_bf16 v[144:147], a[48:51], a[80:83], v[144:147]
    buffer_load_dwordx4 v15, s[12:15], s41 offen offset:1024 lds
    v_mfma_f32_16x16x32_bf16 v[176:179], a[48:51], a[84:87], v[176:179]
    s_bfe_u32 s98, s96, 0x40014
    v_mfma_f32_16x16x32_bf16 v[176:179], a[16:19], a[68:71], v[176:179]
    s_lshl_b32 s36, s98, 19
    v_mfma_f32_16x16x32_bf16 v[208:211], a[16:19], a[72:75], v[208:211]
    s_add_u32 s36, s36, s45
    ds_read_b64_tr_b16 a[16:17], v5 offset:128
    ds_read_b64_tr_b16 a[18:19], v5 offset:640
    v_mfma_f32_16x16x32_bf16 v[208:211], a[48:51], a[88:91], v[208:211]
    s_add_u32 m0, s34, 0
    ds_read_b64_tr_b16 a[48:49], v5 offset:8576
    ds_read_b64_tr_b16 a[50:51], v5 offset:9088
    v_mfma_f32_16x16x32_bf16 v[148:151], a[20:23], a[64:67], v[148:151]
    buffer_load_dwordx4 v10, s[4:7], s36 offen offset:0 lds
    v_mfma_f32_16x16x32_bf16 v[148:151], a[52:55], a[80:83], v[148:151]
    buffer_load_dwordx4 v11, s[4:7], s36 offen offset:1056 lds
    v_mfma_f32_16x16x32_bf16 v[180:183], a[52:55], a[84:87], v[180:183]
    s_waitcnt vmcnt(12)
    v_mfma_f32_16x16x32_bf16 v[180:183], a[20:23], a[68:71], v[180:183]
    ds_read_b128 a[96:99], v18 offset:30720
    v_mfma_f32_16x16x32_bf16 v[212:215], a[20:23], a[72:75], v[212:215]
    ds_read_b64_tr_b16 a[20:21], v5 offset:160
    ds_read_b64_tr_b16 a[22:23], v5 offset:672
    v_mfma_f32_16x16x32_bf16 v[212:215], a[52:55], a[88:91], v[212:215]
    ds_read_b64_tr_b16 a[52:53], v5 offset:8608
    ds_read_b64_tr_b16 a[54:55], v5 offset:9120
    v_mfma_f32_16x16x32_bf16 v[152:155], a[24:27], a[64:67], v[152:155]
    ds_read_b128 a[112:115], v19 offset:30720
    v_mfma_f32_16x16x32_bf16 v[152:155], a[56:59], a[80:83], v[152:155]
    ds_read_b128 a[100:103], v18 offset:32768
    v_mfma_f32_16x16x32_bf16 v[184:187], a[56:59], a[84:87], v[184:187]
    ds_read_b128 a[116:119], v19 offset:32768
    v_mfma_f32_16x16x32_bf16 v[184:187], a[24:27], a[68:71], v[184:187]
    ds_read_b128 a[104:107], v18 offset:34816
    v_mfma_f32_16x16x32_bf16 v[216:219], a[24:27], a[72:75], v[216:219]
    ds_read_b64_tr_b16 a[24:25], v5 offset:192
    ds_read_b64_tr_b16 a[26:27], v5 offset:704
    v_mfma_f32_16x16x32_bf16 v[216:219], a[56:59], a[88:91], v[216:219]
    ds_read_b64_tr_b16 a[56:57], v5 offset:8640
    ds_read_b64_tr_b16 a[58:59], v5 offset:9152
    v_mfma_f32_16x16x32_bf16 v[156:159], a[28:31], a[64:67], v[156:159]
    ds_read_b128 a[120:123], v19 offset:34816
    v_mfma_f32_16x16x32_bf16 v[156:159], a[60:63], a[80:83], v[156:159]
    buffer_load_dwordx4 v12, s[4:7], s36 offen offset:2112 lds
    v_mfma_f32_16x16x32_bf16 v[188:191], a[60:63], a[84:87], v[188:191]
    buffer_load_dwordx4 v13, s[4:7], s36 offen offset:3168 lds
    v_mfma_f32_16x16x32_bf16 v[188:191], a[28:31], a[68:71], v[188:191]
    v_mfma_f32_16x16x32_bf16 v[220:223], a[28:31], a[72:75], v[220:223]
    ds_read_b64_tr_b16 a[28:29], v5 offset:224
    ds_read_b64_tr_b16 a[30:31], v5 offset:736
    v_mfma_f32_16x16x32_bf16 v[220:223], a[60:63], a[88:91], v[220:223]
    s_waitcnt lgkmcnt(15)
    ds_read_b64_tr_b16 a[60:61], v5 offset:8672
    ds_read_b64_tr_b16 a[62:63], v5 offset:9184
    v_mfma_f32_16x16x32_bf16 v[128:131], a[0:3], a[96:99], v[128:131]
    s_waitcnt lgkmcnt(12)
    v_mfma_f32_16x16x32_bf16 v[128:131], a[32:35], a[112:115], v[128:131]
    s_waitcnt lgkmcnt(10)
    v_mfma_f32_16x16x32_bf16 v[160:163], a[32:35], a[116:119], v[160:163]
    v_mfma_f32_16x16x32_bf16 v[160:163], a[0:3], a[100:103], v[160:163]
    s_waitcnt lgkmcnt(9)
    v_mfma_f32_16x16x32_bf16 v[192:195], a[0:3], a[104:107], v[192:195]
    s_waitcnt lgkmcnt(4)
    v_mfma_f32_16x16x32_bf16 v[192:195], a[32:35], a[120:123], v[192:195]
    v_mfma_f32_16x16x32_bf16 v[132:135], a[4:7], a[96:99], v[132:135]
    v_add_u32 v5, 84480, v3
    v_mfma_f32_16x16x32_bf16 v[132:135], a[36:39], a[112:115], v[132:135]
    s_waitcnt vmcnt(10) lgkmcnt(0)
    v_mfma_f32_16x16x32_bf16 v[164:167], a[36:39], a[116:119], v[164:167]
    s_barrier
    v_mfma_f32_16x16x32_bf16 v[164:167], a[4:7], a[100:103], v[164:167]
    s_bfe_u32 s98, s96, 0x40014
    ds_read_b64_tr_b16 a[0:1], v5 offset:0
    ds_read_b64_tr_b16 a[2:3], v5 offset:512
    v_mfma_f32_16x16x32_bf16 v[196:199], a[4:7], a[104:107], v[196:199]
    s_lshl_b32 s40, s98, 7
    ds_read_b64_tr_b16 a[32:33], v5 offset:8448
    ds_read_b64_tr_b16 a[34:35], v5 offset:8960
    v_mfma_f32_16x16x32_bf16 v[196:199], a[36:39], a[120:123], v[196:199]
    s_add_u32 s41, s40, 40960
    ds_read_b64_tr_b16 a[4:5], v5 offset:32
    ds_read_b64_tr_b16 a[6:7], v5 offset:544
    v_mfma_f32_16x16x32_bf16 v[136:139], a[8:11], a[96:99], v[136:139]
    s_add_u32 m0, s42, 30720
    ds_read_b64_tr_b16 a[36:37], v5 offset:8480
    ds_read_b64_tr_b16 a[38:39], v5 offset:8992
    v_mfma_f32_16x16x32_bf16 v[136:139], a[40:43], a[112:115], v[136:139]
    buffer_load_dwordx4 v14, s[12:15], s40 offen offset:0 lds
    v_mfma_f32_16x16x32_bf16 v[168:171], a[40:43], a[116:119], v[168:171]
    buffer_load_dwordx4 v15, s[12:15], s40 offen offset:1024 lds
    v_mfma_f32_16x16x32_bf16 v[168:171], a[8:11], a[100:103], v[168:171]
    v_mfma_f32_16x16x32_bf16 v[200:203], a[8:11], a[104:107], v[200:203]
    ds_read_b64_tr_b16 a[8:9], v5 offset:64
    ds_read_b64_tr_b16 a[10:11], v5 offset:576
    v_mfma_f32_16x16x32_bf16 v[200:203], a[40:43], a[120:123], v[200:203]
    ds_read_b64_tr_b16 a[40:41], v5 offset:8512
    ds_read_b64_tr_b16 a[42:43], v5 offset:9024
    v_mfma_f32_16x16x32_bf16 v[140:143], a[12:15], a[96:99], v[140:143]
    buffer_load_dwordx4 v16, s[12:15], s40 offen offset:2048 lds
    v_mfma_f32_16x16x32_bf16 v[140:143], a[44:47], a[112:115], v[140:143]
    buffer_load_dwordx4 v17, s[12:15], s40 offen offset:3072 lds
    v_mfma_f32_16x16x32_bf16 v[172:175], a[44:47], a[116:119], v[172:175]
    v_mfma_f32_16x16x32_bf16 v[172:175], a[12:15], a[100:103], v[172:175]
    v_mfma_f32_16x16x32_bf16 v[204:207], a[12:15], a[104:107], v[204:207]
    ds_read_b64_tr_b16 a[12:13], v5 offset:96
    ds_read_b64_tr_b16 a[14:15], v5 offset:608
    v_mfma_f32_16x16x32_bf16 v[204:207], a[44:47], a[120:123], v[204:207]
    s_add_u32 m0, s42, 34816
    ds_read_b64_tr_b16 a[44:45], v5 offset:8544
    ds_read_b64_tr_b16 a[46:47], v5 offset:9056
    v_mfma_f32_16x16x32_bf16 v[144:147], a[16:19], a[96:99], v[144:147]
    buffer_load_dwordx4 v14, s[12:15], s41 offen offset:0 lds
    v_mfma_f32_16x16x32_bf16 v[144:147], a[48:51], a[112:115], v[144:147]
    buffer_load_dwordx4 v15, s[12:15], s41 offen offset:1024 lds
    v_mfma_f32_16x16x32_bf16 v[176:179], a[48:51], a[116:119], v[176:179]
    s_bfe_u32 s98, s96, 0x40018
    v_mfma_f32_16x16x32_bf16 v[176:179], a[16:19], a[100:103], v[176:179]
    s_lshl_b32 s36, s98, 19
    v_mfma_f32_16x16x32_bf16 v[208:211], a[16:19], a[104:107], v[208:211]
    s_add_u32 s36, s36, s45
    ds_read_b64_tr_b16 a[16:17], v5 offset:128
    ds_read_b64_tr_b16 a[18:19], v5 offset:640
    v_mfma_f32_16x16x32_bf16 v[208:211], a[48:51], a[120:123], v[208:211]
    s_add_u32 m0, s34, 16896
    ds_read_b64_tr_b16 a[48:49], v5 offset:8576
    ds_read_b64_tr_b16 a[50:51], v5 offset:9088
    v_mfma_f32_16x16x32_bf16 v[148:151], a[20:23], a[96:99], v[148:151]
    buffer_load_dwordx4 v10, s[4:7], s36 offen offset:0 lds
    v_mfma_f32_16x16x32_bf16 v[148:151], a[52:55], a[112:115], v[148:151]
    buffer_load_dwordx4 v11, s[4:7], s36 offen offset:1056 lds
    v_mfma_f32_16x16x32_bf16 v[180:183], a[52:55], a[116:119], v[180:183]
    s_waitcnt vmcnt(12)
    v_mfma_f32_16x16x32_bf16 v[180:183], a[20:23], a[100:103], v[180:183]
    ds_read_b128 a[64:67], v18 offset:0
    v_mfma_f32_16x16x32_bf16 v[212:215], a[20:23], a[104:107], v[212:215]
    ds_read_b64_tr_b16 a[20:21], v5 offset:160
    ds_read_b64_tr_b16 a[22:23], v5 offset:672
    v_mfma_f32_16x16x32_bf16 v[212:215], a[52:55], a[120:123], v[212:215]
    ds_read_b64_tr_b16 a[52:53], v5 offset:8608
    ds_read_b64_tr_b16 a[54:55], v5 offset:9120
    v_mfma_f32_16x16x32_bf16 v[152:155], a[24:27], a[96:99], v[152:155]
    ds_read_b128 a[80:83], v19 offset:0
    v_mfma_f32_16x16x32_bf16 v[152:155], a[56:59], a[112:115], v[152:155]
    ds_read_b128 a[68:71], v18 offset:2048
    v_mfma_f32_16x16x32_bf16 v[184:187], a[56:59], a[116:119], v[184:187]
    ds_read_b128 a[84:87], v19 offset:2048
    v_mfma_f32_16x16x32_bf16 v[184:187], a[24:27], a[100:103], v[184:187]
    ds_read_b128 a[72:75], v18 offset:4096
    v_mfma_f32_16x16x32_bf16 v[216:219], a[24:27], a[104:107], v[216:219]
    ds_read_b64_tr_b16 a[24:25], v5 offset:192
    ds_read_b64_tr_b16 a[26:27], v5 offset:704
    v_mfma_f32_16x16x32_bf16 v[216:219], a[56:59], a[120:123], v[216:219]
    ds_read_b64_tr_b16 a[56:57], v5 offset:8640
    ds_read_b64_tr_b16 a[58:59], v5 offset:9152
    v_mfma_f32_16x16x32_bf16 v[156:159], a[28:31], a[96:99], v[156:159]
    ds_read_b128 a[88:91], v19 offset:4096
    v_mfma_f32_16x16x32_bf16 v[156:159], a[60:63], a[112:115], v[156:159]
    buffer_load_dwordx4 v12, s[4:7], s36 offen offset:2112 lds
    v_mfma_f32_16x16x32_bf16 v[188:191], a[60:63], a[116:119], v[188:191]
    buffer_load_dwordx4 v13, s[4:7], s36 offen offset:3168 lds
    v_mfma_f32_16x16x32_bf16 v[188:191], a[28:31], a[100:103], v[188:191]
    v_mfma_f32_16x16x32_bf16 v[220:223], a[28:31], a[104:107], v[220:223]
    ds_read_b64_tr_b16 a[28:29], v5 offset:224
    ds_read_b64_tr_b16 a[30:31], v5 offset:736
    v_mfma_f32_16x16x32_bf16 v[220:223], a[60:63], a[120:123], v[220:223]
    s_waitcnt lgkmcnt(15)
    ds_read_b64_tr_b16 a[60:61], v5 offset:8672
    ds_read_b64_tr_b16 a[62:63], v5 offset:9184
    v_mfma_f32_16x16x32_bf16 v[128:131], a[0:3], a[64:67], v[128:131]
    s_waitcnt lgkmcnt(12)
    v_mfma_f32_16x16x32_bf16 v[128:131], a[32:35], a[80:83], v[128:131]
    s_waitcnt lgkmcnt(10)
    v_mfma_f32_16x16x32_bf16 v[160:163], a[32:35], a[84:87], v[160:163]
    v_mfma_f32_16x16x32_bf16 v[160:163], a[0:3], a[68:71], v[160:163]
    s_waitcnt lgkmcnt(9)
    v_mfma_f32_16x16x32_bf16 v[192:195], a[0:3], a[72:75], v[192:195]
    s_waitcnt lgkmcnt(4)
    v_mfma_f32_16x16x32_bf16 v[192:195], a[32:35], a[88:91], v[192:195]
    v_mfma_f32_16x16x32_bf16 v[132:135], a[4:7], a[64:67], v[132:135]
    v_add_u32 v5, 0, v3
    v_mfma_f32_16x16x32_bf16 v[132:135], a[36:39], a[80:83], v[132:135]
    s_waitcnt vmcnt(10) lgkmcnt(0)
    v_mfma_f32_16x16x32_bf16 v[164:167], a[36:39], a[84:87], v[164:167]
    s_barrier
    v_mfma_f32_16x16x32_bf16 v[164:167], a[4:7], a[68:71], v[164:167]
    s_bfe_u32 s98, s96, 0x40018
    ds_read_b64_tr_b16 a[0:1], v5 offset:0
    ds_read_b64_tr_b16 a[2:3], v5 offset:512
    v_mfma_f32_16x16x32_bf16 v[196:199], a[4:7], a[72:75], v[196:199]
    s_lshl_b32 s40, s98, 7
    ds_read_b64_tr_b16 a[32:33], v5 offset:8448
    ds_read_b64_tr_b16 a[34:35], v5 offset:8960
    v_mfma_f32_16x16x32_bf16 v[196:199], a[36:39], a[88:91], v[196:199]
    s_add_u32 s41, s40, 40960
    ds_read_b64_tr_b16 a[4:5], v5 offset:32
    ds_read_b64_tr_b16 a[6:7], v5 offset:544
    v_mfma_f32_16x16x32_bf16 v[136:139], a[8:11], a[64:67], v[136:139]
    s_add_u32 m0, s42, 0
    ds_read_b64_tr_b16 a[36:37], v5 offset:8480
    ds_read_b64_tr_b16 a[38:39], v5 offset:8992
    v_mfma_f32_16x16x32_bf16 v[136:139], a[40:43], a[80:83], v[136:139]
    buffer_load_dwordx4 v14, s[12:15], s40 offen offset:0 lds
    v_mfma_f32_16x16x32_bf16 v[168:171], a[40:43], a[84:87], v[168:171]
    buffer_load_dwordx4 v15, s[12:15], s40 offen offset:1024 lds
    v_mfma_f32_16x16x32_bf16 v[168:171], a[8:11], a[68:71], v[168:171]
    buffer_load_dwordx4 v16, s[12:15], s40 offen offset:2048 lds
    v_mfma_f32_16x16x32_bf16 v[200:203], a[8:11], a[72:75], v[200:203]
    ds_read_b64_tr_b16 a[8:9], v5 offset:64
    ds_read_b64_tr_b16 a[10:11], v5 offset:576
    v_mfma_f32_16x16x32_bf16 v[200:203], a[40:43], a[88:91], v[200:203]
    ds_read_b64_tr_b16 a[40:41], v5 offset:8512
    ds_read_b64_tr_b16 a[42:43], v5 offset:9024
    v_mfma_f32_16x16x32_bf16 v[140:143], a[12:15], a[64:67], v[140:143]
    buffer_load_dwordx4 v17, s[12:15], s40 offen offset:3072 lds
    v_mfma_f32_16x16x32_bf16 v[140:143], a[44:47], a[80:83], v[140:143]
    s_add_u32 m0, s42, 4096
    v_mfma_f32_16x16x32_bf16 v[172:175], a[44:47], a[84:87], v[172:175]
    buffer_load_dwordx4 v14, s[12:15], s41 offen offset:0 lds
    v_mfma_f32_16x16x32_bf16 v[172:175], a[12:15], a[68:71], v[172:175]
    v_mfma_f32_16x16x32_bf16 v[204:207], a[12:15], a[72:75], v[204:207]
    ds_read_b64_tr_b16 a[12:13], v5 offset:96
    ds_read_b64_tr_b16 a[14:15], v5 offset:608
    v_mfma_f32_16x16x32_bf16 v[204:207], a[44:47], a[88:91], v[204:207]
    ds_read_b64_tr_b16 a[44:45], v5 offset:8544
    ds_read_b64_tr_b16 a[46:47], v5 offset:9056
    v_mfma_f32_16x16x32_bf16 v[144:147], a[16:19], a[64:67], v[144:147]
    buffer_load_dwordx4 v15, s[12:15], s41 offen offset:1024 lds
    v_mfma_f32_16x16x32_bf16 v[144:147], a[48:51], a[80:83], v[144:147]
    s_bfe_u32 s98, s96, 0x4001c
    s_lshl_b32 s36, s98, 19
    s_add_u32 s36, s36, s45
    s_add_u32 m0, s34, 84480
    s_nop 0
    buffer_load_dwordx4 v10, s[4:7], s36 offen offset:0 lds
    v_mfma_f32_16x16x32_bf16 v[176:179], a[48:51], a[84:87], v[176:179]
    v_mfma_f32_16x16x32_bf16 v[176:179], a[16:19], a[68:71], v[176:179]
    v_mfma_f32_16x16x32_bf16 v[208:211], a[16:19], a[72:75], v[208:211]
    ds_read_b64_tr_b16 a[16:17], v5 offset:128
    ds_read_b64_tr_b16 a[18:19], v5 offset:640
    v_mfma_f32_16x16x32_bf16 v[208:211], a[48:51], a[88:91], v[208:211]
    ds_read_b64_tr_b16 a[48:49], v5 offset:8576
    ds_read_b64_tr_b16 a[50:51], v5 offset:9088
    v_mfma_f32_16x16x32_bf16 v[148:151], a[20:23], a[64:67], v[148:151]
    buffer_load_dwordx4 v11, s[4:7], s36 offen offset:1056 lds
    v_mfma_f32_16x16x32_bf16 v[148:151], a[52:55], a[80:83], v[148:151]
    buffer_load_dwordx4 v12, s[4:7], s36 offen offset:2112 lds
    v_mfma_f32_16x16x32_bf16 v[180:183], a[52:55], a[84:87], v[180:183]
    s_waitcnt vmcnt(13)
    v_mfma_f32_16x16x32_bf16 v[180:183], a[20:23], a[68:71], v[180:183]
    ds_read_b128 a[96:99], v18 offset:30720
    v_mfma_f32_16x16x32_bf16 v[212:215], a[20:23], a[72:75], v[212:215]
    ds_read_b64_tr_b16 a[20:21], v5 offset:160
    ds_read_b64_tr_b16 a[22:23], v5 offset:672
    v_mfma_f32_16x16x32_bf16 v[212:215], a[52:55], a[88:91], v[212:215]
    ds_read_b64_tr_b16 a[52:53], v5 offset:8608
    ds_read_b64_tr_b16 a[54:55], v5 offset:9120
    v_mfma_f32_16x16x32_bf16 v[152:155], a[24:27], a[64:67], v[152:155]
    ds_read_b128 a[112:115], v19 offset:30720
    v_mfma_f32_16x16x32_bf16 v[152:155], a[56:59], a[80:83], v[152:155]
    ds_read_b128 a[100:103], v18 offset:32768
    v_mfma_f32_16x16x32_bf16 v[184:187], a[56:59], a[84:87], v[184:187]
    ds_read_b128 a[116:119], v19 offset:32768
    v_mfma_f32_16x16x32_bf16 v[184:187], a[24:27], a[68:71], v[184:187]
    ds_read_b128 a[104:107], v18 offset:34816
    v_mfma_f32_16x16x32_bf16 v[216:219], a[24:27], a[72:75], v[216:219]
    ds_read_b64_tr_b16 a[24:25], v5 offset:192
    ds_read_b64_tr_b16 a[26:27], v5 offset:704
    v_mfma_f32_16x16x32_bf16 v[216:219], a[56:59], a[88:91], v[216:219]
    ds_read_b64_tr_b16 a[56:57], v5 offset:8640
    ds_read_b64_tr_b16 a[58:59], v5 offset:9152
    v_mfma_f32_16x16x32_bf16 v[156:159], a[28:31], a[64:67], v[156:159]
    ds_read_b128 a[120:123], v19 offset:34816
    v_mfma_f32_16x16x32_bf16 v[156:159], a[60:63], a[80:83], v[156:159]
    buffer_load_dwordx4 v13, s[4:7], s36 offen offset:3168 lds
    v_mfma_f32_16x16x32_bf16 v[188:191], a[60:63], a[84:87], v[188:191]
    s_max_i32 s39, s35, 0
    s_min_i32 s38, s39, 524288
    s_add_i32 s35, s35, 8192
    s_add_u32 m0, s34, 33792
    s_nop 0
    buffer_load_dwordx4 v6, s[8:11], s38 offen offset:0 nt lds
    v_mfma_f32_16x16x32_bf16 v[188:191], a[28:31], a[68:71], v[188:191]
    buffer_load_dwordx4 v7, s[8:11], s38 offen offset:1056 nt lds
    v_mfma_f32_16x16x32_bf16 v[220:223], a[28:31], a[72:75], v[220:223]
    ds_read_b64_tr_b16 a[28:29], v5 offset:224
    ds_read_b64_tr_b16 a[30:31], v5 offset:736
    v_mfma_f32_16x16x32_bf16 v[220:223], a[60:63], a[88:91], v[220:223]
    s_waitcnt lgkmcnt(15)
    ds_read_b64_tr_b16 a[60:61], v5 offset:8672
    ds_read_b64_tr_b16 a[62:63], v5 offset:9184
    buffer_load_dwordx4 v8, s[8:11], s38 offen offset:2112 nt lds
    buffer_load_dwordx4 v9, s[8:11], s38 offen offset:3168 nt lds
    v_mfma_f32_16x16x32_bf16 v[128:131], a[0:3], a[96:99], v[128:131]
    s_waitcnt lgkmcnt(12)
    v_mfma_f32_16x16x32_bf16 v[128:131], a[32:35], a[112:115], v[128:131]
    s_waitcnt lgkmcnt(10)
    v_mfma_f32_16x16x32_bf16 v[160:163], a[32:35], a[116:119], v[160:163]
    v_mfma_f32_16x16x32_bf16 v[160:163], a[0:3], a[100:103], v[160:163]
    s_waitcnt lgkmcnt(9)
    v_mfma_f32_16x16x32_bf16 v[192:195], a[0:3], a[104:107], v[192:195]
    s_waitcnt lgkmcnt(4)
    v_mfma_f32_16x16x32_bf16 v[192:195], a[32:35], a[120:123], v[192:195]
    v_mfma_f32_16x16x32_bf16 v[132:135], a[4:7], a[96:99], v[132:135]
    v_add_u32 v5, 16896, v3
    v_mfma_f32_16x16x32_bf16 v[132:135], a[36:39], a[112:115], v[132:135]
    s_waitcnt vmcnt(14) lgkmcnt(0)
    v_mfma_f32_16x16x32_bf16 v[164:167], a[36:39], a[116:119], v[164:167]
    s_barrier
    v_mfma_f32_16x16x32_bf16 v[164:167], a[4:7], a[100:103], v[164:167]
    s_bfe_u32 s98, s96, 0x4001c
    ds_read_b64_tr_b16 a[0:1], v5 offset:0
    ds_read_b64_tr_b16 a[2:3], v5 offset:512
    v_mfma_f32_16x16x32_bf16 v[196:199], a[4:7], a[104:107], v[196:199]
    s_lshl_b32 s40, s98, 7
    ds_read_b64_tr_b16 a[32:33], v5 offset:8448
    ds_read_b64_tr_b16 a[34:35], v5 offset:8960
    v_mfma_f32_16x16x32_bf16 v[196:199], a[36:39], a[120:123], v[196:199]
    s_add_u32 s41, s40, 40960
    ds_read_b64_tr_b16 a[4:5], v5 offset:32
    ds_read_b64_tr_b16 a[6:7], v5 offset:544
    v_mfma_f32_16x16x32_bf16 v[136:139], a[8:11], a[96:99], v[136:139]
    s_add_u32 m0, s42, 30720
    ds_read_b64_tr_b16 a[36:37], v5 offset:8480
    ds_read_b64_tr_b16 a[38:39], v5 offset:8992
    v_mfma_f32_16x16x32_bf16 v[136:139], a[40:43], a[112:115], v[136:139]
    buffer_load_dwordx4 v14, s[12:15], s40 offen offset:0 lds
    v_mfma_f32_16x16x32_bf16 v[168:171], a[40:43], a[116:119], v[168:171]
    buffer_load_dwordx4 v15, s[12:15], s40 offen offset:1024 lds
    v_mfma_f32_16x16x32_bf16 v[168:171], a[8:11], a[100:103], v[168:171]
    buffer_load_dwordx4 v16, s[12:15], s40 offen offset:2048 lds
    v_mfma_f32_16x16x32_bf16 v[200:203], a[8:11], a[104:107], v[200:203]
    ds_read_b64_tr_b16 a[8:9], v5 offset:64
    ds_read_b64_tr_b16 a[10:11], v5 offset:576
    v_mfma_f32_16x16x32_bf16 v[200:203], a[40:43], a[120:123], v[200:203]
    ds_read_b64_tr_b16 a[40:41], v5 offset:8512
    ds_read_b64_tr_b16 a[42:43], v5 offset:9024
    v_mfma_f32_16x16x32_bf16 v[140:143], a[12:15], a[96:99], v[140:143]
    buffer_load_dwordx4 v17, s[12:15], s40 offen offset:3072 lds
    v_mfma_f32_16x16x32_bf16 v[140:143], a[44:47], a[112:115], v[140:143]
    s_add_u32 m0, s42, 34816
    v_mfma_f32_16x16x32_bf16 v[172:175], a[44:47], a[116:119], v[172:175]
    buffer_load_dwordx4 v14, s[12:15], s41 offen offset:0 lds
    v_mfma_f32_16x16x32_bf16 v[172:175], a[12:15], a[100:103], v[172:175]
    v_mfma_f32_16x16x32_bf16 v[204:207], a[12:15], a[104:107], v[204:207]
    ds_read_b64_tr_b16 a[12:13], v5 offset:96
    ds_read_b64_tr_b16 a[14:15], v5 offset:608
    v_mfma_f32_16x16x32_bf16 v[204:207], a[44:47], a[120:123], v[204:207]
    ds_read_b64_tr_b16 a[44:45], v5 offset:8544
    ds_read_b64_tr_b16 a[46:47], v5 offset:9056
    v_mfma_f32_16x16x32_bf16 v[144:147], a[16:19], a[96:99], v[144:147]
    buffer_load_dwordx4 v15, s[12:15], s41 offen offset:1024 lds
    v_mfma_f32_16x16x32_bf16 v[144:147], a[48:51], a[112:115], v[144:147]
    s_bfe_u32 s98, s97, 0x40000
    s_lshl_b32 s36, s98, 19
    s_add_u32 s36, s36, s45
    s_add_u32 m0, s34, 0
    s_nop 0
    buffer_load_dwordx4 v10, s[4:7], s36 offen offset:0 lds
    v_mfma_f32_16x16x32_bf16 v[176:179], a[48:51], a[116:119], v[176:179]
    v_mfma_f32_16x16x32_bf16 v[176:179], a[16:19], a[100:103], v[176:179]
    v_mfma_f32_16x16x32_bf16 v[208:211], a[16:19], a[104:107], v[208:211]
    ds_read_b64_tr_b16 a[16:17], v5 offset:128
    ds_read_b64_tr_b16 a[18:19], v5 offset:640
    v_mfma_f32_16x16x32_bf16 v[208:211], a[48:51], a[120:123], v[208:211]
    ds_read_b64_tr_b16 a[48:49], v5 offset:8576
    ds_read_b64_tr_b16 a[50:51], v5 offset:9088
    v_mfma_f32_16x16x32_bf16 v[148:151], a[20:23], a[96:99], v[148:151]
    buffer_load_dwordx4 v11, s[4:7], s36 offen offset:1056 lds
    v_mfma_f32_16x16x32_bf16 v[148:151], a[52:55], a[112:115], v[148:151]
    buffer_load_dwordx4 v12, s[4:7], s36 offen offset:2112 lds
    v_mfma_f32_16x16x32_bf16 v[180:183], a[52:55], a[116:119], v[180:183]
    s_waitcnt vmcnt(17)
    v_mfma_f32_16x16x32_bf16 v[180:183], a[20:23], a[100:103], v[180:183]
    ds_read_b128 a[64:67], v18 offset:0
    v_mfma_f32_16x16x32_bf16 v[212:215], a[20:23], a[104:107], v[212:215]
    ds_read_b64_tr_b16 a[20:21], v5 offset:160
    ds_read_b64_tr_b16 a[22:23], v5 offset:672
    v_mfma_f32_16x16x32_bf16 v[212:215], a[52:55], a[120:123], v[212:215]
    ds_read_b64_tr_b16 a[52:53], v5 offset:8608
    ds_read_b64_tr_b16 a[54:55], v5 offset:9120
    v_mfma_f32_16x16x32_bf16 v[152:155], a[24:27], a[96:99], v[152:155]
    ds_read_b128 a[80:83], v19 offset:0
    v_mfma_f32_16x16x32_bf16 v[152:155], a[56:59], a[112:115], v[152:155]
    ds_read_b128 a[68:71], v18 offset:2048
    v_mfma_f32_16x16x32_bf16 v[184:187], a[56:59], a[116:119], v[184:187]
    ds_read_b128 a[84:87], v19 offset:2048
    v_mfma_f32_16x16x32_bf16 v[184:187], a[24:27], a[100:103], v[184:187]
    ds_read_b128 a[72:75], v18 offset:4096
    v_mfma_f32_16x16x32_bf16 v[216:219], a[24:27], a[104:107], v[216:219]
    ds_read_b64_tr_b16 a[24:25], v5 offset:192
    ds_read_b64_tr_b16 a[26:27], v5 offset:704
    v_mfma_f32_16x16x32_bf16 v[216:219], a[56:59], a[120:123], v[216:219]
    ds_read_b64_tr_b16 a[56:57], v5 offset:8640
    ds_read_b64_tr_b16 a[58:59], v5 offset:9152
    v_mfma_f32_16x16x32_bf16 v[156:159], a[28:31], a[96:99], v[156:159]
    ds_read_b128 a[88:91], v19 offset:4096
    v_mfma_f32_16x16x32_bf16 v[156:159], a[60:63], a[112:115], v[156:159]
    buffer_load_dwordx4 v13, s[4:7], s36 offen offset:3168 lds
    v_mfma_f32_16x16x32_bf16 v[188:191], a[60:63], a[116:119], v[188:191]
    s_max_i32 s39, s35, 0
    s_min_i32 s38, s39, 524288
    s_add_i32 s35, s35, 8192
    s_add_u32 m0, s34, 50688
    s_nop 0
    buffer_load_dwordx4 v6, s[8:11], s38 offen offset:0 nt lds
    v_mfma_f32_16x16x32_bf16 v[188:191], a[28:31], a[100:103], v[188:191]
    buffer_load_dwordx4 v7, s[8:11], s38 offen offset:1056 nt lds
    v_mfma_f32_16x16x32_bf16 v[220:223], a[28:31], a[104:107], v[220:223]
    ds_read_b64_tr_b16 a[28:29], v5 offset:224
    ds_read_b64_tr_b16 a[30:31], v5 offset:736
    v_mfma_f32_16x16x32_bf16 v[220:223], a[60:63], a[120:123], v[220:223]
    s_waitcnt lgkmcnt(15)
    ds_read_b64_tr_b16 a[60:61], v5 offset:8672
    ds_read_b64_tr_b16 a[62:63], v5 offset:9184
    buffer_load_dwordx4 v8, s[8:11], s38 offen offset:2112 nt lds
    buffer_load_dwordx4 v9, s[8:11], s38 offen offset:3168 nt lds
    v_mfma_f32_16x16x32_bf16 v[128:131], a[0:3], a[64:67], v[128:131]
    s_waitcnt lgkmcnt(12)
    v_mfma_f32_16x16x32_bf16 v[128:131], a[32:35], a[80:83], v[128:131]
    s_waitcnt lgkmcnt(10)
    v_mfma_f32_16x16x32_bf16 v[160:163], a[32:35], a[84:87], v[160:163]
    v_mfma_f32_16x16x32_bf16 v[160:163], a[0:3], a[68:71], v[160:163]
    s_waitcnt lgkmcnt(9)
    v_mfma_f32_16x16x32_bf16 v[192:195], a[0:3], a[72:75], v[192:195]
    s_waitcnt lgkmcnt(4)
    v_mfma_f32_16x16x32_bf16 v[192:195], a[32:35], a[88:91], v[192:195]
    v_mfma_f32_16x16x32_bf16 v[132:135], a[4:7], a[64:67], v[132:135]
    v_add_u32 v5, 84480, v3
    v_mfma_f32_16x16x32_bf16 v[132:135], a[36:39], a[80:83], v[132:135]
    s_waitcnt vmcnt(18) lgkmcnt(0)
    v_mfma_f32_16x16x32_bf16 v[164:167], a[36:39], a[84:87], v[164:167]
    s_barrier
    v_mfma_f32_16x16x32_bf16 v[164:167], a[4:7], a[68:71], v[164:167]
    s_bfe_u32 s98, s97, 0x40000
    ds_read_b64_tr_b16 a[0:1], v5 offset:0
    ds_read_b64_tr_b16 a[2:3], v5 offset:512
    v_mfma_f32_16x16x32_bf16 v[196:199], a[4:7], a[72:75], v[196:199]
    s_lshl_b32 s40, s98, 7
    ds_read_b64_tr_b16 a[32:33], v5 offset:8448
    ds_read_b64_tr_b16 a[34:35], v5 offset:8960
    v_mfma_f32_16x16x32_bf16 v[196:199], a[36:39], a[88:91], v[196:199]
    s_add_u32 s41, s40, 40960
    ds_read_b64_tr_b16 a[4:5], v5 offset:32
    ds_read_b64_tr_b16 a[6:7], v5 offset:544
    v_mfma_f32_16x16x32_bf16 v[136:139], a[8:11], a[64:67], v[136:139]
    s_add_u32 m0, s42, 0
    ds_read_b64_tr_b16 a[36:37], v5 offset:8480
    ds_read_b64_tr_b16 a[38:39], v5 offset:8992
    v_mfma_f32_16x16x32_bf16 v[136:139], a[40:43], a[80:83], v[136:139]
    buffer_load_dwordx4 v14, s[12:15], s40 offen offset:0 lds
    v_mfma_f32_16x16x32_bf16 v[168:171], a[40:43], a[84:87], v[168:171]
    buffer_load_dwordx4 v15, s[12:15], s40 offen offset:1024 lds
    v_mfma_f32_16x16x32_bf16 v[168:171], a[8:11], a[68:71], v[168:171]
    buffer_load_dwordx4 v16, s[12:15], s40 offen offset:2048 lds
    v_mfma_f32_16x16x32_bf16 v[200:203], a[8:11], a[72:75], v[200:203]
    ds_read_b64_tr_b16 a[8:9], v5 offset:64
    ds_read_b64_tr_b16 a[10:11], v5 offset:576
    v_mfma_f32_16x16x32_bf16 v[200:203], a[40:43], a[88:91], v[200:203]
    ds_read_b64_tr_b16 a[40:41], v5 offset:8512
    ds_read_b64_tr_b16 a[42:43], v5 offset:9024
    v_mfma_f32_16x16x32_bf16 v[140:143], a[12:15], a[64:67], v[140:143]
    buffer_load_dwordx4 v17, s[12:15], s40 offen offset:3072 lds
    v_mfma_f32_16x16x32_bf16 v[140:143], a[44:47], a[80:83], v[140:143]
    s_add_u32 m0, s42, 4096
    v_mfma_f32_16x16x32_bf16 v[172:175], a[44:47], a[84:87], v[172:175]
    buffer_load_dwordx4 v14, s[12:15], s41 offen offset:0 lds
    v_mfma_f32_16x16x32_bf16 v[172:175], a[12:15], a[68:71], v[172:175]
    v_mfma_f32_16x16x32_bf16 v[204:207], a[12:15], a[72:75], v[204:207]
    ds_read_b64_tr_b16 a[12:13], v5 offset:96
    ds_read_b64_tr_b16 a[14:15], v5 offset:608
    v_mfma_f32_16x16x32_bf16 v[204:207], a[44:47], a[88:91], v[204:207]
    ds_read_b64_tr_b16 a[44:45], v5 offset:8544
    ds_read_b64_tr_b16 a[46:47], v5 offset:9056
    v_mfma_f32_16x16x32_bf16 v[144:147], a[16:19], a[64:67], v[144:147]
    buffer_load_dwordx4 v15, s[12:15], s41 offen offset:1024 lds
    v_mfma_f32_16x16x32_bf16 v[144:147], a[48:51], a[80:83], v[144:147]
    s_bfe_u32 s98, s97, 0x40004
    s_lshl_b32 s36, s98, 19
    s_add_u32 s36, s36, s45
    s_add_u32 m0, s34, 16896
    s_nop 0
    buffer_load_dwordx4 v10, s[4:7], s36 offen offset:0 lds
    v_mfma_f32_16x16x32_bf16 v[176:179], a[48:51], a[84:87], v[176:179]
    v_mfma_f32_16x16x32_bf16 v[176:179], a[16:19], a[68:71], v[176:179]
    v_mfma_f32_16x16x32_bf16 v[208:211], a[16:19], a[72:75], v[208:211]
    ds_read_b64_tr_b16 a[16:17], v5 offset:128
    ds_read_b64_tr_b16 a[18:19], v5 offset:640
    v_mfma_f32_16x16x32_bf16 v[208:211], a[48:51], a[88:91], v[208:211]
    ds_read_b64_tr_b16 a[48:49], v5 offset:8576
    ds_read_b64_tr_b16 a[50:51], v5 offset:9088
    v_mfma_f32_16x16x32_bf16 v[148:151], a[20:23], a[64:67], v[148:151]
    buffer_load_dwordx4 v11, s[4:7], s36 offen offset:1056 lds
    v_mfma_f32_16x16x32_bf16 v[148:151], a[52:55], a[80:83], v[148:151]
    buffer_load_dwordx4 v12, s[4:7], s36 offen offset:2112 lds
    v_mfma_f32_16x16x32_bf16 v[180:183], a[52:55], a[84:87], v[180:183]
    s_waitcnt vmcnt(17)
    v_mfma_f32_16x16x32_bf16 v[180:183], a[20:23], a[68:71], v[180:183]
    ds_read_b128 a[96:99], v18 offset:30720
    v_mfma_f32_16x16x32_bf16 v[212:215], a[20:23], a[72:75], v[212:215]
    ds_read_b64_tr_b16 a[20:21], v5 offset:160
    ds_read_b64_tr_b16 a[22:23], v5 offset:672
    v_mfma_f32_16x16x32_bf16 v[212:215], a[52:55], a[88:91], v[212:215]
    ds_read_b64_tr_b16 a[52:53], v5 offset:8608
    ds_read_b64_tr_b16 a[54:55], v5 offset:9120
    v_mfma_f32_16x16x32_bf16 v[152:155], a[24:27], a[64:67], v[152:155]
    ds_read_b128 a[112:115], v19 offset:30720
    v_mfma_f32_16x16x32_bf16 v[152:155], a[56:59], a[80:83], v[152:155]
    ds_read_b128 a[100:103], v18 offset:32768
    v_mfma_f32_16x16x32_bf16 v[184:187], a[56:59], a[84:87], v[184:187]
    ds_read_b128 a[116:119], v19 offset:32768
    v_mfma_f32_16x16x32_bf16 v[184:187], a[24:27], a[68:71], v[184:187]
    ds_read_b128 a[104:107], v18 offset:34816
    v_mfma_f32_16x16x32_bf16 v[216:219], a[24:27], a[72:75], v[216:219]
    ds_read_b64_tr_b16 a[24:25], v5 offset:192
    ds_read_b64_tr_b16 a[26:27], v5 offset:704
    v_mfma_f32_16x16x32_bf16 v[216:219], a[56:59], a[88:91], v[216:219]
    ds_read_b64_tr_b16 a[56:57], v5 offset:8640
    ds_read_b64_tr_b16 a[58:59], v5 offset:9152
    v_mfma_f32_16x16x32_bf16 v[156:159], a[28:31], a[64:67], v[156:159]
    ds_read_b128 a[120:123], v19 offset:34816
    v_mfma_f32_16x16x32_bf16 v[156:159], a[60:63], a[80:83], v[156:159]
    buffer_load_dwordx4 v13, s[4:7], s36 offen offset:3168 lds
    v_mfma_f32_16x16x32_bf16 v[188:191], a[60:63], a[84:87], v[188:191]
    s_max_i32 s39, s35, 0
    s_min_i32 s38, s39, 524288
    s_add_i32 s35, s35, 8192
    s_add_u32 m0, s34, 67584
    s_nop 0
    buffer_load_dwordx4 v6, s[8:11], s38 offen offset:0 nt lds
    v_mfma_f32_16x16x32_bf16 v[188:191], a[28:31], a[68:71], v[188:191]
    buffer_load_dwordx4 v7, s[8:11], s38 offen offset:1056 nt lds
    v_mfma_f32_16x16x32_bf16 v[220:223], a[28:31], a[72:75], v[220:223]
    ds_read_b64_tr_b16 a[28:29], v5 offset:224
    ds_read_b64_tr_b16 a[30:31], v5 offset:736
    v_mfma_f32_16x16x32_bf16 v[220:223], a[60:63], a[88:91], v[220:223]
    s_waitcnt lgkmcnt(15)
    ds_read_b64_tr_b16 a[60:61], v5 offset:8672
    ds_read_b64_tr_b16 a[62:63], v5 offset:9184
    buffer_load_dwordx4 v8, s[8:11], s38 offen offset:2112 nt lds
    buffer_load_dwordx4 v9, s[8:11], s38 offen offset:3168 nt lds
    v_mfma_f32_16x16x32_bf16 v[128:131], a[0:3], a[96:99], v[128:131]
    s_waitcnt lgkmcnt(12)
    v_mfma_f32_16x16x32_bf16 v[128:131], a[32:35], a[112:115], v[128:131]
    s_waitcnt lgkmcnt(10)
    v_mfma_f32_16x16x32_bf16 v[160:163], a[32:35], a[116:119], v[160:163]
    v_mfma_f32_16x16x32_bf16 v[160:163], a[0:3], a[100:103], v[160:163]
    s_waitcnt lgkmcnt(9)
    v_mfma_f32_16x16x32_bf16 v[192:195], a[0:3], a[104:107], v[192:195]
    s_waitcnt lgkmcnt(4)
    v_mfma_f32_16x16x32_bf16 v[192:195], a[32:35], a[120:123], v[192:195]
    v_mfma_f32_16x16x32_bf16 v[132:135], a[4:7], a[96:99], v[132:135]
    v_add_u32 v5, 0, v3
    v_mfma_f32_16x16x32_bf16 v[132:135], a[36:39], a[112:115], v[132:135]
    s_waitcnt vmcnt(18) lgkmcnt(0)
    v_mfma_f32_16x16x32_bf16 v[164:167], a[36:39], a[116:119], v[164:167]
    s_barrier
    v_mfma_f32_16x16x32_bf16 v[164:167], a[4:7], a[100:103], v[164:167]
    s_bfe_u32 s98, s97, 0x40004
    ds_read_b64_tr_b16 a[0:1], v5 offset:0
    ds_read_b64_tr_b16 a[2:3], v5 offset:512
    v_mfma_f32_16x16x32_bf16 v[196:199], a[4:7], a[104:107], v[196:199]
    s_lshl_b32 s40, s98, 7
    ds_read_b64_tr_b16 a[32:33], v5 offset:8448
    ds_read_b64_tr_b16 a[34:35], v5 offset:8960
    v_mfma_f32_16x16x32_bf16 v[196:199], a[36:39], a[120:123], v[196:199]
    s_add_u32 s41, s40, 40960
    ds_read_b64_tr_b16 a[4:5], v5 offset:32
    ds_read_b64_tr_b16 a[6:7], v5 offset:544
    v_mfma_f32_16x16x32_bf16 v[136:139], a[8:11], a[96:99], v[136:139]
    s_add_u32 m0, s42, 30720
    ds_read_b64_tr_b16 a[36:37], v5 offset:8480
    ds_read_b64_tr_b16 a[38:39], v5 offset:8992
    v_mfma_f32_16x16x32_bf16 v[136:139], a[40:43], a[112:115], v[136:139]
    buffer_load_dwordx4 v14, s[12:15], s40 offen offset:0 lds
    v_mfma_f32_16x16x32_bf16 v[168:171], a[40:43], a[116:119], v[168:171]
    buffer_load_dwordx4 v15, s[12:15], s40 offen offset:1024 lds
    v_mfma_f32_16x16x32_bf16 v[168:171], a[8:11], a[100:103], v[168:171]
    v_mfma_f32_16x16x32_bf16 v[200:203], a[8:11], a[104:107], v[200:203]
    ds_read_b64_tr_b16 a[8:9], v5 offset:64
    ds_read_b64_tr_b16 a[10:11], v5 offset:576
    v_mfma_f32_16x16x32_bf16 v[200:203], a[40:43], a[120:123], v[200:203]
    ds_read_b64_tr_b16 a[40:41], v5 offset:8512
    ds_read_b64_tr_b16 a[42:43], v5 offset:9024
    v_mfma_f32_16x16x32_bf16 v[140:143], a[12:15], a[96:99], v[140:143]
    buffer_load_dwordx4 v16, s[12:15], s40 offen offset:2048 lds
    v_mfma_f32_16x16x32_bf16 v[140:143], a[44:47], a[112:115], v[140:143]
    buffer_load_dwordx4 v17, s[12:15], s40 offen offset:3072 lds
    v_mfma_f32_16x16x32_bf16 v[172:175], a[44:47], a[116:119], v[172:175]
    v_mfma_f32_16x16x32_bf16 v[172:175], a[12:15], a[100:103], v[172:175]
    v_mfma_f32_16x16x32_bf16 v[204:207], a[12:15], a[104:107], v[204:207]
    ds_read_b64_tr_b16 a[12:13], v5 offset:96
    ds_read_b64_tr_b16 a[14:15], v5 offset:608
    v_mfma_f32_16x16x32_bf16 v[204:207], a[44:47], a[120:123], v[204:207]
    s_add_u32 m0, s42, 34816
    ds_read_b64_tr_b16 a[44:45], v5 offset:8544
    ds_read_b64_tr_b16 a[46:47], v5 offset:9056
    v_mfma_f32_16x16x32_bf16 v[144:147], a[16:19], a[96:99], v[144:147]
    buffer_load_dwordx4 v14, s[12:15], s41 offen offset:0 lds
    v_mfma_f32_16x16x32_bf16 v[144:147], a[48:51], a[112:115], v[144:147]
    buffer_load_dwordx4 v15, s[12:15], s41 offen offset:1024 lds
    v_mfma_f32_16x16x32_bf16 v[176:179], a[48:51], a[116:119], v[176:179]
    s_bfe_u32 s98, s97, 0x40004
    v_mfma_f32_16x16x32_bf16 v[176:179], a[16:19], a[100:103], v[176:179]
    s_lshl_b32 s36, s98, 19
    v_mfma_f32_16x16x32_bf16 v[208:211], a[16:19], a[104:107], v[208:211]
    s_add_u32 s36, s36, s45
    ds_read_b64_tr_b16 a[16:17], v5 offset:128
    ds_read_b64_tr_b16 a[18:19], v5 offset:640
    v_mfma_f32_16x16x32_bf16 v[208:211], a[48:51], a[120:123], v[208:211]
    s_add_u32 s36, s36, 256
    ds_read_b64_tr_b16 a[48:49], v5 offset:8576
    ds_read_b64_tr_b16 a[50:51], v5 offset:9088
    v_mfma_f32_16x16x32_bf16 v[148:151], a[20:23], a[96:99], v[148:151]
    s_add_u32 m0, s34, 84480
    s_nop 0
    buffer_load_dwordx4 v10, s[4:7], s36 offen offset:0 lds
    v_mfma_f32_16x16x32_bf16 v[148:151], a[52:55], a[112:115], v[148:151]
    buffer_load_dwordx4 v11, s[4:7], s36 offen offset:1056 lds
    v_mfma_f32_16x16x32_bf16 v[180:183], a[52:55], a[116:119], v[180:183]
    s_waitcnt vmcnt(16)
    v_mfma_f32_16x16x32_bf16 v[180:183], a[20:23], a[100:103], v[180:183]
    ds_read_b128 a[64:67], v18 offset:0
    v_mfma_f32_16x16x32_bf16 v[212:215], a[20:23], a[104:107], v[212:215]
    ds_read_b64_tr_b16 a[20:21], v5 offset:160
    ds_read_b64_tr_b16 a[22:23], v5 offset:672
    v_mfma_f32_16x16x32_bf16 v[212:215], a[52:55], a[120:123], v[212:215]
    ds_read_b64_tr_b16 a[52:53], v5 offset:8608
    ds_read_b64_tr_b16 a[54:55], v5 offset:9120
    v_mfma_f32_16x16x32_bf16 v[152:155], a[24:27], a[96:99], v[152:155]
    ds_read_b128 a[80:83], v19 offset:0
    v_mfma_f32_16x16x32_bf16 v[152:155], a[56:59], a[112:115], v[152:155]
    ds_read_b128 a[68:71], v18 offset:2048
    v_mfma_f32_16x16x32_bf16 v[184:187], a[56:59], a[116:119], v[184:187]
    ds_read_b128 a[84:87], v19 offset:2048
    v_mfma_f32_16x16x32_bf16 v[184:187], a[24:27], a[100:103], v[184:187]
    ds_read_b128 a[72:75], v18 offset:4096
    v_mfma_f32_16x16x32_bf16 v[216:219], a[24:27], a[104:107], v[216:219]
    ds_read_b64_tr_b16 a[24:25], v5 offset:192
    ds_read_b64_tr_b16 a[26:27], v5 offset:704
    v_mfma_f32_16x16x32_bf16 v[216:219], a[56:59], a[120:123], v[216:219]
    ds_read_b64_tr_b16 a[56:57], v5 offset:8640
    ds_read_b64_tr_b16 a[58:59], v5 offset:9152
    v_mfma_f32_16x16x32_bf16 v[156:159], a[28:31], a[96:99], v[156:159]
    ds_read_b128 a[88:91], v19 offset:4096
    v_mfma_f32_16x16x32_bf16 v[156:159], a[60:63], a[112:115], v[156:159]
    buffer_load_dwordx4 v12, s[4:7], s36 offen offset:2112 lds
    v_mfma_f32_16x16x32_bf16 v[188:191], a[60:63], a[116:119], v[188:191]
    buffer_load_dwordx4 v13, s[4:7], s36 offen offset:3168 lds
    v_mfma_f32_16x16x32_bf16 v[188:191], a[28:31], a[100:103], v[188:191]
    v_mfma_f32_16x16x32_bf16 v[220:223], a[28:31], a[104:107], v[220:223]
    ds_read_b64_tr_b16 a[28:29], v5 offset:224
    ds_read_b64_tr_b16 a[30:31], v5 offset:736
    v_mfma_f32_16x16x32_bf16 v[220:223], a[60:63], a[120:123], v[220:223]
    s_waitcnt lgkmcnt(15)
    ds_read_b64_tr_b16 a[60:61], v5 offset:8672
    ds_read_b64_tr_b16 a[62:63], v5 offset:9184
    v_mfma_f32_16x16x32_bf16 v[128:131], a[0:3], a[64:67], v[128:131]
    s_waitcnt lgkmcnt(12)
    v_mfma_f32_16x16x32_bf16 v[128:131], a[32:35], a[80:83], v[128:131]
    s_waitcnt lgkmcnt(10)
    v_mfma_f32_16x16x32_bf16 v[160:163], a[32:35], a[84:87], v[160:163]
    v_mfma_f32_16x16x32_bf16 v[160:163], a[0:3], a[68:71], v[160:163]
    s_waitcnt lgkmcnt(9)
    v_mfma_f32_16x16x32_bf16 v[192:195], a[0:3], a[72:75], v[192:195]
    s_waitcnt lgkmcnt(4)
    v_mfma_f32_16x16x32_bf16 v[192:195], a[32:35], a[88:91], v[192:195]
    v_mfma_f32_16x16x32_bf16 v[132:135], a[4:7], a[64:67], v[132:135]
    v_add_u32 v5, 16896, v3
    v_mfma_f32_16x16x32_bf16 v[132:135], a[36:39], a[80:83], v[132:135]
    s_waitcnt vmcnt(14) lgkmcnt(0)
    v_mfma_f32_16x16x32_bf16 v[164:167], a[36:39], a[84:87], v[164:167]
    s_barrier
    v_mfma_f32_16x16x32_bf16 v[164:167], a[4:7], a[68:71], v[164:167]
    s_max_i32 s39, s35, 0
    ds_read_b64_tr_b16 a[0:1], v5 offset:0
    ds_read_b64_tr_b16 a[2:3], v5 offset:512
    v_mfma_f32_16x16x32_bf16 v[196:199], a[4:7], a[72:75], v[196:199]
    s_min_i32 s38, s39, 524288
    ds_read_b64_tr_b16 a[32:33], v5 offset:8448
    ds_read_b64_tr_b16 a[34:35], v5 offset:8960
    v_mfma_f32_16x16x32_bf16 v[196:199], a[36:39], a[88:91], v[196:199]
    s_add_i32 s35, s35, 8192
    ds_read_b64_tr_b16 a[4:5], v5 offset:32
    ds_read_b64_tr_b16 a[6:7], v5 offset:544
    v_mfma_f32_16x16x32_bf16 v[136:139], a[8:11], a[64:67], v[136:139]
    s_add_u32 m0, s34, 0
    ds_read_b64_tr_b16 a[36:37], v5 offset:8480
    ds_read_b64_tr_b16 a[38:39], v5 offset:8992
    v_mfma_f32_16x16x32_bf16 v[136:139], a[40:43], a[80:83], v[136:139]
    buffer_load_dwordx4 v6, s[8:11], s38 offen offset:0 nt lds
    v_mfma_f32_16x16x32_bf16 v[168:171], a[40:43], a[84:87], v[168:171]
    buffer_load_dwordx4 v7, s[8:11], s38 offen offset:1056 nt lds
    v_mfma_f32_16x16x32_bf16 v[168:171], a[8:11], a[68:71], v[168:171]
    v_mfma_f32_16x16x32_bf16 v[200:203], a[8:11], a[72:75], v[200:203]
    ds_read_b64_tr_b16 a[8:9], v5 offset:64
    ds_read_b64_tr_b16 a[10:11], v5 offset:576
    v_mfma_f32_16x16x32_bf16 v[200:203], a[40:43], a[88:91], v[200:203]
    ds_read_b64_tr_b16 a[40:41], v5 offset:8512
    ds_read_b64_tr_b16 a[42:43], v5 offset:9024
    v_mfma_f32_16x16x32_bf16 v[140:143], a[12:15], a[64:67], v[140:143]
    buffer_load_dwordx4 v8, s[8:11], s38 offen offset:2112 nt lds
    v_mfma_f32_16x16x32_bf16 v[140:143], a[44:47], a[80:83], v[140:143]
    buffer_load_dwordx4 v9, s[8:11], s38 offen offset:3168 nt lds
    v_mfma_f32_16x16x32_bf16 v[172:175], a[44:47], a[84:87], v[172:175]
    v_mfma_f32_16x16x32_bf16 v[172:175], a[12:15], a[68:71], v[172:175]
    v_mfma_f32_16x16x32_bf16 v[204:207], a[12:15], a[72:75], v[204:207]
    ds_read_b64_tr_b16 a[12:13], v5 offset:96
    ds_read_b64_tr_b16 a[14:15], v5 offset:608
    v_mfma_f32_16x16x32_bf16 v[204:207], a[44:47], a[88:91], v[204:207]
    ds_read_b64_tr_b16 a[44:45], v5 offset:8544
    ds_read_b64_tr_b16 a[46:47], v5 offset:9056
    v_mfma_f32_16x16x32_bf16 v[144:147], a[16:19], a[64:67], v[144:147]
    v_mfma_f32_16x16x32_bf16 v[144:147], a[48:51], a[80:83], v[144:147]
    v_mfma_f32_16x16x32_bf16 v[176:179], a[48:51], a[84:87], v[176:179]
    v_mfma_f32_16x16x32_bf16 v[176:179], a[16:19], a[68:71], v[176:179]
    v_mfma_f32_16x16x32_bf16 v[208:211], a[16:19], a[72:75], v[208:211]
    ds_read_b64_tr_b16 a[16:17], v5 offset:128
    ds_read_b64_tr_b16 a[18:19], v5 offset:640
    v_mfma_f32_16x16x32_bf16 v[208:211], a[48:51], a[88:91], v[208:211]
    ds_read_b64_tr_b16 a[48:49], v5 offset:8576
    ds_read_b64_tr_b16 a[50:51], v5 offset:9088
    v_mfma_f32_16x16x32_bf16 v[148:151], a[20:23], a[64:67], v[148:151]
    v_mfma_f32_16x16x32_bf16 v[148:151], a[52:55], a[80:83], v[148:151]
    v_mfma_f32_16x16x32_bf16 v[180:183], a[52:55], a[84:87], v[180:183]
    s_waitcnt vmcnt(8)
    v_mfma_f32_16x16x32_bf16 v[180:183], a[20:23], a[68:71], v[180:183]
    ds_read_b128 a[96:99], v18 offset:30720
    v_mfma_f32_16x16x32_bf16 v[212:215], a[20:23], a[72:75], v[212:215]
    ds_read_b64_tr_b16 a[20:21], v5 offset:160
    ds_read_b64_tr_b16 a[22:23], v5 offset:672
    v_mfma_f32_16x16x32_bf16 v[212:215], a[52:55], a[88:91], v[212:215]
    ds_read_b64_tr_b16 a[52:53], v5 offset:8608
    ds_read_b64_tr_b16 a[54:55], v5 offset:9120
    v_mfma_f32_16x16x32_bf16 v[152:155], a[24:27], a[64:67], v[152:155]
    ds_read_b128 a[112:115], v19 offset:30720
    v_mfma_f32_16x16x32_bf16 v[152:155], a[56:59], a[80:83], v[152:155]
    ds_read_b128 a[100:103], v18 offset:32768
    v_mfma_f32_16x16x32_bf16 v[184:187], a[56:59], a[84:87], v[184:187]
    ds_read_b128 a[116:119], v19 offset:32768
    v_mfma_f32_16x16x32_bf16 v[184:187], a[24:27], a[68:71], v[184:187]
    ds_read_b128 a[104:107], v18 offset:34816
    v_mfma_f32_16x16x32_bf16 v[216:219], a[24:27], a[72:75], v[216:219]
    ds_read_b64_tr_b16 a[24:25], v5 offset:192
    ds_read_b64_tr_b16 a[26:27], v5 offset:704
    v_mfma_f32_16x16x32_bf16 v[216:219], a[56:59], a[88:91], v[216:219]
    ds_read_b64_tr_b16 a[56:57], v5 offset:8640
    ds_read_b64_tr_b16 a[58:59], v5 offset:9152
    v_mfma_f32_16x16x32_bf16 v[156:159], a[28:31], a[64:67], v[156:159]
    ds_read_b128 a[120:123], v19 offset:34816
    v_mfma_f32_16x16x32_bf16 v[156:159], a[60:63], a[80:83], v[156:159]
    v_mfma_f32_16x16x32_bf16 v[188:191], a[60:63], a[84:87], v[188:191]
    v_mfma_f32_16x16x32_bf16 v[188:191], a[28:31], a[68:71], v[188:191]
    v_mfma_f32_16x16x32_bf16 v[220:223], a[28:31], a[72:75], v[220:223]
    ds_read_b64_tr_b16 a[28:29], v5 offset:224
    ds_read_b64_tr_b16 a[30:31], v5 offset:736
    v_mfma_f32_16x16x32_bf16 v[220:223], a[60:63], a[88:91], v[220:223]
    ds_read_b64_tr_b16 a[60:61], v5 offset:8672
    ds_read_b64_tr_b16 a[62:63], v5 offset:9184
    s_waitcnt lgkmcnt(15)
    v_mfma_f32_16x16x32_bf16 v[128:131], a[0:3], a[96:99], v[128:131]
    s_waitcnt vmcnt(4) lgkmcnt(0)
    s_barrier
    v_mfma_f32_16x16x32_bf16 v[128:131], a[32:35], a[112:115], v[128:131]
    s_max_i32 s39, s35, 0
    v_add_u32 v5, 84480, v3
    s_add_u32 m0, s34, 16896
    v_mfma_f32_16x16x32_bf16 v[132:135], a[36:39], a[112:115], v[132:135]
    s_min_i32 s38, s39, 524288
    buffer_load_dwordx4 v6, s[8:11], s38 offen offset:0 nt lds
    v_mfma_f32_16x16x32_bf16 v[132:135], a[4:7], a[96:99], v[132:135]
    s_bfe_u32 s98, s97, 0x40000
    s_lshl_b32 s36, s98, 19
    s_add_u32 s36, s36, s45
    v_mfma_f32_16x16x32_bf16 v[136:139], a[8:11], a[96:99], v[136:139]
    s_add_u32 s36, s36, 256
    v_add_u32 v4, 33792, v2
    v_mul_f32 v128, s46, v128
    v_mfma_f32_16x16x32_bf16 v[136:139], a[40:43], a[112:115], v[136:139]
    s_bfe_u32 s98, s96, 0x4001c
    v_mul_f32 v129, s46, v129
    v_mul_f32 v130, s46, v130
    v_mfma_f32_16x16x32_bf16 v[140:143], a[44:47], a[112:115], v[140:143]
    s_lshl_b32 s40, s98, 7
    buffer_load_dwordx4 v7, s[8:11], s38 offen offset:1056 nt lds
    v_mfma_f32_16x16x32_bf16 v[140:143], a[12:15], a[96:99], v[140:143]
    s_add_u32 s94, s32, s34
    v_mul_f32 v131, s46, v131
    v_mul_f32 v132, s46, v132
    v_mfma_f32_16x16x32_bf16 v[144:147], a[16:19], a[96:99], v[144:147]
    s_add_u32 s32, s32, 16896
    v_mul_f32 v133, s46, v133
    v_mul_f32 v134, s46, v134
    v_mfma_f32_16x16x32_bf16 v[144:147], a[48:51], a[112:115], v[144:147]
    s_cmp_ge_u32 s32, 84480
    s_cselect_b32 s32, 0, s32
    v_mul_f32 v135, s46, v135
    v_mfma_f32_16x16x32_bf16 v[148:151], a[52:55], a[112:115], v[148:151]
    s_add_i32 s35, s35, 8192
    buffer_load_dwordx4 v8, s[8:11], s38 offen offset:2112 nt lds
    v_mfma_f32_16x16x32_bf16 v[148:151], a[20:23], a[96:99], v[148:151]
    s_max_i32 s39, s35, 0
    v_cvt_pk_bf16_f32 v128, v128, v129
    v_cvt_pk_bf16_f32 v129, v130, v131
    v_mfma_f32_16x16x32_bf16 v[152:155], a[24:27], a[96:99], v[152:155]
    s_add_i32 s35, s35, 8192
    v_cvt_pk_bf16_f32 v130, v132, v133
    v_cvt_pk_bf16_f32 v131, v134, v135
    v_mfma_f32_16x16x32_bf16 v[152:155], a[56:59], a[112:115], v[152:155]
    s_lshl_b32 s57, s56, 16
    v_mul_f32 v136, s46, v136
    v_mul_f32 v137, s46, v137
    v_mfma_f32_16x16x32_bf16 v[156:159], a[60:63], a[112:115], v[156:159]
    s_mul_i32 s58, s55, 49152
    buffer_load_dwordx4 v9, s[8:11], s38 offen offset:3168 nt lds
    v_mfma_f32_16x16x32_bf16 v[156:159], a[28:31], a[96:99], v[156:159]
    s_add_u32 m0, s34, 84480
    v_mul_f32 v138, s46, v138
    v_mul_f32 v139, s46, v139
    v_mfma_f32_16x16x32_bf16 v[160:163], a[0:3], a[100:103], v[160:163]
    s_min_i32 s38, s39, 524288
    v_mul_f32 v140, s46, v140
    v_mul_f32 v141, s46, v141
    v_mfma_f32_16x16x32_bf16 v[160:163], a[32:35], a[116:119], v[160:163]
    s_max_i32 s39, s35, 0
    v_mul_f32 v142, s46, v142
    v_mul_f32 v143, s46, v143
    v_mfma_f32_16x16x32_bf16 v[164:167], a[36:39], a[116:119], v[164:167]
    s_sub_u32 s57, s57, s58
    v_permlane32_swap_b32 v128, v130
    v_permlane32_swap_b32 v129, v131
    v_mfma_f32_16x16x32_bf16 v[164:167], a[4:7], a[100:103], v[164:167]
    s_add_u32 s57, s57, 256
    v_cvt_pk_bf16_f32 v132, v136, v137
    v_cvt_pk_bf16_f32 v133, v138, v139
    v_mfma_f32_16x16x32_bf16 v[168:171], a[8:11], a[100:103], v[168:171]
    s_lshl_b32 s58, s2, 2
    v_cvt_pk_bf16_f32 v134, v140, v141
    v_cvt_pk_bf16_f32 v135, v142, v143
    v_mfma_f32_16x16x32_bf16 v[168:171], a[40:43], a[116:119], v[168:171]
    s_add_u32 s58, s58, s3
    v_mul_f32 v144, s46, v144
    v_mul_f32 v145, s46, v145
    v_mfma_f32_16x16x32_bf16 v[172:175], a[44:47], a[116:119], v[172:175]
    s_add_u32 s41, s40, 40960
    v_mul_f32 v160, s46, v160
    v_mul_f32 v161, s46, v161
    v_mfma_f32_16x16x32_bf16 v[172:175], a[12:15], a[100:103], v[172:175]
    s_lshl_b32 s96, s96, 4
    v_permlane16_swap_b32 v128, v130
    v_permlane16_swap_b32 v129, v131
    v_mfma_f32_16x16x32_bf16 v[176:179], a[16:19], a[100:103], v[176:179]
    s_mul_i32 s58, s58, 5120
    v_mul_f32 v146, s46, v146
    v_mul_f32 v147, s46, v147
    v_mfma_f32_16x16x32_bf16 v[176:179], a[48:51], a[116:119], v[176:179]
    s_add_i32 s35, s35, 8192
    v_mul_f32 v148, s46, v148
    v_mul_f32 v149, s46, v149
    v_mfma_f32_16x16x32_bf16 v[180:183], a[52:55], a[116:119], v[180:183]
    v_mul_f32 v150, s46, v150
    v_mul_f32 v151, s46, v151
    v_mfma_f32_16x16x32_bf16 v[180:183], a[20:23], a[100:103], v[180:183]
    v_cvt_pk_bf16_f32 v136, v144, v145
    v_permlane32_swap_b32 v132, v134
    v_mfma_f32_16x16x32_bf16 v[184:187], a[24:27], a[100:103], v[184:187]
    v_permlane32_swap_b32 v133, v135
    v_cvt_pk_bf16_f32 v144, v160, v161
    v_mfma_f32_16x16x32_bf16 v[184:187], a[56:59], a[116:119], v[184:187]
    v_cvt_pk_bf16_f32 v137, v146, v147
    v_cvt_pk_bf16_f32 v138, v148, v149
    v_mfma_f32_16x16x32_bf16 v[188:191], a[60:63], a[116:119], v[188:191]
    v_cvt_pk_bf16_f32 v139, v150, v151
    v_permlane16_swap_b32 v132, v134
    v_mfma_f32_16x16x32_bf16 v[188:191], a[28:31], a[100:103], v[188:191]
    v_permlane16_swap_b32 v133, v135
    v_mul_f32 v152, s46, v152
    v_mfma_f32_16x16x32_bf16 v[192:195], a[0:3], a[104:107], v[192:195]
    ds_read_b64_tr_b16 a[0:1], v5 offset:0
    ds_read_b64_tr_b16 a[2:3], v5 offset:512
    v_mfma_f32_16x16x32_bf16 v[192:195], a[32:35], a[120:123], v[192:195]
    ds_read_b64_tr_b16 a[32:33], v5 offset:8448
    ds_read_b64_tr_b16 a[34:35], v5 offset:8960
    v_mfma_f32_16x16x32_bf16 v[196:199], a[36:39], a[120:123], v[196:199]
    ds_read_b64_tr_b16 a[36:37], v5 offset:8480
    ds_read_b64_tr_b16 a[38:39], v5 offset:8992
    v_mfma_f32_16x16x32_bf16 v[196:199], a[4:7], a[104:107], v[196:199]
    ds_read_b64_tr_b16 a[4:5], v5 offset:32
    ds_read_b64_tr_b16 a[6:7], v5 offset:544
    v_mfma_f32_16x16x32_bf16 v[200:203], a[8:11], a[104:107], v[200:203]
    ds_read_b64_tr_b16 a[8:9], v5 offset:64
    ds_read_b64_tr_b16 a[10:11], v5 offset:576
    v_mfma_f32_16x16x32_bf16 v[200:203], a[40:43], a[120:123], v[200:203]
    ds_read_b64_tr_b16 a[40:41], v5 offset:8512
    ds_read_b64_tr_b16 a[42:43], v5 offset:9024
    v_mfma_f32_16x16x32_bf16 v[204:207], a[44:47], a[120:123], v[204:207]
    ds_read_b64_tr_b16 a[44:45], v5 offset:8544
    ds_read_b64_tr_b16 a[46:47], v5 offset:9056
    v_mfma_f32_16x16x32_bf16 v[204:207], a[12:15], a[104:107], v[204:207]
    ds_read_b64_tr_b16 a[12:13], v5 offset:96
    ds_read_b64_tr_b16 a[14:15], v5 offset:608
    v_mfma_f32_16x16x32_bf16 v[208:211], a[16:19], a[104:107], v[208:211]
    ds_read_b64_tr_b16 a[16:17], v5 offset:128
    ds_read_b64_tr_b16 a[18:19], v5 offset:640
    v_mfma_f32_16x16x32_bf16 v[208:211], a[48:51], a[120:123], v[208:211]
    ds_read_b64_tr_b16 a[48:49], v5 offset:8576
    ds_read_b64_tr_b16 a[50:51], v5 offset:9088
    v_mfma_f32_16x16x32_bf16 v[212:215], a[52:55], a[120:123], v[212:215]
    ds_read_b64_tr_b16 a[52:53], v5 offset:8608
    ds_read_b64_tr_b16 a[54:55], v5 offset:9120
    v_mfma_f32_16x16x32_bf16 v[212:215], a[20:23], a[104:107], v[212:215]
    ds_read_b64_tr_b16 a[20:21], v5 offset:160
    ds_read_b64_tr_b16 a[22:23], v5 offset:672
    v_mfma_f32_16x16x32_bf16 v[216:219], a[24:27], a[104:107], v[216:219]
    ds_read_b64_tr_b16 a[24:25], v5 offset:192
    ds_read_b64_tr_b16 a[26:27], v5 offset:704
    v_mfma_f32_16x16x32_bf16 v[216:219], a[56:59], a[120:123], v[216:219]
    ds_read_b64_tr_b16 a[56:57], v5 offset:8640
    ds_read_b64_tr_b16 a[58:59], v5 offset:9152
    v_mfma_f32_16x16x32_bf16 v[220:223], a[60:63], a[120:123], v[220:223]
    ds_read_b64_tr_b16 a[60:61], v5 offset:8672
    ds_read_b64_tr_b16 a[62:63], v5 offset:9184
    v_mfma_f32_16x16x32_bf16 v[220:223], a[28:31], a[104:107], v[220:223]
    s_waitcnt lgkmcnt(15)
    ds_read_b64_tr_b16 a[28:29], v5 offset:224
    ds_read_b64_tr_b16 a[30:31], v5 offset:736
    v_mfma_f32_16x16x32_bf16 a[128:131], a[0:3], a[96:99], 0
    v_mul_f32 v192, s46, v192
    v_mul_f32 v193, s46, v193
    v_mfma_f32_16x16x32_bf16 a[128:131], a[32:35], a[112:115], a[128:131]
    v_mul_f32 v194, s46, v194
    v_mul_f32 v195, s46, v195
    v_mfma_f32_16x16x32_bf16 a[160:163], a[32:35], a[116:119], 0
    v_cvt_pk_bf16_f32 v160, v192, v193
    v_cvt_pk_bf16_f32 v161, v194, v195
    v_mfma_f32_16x16x32_bf16 a[160:163], a[0:3], a[100:103], a[160:163]
    v_mul_f32 v153, s46, v153
    v_mul_f32 v154, s46, v154
    v_mfma_f32_16x16x32_bf16 a[192:195], a[0:3], a[104:107], 0
    v_mul_f32 v155, s46, v155
    v_mul_f32 v156, s46, v156
    v_mfma_f32_16x16x32_bf16 a[192:195], a[32:35], a[120:123], a[192:195]
    v_mul_f32 v157, s46, v157
    v_mul_f32 v158, s46, v158
    v_mfma_f32_16x16x32_bf16 a[132:135], a[4:7], a[96:99], 0
    v_mul_f32 v159, s46, v159
    v_permlane32_swap_b32 v136, v138
    v_mfma_f32_16x16x32_bf16 a[132:135], a[36:39], a[112:115], a[132:135]
    v_permlane32_swap_b32 v137, v139
    v_cvt_pk_bf16_f32 v140, v152, v153
    v_mfma_f32_16x16x32_bf16 a[164:167], a[36:39], a[116:119], 0
    s_waitcnt vmcnt(46) lgkmcnt(0)
    s_barrier
    v_mfma_f32_16x16x32_bf16 a[164:167], a[4:7], a[100:103], a[164:167]
    buffer_load_dwordx4 v10, s[4:7], s36 offen offset:0 lds
    v_mfma_f32_16x16x32_bf16 a[196:199], a[4:7], a[104:107], 0
    ds_read_b128 v[32:35], v4 offset:0
    ds_read_b128 v[36:39], v4 offset:64
    v_mfma_f32_16x16x32_bf16 a[196:199], a[36:39], a[120:123], a[196:199]
    ds_read_b128 v[40:43], v4 offset:128
    ds_read_b128 v[44:47], v4 offset:192
    v_mfma_f32_16x16x32_bf16 a[136:139], a[8:11], a[96:99], 0
    ds_read_b128 v[60:63], v4 offset:704
    ds_read_b128 v[56:59], v4 offset:640
    v_mfma_f32_16x16x32_bf16 a[136:139], a[40:43], a[112:115], a[136:139]
    buffer_load_dwordx4 v11, s[4:7], s36 offen offset:1056 lds
    v_mfma_f32_16x16x32_bf16 a[168:171], a[40:43], a[116:119], 0
    ds_read_b128 v[52:55], v4 offset:576
    ds_read_b128 v[48:51], v4 offset:512
    v_mfma_f32_16x16x32_bf16 a[168:171], a[8:11], a[100:103], a[168:171]
    v_cvt_pk_bf16_f32 v141, v154, v155
    v_cvt_pk_bf16_f32 v142, v156, v157
    v_mfma_f32_16x16x32_bf16 a[200:203], a[8:11], a[104:107], 0
    v_cvt_pk_bf16_f32 v143, v158, v159
    v_permlane16_swap_b32 v136, v138
    v_mfma_f32_16x16x32_bf16 a[200:203], a[40:43], a[120:123], a[200:203]
    buffer_load_dwordx4 v12, s[4:7], s36 offen offset:2112 lds
    v_mfma_f32_16x16x32_bf16 a[140:143], a[12:15], a[96:99], 0
    v_permlane16_swap_b32 v137, v139
    v_permlane32_swap_b32 v140, v142
    v_mfma_f32_16x16x32_bf16 a[140:143], a[44:47], a[112:115], a[140:143]
    v_permlane32_swap_b32 v141, v143
    v_permlane16_swap_b32 v140, v142
    v_mfma_f32_16x16x32_bf16 a[172:175], a[44:47], a[116:119], 0
    v_permlane16_swap_b32 v141, v143
    v_mul_f32 v162, s46, v162
    v_mfma_f32_16x16x32_bf16 a[172:175], a[12:15], a[100:103], a[172:175]
    buffer_load_dwordx4 v13, s[4:7], s36 offen offset:3168 lds
    v_mfma_f32_16x16x32_bf16 a[204:207], a[12:15], a[104:107], 0
    s_add_u32 m0, s42, 30720
    v_mul_f32 v163, s46, v163
    v_mul_f32 v196, s46, v196
    v_mfma_f32_16x16x32_bf16 a[204:207], a[44:47], a[120:123], a[204:207]
    s_add_u32 s42, s42, 30720
    v_mul_f32 v197, s46, v197
    v_mul_f32 v198, s46, v198
    v_mfma_f32_16x16x32_bf16 a[144:147], a[16:19], a[96:99], 0
    s_mov_b32 s33, s42
    v_mul_f32 v199, s46, v199
    v_cvt_pk_bf16_f32 v145, v162, v163
    v_mfma_f32_16x16x32_bf16 a[144:147], a[48:51], a[112:115], a[144:147]
    buffer_load_dwordx4 v14, s[12:15], s40 offen offset:0 lds
    v_mfma_f32_16x16x32_bf16 a[176:179], a[48:51], a[116:119], 0
    v_cvt_pk_bf16_f32 v162, v196, v197
    v_cvt_pk_bf16_f32 v163, v198, v199
    v_mfma_f32_16x16x32_bf16 a[176:179], a[16:19], a[100:103], a[176:179]
    v_mul_f32 v164, s46, v164
    v_mul_f32 v165, s46, v165
    v_mfma_f32_16x16x32_bf16 a[208:211], a[16:19], a[104:107], 0
    v_mul_f32 v166, s46, v166
    v_mul_f32 v167, s46, v167
    v_mfma_f32_16x16x32_bf16 a[208:211], a[48:51], a[120:123], a[208:211]
    buffer_load_dwordx4 v15, s[12:15], s40 offen offset:1024 lds
    v_mfma_f32_16x16x32_bf16 a[148:151], a[20:23], a[96:99], 0
    v_cvt_pk_bf16_f32 v146, v164, v165
    v_cvt_pk_bf16_f32 v147, v166, v167
    v_mfma_f32_16x16x32_bf16 a[148:151], a[52:55], a[112:115], a[148:151]
    v_mul_f32 v168, s46, v168
    v_mul_f32 v169, s46, v169
    v_mfma_f32_16x16x32_bf16 a[180:183], a[52:55], a[116:119], 0
    v_mul_f32 v170, s46, v170
    v_mul_f32 v171, s46, v171
    v_mfma_f32_16x16x32_bf16 a[180:183], a[20:23], a[100:103], a[180:183]
    buffer_load_dwordx4 v16, s[12:15], s40 offen offset:2048 lds
    v_mfma_f32_16x16x32_bf16 a[212:215], a[20:23], a[104:107], 0
    v_mul_f32 v172, s46, v172
    v_mul_f32 v173, s46, v173
    v_mfma_f32_16x16x32_bf16 a[212:215], a[52:55], a[120:123], a[212:215]
    v_mul_f32 v174, s46, v174
    v_mul_f32 v175, s46, v175
    v_mfma_f32_16x16x32_bf16 a[152:155], a[24:27], a[96:99], 0
    v_permlane32_swap_b32 v144, v146
    v_permlane32_swap_b32 v145, v147
    v_mfma_f32_16x16x32_bf16 a[152:155], a[56:59], a[112:115], a[152:155]
    buffer_load_dwordx4 v17, s[12:15], s40 offen offset:3072 lds
    v_mfma_f32_16x16x32_bf16 a[184:187], a[56:59], a[116:119], 0
    s_waitcnt vmcnt(40) lgkmcnt(0)
    s_barrier
    v_mfma_f32_16x16x32_bf16 a[184:187], a[24:27], a[100:103], a[184:187]
    s_mov_b32 m0, s94
    v_cvt_pk_bf16_f32 v148, v168, v169
    v_cvt_pk_bf16_f32 v149, v170, v171
    v_mfma_f32_16x16x32_bf16 a[216:219], a[24:27], a[104:107], 0
    s_add_u32 s94, s32, s34
    buffer_load_dwordx4 v6, s[8:11], s38 offen offset:0 nt lds
    v_mfma_f32_16x16x32_bf16 a[216:219], a[56:59], a[120:123], a[216:219]
    v_cvt_pk_bf16_f32 v150, v172, v173
    v_cvt_pk_bf16_f32 v151, v174, v175
    v_mfma_f32_16x16x32_bf16 a[156:159], a[28:31], a[96:99], 0
    v_permlane16_swap_b32 v144, v146
    v_permlane16_swap_b32 v145, v147
    v_mfma_f32_16x16x32_bf16 a[156:159], a[60:63], a[112:115], a[156:159]
    v_mul_f32 v176, s46, v176
    v_mul_f32 v177, s46, v177
    v_mfma_f32_16x16x32_bf16 a[188:191], a[60:63], a[116:119], 0
    buffer_load_dwordx4 v7, s[8:11], s38 offen offset:1056 nt lds
    v_mfma_f32_16x16x32_bf16 a[188:191], a[28:31], a[100:103], a[188:191]
    v_mul_f32 v178, s46, v178
    v_mul_f32 v179, s46, v179
    v_mfma_f32_16x16x32_bf16 a[220:223], a[28:31], a[104:107], 0
    v_mul_f32 v180, s46, v180
    v_mul_f32 v181, s46, v181
    v_mfma_f32_16x16x32_bf16 a[220:223], a[60:63], a[120:123], a[220:223]
    v_mul_f32 v182, s46, v182
    v_mul_f32 v183, s46, v183
    v_mfma_f32_16x16x32_bf16 v[192:195], v[32:35], v[128:131], 0
    buffer_load_dwordx4 v8, s[8:11], s38 offen offset:2112 nt lds
    v_mfma_f32_16x16x32_bf16 v[192:195], v[36:39], v[132:135], v[192:195]
    v_mul_f32 v200, s46, v200
    v_mul_f32 v201, s46, v201
    v_mfma_f32_16x16x32_bf16 v[192:195], v[40:43], v[136:139], v[192:195]
    v_mul_f32 v202, s46, v202
    v_mul_f32 v203, s46, v203
    v_mfma_f32_16x16x32_bf16 v[192:195], v[44:47], v[140:143], v[192:195]
    v_permlane32_swap_b32 v148, v150
    v_permlane32_swap_b32 v149, v151
    v_mfma_f32_16x16x32_bf16 v[196:199], v[60:63], v[140:143], 0
    buffer_load_dwordx4 v9, s[8:11], s38 offen offset:3168 nt lds
    v_mfma_f32_16x16x32_bf16 v[196:199], v[56:59], v[136:139], v[196:199]
    s_mov_b32 m0, s94
    v_cvt_pk_bf16_f32 v152, v176, v177
    v_cvt_pk_bf16_f32 v153, v178, v179
    v_mfma_f32_16x16x32_bf16 v[196:199], v[52:55], v[132:135], v[196:199]
    s_min_i32 s38, s39, 524288
    v_cvt_pk_bf16_f32 v154, v180, v181
    v_cvt_pk_bf16_f32 v155, v182, v183
    v_mfma_f32_16x16x32_bf16 v[196:199], v[48:51], v[128:131], v[196:199]
    v_cvt_pk_bf16_f32 v164, v200, v201
    v_cvt_pk_bf16_f32 v165, v202, v203
    v_mfma_f32_16x16x32_bf16 v[200:203], v[32:35], v[144:147], 0
    v_permlane16_swap_b32 v148, v150
    v_permlane16_swap_b32 v149, v151
    v_mul_f32 v184, s46, v184
    v_mul_f32 v185, s46, v185
    v_mfma_f32_16x16x32_bf16 v[200:203], v[36:39], v[148:151], v[200:203]
    v_mul_f32 v186, s46, v186
    v_mul_f32 v187, s46, v187
    v_mul_f32 v188, s46, v188
    v_mul_f32 v189, s46, v189
    v_mul_f32 v190, s46, v190
    v_mul_f32 v191, s46, v191
    v_permlane32_swap_b32 v152, v154
    v_permlane32_swap_b32 v153, v155
    v_cvt_pk_bf16_f32 v156, v184, v185
    v_cvt_pk_bf16_f32 v157, v186, v187
    v_cvt_pk_bf16_f32 v158, v188, v189
    v_cvt_pk_bf16_f32 v159, v190, v191
    v_permlane16_swap_b32 v152, v154
    v_permlane16_swap_b32 v153, v155
    v_permlane32_swap_b32 v156, v158
    v_permlane32_swap_b32 v157, v159
    v_mfma_f32_16x16x32_bf16 v[200:203], v[40:43], v[152:155], v[200:203]
    v_permlane16_swap_b32 v156, v158
    v_permlane16_swap_b32 v157, v159
    v_mul_f32 v204, s46, v204
    v_mul_f32 v205, s46, v205
    v_mfma_f32_16x16x32_bf16 v[200:203], v[44:47], v[156:159], v[200:203]
    v_mul_f32 v206, s46, v206
    v_mul_f32 v207, s46, v207
    v_cvt_pk_bf16_f32 v166, v204, v205
    v_cvt_pk_bf16_f32 v167, v206, v207
    v_mfma_f32_16x16x32_bf16 v[204:207], v[60:63], v[156:159], 0
    v_add_u32 v5, s32, v3
    v_permlane32_swap_b32 v160, v162
    v_mfma_f32_16x16x32_bf16 v[204:207], v[56:59], v[152:155], v[204:207]
    ds_read_b64_tr_b16 v[64:65], v5 offset:8448
    ds_read_b64_tr_b16 v[66:67], v5 offset:8960
    v_mfma_f32_16x16x32_bf16 v[204:207], v[52:55], v[148:151], v[204:207]
    ds_read_b64_tr_b16 v[68:69], v5 offset:8480
    ds_read_b64_tr_b16 v[70:71], v5 offset:8992
    v_mfma_f32_16x16x32_bf16 v[204:207], v[48:51], v[144:147], v[204:207]
    ds_read_b64_tr_b16 v[72:73], v5 offset:8512
    ds_read_b64_tr_b16 v[74:75], v5 offset:9024
    ds_read_b64_tr_b16 v[76:77], v5 offset:8544
    ds_read_b64_tr_b16 v[78:79], v5 offset:9056
    ds_read_b64_tr_b16 v[80:81], v5 offset:8576
    ds_read_b64_tr_b16 v[82:83], v5 offset:9088
    ds_read_b64_tr_b16 v[84:85], v5 offset:8608
    ds_read_b64_tr_b16 v[86:87], v5 offset:9120
    ds_read_b64_tr_b16 v[88:89], v5 offset:8640
    ds_read_b64_tr_b16 v[90:91], v5 offset:9152
    ds_read_b64_tr_b16 v[92:93], v5 offset:8672
    ds_read_b64_tr_b16 v[94:95], v5 offset:9184
    v_permlane32_swap_b32 v161, v163
    v_permlane16_swap_b32 v160, v162
    v_mul_f32 v208, s46, v208
    v_permlane16_swap_b32 v161, v163
    v_mul_f32 v209, s46, v209
    v_mul_f32 v210, s46, v210
    v_mul_f32 v211, s46, v211
    v_mul_f32 v212, s46, v212
    v_mul_f32 v213, s46, v213
    v_mul_f32 v214, s46, v214
    v_mul_f32 v215, s46, v215
    v_permlane32_swap_b32 v164, v166
    v_permlane32_swap_b32 v165, v167
    v_cvt_pk_bf16_f32 v168, v208, v209
    v_cvt_pk_bf16_f32 v169, v210, v211
    v_mfma_f32_16x16x32_bf16 v[208:211], v[32:35], v[160:163], 0
    v_cvt_pk_bf16_f32 v170, v212, v213
    v_cvt_pk_bf16_f32 v171, v214, v215
    v_permlane16_swap_b32 v164, v166
    v_permlane16_swap_b32 v165, v167
    v_mul_f32 v216, s46, v216
    v_mul_f32 v217, s46, v217
    v_mfma_f32_16x16x32_bf16 v[208:211], v[36:39], v[164:167], v[208:211]
    v_mul_f32 v218, s46, v218
    v_mul_f32 v219, s46, v219
    v_mul_f32 v220, s46, v220
    v_mul_f32 v221, s46, v221
    v_mul_f32 v222, s46, v222
    v_mul_f32 v223, s46, v223
    v_permlane32_swap_b32 v168, v170
    v_permlane32_swap_b32 v169, v171
    v_cvt_pk_bf16_f32 v172, v216, v217
    v_cvt_pk_bf16_f32 v173, v218, v219
    v_cvt_pk_bf16_f32 v174, v220, v221
    v_cvt_pk_bf16_f32 v175, v222, v223
    v_max3_f32 v240, v192, v193, v194
    v_permlane16_swap_b32 v168, v170
    v_permlane16_swap_b32 v169, v171
    v_permlane32_swap_b32 v172, v174
    v_permlane32_swap_b32 v173, v175
    v_mfma_f32_16x16x32_bf16 v[208:211], v[40:43], v[168:171], v[208:211]
    v_max3_f32 v241, v195, v196, v197
    v_max3_f32 v240, v240, v198, v199
    v_permlane16_swap_b32 v172, v174
    v_max_f32 v240, v240, v241
    v_permlane16_swap_b32 v173, v175
    v_mov_b32 v241, v240
    v_add_u32 v4, s32, v2
    v_mfma_f32_16x16x32_bf16 v[208:211], v[44:47], v[172:175], v[208:211]
    s_add_u32 s32, s32, 16896
    ds_read_b128 v[32:35], v4 offset:0
    ds_read_b128 v[36:39], v4 offset:64
    v_mfma_f32_16x16x32_bf16 v[212:215], v[60:63], v[172:175], 0
    s_cmp_ge_u32 s32, 84480
    s_cselect_b32 s32, 0, s32
    ds_read_b128 v[40:43], v4 offset:128
    v_mfma_f32_16x16x32_bf16 v[212:215], v[56:59], v[168:171], v[212:215]
    ds_read_b128 v[44:47], v4 offset:192
    ds_read_b128 v[60:63], v4 offset:704
    v_mfma_f32_16x16x32_bf16 v[212:215], v[52:55], v[164:167], v[212:215]
    ds_read_b128 v[56:59], v4 offset:640
    ds_read_b128 v[52:55], v4 offset:576
    v_mfma_f32_16x16x32_bf16 v[212:215], v[48:51], v[160:163], v[212:215]
    s_waitcnt lgkmcnt(15)
    ds_read_b128 v[48:51], v4 offset:512
    v_permlane32_swap_b32 v240, v241
    v_mov_b32 v96, 0x3f803f80
    v_max_f32 v240, v240, v241
    v_mov_b32 v97, 0x3f803f80
    v_mov_b32 v241, v240
    v_mov_b32 v98, 0x3f803f80
    v_mov_b32 v99, 0x3f803f80
    v_permlane16_swap_b32 v240, v241
    v_max3_f32 v244, v200, v201, v202
    v_max_f32 v240, v240, v241
    v_max3_f32 v245, v203, v204, v205
    v_sub_f32 v192, v192, v240
    v_sub_f32 v193, v193, v240
    v_sub_f32 v194, v194, v240
    v_sub_f32 v195, v195, v240
    v_sub_f32 v196, v196, v240
    v_sub_f32 v197, v197, v240
    v_sub_f32 v198, v198, v240
    v_sub_f32 v199, v199, v240
    v_exp_f32 v192, v192
    v_exp_f32 v193, v193
    v_exp_f32 v194, v194
    v_exp_f32 v195, v195
    v_exp_f32 v196, v196
    v_exp_f32 v197, v197
    v_exp_f32 v198, v198
    v_exp_f32 v199, v199
    v_cvt_pk_bf16_f32 v224, v192, v193
    v_cvt_pk_bf16_f32 v225, v194, v195
    v_cvt_pk_bf16_f32 v226, v196, v197
    v_cvt_pk_bf16_f32 v227, v198, v199
    v_sub_f32 v241, 0, v240
    v_sub_f32 v242, 0, v240
    v_mfma_f32_16x16x32_bf16 a[0:3], v[64:67], v[224:227], 0
    s_waitcnt vmcnt(30) lgkmcnt(0)
    s_barrier
    v_mfma_f32_16x16x32_bf16 a[4:7], v[68:71], v[224:227], 0
    buffer_load_dwordx4 v6, s[8:11], s38 offen offset:0 nt lds
    v_mfma_f32_16x16x32_bf16 a[8:11], v[72:75], v[224:227], 0
    v_sub_f32 v243, 0, v240
    v_sub_f32 v240, 0, v240
    v_mfma_f32_16x16x32_bf16 a[12:15], v[76:79], v[224:227], 0
    v_max3_f32 v244, v244, v206, v207
    v_max3_f32 v248, v208, v209, v210
    v_mfma_f32_16x16x32_bf16 a[16:19], v[80:83], v[224:227], 0
    v_max_f32 v244, v244, v245
    v_max3_f32 v249, v211, v212, v213
    v_mfma_f32_16x16x32_bf16 a[20:23], v[84:87], v[224:227], 0
    buffer_load_dwordx4 v7, s[8:11], s38 offen offset:1056 nt lds
    v_mfma_f32_16x16x32_bf16 a[24:27], v[88:91], v[224:227], 0
    v_mov_b32 v245, v244
    v_max3_f32 v248, v248, v214, v215
    v_mfma_f32_16x16x32_bf16 a[28:31], v[92:95], v[224:227], 0
    v_permlane32_swap_b32 v244, v245
    v_max_f32 v248, v248, v249
    v_mfma_f32_16x16x32_bf16 v[100:103], v[96:99], v[224:227], 0
    v_max_f32 v244, v244, v245
    v_mov_b32 v249, v248
    v_mfma_f32_16x16x32_bf16 v[192:195], v[32:35], v[128:131], v[240:243]
    buffer_load_dwordx4 v8, s[8:11], s38 offen offset:2112 nt lds
    v_mfma_f32_16x16x32_bf16 v[192:195], v[36:39], v[132:135], v[192:195]
    v_mov_b32 v245, v244
    v_permlane32_swap_b32 v248, v249
    v_mfma_f32_16x16x32_bf16 v[192:195], v[40:43], v[136:139], v[192:195]
    v_permlane16_swap_b32 v244, v245
    v_max_f32 v248, v248, v249
    v_mfma_f32_16x16x32_bf16 v[192:195], v[44:47], v[140:143], v[192:195]
    v_max_f32 v244, v244, v245
    v_mov_b32 v249, v248
    v_mfma_f32_16x16x32_bf16 v[196:199], v[60:63], v[140:143], v[240:243]
    buffer_load_dwordx4 v9, s[8:11], s38 offen offset:3168 nt lds
    v_mfma_f32_16x16x32_bf16 v[196:199], v[56:59], v[136:139], v[196:199]
    v_sub_f32 v200, v200, v244
    v_sub_f32 v201, v201, v244
    v_mfma_f32_16x16x32_bf16 v[196:199], v[52:55], v[132:135], v[196:199]
    v_sub_f32 v202, v202, v244
    v_sub_f32 v203, v203, v244
    v_mfma_f32_16x16x32_bf16 v[196:199], v[48:51], v[128:131], v[196:199]
    v_sub_f32 v204, v204, v244
    v_sub_f32 v205, v205, v244
    v_sub_f32 v206, v206, v244
    v_sub_f32 v207, v207, v244
    v_exp_f32 v200, v200
    v_exp_f32 v201, v201
    v_exp_f32 v202, v202
    v_exp_f32 v203, v203
    v_exp_f32 v204, v204
    v_exp_f32 v205, v205
    v_exp_f32 v206, v206
    v_exp_f32 v207, v207
    v_cvt_pk_bf16_f32 v228, v200, v201
    v_cvt_pk_bf16_f32 v229, v202, v203
    v_cvt_pk_bf16_f32 v230, v204, v205
    v_cvt_pk_bf16_f32 v231, v206, v207
    v_sub_f32 v245, 0, v244
    v_sub_f32 v246, 0, v244
    v_mfma_f32_16x16x32_bf16 a[32:35], v[64:67], v[228:231], 0
    v_sub_f32 v247, 0, v244
    v_sub_f32 v244, 0, v244
    v_mfma_f32_16x16x32_bf16 a[36:39], v[68:71], v[228:231], 0
    v_permlane16_swap_b32 v248, v249
    v_add_u32 v5, s32, v3
    v_mfma_f32_16x16x32_bf16 a[40:43], v[72:75], v[228:231], 0
    v_max_f32 v248, v248, v249
    v_add_u32 v4, s32, v2
    v_mfma_f32_16x16x32_bf16 a[44:47], v[76:79], v[228:231], 0
    v_sub_f32 v208, v208, v248
    v_sub_f32 v209, v209, v248
    v_mfma_f32_16x16x32_bf16 a[48:51], v[80:83], v[228:231], 0
    v_sub_f32 v210, v210, v248
    v_sub_f32 v211, v211, v248
    v_mfma_f32_16x16x32_bf16 a[52:55], v[84:87], v[228:231], 0
    v_sub_f32 v212, v212, v248
    v_sub_f32 v213, v213, v248
    v_mfma_f32_16x16x32_bf16 a[56:59], v[88:91], v[228:231], 0
    v_sub_f32 v214, v214, v248
    v_sub_f32 v215, v215, v248
    v_mfma_f32_16x16x32_bf16 a[60:63], v[92:95], v[228:231], 0
    v_exp_f32 v208, v208
    v_mfma_f32_16x16x32_bf16 v[104:107], v[96:99], v[228:231], 0
    v_exp_f32 v209, v209
    v_mfma_f32_16x16x32_bf16 v[200:203], v[32:35], v[144:147], v[244:247]
    v_exp_f32 v210, v210
    v_mfma_f32_16x16x32_bf16 v[200:203], v[36:39], v[148:151], v[200:203]
    v_exp_f32 v211, v211
    v_mfma_f32_16x16x32_bf16 v[200:203], v[40:43], v[152:155], v[200:203]
    v_exp_f32 v212, v212
    v_mfma_f32_16x16x32_bf16 v[200:203], v[44:47], v[156:159], v[200:203]
    v_exp_f32 v213, v213
    v_mfma_f32_16x16x32_bf16 v[204:207], v[60:63], v[156:159], v[244:247]
    v_exp_f32 v214, v214
    v_mfma_f32_16x16x32_bf16 v[204:207], v[56:59], v[152:155], v[204:207]
    v_exp_f32 v215, v215
    v_mfma_f32_16x16x32_bf16 v[204:207], v[52:55], v[148:151], v[204:207]
    v_cvt_pk_bf16_f32 v232, v208, v209
    v_cvt_pk_bf16_f32 v233, v210, v211
    v_mfma_f32_16x16x32_bf16 v[204:207], v[48:51], v[144:147], v[204:207]
    v_cvt_pk_bf16_f32 v234, v212, v213
    v_cvt_pk_bf16_f32 v235, v214, v215
    v_sub_f32 v249, 0, v248
    v_sub_f32 v250, 0, v248
    v_mfma_f32_16x16x32_bf16 a[64:67], v[64:67], v[232:235], 0
    ds_read_b64_tr_b16 v[64:65], v5 offset:8448
    ds_read_b64_tr_b16 v[66:67], v5 offset:8960
    v_mfma_f32_16x16x32_bf16 a[68:71], v[68:71], v[232:235], 0
    ds_read_b64_tr_b16 v[68:69], v5 offset:8480
    ds_read_b64_tr_b16 v[70:71], v5 offset:8992
    v_mfma_f32_16x16x32_bf16 a[72:75], v[72:75], v[232:235], 0
    ds_read_b64_tr_b16 v[72:73], v5 offset:8512
    ds_read_b64_tr_b16 v[74:75], v5 offset:9024
    v_mfma_f32_16x16x32_bf16 a[76:79], v[76:79], v[232:235], 0
    ds_read_b64_tr_b16 v[76:77], v5 offset:8544
    ds_read_b64_tr_b16 v[78:79], v5 offset:9056
    v_mfma_f32_16x16x32_bf16 a[80:83], v[80:83], v[232:235], 0
    ds_read_b64_tr_b16 v[80:81], v5 offset:8576
    ds_read_b64_tr_b16 v[82:83], v5 offset:9088
    v_mfma_f32_16x16x32_bf16 a[84:87], v[84:87], v[232:235], 0
    ds_read_b64_tr_b16 v[84:85], v5 offset:8608
    ds_read_b64_tr_b16 v[86:87], v5 offset:9120
    v_mfma_f32_16x16x32_bf16 a[88:91], v[88:91], v[232:235], 0
    ds_read_b64_tr_b16 v[88:89], v5 offset:8640
    ds_read_b64_tr_b16 v[90:91], v5 offset:9152
    v_mfma_f32_16x16x32_bf16 a[92:95], v[92:95], v[232:235], 0
    ds_read_b64_tr_b16 v[92:93], v5 offset:8672
    ds_read_b64_tr_b16 v[94:95], v5 offset:9184
    v_mfma_f32_16x16x32_bf16 v[108:111], v[96:99], v[232:235], 0
    v_sub_f32 v251, 0, v248
    v_sub_f32 v248, 0, v248
    v_exp_f32 v192, v192
    s_nop 0
    v_mfma_f32_16x16x32_bf16 v[208:211], v[32:35], v[160:163], v[248:251]
    ds_read_b128 v[32:35], v4 offset:0
    v_add_u32 v10, s57, v10
    v_mfma_f32_16x16x32_bf16 v[208:211], v[36:39], v[164:167], v[208:211]
    ds_read_b128 v[36:39], v4 offset:64
    v_add_u32 v11, s57, v11
    v_mfma_f32_16x16x32_bf16 v[208:211], v[40:43], v[168:171], v[208:211]
    s_bfe_u32 s57, s97, 0x40000
    ds_read_b128 v[40:43], v4 offset:128
    v_and_b32 v22, 7, v1
    v_mfma_f32_16x16x32_bf16 v[208:211], v[44:47], v[172:175], v[208:211]
    s_lshl_b32 s36, s57, 19
    ds_read_b128 v[44:47], v4 offset:192
    v_add_u32 v21, 84480, v3
    v_mfma_f32_16x16x32_bf16 v[212:215], v[60:63], v[172:175], v[248:251]
    ds_read_b128 v[60:63], v4 offset:704
    v_mul_u32_u24 v22, 80, v22
    v_mfma_f32_16x16x32_bf16 v[212:215], v[56:59], v[168:171], v[212:215]
    ds_read_b128 v[56:59], v4 offset:640
    v_mfma_f32_16x16x32_bf16 v[212:215], v[52:55], v[164:167], v[212:215]
    ds_read_b128 v[52:55], v4 offset:576
    v_mfma_f32_16x16x32_bf16 v[212:215], v[48:51], v[160:163], v[212:215]
    s_waitcnt lgkmcnt(15)
    ds_read_b128 v[48:51], v4 offset:512
    v_exp_f32 v193, v193
    v_exp_f32 v194, v194
    v_exp_f32 v195, v195
    v_exp_f32 v196, v196
    v_exp_f32 v197, v197
    v_exp_f32 v198, v198
    v_exp_f32 v199, v199
    v_cvt_pk_bf16_f32 v224, v192, v193
    v_cvt_pk_bf16_f32 v225, v194, v195
    v_cvt_pk_bf16_f32 v226, v196, v197
    v_cvt_pk_bf16_f32 v227, v198, v199
    v_exp_f32 v200, v200
    s_nop 0
    v_mfma_f32_16x16x32_bf16 a[0:3], v[64:67], v[224:227], a[0:3]
    v_exp_f32 v201, v201
    v_mfma_f32_16x16x32_bf16 a[4:7], v[68:71], v[224:227], a[4:7]
    v_exp_f32 v202, v202
    v_mfma_f32_16x16x32_bf16 a[8:11], v[72:75], v[224:227], a[8:11]
    v_exp_f32 v203, v203
    v_mfma_f32_16x16x32_bf16 a[12:15], v[76:79], v[224:227], a[12:15]
    s_waitcnt lgkmcnt(14)
    v_exp_f32 v204, v204
    v_mfma_f32_16x16x32_bf16 a[16:19], v[80:83], v[224:227], a[16:19]
    s_waitcnt lgkmcnt(12)
    v_exp_f32 v205, v205
    v_mfma_f32_16x16x32_bf16 a[20:23], v[84:87], v[224:227], a[20:23]
    s_waitcnt lgkmcnt(10)
    v_exp_f32 v206, v206
    v_mfma_f32_16x16x32_bf16 a[24:27], v[88:91], v[224:227], a[24:27]
    s_waitcnt lgkmcnt(8)
    v_exp_f32 v207, v207
    v_mfma_f32_16x16x32_bf16 a[28:31], v[92:95], v[224:227], a[28:31]
    v_cvt_pk_bf16_f32 v228, v200, v201
    v_cvt_pk_bf16_f32 v229, v202, v203
    v_mfma_f32_16x16x32_bf16 v[100:103], v[96:99], v[224:227], v[100:103]
    v_cvt_pk_bf16_f32 v230, v204, v205
    v_exp_f32 v208, v208
    v_cvt_pk_bf16_f32 v231, v206, v207
    v_exp_f32 v209, v209
    s_mov_b32 s44, 0
    s_waitcnt lgkmcnt(0)
.p2align 6
L1v3_wloop:
    v_mfma_f32_16x16x32_bf16 v[192:195], v[32:35], v[128:131], v[240:243]
    s_waitcnt vmcnt(8) lgkmcnt(0)
    s_barrier
    v_mfma_f32_16x16x32_bf16 v[192:195], v[36:39], v[132:135], v[192:195]
    s_add_u32 m0, s100, 8448
    ds_read_b128 v[116:119], v18 offset:0
    s_add_u32 s36, s36, 262144
    v_mfma_f32_16x16x32_bf16 v[192:195], v[40:43], v[136:139], v[192:195]
    s_add_u32 s94, s32, s34
    buffer_load_dwordx4 v10, s[4:7], s36 offen offset:0 lds
    v_mfma_f32_16x16x32_bf16 v[192:195], v[44:47], v[140:143], v[192:195]
    s_add_u32 s32, s32, 16896
    ds_read_b128 v[124:127], v18 offset:2048
    v_cvt_pk_bf16_f32 v232, v208, v209
    v_mfma_f32_16x16x32_bf16 v[196:199], v[60:63], v[140:143], v[240:243]
    s_cmp_ge_u32 s32, 84480
    s_cselect_b32 s32, 0, s32
    ds_read_b128 v[28:31], v18 offset:4096
    v_mfma_f32_16x16x32_bf16 v[196:199], v[56:59], v[136:139], v[196:199]
    s_max_i32 s39, s35, 0
    v_exp_f32 v210, v210
    v_mfma_f32_16x16x32_bf16 v[196:199], v[52:55], v[132:135], v[196:199]
    s_min_i32 s38, s39, 524288
    v_exp_f32 v211, v211
    v_mfma_f32_16x16x32_bf16 v[196:199], v[48:51], v[128:131], v[196:199]
    s_add_i32 s35, s35, 8192
    v_exp_f32 v212, v212
    v_mfma_f32_16x16x32_bf16 a[32:35], v[64:67], v[228:231], a[32:35]
    s_max_i32 s39, s35, 0
    v_exp_f32 v213, v213
    v_mfma_f32_16x16x32_bf16 a[36:39], v[68:71], v[228:231], a[36:39]
    s_sub_u32 s42, s42, s43
    v_exp_f32 v214, v214
    v_mfma_f32_16x16x32_bf16 a[40:43], v[72:75], v[228:231], a[40:43]
    s_add_i32 s35, s35, 8192
    buffer_load_dwordx4 v11, s[4:7], s36 offen offset:1056 lds
    v_mfma_f32_16x16x32_bf16 a[44:47], v[76:79], v[228:231], a[44:47]
    s_mov_b32 m0, s94
    v_exp_f32 v215, v215
    v_mfma_f32_16x16x32_bf16 a[48:51], v[80:83], v[228:231], a[48:51]
    s_lshl_b32 s36, s98, 19
    v_cvt_pk_bf16_f32 v233, v210, v211
    v_cvt_pk_bf16_f32 v234, v212, v213
    v_mfma_f32_16x16x32_bf16 a[52:55], v[84:87], v[228:231], a[52:55]
    s_add_u32 s94, s32, s34
    v_cvt_pk_bf16_f32 v235, v214, v215
    v_add_u32 v5, s32, v3
    v_mfma_f32_16x16x32_bf16 a[56:59], v[88:91], v[228:231], a[56:59]
    s_lshr_b32 s98, s96, 28
    v_exp_f32 v192, v192
    v_mfma_f32_16x16x32_bf16 a[60:63], v[92:95], v[228:231], a[60:63]
    s_lshl_b32 s40, s98, 7
    v_exp_f32 v193, v193
    v_mfma_f32_16x16x32_bf16 v[104:107], v[96:99], v[228:231], v[104:107]
    s_lshl_b32 s96, s96, 4
    v_exp_f32 v194, v194
    v_mfma_f32_16x16x32_bf16 v[200:203], v[32:35], v[144:147], v[244:247]
    v_exp_f32 v195, v195
    v_mfma_f32_16x16x32_bf16 v[200:203], v[36:39], v[148:151], v[200:203]
    buffer_load_dword v23, v22, s[60:63], s58 offen
    v_mfma_f32_16x16x32_bf16 v[200:203], v[40:43], v[152:155], v[200:203]
    s_add_u32 s58, s58, 640
    v_exp_f32 v196, v196
    v_mfma_f32_16x16x32_bf16 v[200:203], v[44:47], v[156:159], v[200:203]
    v_exp_f32 v197, v197
    v_mfma_f32_16x16x32_bf16 v[204:207], v[60:63], v[156:159], v[244:247]
    v_exp_f32 v198, v198
    v_mfma_f32_16x16x32_bf16 v[204:207], v[56:59], v[152:155], v[204:207]
    v_exp_f32 v199, v199
    v_mfma_f32_16x16x32_bf16 v[204:207], v[52:55], v[148:151], v[204:207]
    v_cvt_pk_bf16_f32 v224, v192, v193
    v_cvt_pk_bf16_f32 v225, v194, v195
    v_mfma_f32_16x16x32_bf16 v[204:207], v[48:51], v[144:147], v[204:207]
    v_cvt_pk_bf16_f32 v226, v196, v197
    v_cvt_pk_bf16_f32 v227, v198, v199
    v_mfma_f32_16x16x32_bf16 a[64:67], v[64:67], v[232:235], a[64:67]
    ds_read_b64_tr_b16 v[64:65], v5 offset:8448
    ds_read_b64_tr_b16 v[66:67], v5 offset:8960
    v_mfma_f32_16x16x32_bf16 a[68:71], v[68:71], v[232:235], a[68:71]
    ds_read_b64_tr_b16 v[68:69], v5 offset:8480
    ds_read_b64_tr_b16 v[70:71], v5 offset:8992
    v_mfma_f32_16x16x32_bf16 a[72:75], v[72:75], v[232:235], a[72:75]
    ds_read_b64_tr_b16 v[72:73], v5 offset:8512
    ds_read_b64_tr_b16 v[74:75], v5 offset:9024
    v_mfma_f32_16x16x32_bf16 a[76:79], v[76:79], v[232:235], a[76:79]
    ds_read_b64_tr_b16 v[76:77], v5 offset:8544
    ds_read_b64_tr_b16 v[78:79], v5 offset:9056
    v_mfma_f32_16x16x32_bf16 a[80:83], v[80:83], v[232:235], a[80:83]
    ds_read_b64_tr_b16 v[80:81], v5 offset:8576
    ds_read_b64_tr_b16 v[82:83], v5 offset:9088
    v_mfma_f32_16x16x32_bf16 a[84:87], v[84:87], v[232:235], a[84:87]
    ds_read_b64_tr_b16 v[84:85], v5 offset:8608
    ds_read_b64_tr_b16 v[86:87], v5 offset:9120
    v_mfma_f32_16x16x32_bf16 a[88:91], v[88:91], v[232:235], a[88:91]
    ds_read_b64_tr_b16 v[88:89], v5 offset:8640
    ds_read_b64_tr_b16 v[90:91], v5 offset:9152
    v_mfma_f32_16x16x32_bf16 a[92:95], v[92:95], v[232:235], a[92:95]
    ds_read_b64_tr_b16 v[92:93], v5 offset:8672
    ds_read_b64_tr_b16 v[94:95], v5 offset:9184
    v_mfma_f32_16x16x32_bf16 v[108:111], v[96:99], v[232:235], v[108:111]
    buffer_load_dwordx4 v6, s[8:11], s38 offen offset:0 nt lds
    v_mfma_f32_16x16x32_bf16 v[208:211], v[32:35], v[160:163], v[248:251]
    ds_read_b64_tr_b16 v[32:33], v21 offset:0
    ds_read_b64_tr_b16 v[34:35], v21 offset:512
    v_mfma_f32_16x16x32_bf16 v[208:211], v[36:39], v[164:167], v[208:211]
    ds_read_b64_tr_b16 v[36:37], v21 offset:32
    ds_read_b64_tr_b16 v[38:39], v21 offset:544
    v_mfma_f32_16x16x32_bf16 v[208:211], v[40:43], v[168:171], v[208:211]
    ds_read_b64_tr_b16 v[40:41], v21 offset:64
    ds_read_b64_tr_b16 v[42:43], v21 offset:576
    v_mfma_f32_16x16x32_bf16 v[208:211], v[44:47], v[172:175], v[208:211]
    ds_read_b64_tr_b16 v[44:45], v21 offset:96
    ds_read_b64_tr_b16 v[46:47], v21 offset:608
    v_mfma_f32_16x16x32_bf16 v[212:215], v[60:63], v[172:175], v[248:251]
    ds_read_b64_tr_b16 v[60:61], v21 offset:224
    ds_read_b64_tr_b16 v[62:63], v21 offset:736
    v_mfma_f32_16x16x32_bf16 v[212:215], v[56:59], v[168:171], v[212:215]
    ds_read_b64_tr_b16 v[56:57], v21 offset:192
    ds_read_b64_tr_b16 v[58:59], v21 offset:704
    v_mfma_f32_16x16x32_bf16 v[212:215], v[52:55], v[164:167], v[212:215]
    ds_read_b64_tr_b16 v[52:53], v21 offset:160
    ds_read_b64_tr_b16 v[54:55], v21 offset:672
    v_mfma_f32_16x16x32_bf16 v[212:215], v[48:51], v[160:163], v[212:215]
    s_waitcnt lgkmcnt(15)
    buffer_load_dwordx4 v7, s[8:11], s38 offen offset:1056 nt lds
    v_mfma_f32_16x16x32_bf16 a[0:3], v[64:67], v[224:227], a[0:3]
    ds_read_b64_tr_b16 v[48:49], v21 offset:128
    ds_read_b64_tr_b16 v[50:51], v21 offset:640
    v_mfma_f32_16x16x32_bf16 a[4:7], v[68:71], v[224:227], a[4:7]
    v_add_u32 v4, s32, v2
    s_add_u32 s32, s32, 16896
    v_mfma_f32_16x16x32_bf16 a[8:11], v[72:75], v[224:227], a[8:11]
    s_cmp_ge_u32 s32, 84480
    s_cselect_b32 s32, 0, s32
    v_add_u32 v5, s32, v3
    v_mfma_f32_16x16x32_bf16 a[12:15], v[76:79], v[224:227], a[12:15]
    v_exp_f32 v200, v200
    v_mfma_f32_16x16x32_bf16 a[16:19], v[80:83], v[224:227], a[16:19]
    v_exp_f32 v201, v201
    v_mfma_f32_16x16x32_bf16 a[20:23], v[84:87], v[224:227], a[20:23]
    v_exp_f32 v202, v202
    v_mfma_f32_16x16x32_bf16 a[24:27], v[88:91], v[224:227], a[24:27]
    s_waitcnt lgkmcnt(15)
    v_exp_f32 v203, v203
    v_mfma_f32_16x16x32_bf16 a[28:31], v[92:95], v[224:227], a[28:31]
    buffer_load_dwordx4 v8, s[8:11], s38 offen offset:2112 nt lds
    v_mfma_f32_16x16x32_bf16 v[100:103], v[96:99], v[224:227], v[100:103]
    s_waitcnt lgkmcnt(14)
    v_exp_f32 v204, v204
    v_mfma_f32_16x16x32_bf16 a[128:131], v[32:35], v[116:119], a[128:131]
    v_exp_f32 v205, v205
    v_mfma_f32_16x16x32_bf16 a[160:163], v[32:35], v[124:127], a[160:163]
    v_exp_f32 v206, v206
    v_mfma_f32_16x16x32_bf16 a[192:195], v[32:35], v[28:31], a[192:195]
    s_waitcnt lgkmcnt(12)
    ds_read_b128 v[32:35], v4 offset:0
    v_cvt_pk_bf16_f32 v228, v200, v201
    v_mfma_f32_16x16x32_bf16 a[132:135], v[36:39], v[116:119], a[132:135]
    v_exp_f32 v207, v207
    v_mfma_f32_16x16x32_bf16 a[164:167], v[36:39], v[124:127], a[164:167]
    v_cvt_pk_bf16_f32 v229, v202, v203
    v_cvt_pk_bf16_f32 v230, v204, v205
    v_mfma_f32_16x16x32_bf16 a[196:199], v[36:39], v[28:31], a[196:199]
    s_waitcnt lgkmcnt(11)
    ds_read_b128 v[36:39], v4 offset:64
    v_cvt_pk_bf16_f32 v231, v206, v207
    v_mfma_f32_16x16x32_bf16 a[136:139], v[40:43], v[116:119], a[136:139]
    buffer_load_dwordx4 v9, s[8:11], s38 offen offset:3168 nt lds
    v_mfma_f32_16x16x32_bf16 a[168:171], v[40:43], v[124:127], a[168:171]
    s_add_u32 m0, s33, 4096
    v_exp_f32 v208, v208
    v_mfma_f32_16x16x32_bf16 a[200:203], v[40:43], v[28:31], a[200:203]
    s_waitcnt lgkmcnt(10)
    s_min_i32 s38, s39, 524288
    ds_read_b128 v[40:43], v4 offset:128
    v_add_u32 v18, s43, v18
    v_mfma_f32_16x16x32_bf16 a[140:143], v[44:47], v[116:119], a[140:143]
    s_cmp_lt_u32 s44, 7
    s_cselect_b32 s57, -1, 0
    s_cselect_b32 s33, s42, 163840
    v_mfma_f32_16x16x32_bf16 a[172:175], v[44:47], v[124:127], a[172:175]
    s_add_u32 s44, s44, 1
    v_exp_f32 v209, v209
    v_mfma_f32_16x16x32_bf16 a[204:207], v[44:47], v[28:31], a[204:207]
    s_waitcnt lgkmcnt(9)
    ds_read_b128 v[44:47], v4 offset:192
    v_cvt_pk_bf16_f32 v232, v208, v209
    v_mfma_f32_16x16x32_bf16 a[156:159], v[60:63], v[116:119], a[156:159]
    v_exp_f32 v210, v210
    v_mfma_f32_16x16x32_bf16 a[188:191], v[60:63], v[124:127], a[188:191]
    v_exp_f32 v211, v211
    v_mfma_f32_16x16x32_bf16 a[220:223], v[60:63], v[28:31], a[220:223]
    s_waitcnt lgkmcnt(8)
    ds_read_b128 v[60:63], v4 offset:704
    v_cvt_pk_bf16_f32 v233, v210, v211
    v_mfma_f32_16x16x32_bf16 a[152:155], v[56:59], v[116:119], a[152:155]
    buffer_load_dwordx4 v14, s[12:15], s41 offen offset:0 lds
    v_mfma_f32_16x16x32_bf16 a[184:187], v[56:59], v[124:127], a[184:187]
    v_exp_f32 v212, v212
    v_mfma_f32_16x16x32_bf16 a[216:219], v[56:59], v[28:31], a[216:219]
    s_waitcnt lgkmcnt(7)
    ds_read_b128 v[56:59], v4 offset:640
    v_mfma_f32_16x16x32_bf16 a[148:151], v[52:55], v[116:119], a[148:151]
    v_exp_f32 v213, v213
    v_mfma_f32_16x16x32_bf16 a[180:183], v[52:55], v[124:127], a[180:183]
    v_exp_f32 v214, v214
    v_mfma_f32_16x16x32_bf16 a[212:215], v[52:55], v[28:31], a[212:215]
    s_waitcnt lgkmcnt(6)
    ds_read_b128 v[52:55], v4 offset:576
    v_cvt_pk_bf16_f32 v234, v212, v213
    v_mfma_f32_16x16x32_bf16 a[144:147], v[48:51], v[116:119], a[144:147]
    v_exp_f32 v215, v215
    v_mfma_f32_16x16x32_bf16 a[176:179], v[48:51], v[124:127], a[176:179]
    v_cvt_pk_bf16_f32 v235, v214, v215
    v_mfma_f32_16x16x32_bf16 a[208:211], v[48:51], v[28:31], a[208:211]
    s_waitcnt lgkmcnt(6)
    ds_read_b128 v[48:51], v4 offset:512
    v_add_u32 v4, s32, v2
    v_mfma_f32_16x16x32_bf16 v[192:195], v[32:35], v[128:131], v[240:243]
    s_waitcnt lgkmcnt(6)
    buffer_load_dwordx4 v15, s[12:15], s41 offen offset:1024 lds
    v_mfma_f32_16x16x32_bf16 v[192:195], v[36:39], v[132:135], v[192:195]
    s_waitcnt lgkmcnt(5)
    s_add_u32 m0, s100, 0
    s_add_u32 s41, s40, 40960
    s_and_b32 s14, s95, s57
    v_mfma_f32_16x16x32_bf16 v[192:195], v[40:43], v[136:139], v[192:195]
    s_waitcnt lgkmcnt(4)
    s_and_b32 s40, s40, s57
    s_and_b32 s41, s41, s57
    v_mfma_f32_16x16x32_bf16 v[192:195], v[44:47], v[140:143], v[192:195]
    s_waitcnt lgkmcnt(3)
    v_mfma_f32_16x16x32_bf16 v[196:199], v[60:63], v[140:143], v[240:243]
    s_waitcnt lgkmcnt(2)
    v_mfma_f32_16x16x32_bf16 v[196:199], v[56:59], v[136:139], v[196:199]
    s_waitcnt lgkmcnt(1)
    s_nop 2
    v_exp_f32 v192, v192
    v_mfma_f32_16x16x32_bf16 v[196:199], v[52:55], v[132:135], v[196:199]
    v_exp_f32 v193, v193
    v_exp_f32 v194, v194
    v_exp_f32 v195, v195
    s_waitcnt vmcnt(7) lgkmcnt(0)
    s_barrier
    v_mfma_f32_16x16x32_bf16 v[196:199], v[48:51], v[128:131], v[196:199]
    buffer_load_dwordx4 v10, s[4:7], s36 offen offset:0 lds
    v_mfma_f32_16x16x32_bf16 a[32:35], v[64:67], v[228:231], a[32:35]
    ds_read_b128 v[116:119], v19 offset:0
    v_cvt_pk_bf16_f32 v224, v192, v193
    v_mfma_f32_16x16x32_bf16 a[36:39], v[68:71], v[228:231], a[36:39]
    ds_read_b128 v[124:127], v19 offset:2048
    v_cvt_pk_bf16_f32 v225, v194, v195
    v_mfma_f32_16x16x32_bf16 a[40:43], v[72:75], v[228:231], a[40:43]
    ds_read_b128 v[28:31], v19 offset:4096
    v_add_u32 v19, s43, v19
    v_mfma_f32_16x16x32_bf16 a[44:47], v[76:79], v[228:231], a[44:47]
    s_sub_u32 s43, 0, s43
    v_exp_f32 v196, v196
    v_mfma_f32_16x16x32_bf16 a[48:51], v[80:83], v[228:231], a[48:51]
    s_cmp_lt_u32 s44, 9
    v_exp_f32 v197, v197
    v_mfma_f32_16x16x32_bf16 a[52:55], v[84:87], v[228:231], a[52:55]
    v_exp_f32 v198, v198
    v_mfma_f32_16x16x32_bf16 a[56:59], v[88:91], v[228:231], a[56:59]
    v_exp_f32 v199, v199
    v_mfma_f32_16x16x32_bf16 a[60:63], v[92:95], v[228:231], a[60:63]
    buffer_load_dwordx4 v11, s[4:7], s36 offen offset:1056 lds
    v_mfma_f32_16x16x32_bf16 v[104:107], v[96:99], v[228:231], v[104:107]
    s_mov_b32 m0, s94
    v_cvt_pk_bf16_f32 v226, v196, v197
    v_cvt_pk_bf16_f32 v227, v198, v199
    v_mfma_f32_16x16x32_bf16 v[200:203], v[32:35], v[144:147], v[244:247]
    v_mfma_f32_16x16x32_bf16 v[200:203], v[36:39], v[148:151], v[200:203]
    v_mfma_f32_16x16x32_bf16 v[200:203], v[40:43], v[152:155], v[200:203]
    v_mfma_f32_16x16x32_bf16 v[200:203], v[44:47], v[156:159], v[200:203]
    v_mfma_f32_16x16x32_bf16 v[204:207], v[60:63], v[156:159], v[244:247]
    v_mfma_f32_16x16x32_bf16 v[204:207], v[56:59], v[152:155], v[204:207]
    v_mfma_f32_16x16x32_bf16 v[204:207], v[52:55], v[148:151], v[204:207]
    buffer_load_dwordx4 v6, s[8:11], s38 offen offset:0 nt lds
    v_mfma_f32_16x16x32_bf16 v[204:207], v[48:51], v[144:147], v[204:207]
    v_mfma_f32_16x16x32_bf16 a[64:67], v[64:67], v[232:235], a[64:67]
    ds_read_b64_tr_b16 v[64:65], v5 offset:8448
    ds_read_b64_tr_b16 v[66:67], v5 offset:8960
    v_mfma_f32_16x16x32_bf16 a[68:71], v[68:71], v[232:235], a[68:71]
    ds_read_b64_tr_b16 v[68:69], v5 offset:8480
    ds_read_b64_tr_b16 v[70:71], v5 offset:8992
    v_mfma_f32_16x16x32_bf16 a[72:75], v[72:75], v[232:235], a[72:75]
    ds_read_b64_tr_b16 v[72:73], v5 offset:8512
    ds_read_b64_tr_b16 v[74:75], v5 offset:9024
    v_mfma_f32_16x16x32_bf16 a[76:79], v[76:79], v[232:235], a[76:79]
    ds_read_b64_tr_b16 v[76:77], v5 offset:8544
    ds_read_b64_tr_b16 v[78:79], v5 offset:9056
    v_mfma_f32_16x16x32_bf16 a[80:83], v[80:83], v[232:235], a[80:83]
    ds_read_b64_tr_b16 v[80:81], v5 offset:8576
    ds_read_b64_tr_b16 v[82:83], v5 offset:9088
    v_mfma_f32_16x16x32_bf16 a[84:87], v[84:87], v[232:235], a[84:87]
    ds_read_b64_tr_b16 v[84:85], v5 offset:8608
    ds_read_b64_tr_b16 v[86:87], v5 offset:9120
    v_mfma_f32_16x16x32_bf16 a[88:91], v[88:91], v[232:235], a[88:91]
    ds_read_b64_tr_b16 v[88:89], v5 offset:8640
    ds_read_b64_tr_b16 v[90:91], v5 offset:9152
    v_mfma_f32_16x16x32_bf16 a[92:95], v[92:95], v[232:235], a[92:95]
    buffer_load_dwordx4 v7, s[8:11], s38 offen offset:1056 nt lds
    v_mfma_f32_16x16x32_bf16 v[108:111], v[96:99], v[232:235], v[108:111]
    ds_read_b64_tr_b16 v[92:93], v5 offset:8672
    ds_read_b64_tr_b16 v[94:95], v5 offset:9184
    v_mfma_f32_16x16x32_bf16 v[208:211], v[32:35], v[160:163], v[248:251]
    ds_read_b64_tr_b16 v[32:33], v21 offset:8448
    ds_read_b64_tr_b16 v[34:35], v21 offset:8960
    v_mfma_f32_16x16x32_bf16 v[208:211], v[36:39], v[164:167], v[208:211]
    ds_read_b64_tr_b16 v[36:37], v21 offset:8480
    ds_read_b64_tr_b16 v[38:39], v21 offset:8992
    v_mfma_f32_16x16x32_bf16 v[208:211], v[40:43], v[168:171], v[208:211]
    ds_read_b64_tr_b16 v[40:41], v21 offset:8512
    ds_read_b64_tr_b16 v[42:43], v21 offset:9024
    v_mfma_f32_16x16x32_bf16 v[208:211], v[44:47], v[172:175], v[208:211]
    ds_read_b64_tr_b16 v[44:45], v21 offset:8544
    ds_read_b64_tr_b16 v[46:47], v21 offset:9056
    v_mfma_f32_16x16x32_bf16 v[212:215], v[60:63], v[172:175], v[248:251]
    ds_read_b64_tr_b16 v[60:61], v21 offset:8672
    ds_read_b64_tr_b16 v[62:63], v21 offset:9184
    v_mfma_f32_16x16x32_bf16 v[212:215], v[56:59], v[168:171], v[212:215]
    ds_read_b64_tr_b16 v[56:57], v21 offset:8640
    ds_read_b64_tr_b16 v[58:59], v21 offset:9152
    v_mfma_f32_16x16x32_bf16 v[212:215], v[52:55], v[164:167], v[212:215]
    buffer_load_dwordx4 v8, s[8:11], s38 offen offset:2112 nt lds
    v_mfma_f32_16x16x32_bf16 v[212:215], v[48:51], v[160:163], v[212:215]
    s_waitcnt lgkmcnt(15)
    ds_read_b64_tr_b16 v[52:53], v21 offset:8608
    ds_read_b64_tr_b16 v[54:55], v21 offset:9120
    v_mfma_f32_16x16x32_bf16 a[0:3], v[64:67], v[224:227], a[0:3]
    ds_read_b64_tr_b16 v[48:49], v21 offset:8576
    ds_read_b64_tr_b16 v[50:51], v21 offset:9088
    v_mfma_f32_16x16x32_bf16 a[4:7], v[68:71], v[224:227], a[4:7]
    v_exp_f32 v200, v200
    v_mfma_f32_16x16x32_bf16 a[8:11], v[72:75], v[224:227], a[8:11]
    v_exp_f32 v201, v201
    v_mfma_f32_16x16x32_bf16 a[12:15], v[76:79], v[224:227], a[12:15]
    v_exp_f32 v202, v202
    v_mfma_f32_16x16x32_bf16 a[16:19], v[80:83], v[224:227], a[16:19]
    v_exp_f32 v203, v203
    v_mfma_f32_16x16x32_bf16 a[20:23], v[84:87], v[224:227], a[20:23]
    s_waitcnt lgkmcnt(15)
    v_exp_f32 v204, v204
    v_mfma_f32_16x16x32_bf16 a[24:27], v[88:91], v[224:227], a[24:27]
    buffer_load_dwordx4 v9, s[8:11], s38 offen offset:3168 nt lds
    v_mfma_f32_16x16x32_bf16 a[28:31], v[92:95], v[224:227], a[28:31]
    s_mov_b32 m0, s33
    v_exp_f32 v205, v205
    v_mfma_f32_16x16x32_bf16 v[100:103], v[96:99], v[224:227], v[100:103]
    s_waitcnt lgkmcnt(14)
    v_exp_f32 v206, v206
    v_mfma_f32_16x16x32_bf16 a[128:131], v[32:35], v[116:119], a[128:131]
    v_exp_f32 v207, v207
    v_mfma_f32_16x16x32_bf16 a[160:163], v[32:35], v[124:127], a[160:163]
    v_cvt_pk_bf16_f32 v228, v200, v201
    v_cvt_pk_bf16_f32 v229, v202, v203
    v_mfma_f32_16x16x32_bf16 a[192:195], v[32:35], v[28:31], a[192:195]
    s_waitcnt lgkmcnt(12)
    ds_read_b128 v[32:35], v4 offset:0
    v_cvt_pk_bf16_f32 v230, v204, v205
    v_mfma_f32_16x16x32_bf16 a[132:135], v[36:39], v[116:119], a[132:135]
    v_cvt_pk_bf16_f32 v231, v206, v207
    v_mfma_f32_16x16x32_bf16 a[164:167], v[36:39], v[124:127], a[164:167]
    v_exp_f32 v208, v208
    v_mfma_f32_16x16x32_bf16 a[196:199], v[36:39], v[28:31], a[196:199]
    s_waitcnt lgkmcnt(11)
    buffer_load_dwordx4 v14, s[12:15], s40 offen offset:0 lds
    v_mfma_f32_16x16x32_bf16 a[136:139], v[40:43], v[116:119], a[136:139]
    ds_read_b128 v[36:39], v4 offset:64
    v_mfma_f32_16x16x32_bf16 a[168:171], v[40:43], v[124:127], a[168:171]
    v_exp_f32 v209, v209
    v_mfma_f32_16x16x32_bf16 a[200:203], v[40:43], v[28:31], a[200:203]
    s_waitcnt lgkmcnt(10)
    ds_read_b128 v[40:43], v4 offset:128
    v_mfma_f32_16x16x32_bf16 a[140:143], v[44:47], v[116:119], a[140:143]
    v_mfma_f32_16x16x32_bf16 a[172:175], v[44:47], v[124:127], a[172:175]
    v_mfma_f32_16x16x32_bf16 a[204:207], v[44:47], v[28:31], a[204:207]
    s_waitcnt lgkmcnt(9)
    ds_read_b128 v[44:47], v4 offset:192
    v_mfma_f32_16x16x32_bf16 a[156:159], v[60:63], v[116:119], a[156:159]
    v_mfma_f32_16x16x32_bf16 a[188:191], v[60:63], v[124:127], a[188:191]
    buffer_load_dwordx4 v15, s[12:15], s40 offen offset:1024 lds
    v_mfma_f32_16x16x32_bf16 a[220:223], v[60:63], v[28:31], a[220:223]
    s_waitcnt lgkmcnt(8)
    ds_read_b128 v[60:63], v4 offset:704
    v_mfma_f32_16x16x32_bf16 a[152:155], v[56:59], v[116:119], a[152:155]
    v_mfma_f32_16x16x32_bf16 a[184:187], v[56:59], v[124:127], a[184:187]
    v_mfma_f32_16x16x32_bf16 a[216:219], v[56:59], v[28:31], a[216:219]
    s_waitcnt lgkmcnt(7)
    ds_read_b128 v[56:59], v4 offset:640
    v_mfma_f32_16x16x32_bf16 a[148:151], v[52:55], v[116:119], a[148:151]
    v_mfma_f32_16x16x32_bf16 a[180:183], v[52:55], v[124:127], a[180:183]
    v_mfma_f32_16x16x32_bf16 a[212:215], v[52:55], v[28:31], a[212:215]
    s_waitcnt lgkmcnt(6)
    ds_read_b128 v[52:55], v4 offset:576
    v_mfma_f32_16x16x32_bf16 a[144:147], v[48:51], v[116:119], a[144:147]
    buffer_load_dwordx4 v16, s[12:15], s40 offen offset:2048 lds
    v_mfma_f32_16x16x32_bf16 a[176:179], v[48:51], v[124:127], a[176:179]
    v_mfma_f32_16x16x32_bf16 a[208:211], v[48:51], v[28:31], a[208:211]
    ds_read_b128 v[48:51], v4 offset:512
    buffer_load_dwordx4 v17, s[12:15], s40 offen offset:3072 lds
    s_waitcnt lgkmcnt(0)
    s_cbranch_scc1 L1v3_wloop
    s_mov_b32 s14, s95
    v_add_u32 v18, s69, v20
    v_add_u32 v19, s69, v20
    s_mov_b32 s44, 0
    s_mov_b32 s95, 0
    s_mov_b32 s96, 0
    s_mov_b32 s97, 0
.p2align 6
L1v3_aloop:
    v_mfma_f32_16x16x32_bf16 v[192:195], v[32:35], v[128:131], v[240:243]
    s_set_gpr_idx_on s96, gpr_idx(SRC0)
    v_accvgpr_read_b32 v116, a128
    v_accvgpr_read_b32 v117, a129
    v_accvgpr_read_b32 v118, a130
    v_accvgpr_read_b32 v119, a131
    s_set_gpr_idx_off
    v_mfma_f32_16x16x32_bf16 v[192:195], v[36:39], v[132:135], v[192:195]
    s_set_gpr_idx_on s96, gpr_idx(SRC0)
    v_accvgpr_read_b32 v124, a132
    v_accvgpr_read_b32 v125, a133
    v_accvgpr_read_b32 v126, a134
    v_accvgpr_read_b32 v127, a135
    s_set_gpr_idx_off
    v_mfma_f32_16x16x32_bf16 v[192:195], v[40:43], v[136:139], v[192:195]
    s_set_gpr_idx_on s96, gpr_idx(SRC0)
    v_accvgpr_read_b32 v28, a136
    v_accvgpr_read_b32 v29, a137
    v_accvgpr_read_b32 v30, a138
    v_accvgpr_read_b32 v31, a139
    s_set_gpr_idx_off
    v_mfma_f32_16x16x32_bf16 v[192:195], v[44:47], v[140:143], v[192:195]
    s_waitcnt vmcnt(12) lgkmcnt(0)
    s_barrier
    v_mfma_f32_16x16x32_bf16 v[196:199], v[60:63], v[140:143], v[240:243]
    s_add_u32 s94, s32, s34
    s_mov_b32 m0, s94
    s_max_i32 s39, s35, 0
    v_mfma_f32_16x16x32_bf16 v[196:199], v[56:59], v[136:139], v[196:199]
    s_min_i32 s38, s39, 524288
    buffer_load_dwordx4 v6, s[8:11], s38 offen offset:0 nt lds
    v_mfma_f32_16x16x32_bf16 v[196:199], v[52:55], v[132:135], v[196:199]
    s_add_u32 s32, s32, 16896
    v_exp_f32 v210, v210
    v_mfma_f32_16x16x32_bf16 v[196:199], v[48:51], v[128:131], v[196:199]
    s_cmp_ge_u32 s32, 84480
    s_cselect_b32 s32, 0, s32
    v_cvt_pk_bf16_f32 v232, v208, v209
    v_mfma_f32_16x16x32_bf16 a[32:35], v[64:67], v[228:231], a[32:35]
    s_add_u32 s95, s95, 3
    v_exp_f32 v211, v211
    v_mfma_f32_16x16x32_bf16 a[36:39], v[68:71], v[228:231], a[36:39]
    s_min_u32 s98, s95, 21
    v_exp_f32 v212, v212
    v_mfma_f32_16x16x32_bf16 a[40:43], v[72:75], v[228:231], a[40:43]
    s_lshl_b32 s96, s98, 2
    v_exp_f32 v213, v213
    v_mfma_f32_16x16x32_bf16 a[44:47], v[76:79], v[228:231], a[44:47]
    s_add_i32 s35, s35, 8192
    v_exp_f32 v214, v214
    v_mfma_f32_16x16x32_bf16 a[48:51], v[80:83], v[228:231], a[48:51]
    s_add_u32 s44, s44, 1
    v_exp_f32 v215, v215
    v_mfma_f32_16x16x32_bf16 a[52:55], v[84:87], v[228:231], a[52:55]
    v_cvt_pk_bf16_f32 v233, v210, v211
    v_cvt_pk_bf16_f32 v234, v212, v213
    v_mfma_f32_16x16x32_bf16 a[56:59], v[88:91], v[228:231], a[56:59]
    v_cvt_pk_bf16_f32 v235, v214, v215
    v_add_u32 v5, s32, v3
    v_mfma_f32_16x16x32_bf16 a[60:63], v[92:95], v[228:231], a[60:63]
    v_add_u32 v4, s32, v2
    v_mul_f32 v116, s46, v116
    v_mfma_f32_16x16x32_bf16 v[104:107], v[96:99], v[228:231], v[104:107]
    v_exp_f32 v192, v192
    v_mfma_f32_16x16x32_bf16 v[200:203], v[32:35], v[144:147], v[244:247]
    v_exp_f32 v193, v193
    v_mfma_f32_16x16x32_bf16 v[200:203], v[36:39], v[148:151], v[200:203]
    buffer_load_dwordx4 v7, s[8:11], s38 offen offset:1056 nt lds
    v_mfma_f32_16x16x32_bf16 v[200:203], v[40:43], v[152:155], v[200:203]
    v_exp_f32 v194, v194
    v_mfma_f32_16x16x32_bf16 v[200:203], v[44:47], v[156:159], v[200:203]
    v_exp_f32 v195, v195
    v_mfma_f32_16x16x32_bf16 v[204:207], v[60:63], v[156:159], v[244:247]
    v_exp_f32 v196, v196
    v_mfma_f32_16x16x32_bf16 v[204:207], v[56:59], v[152:155], v[204:207]
    v_exp_f32 v197, v197
    v_mfma_f32_16x16x32_bf16 v[204:207], v[52:55], v[148:151], v[204:207]
    v_exp_f32 v198, v198
    v_mfma_f32_16x16x32_bf16 v[204:207], v[48:51], v[144:147], v[204:207]
    v_exp_f32 v199, v199
    v_mfma_f32_16x16x32_bf16 a[64:67], v[64:67], v[232:235], a[64:67]
    ds_read_b64_tr_b16 v[64:65], v5 offset:8448
    ds_read_b64_tr_b16 v[66:67], v5 offset:8960
    v_mfma_f32_16x16x32_bf16 a[68:71], v[68:71], v[232:235], a[68:71]
    ds_read_b64_tr_b16 v[68:69], v5 offset:8480
    ds_read_b64_tr_b16 v[70:71], v5 offset:8992
    v_mfma_f32_16x16x32_bf16 a[72:75], v[72:75], v[232:235], a[72:75]
    ds_read_b64_tr_b16 v[72:73], v5 offset:8512
    ds_read_b64_tr_b16 v[74:75], v5 offset:9024
    v_mfma_f32_16x16x32_bf16 a[76:79], v[76:79], v[232:235], a[76:79]
    ds_read_b64_tr_b16 v[76:77], v5 offset:8544
    ds_read_b64_tr_b16 v[78:79], v5 offset:9056
    v_mfma_f32_16x16x32_bf16 a[80:83], v[80:83], v[232:235], a[80:83]
    ds_read_b64_tr_b16 v[80:81], v5 offset:8576
    ds_read_b64_tr_b16 v[82:83], v5 offset:9088
    v_mfma_f32_16x16x32_bf16 a[84:87], v[84:87], v[232:235], a[84:87]
    ds_read_b64_tr_b16 v[84:85], v5 offset:8608
    ds_read_b64_tr_b16 v[86:87], v5 offset:9120
    v_mfma_f32_16x16x32_bf16 a[88:91], v[88:91], v[232:235], a[88:91]
    buffer_load_dwordx4 v8, s[8:11], s38 offen offset:2112 nt lds
    v_mfma_f32_16x16x32_bf16 a[92:95], v[92:95], v[232:235], a[92:95]
    ds_read_b64_tr_b16 v[88:89], v5 offset:8640
    ds_read_b64_tr_b16 v[90:91], v5 offset:9152
    v_mfma_f32_16x16x32_bf16 v[108:111], v[96:99], v[232:235], v[108:111]
    ds_read_b64_tr_b16 v[92:93], v5 offset:8672
    ds_read_b64_tr_b16 v[94:95], v5 offset:9184
    v_mfma_f32_16x16x32_bf16 v[208:211], v[32:35], v[160:163], v[248:251]
    ds_read_b128 v[32:35], v4 offset:0
    v_cvt_pk_bf16_f32 v224, v192, v193
    v_mfma_f32_16x16x32_bf16 v[208:211], v[36:39], v[164:167], v[208:211]
    ds_read_b128 v[36:39], v4 offset:64
    v_cvt_pk_bf16_f32 v225, v194, v195
    v_mfma_f32_16x16x32_bf16 v[208:211], v[40:43], v[168:171], v[208:211]
    ds_read_b128 v[40:43], v4 offset:128
    v_cvt_pk_bf16_f32 v226, v196, v197
    v_mfma_f32_16x16x32_bf16 v[208:211], v[44:47], v[172:175], v[208:211]
    ds_read_b128 v[44:47], v4 offset:192
    v_cvt_pk_bf16_f32 v227, v198, v199
    v_mfma_f32_16x16x32_bf16 v[212:215], v[60:63], v[172:175], v[248:251]
    ds_read_b128 v[60:63], v4 offset:704
    v_mul_f32 v117, s46, v117
    v_mfma_f32_16x16x32_bf16 v[212:215], v[56:59], v[168:171], v[212:215]
    ds_read_b128 v[56:59], v4 offset:640
    v_mul_f32 v118, s46, v118
    v_mfma_f32_16x16x32_bf16 v[212:215], v[52:55], v[164:167], v[212:215]
    ds_read_b128 v[52:55], v4 offset:576
    v_mul_f32 v119, s46, v119
    v_mfma_f32_16x16x32_bf16 v[212:215], v[48:51], v[160:163], v[212:215]
    s_waitcnt lgkmcnt(15)
    ds_read_b128 v[48:51], v4 offset:512
    v_mul_f32 v124, s46, v124
    v_mfma_f32_16x16x32_bf16 a[0:3], v[64:67], v[224:227], a[0:3]
    v_mul_f32 v125, s46, v125
    v_mul_f32 v126, s46, v126
    v_mfma_f32_16x16x32_bf16 a[4:7], v[68:71], v[224:227], a[4:7]
    v_mul_f32 v127, s46, v127
    v_mul_f32 v28, s46, v28
    v_mfma_f32_16x16x32_bf16 a[8:11], v[72:75], v[224:227], a[8:11]
    buffer_load_dwordx4 v9, s[8:11], s38 offen offset:3168 nt lds
    v_mfma_f32_16x16x32_bf16 a[12:15], v[76:79], v[224:227], a[12:15]
    s_waitcnt lgkmcnt(14)
    v_mul_f32 v29, s46, v29
    v_mul_f32 v30, s46, v30
    v_mfma_f32_16x16x32_bf16 a[16:19], v[80:83], v[224:227], a[16:19]
    s_waitcnt lgkmcnt(12)
    v_mul_f32 v31, s46, v31
    v_add_u32 v122, s97, v123
    v_mfma_f32_16x16x32_bf16 a[20:23], v[84:87], v[224:227], a[20:23]
    s_waitcnt lgkmcnt(10)
    s_lshl_b32 s97, s98, 9
    v_exp_f32 v200, v200
    v_mfma_f32_16x16x32_bf16 a[24:27], v[88:91], v[224:227], a[24:27]
    s_waitcnt lgkmcnt(8)
    s_cmp_lt_u32 s44, 12
    v_exp_f32 v201, v201
    v_mfma_f32_16x16x32_bf16 a[28:31], v[92:95], v[224:227], a[28:31]
    v_exp_f32 v202, v202
    v_mfma_f32_16x16x32_bf16 v[100:103], v[96:99], v[224:227], v[100:103]
    v_exp_f32 v203, v203
    v_exp_f32 v204, v204
    v_exp_f32 v205, v205
    v_exp_f32 v206, v206
    v_exp_f32 v207, v207
    v_cvt_pk_bf16_f32 v10, v116, v117
    v_cvt_pk_bf16_f32 v11, v118, v119
    v_cvt_pk_bf16_f32 v12, v124, v125
    ds_write_b64 v122, v[10:11] offset:0
    v_cvt_pk_bf16_f32 v13, v126, v127
    v_cvt_pk_bf16_f32 v14, v28, v29
    ds_write_b64 v122, v[12:13] offset:512
    v_cvt_pk_bf16_f32 v15, v30, v31
    v_cvt_pk_bf16_f32 v228, v200, v201
    ds_write_b64 v122, v[14:15] offset:1024
    v_cvt_pk_bf16_f32 v229, v202, v203
    v_cvt_pk_bf16_f32 v230, v204, v205
    v_exp_f32 v208, v208
    v_cvt_pk_bf16_f32 v231, v206, v207
    v_exp_f32 v209, v209
    s_waitcnt lgkmcnt(0)
    s_cbranch_scc1 L1v3_aloop
    v_mfma_f32_16x16x32_bf16 a[32:35], v[64:67], v[228:231], a[32:35]
    s_add_u32 s94, s32, s34
    ds_read_b128 v[128:131], v18 offset:0
    ds_read_b128 v[132:135], v18 offset:1024
    v_mfma_f32_16x16x32_bf16 a[36:39], v[68:71], v[228:231], a[36:39]
    s_add_u32 s32, s32, 16896
    ds_read_b128 v[136:139], v18 offset:2048
    ds_read_b128 v[140:143], v18 offset:3072
    v_mfma_f32_16x16x32_bf16 a[40:43], v[72:75], v[228:231], a[40:43]
    s_cmp_ge_u32 s32, 84480
    s_cselect_b32 s32, 0, s32
    ds_read_b128 v[144:147], v18 offset:4096
    v_mfma_f32_16x16x32_bf16 a[44:47], v[76:79], v[228:231], a[44:47]
    s_mov_b32 m0, s94
    ds_read_b128 v[148:151], v18 offset:5120
    ds_read_b128 v[152:155], v18 offset:6144
    v_mfma_f32_16x16x32_bf16 a[48:51], v[80:83], v[228:231], a[48:51]
    s_max_i32 s39, s35, 0
    ds_read_b128 v[156:159], v18 offset:7168
    ds_read_b128 v[160:163], v18 offset:8192
    v_mfma_f32_16x16x32_bf16 a[52:55], v[84:87], v[228:231], a[52:55]
    s_min_i32 s38, s39, 524288
    ds_read_b128 v[164:167], v18 offset:9216
    ds_read_b128 v[168:171], v18 offset:10240
    v_mfma_f32_16x16x32_bf16 a[56:59], v[88:91], v[228:231], a[56:59]
    s_add_i32 s35, s35, 8192
    ds_read_b128 v[172:175], v18 offset:11264
    v_cvt_pk_bf16_f32 v232, v208, v209
    v_mfma_f32_16x16x32_bf16 a[60:63], v[92:95], v[228:231], a[60:63]
    s_max_i32 s39, s35, 0
    v_exp_f32 v210, v210
    v_mfma_f32_16x16x32_bf16 v[104:107], v[96:99], v[228:231], v[104:107]
    s_add_u32 s94, s32, s34
    v_exp_f32 v211, v211
    v_exp_f32 v212, v212
    v_exp_f32 v213, v213
    v_exp_f32 v214, v214
    v_exp_f32 v215, v215
    v_cvt_pk_bf16_f32 v233, v210, v211
    v_cvt_pk_bf16_f32 v234, v212, v213
    v_cvt_pk_bf16_f32 v235, v214, v215
    v_mov_b32 v23, 0
    v_add_u32 v5, s32, v3
    v_mfma_f32_16x16x32_bf16 a[64:67], v[64:67], v[232:235], a[64:67]
    s_add_i32 s35, s35, 8192
    buffer_load_dword v0, v23, s[64:67], 0 offen
    v_mfma_f32_16x16x32_bf16 a[68:71], v[68:71], v[232:235], a[68:71]
    s_waitcnt vmcnt(13) lgkmcnt(0)
    s_barrier
    v_mfma_f32_16x16x32_bf16 a[72:75], v[72:75], v[232:235], a[72:75]
    ds_read_b64_tr_b16 v[64:65], v5 offset:8448
    ds_read_b64_tr_b16 v[66:67], v5 offset:8960
    v_mfma_f32_16x16x32_bf16 a[76:79], v[76:79], v[232:235], a[76:79]
    ds_read_b64_tr_b16 v[68:69], v5 offset:8480
    ds_read_b64_tr_b16 v[70:71], v5 offset:8992
    v_mfma_f32_16x16x32_bf16 a[80:83], v[80:83], v[232:235], a[80:83]
    ds_read_b64_tr_b16 v[72:73], v5 offset:8512
    ds_read_b64_tr_b16 v[74:75], v5 offset:9024
    v_mfma_f32_16x16x32_bf16 a[84:87], v[84:87], v[232:235], a[84:87]
    ds_read_b64_tr_b16 v[76:77], v5 offset:8544
    ds_read_b64_tr_b16 v[78:79], v5 offset:9056
    v_mfma_f32_16x16x32_bf16 a[88:91], v[88:91], v[232:235], a[88:91]
    ds_read_b64_tr_b16 v[80:81], v5 offset:8576
    ds_read_b64_tr_b16 v[82:83], v5 offset:9088
    v_mfma_f32_16x16x32_bf16 a[92:95], v[92:95], v[232:235], a[92:95]
    ds_read_b64_tr_b16 v[84:85], v5 offset:8608
    ds_read_b64_tr_b16 v[86:87], v5 offset:9120
    v_mfma_f32_16x16x32_bf16 v[108:111], v[96:99], v[232:235], v[108:111]
    ds_read_b64_tr_b16 v[88:89], v5 offset:8640
    ds_read_b64_tr_b16 v[90:91], v5 offset:9152
    v_mfma_f32_16x16x32_bf16 v[192:195], v[32:35], v[128:131], 0
    ds_read_b64_tr_b16 v[92:93], v5 offset:8672
    ds_read_b64_tr_b16 v[94:95], v5 offset:9184
    v_mfma_f32_16x16x32_bf16 v[192:195], v[36:39], v[132:135], v[192:195]
    buffer_load_dwordx4 v6, s[8:11], s38 offen offset:0 nt lds
    v_mfma_f32_16x16x32_bf16 v[192:195], v[40:43], v[136:139], v[192:195]
    v_add_u32 v4, s32, v2
    v_cmp_nlt_f32 s[52:53], v100, s47
    v_mfma_f32_16x16x32_bf16 v[192:195], v[44:47], v[140:143], v[192:195]
    s_add_u32 s32, s32, 16896
    v_rcp_f32 v24, v100
    v_mfma_f32_16x16x32_bf16 v[196:199], v[60:63], v[140:143], 0
    s_cmp_ge_u32 s32, 101376
    s_cselect_b32 s32, 0, s32
    v_cmp_nlt_f32 s[54:55], v104, s47
    v_mfma_f32_16x16x32_bf16 v[196:199], v[56:59], v[136:139], v[196:199]
    buffer_load_dwordx4 v7, s[8:11], s38 offen offset:1056 nt lds
    v_mfma_f32_16x16x32_bf16 v[196:199], v[52:55], v[132:135], v[196:199]
    s_nop 0
    s_or_b64 s[52:53], s[52:53], s[54:55]
    v_max3_f32 v240, v192, v193, v194
    v_cmp_nlt_f32 s[56:57], v108, s47
    v_mfma_f32_16x16x32_bf16 v[196:199], v[48:51], v[128:131], v[196:199]
    v_rcp_f32 v25, v104
    v_mfma_f32_16x16x32_bf16 v[200:203], v[32:35], v[144:147], 0
    s_nop 0
    s_or_b64 s[52:53], s[52:53], s[56:57]
    s_cselect_b32 s54, 1, 0
    v_add_u32 v5, s32, v3
    v_mfma_f32_16x16x32_bf16 v[200:203], v[36:39], v[148:151], v[200:203]
    s_lshl_b32 s57, s3, 2
    buffer_load_dwordx4 v8, s[8:11], s38 offen offset:2112 nt lds
    v_mfma_f32_16x16x32_bf16 v[200:203], v[40:43], v[152:155], v[200:203]
    s_or_b32 s99, s99, s54
    v_max3_f32 v241, v195, v196, v197
    v_max3_f32 v240, v240, v198, v199
    v_mfma_f32_16x16x32_bf16 v[200:203], v[44:47], v[156:159], v[200:203]
    s_add_u32 s57, s57, 162816
    v_max_f32 v240, v240, v241
    v_mov_b32 v21, s57
    v_mfma_f32_16x16x32_bf16 v[204:207], v[60:63], v[156:159], 0
    v_mov_b32 v241, v240
    v_mov_b32 v22, s99
    v_mfma_f32_16x16x32_bf16 v[204:207], v[56:59], v[152:155], v[204:207]
    buffer_load_dwordx4 v9, s[8:11], s38 offen offset:3168 nt lds
    v_mfma_f32_16x16x32_bf16 v[204:207], v[52:55], v[148:151], v[204:207]
    s_add_u32 m0, s34, 84480
    ds_write_b32 v21, v22
    v_mfma_f32_16x16x32_bf16 v[204:207], v[48:51], v[144:147], v[204:207]
    s_min_i32 s38, s39, 524288
    v_permlane32_swap_b32 v240, v241
    v_max3_f32 v244, v200, v201, v202
    v_mfma_f32_16x16x32_bf16 v[208:211], v[32:35], v[160:163], 0
    s_max_i32 s39, s35, 0
    ds_read_b128 v[32:35], v4 offset:0
    v_max_f32 v240, v240, v241
    v_mfma_f32_16x16x32_bf16 v[208:211], v[36:39], v[164:167], v[208:211]
    s_add_i32 s35, s35, 8192
    ds_read_b128 v[36:39], v4 offset:64
    v_mov_b32 v241, v240
    v_mfma_f32_16x16x32_bf16 v[208:211], v[40:43], v[168:171], v[208:211]
    ds_read_b128 v[40:43], v4 offset:128
    v_permlane16_swap_b32 v240, v241
    v_mfma_f32_16x16x32_bf16 v[208:211], v[44:47], v[172:175], v[208:211]
    ds_read_b128 v[44:47], v4 offset:192
    v_max_f32 v240, v240, v241
    v_mfma_f32_16x16x32_bf16 v[212:215], v[60:63], v[172:175], 0
    ds_read_b128 v[60:63], v4 offset:704
    v_sub_f32 v192, v192, v240
    v_mfma_f32_16x16x32_bf16 v[212:215], v[56:59], v[168:171], v[212:215]
    ds_read_b128 v[56:59], v4 offset:640
    v_sub_f32 v193, v193, v240
    v_mfma_f32_16x16x32_bf16 v[212:215], v[52:55], v[164:167], v[212:215]
    ds_read_b128 v[52:55], v4 offset:576
    v_sub_f32 v194, v194, v240
    v_mfma_f32_16x16x32_bf16 v[212:215], v[48:51], v[160:163], v[212:215]
    s_waitcnt lgkmcnt(15)
    ds_read_b128 v[48:51], v4 offset:512
    buffer_load_dwordx4 v6, s[8:11], s38 offen offset:0 nt lds
    v_sub_f32 v195, v195, v240
    v_sub_f32 v196, v196, v240
    v_sub_f32 v197, v197, v240
    v_sub_f32 v198, v198, v240
    v_sub_f32 v199, v199, v240
    v_exp_f32 v192, v192
    v_exp_f32 v193, v193
    v_exp_f32 v194, v194
    v_exp_f32 v195, v195
    buffer_load_dwordx4 v7, s[8:11], s38 offen offset:1056 nt lds
    v_exp_f32 v196, v196
    v_exp_f32 v197, v197
    v_exp_f32 v198, v198
    v_exp_f32 v199, v199
    v_cvt_pk_bf16_f32 v224, v192, v193
    v_cvt_pk_bf16_f32 v225, v194, v195
    v_cvt_pk_bf16_f32 v226, v196, v197
    v_cvt_pk_bf16_f32 v227, v198, v199
    v_sub_f32 v241, 0, v240
    v_sub_f32 v242, 0, v240
    v_mfma_f32_16x16x32_bf16 a[128:131], v[64:67], v[224:227], 0
    buffer_load_dwordx4 v8, s[8:11], s38 offen offset:2112 nt lds
    v_mfma_f32_16x16x32_bf16 a[132:135], v[68:71], v[224:227], 0
    v_sub_f32 v243, 0, v240
    v_sub_f32 v240, 0, v240
    v_mfma_f32_16x16x32_bf16 a[136:139], v[72:75], v[224:227], 0
    v_max3_f32 v245, v203, v204, v205
    v_max3_f32 v244, v244, v206, v207
    v_mfma_f32_16x16x32_bf16 a[140:143], v[76:79], v[224:227], 0
    s_waitcnt lgkmcnt(15)
    v_max_f32 v244, v244, v245
    v_max3_f32 v248, v208, v209, v210
    v_mfma_f32_16x16x32_bf16 a[144:147], v[80:83], v[224:227], 0
    s_waitcnt lgkmcnt(13)
    buffer_load_dwordx4 v9, s[8:11], s38 offen offset:3168 nt lds
    v_mfma_f32_16x16x32_bf16 a[148:151], v[84:87], v[224:227], 0
    s_waitcnt vmcnt(17) lgkmcnt(0)
    s_barrier
    v_mfma_f32_16x16x32_bf16 a[152:155], v[88:91], v[224:227], 0
    s_mov_b32 m0, s94
    v_mov_b32 v245, v244
    v_max3_f32 v249, v211, v212, v213
    v_mfma_f32_16x16x32_bf16 a[156:159], v[92:95], v[224:227], 0
    s_min_i32 s38, s39, 524288
    buffer_load_dwordx4 v6, s[8:11], s38 offen offset:0 nt lds
    v_mfma_f32_16x16x32_bf16 v[100:103], v[96:99], v[224:227], 0
    v_permlane32_swap_b32 v244, v245
    v_max3_f32 v248, v248, v214, v215
    v_mfma_f32_16x16x32_bf16 v[192:195], v[32:35], v[128:131], v[240:243]
    v_max_f32 v244, v244, v245
    v_max_f32 v248, v248, v249
    v_mfma_f32_16x16x32_bf16 v[192:195], v[36:39], v[132:135], v[192:195]
    v_mov_b32 v245, v244
    v_mov_b32 v249, v248
    v_mfma_f32_16x16x32_bf16 v[192:195], v[40:43], v[136:139], v[192:195]
    buffer_load_dwordx4 v7, s[8:11], s38 offen offset:1056 nt lds
    v_mfma_f32_16x16x32_bf16 v[192:195], v[44:47], v[140:143], v[192:195]
    v_permlane16_swap_b32 v244, v245
    v_permlane32_swap_b32 v248, v249
    v_mfma_f32_16x16x32_bf16 v[196:199], v[60:63], v[140:143], v[240:243]
    v_max_f32 v244, v244, v245
    v_max_f32 v248, v248, v249
    v_mfma_f32_16x16x32_bf16 v[196:199], v[56:59], v[136:139], v[196:199]
    v_sub_f32 v200, v200, v244
    v_sub_f32 v201, v201, v244
    v_mfma_f32_16x16x32_bf16 v[196:199], v[52:55], v[132:135], v[196:199]
    buffer_load_dwordx4 v8, s[8:11], s38 offen offset:2112 nt lds
    v_mfma_f32_16x16x32_bf16 v[196:199], v[48:51], v[128:131], v[196:199]
    v_sub_f32 v202, v202, v244
    v_sub_f32 v203, v203, v244
    v_sub_f32 v204, v204, v244
    v_sub_f32 v205, v205, v244
    v_sub_f32 v206, v206, v244
    v_sub_f32 v207, v207, v244
    v_exp_f32 v200, v200
    v_exp_f32 v201, v201
    buffer_load_dwordx4 v9, s[8:11], s38 offen offset:3168 nt lds
    v_exp_f32 v202, v202
    v_exp_f32 v203, v203
    v_exp_f32 v204, v204
    v_exp_f32 v205, v205
    v_exp_f32 v206, v206
    v_exp_f32 v207, v207
    v_cvt_pk_bf16_f32 v228, v200, v201
    v_cvt_pk_bf16_f32 v229, v202, v203
    v_cvt_pk_bf16_f32 v230, v204, v205
    v_cvt_pk_bf16_f32 v231, v206, v207
    v_sub_f32 v245, 0, v244
    v_sub_f32 v246, 0, v244
    v_mfma_f32_16x16x32_bf16 a[160:163], v[64:67], v[228:231], 0
    v_sub_f32 v247, 0, v244
    v_sub_f32 v244, 0, v244
    v_mfma_f32_16x16x32_bf16 a[164:167], v[68:71], v[228:231], 0
    v_mov_b32 v249, v248
    v_add_u32 v4, s32, v2
    v_mfma_f32_16x16x32_bf16 a[168:171], v[72:75], v[228:231], 0
    v_permlane16_swap_b32 v248, v249
    v_mfma_f32_16x16x32_bf16 a[172:175], v[76:79], v[228:231], 0
    v_max_f32 v248, v248, v249
    v_mfma_f32_16x16x32_bf16 a[176:179], v[80:83], v[228:231], 0
    v_sub_f32 v208, v208, v248
    v_sub_f32 v209, v209, v248
    v_mfma_f32_16x16x32_bf16 a[180:183], v[84:87], v[228:231], 0
    v_sub_f32 v210, v210, v248
    v_sub_f32 v211, v211, v248
    v_mfma_f32_16x16x32_bf16 a[184:187], v[88:91], v[228:231], 0
    v_sub_f32 v212, v212, v248
    v_sub_f32 v213, v213, v248
    v_mfma_f32_16x16x32_bf16 a[188:191], v[92:95], v[228:231], 0
    v_sub_f32 v214, v214, v248
    v_sub_f32 v215, v215, v248
    v_mfma_f32_16x16x32_bf16 v[104:107], v[96:99], v[228:231], 0
    v_exp_f32 v208, v208
    v_mfma_f32_16x16x32_bf16 v[200:203], v[32:35], v[144:147], v[244:247]
    v_exp_f32 v209, v209
    v_mfma_f32_16x16x32_bf16 v[200:203], v[36:39], v[148:151], v[200:203]
    v_exp_f32 v210, v210
    v_mfma_f32_16x16x32_bf16 v[200:203], v[40:43], v[152:155], v[200:203]
    v_exp_f32 v211, v211
    v_mfma_f32_16x16x32_bf16 v[200:203], v[44:47], v[156:159], v[200:203]
    v_exp_f32 v212, v212
    v_mfma_f32_16x16x32_bf16 v[204:207], v[60:63], v[156:159], v[244:247]
    v_exp_f32 v213, v213
    v_mfma_f32_16x16x32_bf16 v[204:207], v[56:59], v[152:155], v[204:207]
    v_exp_f32 v214, v214
    v_mfma_f32_16x16x32_bf16 v[204:207], v[52:55], v[148:151], v[204:207]
    v_exp_f32 v215, v215
    v_mfma_f32_16x16x32_bf16 v[204:207], v[48:51], v[144:147], v[204:207]
    v_cvt_pk_bf16_f32 v232, v208, v209
    v_cvt_pk_bf16_f32 v233, v210, v211
    v_cvt_pk_bf16_f32 v234, v212, v213
    v_cvt_pk_bf16_f32 v235, v214, v215
    v_rcp_f32 v26, v108
    s_nop 0
    v_mfma_f32_16x16x32_bf16 a[192:195], v[64:67], v[232:235], 0
    ds_read_b64_tr_b16 v[64:65], v5 offset:8448
    ds_read_b64_tr_b16 v[66:67], v5 offset:8960
    v_mfma_f32_16x16x32_bf16 a[196:199], v[68:71], v[232:235], 0
    ds_read_b64_tr_b16 v[68:69], v5 offset:8480
    ds_read_b64_tr_b16 v[70:71], v5 offset:8992
    v_mfma_f32_16x16x32_bf16 a[200:203], v[72:75], v[232:235], 0
    ds_read_b64_tr_b16 v[72:73], v5 offset:8512
    ds_read_b64_tr_b16 v[74:75], v5 offset:9024
    v_mfma_f32_16x16x32_bf16 a[204:207], v[76:79], v[232:235], 0
    ds_read_b64_tr_b16 v[76:77], v5 offset:8544
    ds_read_b64_tr_b16 v[78:79], v5 offset:9056
    v_mfma_f32_16x16x32_bf16 a[208:211], v[80:83], v[232:235], 0
    ds_read_b64_tr_b16 v[80:81], v5 offset:8576
    ds_read_b64_tr_b16 v[82:83], v5 offset:9088
    v_mfma_f32_16x16x32_bf16 a[212:215], v[84:87], v[232:235], 0
    ds_read_b64_tr_b16 v[84:85], v5 offset:8608
    ds_read_b64_tr_b16 v[86:87], v5 offset:9120
    v_mfma_f32_16x16x32_bf16 a[216:219], v[88:91], v[232:235], 0
    ds_read_b64_tr_b16 v[88:89], v5 offset:8640
    ds_read_b64_tr_b16 v[90:91], v5 offset:9152
    v_mfma_f32_16x16x32_bf16 a[220:223], v[92:95], v[232:235], 0
    ds_read_b64_tr_b16 v[92:93], v5 offset:8672
    ds_read_b64_tr_b16 v[94:95], v5 offset:9184
    v_mfma_f32_16x16x32_bf16 v[108:111], v[96:99], v[232:235], 0
    v_sub_f32 v249, 0, v248
    v_sub_f32 v250, 0, v248
    v_sub_f32 v251, 0, v248
    v_sub_f32 v248, 0, v248
    v_exp_f32 v192, v192
    s_nop 0
    v_mfma_f32_16x16x32_bf16 v[208:211], v[32:35], v[160:163], v[248:251]
    ds_read_b128 v[32:35], v4 offset:0
    v_mfma_f32_16x16x32_bf16 v[208:211], v[36:39], v[164:167], v[208:211]
    ds_read_b128 v[36:39], v4 offset:64
    v_mfma_f32_16x16x32_bf16 v[208:211], v[40:43], v[168:171], v[208:211]
    ds_read_b128 v[40:43], v4 offset:128
    v_mfma_f32_16x16x32_bf16 v[208:211], v[44:47], v[172:175], v[208:211]
    ds_read_b128 v[44:47], v4 offset:192
    v_mfma_f32_16x16x32_bf16 v[212:215], v[60:63], v[172:175], v[248:251]
    ds_read_b128 v[60:63], v4 offset:704
    v_mfma_f32_16x16x32_bf16 v[212:215], v[56:59], v[168:171], v[212:215]
    ds_read_b128 v[56:59], v4 offset:640
    v_mfma_f32_16x16x32_bf16 v[212:215], v[52:55], v[164:167], v[212:215]
    ds_read_b128 v[52:55], v4 offset:576
    v_mfma_f32_16x16x32_bf16 v[212:215], v[48:51], v[160:163], v[212:215]
    s_waitcnt lgkmcnt(15)
    ds_read_b128 v[48:51], v4 offset:512
    v_exp_f32 v193, v193
    v_exp_f32 v194, v194
    v_exp_f32 v195, v195
    v_exp_f32 v196, v196
    v_exp_f32 v197, v197
    v_exp_f32 v198, v198
    v_exp_f32 v199, v199
    v_cvt_pk_bf16_f32 v224, v192, v193
    v_cvt_pk_bf16_f32 v225, v194, v195
    v_cvt_pk_bf16_f32 v226, v196, v197
    v_cvt_pk_bf16_f32 v227, v198, v199
    v_exp_f32 v200, v200
    s_nop 0
    v_mfma_f32_16x16x32_bf16 a[128:131], v[64:67], v[224:227], a[128:131]
    v_exp_f32 v201, v201
    v_mfma_f32_16x16x32_bf16 a[132:135], v[68:71], v[224:227], a[132:135]
    v_exp_f32 v202, v202
    v_mfma_f32_16x16x32_bf16 a[136:139], v[72:75], v[224:227], a[136:139]
    v_exp_f32 v203, v203
    v_mfma_f32_16x16x32_bf16 a[140:143], v[76:79], v[224:227], a[140:143]
    s_waitcnt lgkmcnt(14)
    v_exp_f32 v204, v204
    v_mfma_f32_16x16x32_bf16 a[144:147], v[80:83], v[224:227], a[144:147]
    s_waitcnt lgkmcnt(12)
    v_exp_f32 v205, v205
    v_mfma_f32_16x16x32_bf16 a[148:151], v[84:87], v[224:227], a[148:151]
    s_waitcnt lgkmcnt(10)
    v_exp_f32 v206, v206
    v_mfma_f32_16x16x32_bf16 a[152:155], v[88:91], v[224:227], a[152:155]
    s_waitcnt lgkmcnt(8)
    v_exp_f32 v207, v207
    v_mfma_f32_16x16x32_bf16 a[156:159], v[92:95], v[224:227], a[156:159]
    v_cvt_pk_bf16_f32 v228, v200, v201
    v_cvt_pk_bf16_f32 v229, v202, v203
    v_mfma_f32_16x16x32_bf16 v[100:103], v[96:99], v[224:227], v[100:103]
    v_cvt_pk_bf16_f32 v230, v204, v205
    v_exp_f32 v208, v208
    v_cvt_pk_bf16_f32 v231, v206, v207
    v_exp_f32 v209, v209
    s_mov_b32 s44, 0
    s_mov_b32 s95, 0
    s_mov_b32 s96, 0
    s_mov_b32 s97, 0
    s_waitcnt lgkmcnt(0)
.p2align 6
L1v3_bloop:
    v_mfma_f32_16x16x32_bf16 v[192:195], v[32:35], v[128:131], v[240:243]
    s_waitcnt vmcnt(16) lgkmcnt(0)
    v_exp_f32 v210, v210
    v_cvt_pk_bf16_f32 v232, v208, v209
    v_mfma_f32_16x16x32_bf16 v[192:195], v[36:39], v[132:135], v[192:195]
    s_barrier
    v_mfma_f32_16x16x32_bf16 v[192:195], v[40:43], v[136:139], v[192:195]
    s_add_u32 s94, s32, s34
    v_exp_f32 v211, v211
    v_mfma_f32_16x16x32_bf16 v[192:195], v[44:47], v[140:143], v[192:195]
    s_add_u32 s32, s32, 16896
    v_exp_f32 v212, v212
    v_cvt_pk_bf16_f32 v233, v210, v211
    v_mfma_f32_16x16x32_bf16 v[196:199], v[60:63], v[140:143], v[240:243]
    s_cmp_ge_u32 s32, 101376
    v_exp_f32 v213, v213
    v_mfma_f32_16x16x32_bf16 v[196:199], v[56:59], v[136:139], v[196:199]
    s_set_gpr_idx_on s96, gpr_idx(SRC0)
    v_accvgpr_read_b32 v116, a0
    v_accvgpr_read_b32 v117, a1
    s_set_gpr_idx_off
    v_cvt_pk_bf16_f32 v234, v212, v213
    v_mfma_f32_16x16x32_bf16 v[196:199], v[52:55], v[132:135], v[196:199]
    s_set_gpr_idx_on s96, gpr_idx(SRC0)
    v_accvgpr_read_b32 v118, a2
    v_accvgpr_read_b32 v119, a3
    s_set_gpr_idx_off
    v_mfma_f32_16x16x32_bf16 v[196:199], v[48:51], v[128:131], v[196:199]
    s_cselect_b32 s32, 0, s32
    v_exp_f32 v214, v214
    v_mfma_f32_16x16x32_bf16 a[160:163], v[64:67], v[228:231], a[160:163]
    s_mov_b32 m0, s94
    v_add_u32 v5, s32, v3
    v_add_u32 v4, s32, v2
    v_mfma_f32_16x16x32_bf16 a[164:167], v[68:71], v[228:231], a[164:167]
    s_max_i32 s39, s35, 0
    v_exp_f32 v215, v215
    v_mfma_f32_16x16x32_bf16 a[168:171], v[72:75], v[228:231], a[168:171]
    s_min_i32 s38, s39, 524288
    v_cvt_pk_bf16_f32 v235, v214, v215
    v_exp_f32 v192, v192
    v_mfma_f32_16x16x32_bf16 a[172:175], v[76:79], v[228:231], a[172:175]
    s_add_i32 s35, s35, 8192
    v_exp_f32 v193, v193
    v_mfma_f32_16x16x32_bf16 a[176:179], v[80:83], v[228:231], a[176:179]
    v_exp_f32 v194, v194
    v_mfma_f32_16x16x32_bf16 a[180:183], v[84:87], v[228:231], a[180:183]
    v_exp_f32 v195, v195
    v_mfma_f32_16x16x32_bf16 a[184:187], v[88:91], v[228:231], a[184:187]
    buffer_load_dwordx4 v6, s[8:11], s38 offen offset:0 nt lds
    v_mfma_f32_16x16x32_bf16 a[188:191], v[92:95], v[228:231], a[188:191]
    v_exp_f32 v196, v196
    v_mfma_f32_16x16x32_bf16 v[104:107], v[96:99], v[228:231], v[104:107]
    v_exp_f32 v197, v197
    v_mfma_f32_16x16x32_bf16 v[200:203], v[32:35], v[144:147], v[244:247]
    buffer_load_dwordx4 v7, s[8:11], s38 offen offset:1056 nt lds
    v_mfma_f32_16x16x32_bf16 v[200:203], v[36:39], v[148:151], v[200:203]
    v_exp_f32 v198, v198
    v_mfma_f32_16x16x32_bf16 v[200:203], v[40:43], v[152:155], v[200:203]
    v_exp_f32 v199, v199
    v_mfma_f32_16x16x32_bf16 v[200:203], v[44:47], v[156:159], v[200:203]
    buffer_load_dwordx4 v8, s[8:11], s38 offen offset:2112 nt lds
    v_mfma_f32_16x16x32_bf16 v[204:207], v[60:63], v[156:159], v[244:247]
    v_cvt_pk_bf16_f32 v224, v192, v193
    v_cvt_pk_bf16_f32 v225, v194, v195
    v_mfma_f32_16x16x32_bf16 v[204:207], v[56:59], v[152:155], v[204:207]
    v_cvt_pk_bf16_f32 v226, v196, v197
    v_cvt_pk_bf16_f32 v227, v198, v199
    v_mfma_f32_16x16x32_bf16 v[204:207], v[52:55], v[148:151], v[204:207]
    buffer_load_dwordx4 v9, s[8:11], s38 offen offset:3168 nt lds
    v_mfma_f32_16x16x32_bf16 v[204:207], v[48:51], v[144:147], v[204:207]
    v_add_u32 v122, s97, v18
    v_mul_f32 v116, v24, v116
    v_mfma_f32_16x16x32_bf16 a[192:195], v[64:67], v[232:235], a[192:195]
    ds_read_b64_tr_b16 v[64:65], v5 offset:8448
    ds_read_b64_tr_b16 v[66:67], v5 offset:8960
    v_mfma_f32_16x16x32_bf16 a[196:199], v[68:71], v[232:235], a[196:199]
    s_add_u32 s95, s95, 1
    ds_read_b64_tr_b16 v[68:69], v5 offset:8480
    ds_read_b64_tr_b16 v[70:71], v5 offset:8992
    v_mfma_f32_16x16x32_bf16 a[200:203], v[72:75], v[232:235], a[200:203]
    s_min_u32 s98, s95, 23
    ds_read_b64_tr_b16 v[72:73], v5 offset:8512
    ds_read_b64_tr_b16 v[74:75], v5 offset:9024
    v_mfma_f32_16x16x32_bf16 a[204:207], v[76:79], v[232:235], a[204:207]
    s_lshl_b32 s96, s98, 2
    ds_read_b64_tr_b16 v[76:77], v5 offset:8544
    ds_read_b64_tr_b16 v[78:79], v5 offset:9056
    v_mfma_f32_16x16x32_bf16 a[208:211], v[80:83], v[232:235], a[208:211]
    s_lshr_b32 s97, s98, 1
    ds_read_b64_tr_b16 v[80:81], v5 offset:8576
    ds_read_b64_tr_b16 v[82:83], v5 offset:9088
    v_mfma_f32_16x16x32_bf16 a[212:215], v[84:87], v[232:235], a[212:215]
    s_lshl_b32 s97, s97, 10
    ds_read_b64_tr_b16 v[84:85], v5 offset:8608
    ds_read_b64_tr_b16 v[86:87], v5 offset:9120
    v_mfma_f32_16x16x32_bf16 a[216:219], v[88:91], v[232:235], a[216:219]
    s_and_b32 s98, s98, 1
    ds_read_b64_tr_b16 v[88:89], v5 offset:8640
    ds_read_b64_tr_b16 v[90:91], v5 offset:9152
    v_mfma_f32_16x16x32_bf16 a[220:223], v[92:95], v[232:235], a[220:223]
    s_lshl_b32 s98, s98, 3
    ds_read_b64_tr_b16 v[92:93], v5 offset:8672
    ds_read_b64_tr_b16 v[94:95], v5 offset:9184
    v_mfma_f32_16x16x32_bf16 v[108:111], v[96:99], v[232:235], v[108:111]
    s_add_u32 s97, s97, s98
    v_exp_f32 v200, v200
    v_mfma_f32_16x16x32_bf16 v[208:211], v[32:35], v[160:163], v[248:251]
    ds_read_b128 v[32:35], v4 offset:0
    v_mul_f32 v117, v24, v117
    v_mfma_f32_16x16x32_bf16 v[208:211], v[36:39], v[164:167], v[208:211]
    ds_read_b128 v[36:39], v4 offset:64
    v_mul_f32 v118, v24, v118
    v_mfma_f32_16x16x32_bf16 v[208:211], v[40:43], v[168:171], v[208:211]
    ds_read_b128 v[40:43], v4 offset:128
    v_mul_f32 v119, v24, v119
    v_mfma_f32_16x16x32_bf16 v[208:211], v[44:47], v[172:175], v[208:211]
    ds_read_b128 v[44:47], v4 offset:192
    v_cvt_pk_bf16_f32 v120, v116, v117
    v_mfma_f32_16x16x32_bf16 v[212:215], v[60:63], v[172:175], v[248:251]
    ds_read_b128 v[60:63], v4 offset:704
    v_cvt_pk_bf16_f32 v121, v118, v119
    v_mfma_f32_16x16x32_bf16 v[212:215], v[56:59], v[168:171], v[212:215]
    ds_read_b128 v[56:59], v4 offset:640
    ds_write_b64 v122, v[120:121]
    v_mfma_f32_16x16x32_bf16 v[212:215], v[52:55], v[164:167], v[212:215]
    ds_read_b128 v[52:55], v4 offset:576
    v_mfma_f32_16x16x32_bf16 v[212:215], v[48:51], v[160:163], v[212:215]
    s_waitcnt lgkmcnt(15)
    ds_read_b128 v[48:51], v4 offset:512
    v_mfma_f32_16x16x32_bf16 a[128:131], v[64:67], v[224:227], a[128:131]
    v_exp_f32 v201, v201
    v_mfma_f32_16x16x32_bf16 a[132:135], v[68:71], v[224:227], a[132:135]
    v_exp_f32 v202, v202
    v_cvt_pk_bf16_f32 v228, v200, v201
    v_mfma_f32_16x16x32_bf16 a[136:139], v[72:75], v[224:227], a[136:139]
    v_exp_f32 v203, v203
    v_mfma_f32_16x16x32_bf16 a[140:143], v[76:79], v[224:227], a[140:143]
    s_waitcnt lgkmcnt(15)
    s_and_b32 s98, s95, 7
    v_exp_f32 v204, v204
    v_cvt_pk_bf16_f32 v229, v202, v203
    v_mfma_f32_16x16x32_bf16 a[144:147], v[80:83], v[224:227], a[144:147]
    s_cbranch_scc0 L1v3_rot
L1v3_rotb:
    v_exp_f32 v205, v205
    s_waitcnt lgkmcnt(13)
    v_mfma_f32_16x16x32_bf16 a[148:151], v[84:87], v[224:227], a[148:151]
    s_waitcnt lgkmcnt(11)
    v_exp_f32 v206, v206
    v_cvt_pk_bf16_f32 v230, v204, v205
    v_mfma_f32_16x16x32_bf16 a[152:155], v[88:91], v[224:227], a[152:155]
    s_waitcnt lgkmcnt(9)
    s_add_u32 s44, s44, 1
    v_exp_f32 v207, v207
    v_mfma_f32_16x16x32_bf16 a[156:159], v[92:95], v[224:227], a[156:159]
    s_cmp_lt_u32 s44, 25
    v_exp_f32 v208, v208
    v_cvt_pk_bf16_f32 v231, v206, v207
    v_mfma_f32_16x16x32_bf16 v[100:103], v[96:99], v[224:227], v[100:103]
    s_waitcnt lgkmcnt(0)
    v_exp_f32 v209, v209
    s_cbranch_scc1 L1v3_bloop
    s_mov_b32 s44, 0
L1v3_non:
    v_readfirstlane_b32 s69, v0
    s_nop 3
    s_cmp_eq_u32 s69, 0
    s_cbranch_scc1 L1v3_nons
L1v3_nong:
    s_mov_b32 s44, 0
    s_getpc_b64 s[4:5]
L1v3_pc2:
    s_mov_b32 s6, L1_fbs-L1v3_pc2
    s_mov_b32 s7, 0x20000
    s_lshl_b32 s57, s3, 11
    s_add_u32 s57, s57, L2_start-L1v3_pc2
    v_lshl_add_u32 v21, v20, 1, s57
    buffer_load_dword v22, v21, s[4:7], 0 offen
    s_bfe_u32 s57, s2, 0x20003
    s_lshl_b32 s57, s57, 11
    v_lshl_add_u32 v21, v20, 1, s57
    buffer_load_dword v22, v21, s[4:7], 0 offen
.p2align 4
L1v3_dloop:
    v_mfma_f32_16x16x32_bf16 v[192:195], v[32:35], v[128:131], v[240:243]
    s_waitcnt vmcnt(16) lgkmcnt(0)
    v_exp_f32 v210, v210
    v_cvt_pk_bf16_f32 v232, v208, v209
    v_mfma_f32_16x16x32_bf16 v[192:195], v[36:39], v[132:135], v[192:195]
    s_barrier
    v_mfma_f32_16x16x32_bf16 v[192:195], v[40:43], v[136:139], v[192:195]
    v_exp_f32 v211, v211
    v_mfma_f32_16x16x32_bf16 v[192:195], v[44:47], v[140:143], v[192:195]
    s_add_u32 s32, s32, 16896
    v_exp_f32 v212, v212
    v_cvt_pk_bf16_f32 v233, v210, v211
    v_mfma_f32_16x16x32_bf16 v[196:199], v[60:63], v[140:143], v[240:243]
    s_cmp_ge_u32 s32, 101376
    v_exp_f32 v213, v213
    v_mfma_f32_16x16x32_bf16 v[196:199], v[56:59], v[136:139], v[196:199]
    ds_read_b128 v[124:127], v19 offset:0
    ds_read_b128 v[28:31], v19 offset:1024
    v_cvt_pk_bf16_f32 v234, v212, v213
    v_mfma_f32_16x16x32_bf16 v[196:199], v[52:55], v[132:135], v[196:199]
    ds_read_b128 v[10:13], v19 offset:2048
    ds_read_b128 v[14:17], v19 offset:3072
    v_mfma_f32_16x16x32_bf16 v[196:199], v[48:51], v[128:131], v[196:199]
    s_cselect_b32 s32, 0, s32
    v_exp_f32 v214, v214
    v_mfma_f32_16x16x32_bf16 a[160:163], v[64:67], v[228:231], a[160:163]
    s_cmp_lt_u32 s44, 4
    v_add_u32 v5, s32, v3
    v_add_u32 v4, s32, v2
    v_mfma_f32_16x16x32_bf16 a[164:167], v[68:71], v[228:231], a[164:167]
    s_cselect_b32 s86, s37, 0
    v_exp_f32 v215, v215
    v_mfma_f32_16x16x32_bf16 a[168:171], v[72:75], v[228:231], a[168:171]
    v_cvt_pk_bf16_f32 v235, v214, v215
    v_exp_f32 v192, v192
    v_mfma_f32_16x16x32_bf16 a[172:175], v[76:79], v[228:231], a[172:175]
    v_exp_f32 v193, v193
    v_mfma_f32_16x16x32_bf16 a[176:179], v[80:83], v[228:231], a[176:179]
    s_cmp_lt_u32 s44, 3
    v_exp_f32 v194, v194
    v_mfma_f32_16x16x32_bf16 a[180:183], v[84:87], v[228:231], a[180:183]
    s_cselect_b32 s68, 4096, 0
    v_exp_f32 v195, v195
    v_mfma_f32_16x16x32_bf16 a[184:187], v[88:91], v[228:231], a[184:187]
    s_waitcnt lgkmcnt(3)
    buffer_store_dwordx4 v[124:127], v19, s[84:87], 0 offen offset:0 sc1
    v_mfma_f32_16x16x32_bf16 a[188:191], v[92:95], v[228:231], a[188:191]
    v_exp_f32 v196, v196
    v_mfma_f32_16x16x32_bf16 v[104:107], v[96:99], v[228:231], v[104:107]
    v_exp_f32 v197, v197
    v_mfma_f32_16x16x32_bf16 v[200:203], v[32:35], v[144:147], v[244:247]
    s_waitcnt lgkmcnt(2)
    buffer_store_dwordx4 v[28:31], v19, s[84:87], 0 offen offset:1024 sc1
    v_mfma_f32_16x16x32_bf16 v[200:203], v[36:39], v[148:151], v[200:203]
    v_exp_f32 v198, v198
    v_mfma_f32_16x16x32_bf16 v[200:203], v[40:43], v[152:155], v[200:203]
    v_exp_f32 v199, v199
    v_mfma_f32_16x16x32_bf16 v[200:203], v[44:47], v[156:159], v[200:203]
    s_waitcnt lgkmcnt(1)
    buffer_store_dwordx4 v[10:13], v19, s[84:87], 0 offen offset:2048 sc1
    v_mfma_f32_16x16x32_bf16 v[204:207], v[60:63], v[156:159], v[244:247]
    v_cvt_pk_bf16_f32 v224, v192, v193
    v_cvt_pk_bf16_f32 v225, v194, v195
    v_mfma_f32_16x16x32_bf16 v[204:207], v[56:59], v[152:155], v[204:207]
    v_cvt_pk_bf16_f32 v226, v196, v197
    v_cvt_pk_bf16_f32 v227, v198, v199
    v_mfma_f32_16x16x32_bf16 v[204:207], v[52:55], v[148:151], v[204:207]
    s_waitcnt lgkmcnt(0)
    buffer_store_dwordx4 v[14:17], v19, s[84:87], 0 offen offset:3072 sc1
    v_mfma_f32_16x16x32_bf16 v[204:207], v[48:51], v[144:147], v[204:207]
    v_mfma_f32_16x16x32_bf16 a[192:195], v[64:67], v[232:235], a[192:195]
    ds_read_b64_tr_b16 v[64:65], v5 offset:8448
    ds_read_b64_tr_b16 v[66:67], v5 offset:8960
    v_mfma_f32_16x16x32_bf16 a[196:199], v[68:71], v[232:235], a[196:199]
    ds_read_b64_tr_b16 v[68:69], v5 offset:8480
    ds_read_b64_tr_b16 v[70:71], v5 offset:8992
    v_mfma_f32_16x16x32_bf16 a[200:203], v[72:75], v[232:235], a[200:203]
    ds_read_b64_tr_b16 v[72:73], v5 offset:8512
    ds_read_b64_tr_b16 v[74:75], v5 offset:9024
    v_mfma_f32_16x16x32_bf16 a[204:207], v[76:79], v[232:235], a[204:207]
    ds_read_b64_tr_b16 v[76:77], v5 offset:8544
    ds_read_b64_tr_b16 v[78:79], v5 offset:9056
    v_mfma_f32_16x16x32_bf16 a[208:211], v[80:83], v[232:235], a[208:211]
    ds_read_b64_tr_b16 v[80:81], v5 offset:8576
    ds_read_b64_tr_b16 v[82:83], v5 offset:9088
    v_mfma_f32_16x16x32_bf16 a[212:215], v[84:87], v[232:235], a[212:215]
    ds_read_b64_tr_b16 v[84:85], v5 offset:8608
    ds_read_b64_tr_b16 v[86:87], v5 offset:9120
    v_mfma_f32_16x16x32_bf16 a[216:219], v[88:91], v[232:235], a[216:219]
    ds_read_b64_tr_b16 v[88:89], v5 offset:8640
    ds_read_b64_tr_b16 v[90:91], v5 offset:9152
    v_mfma_f32_16x16x32_bf16 a[220:223], v[92:95], v[232:235], a[220:223]
    ds_read_b64_tr_b16 v[92:93], v5 offset:8672
    ds_read_b64_tr_b16 v[94:95], v5 offset:9184
    v_mfma_f32_16x16x32_bf16 v[108:111], v[96:99], v[232:235], v[108:111]
    v_exp_f32 v200, v200
    v_mfma_f32_16x16x32_bf16 v[208:211], v[32:35], v[160:163], v[248:251]
    ds_read_b128 v[32:35], v4 offset:0
    v_mfma_f32_16x16x32_bf16 v[208:211], v[36:39], v[164:167], v[208:211]
    ds_read_b128 v[36:39], v4 offset:64
    v_mfma_f32_16x16x32_bf16 v[208:211], v[40:43], v[168:171], v[208:211]
    ds_read_b128 v[40:43], v4 offset:128
    v_mfma_f32_16x16x32_bf16 v[208:211], v[44:47], v[172:175], v[208:211]
    ds_read_b128 v[44:47], v4 offset:192
    v_mfma_f32_16x16x32_bf16 v[212:215], v[60:63], v[172:175], v[248:251]
    ds_read_b128 v[60:63], v4 offset:704
    v_mfma_f32_16x16x32_bf16 v[212:215], v[56:59], v[168:171], v[212:215]
    ds_read_b128 v[56:59], v4 offset:640
    v_mfma_f32_16x16x32_bf16 v[212:215], v[52:55], v[164:167], v[212:215]
    ds_read_b128 v[52:55], v4 offset:576
    v_mfma_f32_16x16x32_bf16 v[212:215], v[48:51], v[160:163], v[212:215]
    s_waitcnt lgkmcnt(15)
    ds_read_b128 v[48:51], v4 offset:512
    v_mfma_f32_16x16x32_bf16 a[128:131], v[64:67], v[224:227], a[128:131]
    v_exp_f32 v201, v201
    v_mfma_f32_16x16x32_bf16 a[132:135], v[68:71], v[224:227], a[132:135]
    v_exp_f32 v202, v202
    v_cvt_pk_bf16_f32 v228, v200, v201
    v_mfma_f32_16x16x32_bf16 a[136:139], v[72:75], v[224:227], a[136:139]
    v_exp_f32 v203, v203
    v_mfma_f32_16x16x32_bf16 a[140:143], v[76:79], v[224:227], a[140:143]
    s_waitcnt lgkmcnt(14)
    v_exp_f32 v204, v204
    v_cvt_pk_bf16_f32 v229, v202, v203
    v_mfma_f32_16x16x32_bf16 a[144:147], v[80:83], v[224:227], a[144:147]
    s_waitcnt lgkmcnt(12)
    v_exp_f32 v205, v205
    v_mfma_f32_16x16x32_bf16 a[148:151], v[84:87], v[224:227], a[148:151]
    s_waitcnt lgkmcnt(10)
    v_exp_f32 v206, v206
    v_cvt_pk_bf16_f32 v230, v204, v205
    v_mfma_f32_16x16x32_bf16 a[152:155], v[88:91], v[224:227], a[152:155]
    s_waitcnt lgkmcnt(8)
    s_add_u32 s44, s44, 1
    v_exp_f32 v207, v207
    v_mfma_f32_16x16x32_bf16 a[156:159], v[92:95], v[224:227], a[156:159]
    s_cmp_lt_u32 s44, 4
    v_exp_f32 v208, v208
    v_cvt_pk_bf16_f32 v231, v206, v207
    v_add_u32 v19, s68, v19
    v_mfma_f32_16x16x32_bf16 v[100:103], v[96:99], v[224:227], v[100:103]
    s_waitcnt lgkmcnt(0)
    v_exp_f32 v209, v209
    s_cbranch_scc1 L1v3_dloop
    v_mfma_f32_16x16x32_bf16 v[192:195], v[32:35], v[128:131], v[240:243]
    s_lshr_b32 s98, s2, 3
    v_exp_f32 v210, v210
    v_mfma_f32_16x16x32_bf16 v[192:195], v[36:39], v[132:135], v[192:195]
    s_mul_i32 s95, s98, 52
    v_exp_f32 v211, v211
    v_mfma_f32_16x16x32_bf16 v[192:195], v[40:43], v[136:139], v[192:195]
    s_lshr_b32 s95, s95, 8
    v_exp_f32 v212, v212
    v_mfma_f32_16x16x32_bf16 v[192:195], v[44:47], v[140:143], v[192:195]
    s_bfe_u32 s94, s2, 0x20001
    v_exp_f32 v213, v213
    v_mfma_f32_16x16x32_bf16 v[196:199], v[60:63], v[140:143], v[240:243]
    s_mul_i32 s97, s95, 5
    v_exp_f32 v214, v214
    v_mfma_f32_16x16x32_bf16 v[196:199], v[56:59], v[136:139], v[196:199]
    s_waitcnt vmcnt(16) lgkmcnt(0)
    s_barrier
    v_mfma_f32_16x16x32_bf16 v[196:199], v[52:55], v[132:135], v[196:199]
    s_sub_u32 s97, s98, s97
    v_exp_f32 v215, v215
    v_mfma_f32_16x16x32_bf16 v[196:199], v[48:51], v[128:131], v[196:199]
    s_mul_i32 s96, s94, 6
    v_cvt_pk_bf16_f32 v232, v208, v209
    v_cvt_pk_bf16_f32 v233, v210, v211
    v_mfma_f32_16x16x32_bf16 a[160:163], v[64:67], v[228:231], a[160:163]
    s_lshl_b32 s94, s97, 8
    v_cvt_pk_bf16_f32 v234, v212, v213
    v_cvt_pk_bf16_f32 v235, v214, v215
    v_mfma_f32_16x16x32_bf16 a[164:167], v[68:71], v[228:231], a[164:167]
    s_add_u32 s84, s88, s94
    s_addc_u32 s85, s89, 0
    s_sub_u32 s86, 5242880, s94
    v_mfma_f32_16x16x32_bf16 a[168:171], v[72:75], v[228:231], a[168:171]
    s_add_u32 s96, s96, s95
    v_lshrrev_b32 v143, 4, v1
    s_lshr_b32 s94, s3, 1
    v_mfma_f32_16x16x32_bf16 a[172:175], v[76:79], v[228:231], a[172:175]
    s_mul_i32 s94, s94, 30720
    s_mul_i32 s95, s3, 5120
    v_mul_u32_u24 v143, 9984, v143
    v_mfma_f32_16x16x32_bf16 a[176:179], v[80:83], v[228:231], a[176:179]
    s_mul_i32 s34, s3, 4224
    s_add_u32 s94, s94, s95
    s_and_b32 s58, s2, 1
    v_mfma_f32_16x16x32_bf16 a[180:183], v[84:87], v[228:231], a[180:183]
    s_add_u32 m0, 0, s34
    v_add3_u32 v128, v143, v20, s94
    s_mov_b32 s87, 0x20000
    v_mfma_f32_16x16x32_bf16 a[184:187], v[88:91], v[228:231], a[184:187]
    s_mul_i32 s37, s58, 2621440
    buffer_load_dwordx4 v128, s[84:87], s37 offen offset:0 lds
    v_mfma_f32_16x16x32_bf16 a[188:191], v[92:95], v[228:231], a[188:191]
    s_add_u32 s32, s32, 16896
    v_add_u32 v129, 224, v128
    v_add_u32 v130, 448, v128
    v_mfma_f32_16x16x32_bf16 v[104:107], v[96:99], v[228:231], v[104:107]
    s_cmp_ge_u32 s32, 101376
    s_cselect_b32 s32, 0, s32
    v_add_u32 v5, s32, v3
    v_mfma_f32_16x16x32_bf16 v[200:203], v[32:35], v[144:147], v[244:247]
    s_add_u32 s44, s37, 81920
    buffer_load_dwordx4 v129, s[84:87], s37 offen offset:1056 lds
    v_mfma_f32_16x16x32_bf16 v[200:203], v[36:39], v[148:151], v[200:203]
    s_add_u32 s20, s37, 327680
    v_add_u32 v131, 672, v128
    v_mov_b32 v21, 162816
    v_mfma_f32_16x16x32_bf16 v[200:203], v[40:43], v[152:155], v[200:203]
    s_add_u32 s92, s37, 409600
    ds_read_b128 v[124:127], v21
    s_bfe_u32 s60, s30, 0x10001
    v_mfma_f32_16x16x32_bf16 v[200:203], v[44:47], v[156:159], v[200:203]
    s_lshr_b32 s61, s30, 2
    buffer_load_dwordx4 v130, s[84:87], s37 offen offset:2112 lds
    v_mfma_f32_16x16x32_bf16 v[204:207], v[60:63], v[156:159], v[244:247]
    s_mul_i32 s60, s60, 15360
    v_exp_f32 v192, v192
    v_mfma_f32_16x16x32_bf16 v[204:207], v[56:59], v[152:155], v[204:207]
    s_lshl_b32 s61, s61, 8
    v_exp_f32 v193, v193
    v_mfma_f32_16x16x32_bf16 v[204:207], v[52:55], v[148:151], v[204:207]
    s_add_u32 s60, s60, s61
    buffer_load_dwordx4 v131, s[84:87], s37 offen offset:3168 lds
    v_mfma_f32_16x16x32_bf16 v[204:207], v[48:51], v[144:147], v[204:207]
    s_add_u32 m0, 37376, s34
    v_exp_f32 v194, v194
    v_mfma_f32_16x16x32_bf16 a[192:195], v[64:67], v[232:235], a[192:195]
    s_and_b32 s61, s30, 1
    ds_read_b64_tr_b16 v[64:65], v5 offset:8448
    ds_read_b64_tr_b16 v[66:67], v5 offset:8960
    v_mfma_f32_16x16x32_bf16 a[196:199], v[68:71], v[232:235], a[196:199]
    s_lshl_b32 s61, s61, 4
    ds_read_b64_tr_b16 v[68:69], v5 offset:8480
    ds_read_b64_tr_b16 v[70:71], v5 offset:8992
    v_mfma_f32_16x16x32_bf16 a[200:203], v[72:75], v[232:235], a[200:203]
    s_add_u32 s61, s61, s31
    ds_read_b64_tr_b16 v[72:73], v5 offset:8512
    ds_read_b64_tr_b16 v[74:75], v5 offset:9024
    v_mfma_f32_16x16x32_bf16 a[204:207], v[76:79], v[232:235], a[204:207]
    s_lshl_b32 s61, s61, 2
    ds_read_b64_tr_b16 v[76:77], v5 offset:8544
    ds_read_b64_tr_b16 v[78:79], v5 offset:9056
    v_mfma_f32_16x16x32_bf16 a[208:211], v[80:83], v[232:235], a[208:211]
    s_add_u32 s60, s60, s61
    ds_read_b64_tr_b16 v[80:81], v5 offset:8576
    ds_read_b64_tr_b16 v[82:83], v5 offset:9088
    v_mfma_f32_16x16x32_bf16 a[212:215], v[84:87], v[232:235], a[212:215]
    s_add_u32 s65, s69, 1
    ds_read_b64_tr_b16 v[84:85], v5 offset:8608
    ds_read_b64_tr_b16 v[86:87], v5 offset:9120
    v_mfma_f32_16x16x32_bf16 a[216:219], v[88:91], v[232:235], a[216:219]
    s_add_u32 s40, s28, 32505856
    s_addc_u32 s41, s29, 0
    ds_read_b64_tr_b16 v[88:89], v5 offset:8640
    v_mfma_f32_16x16x32_bf16 a[220:223], v[92:95], v[232:235], a[220:223]
    s_mov_b32 s43, 0x20000
    ds_read_b64_tr_b16 v[90:91], v5 offset:9152
    ds_read_b64_tr_b16 v[92:93], v5 offset:8672
    v_mfma_f32_16x16x32_bf16 v[108:111], v[96:99], v[232:235], v[108:111]
    s_lshl_b32 s66, s2, 7
    ds_read_b64_tr_b16 v[94:95], v5 offset:9184
    v_cvt_pk_bf16_f32 v224, v192, v193
    v_mfma_f32_16x16x32_bf16 v[208:211], v[32:35], v[160:163], v[248:251]
    s_add_u32 s66, s66, 32505856
    buffer_load_dwordx4 v128, s[84:87], s44 offen offset:0 lds
    v_mfma_f32_16x16x32_bf16 v[208:211], v[36:39], v[164:167], v[208:211]
    s_add_u32 s4, s28, s66
    s_addc_u32 s5, s29, 0
    s_waitcnt lgkmcnt(15)
    v_or3_b32 v124, v124, v125, v126
    v_mfma_f32_16x16x32_bf16 v[208:211], v[40:43], v[168:171], v[208:211]
    s_mul_i32 s66, s96, 43
    v_exp_f32 v195, v195
    v_mfma_f32_16x16x32_bf16 v[208:211], v[44:47], v[172:175], v[208:211]
    s_lshr_b32 s66, s66, 7
    buffer_load_dwordx4 v129, s[84:87], s44 offen offset:1056 lds
    v_mfma_f32_16x16x32_bf16 v[212:215], v[60:63], v[172:175], v[248:251]
    s_mul_i32 s66, s66, 3
    v_exp_f32 v196, v196
    v_mfma_f32_16x16x32_bf16 v[212:215], v[56:59], v[168:171], v[212:215]
    s_sub_u32 s66, s96, s66
    v_exp_f32 v197, v197
    v_mfma_f32_16x16x32_bf16 v[212:215], v[52:55], v[164:167], v[212:215]
    s_and_b32 s67, s66, 1
    buffer_load_dwordx4 v130, s[84:87], s44 offen offset:2112 lds
    v_mfma_f32_16x16x32_bf16 v[212:215], v[48:51], v[160:163], v[212:215]
    s_waitcnt lgkmcnt(14)
    s_lshl_b32 s67, s67, 6
    v_exp_f32 v198, v198
    v_exp_f32 v199, v199
    v_cvt_pk_bf16_f32 v225, v194, v195
    v_cvt_pk_bf16_f32 v226, v196, v197
    v_cvt_pk_bf16_f32 v227, v198, v199
    v_exp_f32 v200, v200
    s_nop 0
    v_mfma_f32_16x16x32_bf16 a[128:131], v[64:67], v[224:227], a[128:131]
    s_waitcnt lgkmcnt(12)
    s_lshl_b32 s62, s58, 5
    buffer_load_dwordx4 v131, s[84:87], s44 offen offset:3168 lds
    v_mfma_f32_16x16x32_bf16 a[132:135], v[68:71], v[224:227], a[132:135]
    s_waitcnt lgkmcnt(10)
    s_add_u32 m0, 74752, s34
    v_exp_f32 v201, v201
    v_mfma_f32_16x16x32_bf16 a[136:139], v[72:75], v[224:227], a[136:139]
    s_waitcnt lgkmcnt(8)
    s_add_u32 s67, s67, 28
    v_exp_f32 v202, v202
    v_mfma_f32_16x16x32_bf16 a[140:143], v[76:79], v[224:227], a[140:143]
    s_waitcnt lgkmcnt(6)
    s_add_u32 s63, s67, s62
    buffer_load_dwordx4 v128, s[84:87], s20 offen offset:0 lds
    v_mfma_f32_16x16x32_bf16 a[144:147], v[80:83], v[224:227], a[144:147]
    s_waitcnt lgkmcnt(4)
    s_lshr_b32 s66, s66, 1
    v_exp_f32 v203, v203
    v_mfma_f32_16x16x32_bf16 a[148:151], v[84:87], v[224:227], a[148:151]
    s_waitcnt lgkmcnt(2)
    s_lshl_b32 s66, s66, 6
    v_exp_f32 v204, v204
    v_mfma_f32_16x16x32_bf16 a[152:155], v[88:91], v[224:227], a[152:155]
    s_waitcnt lgkmcnt(0)
    s_mov_b32 s52, 0
    buffer_load_dwordx4 v129, s[84:87], s20 offen offset:1056 lds
    v_mfma_f32_16x16x32_bf16 a[156:159], v[92:95], v[224:227], a[156:159]
    s_mov_b32 s57, 0
    v_exp_f32 v205, v205
    v_mfma_f32_16x16x32_bf16 v[100:103], v[96:99], v[224:227], v[100:103]
    s_cmp_eq_u32 s58, 0
    s_cselect_b32 s56, 4, 20
    s_cselect_b32 s35, 14, 18
    s_cselect_b32 s45, -12, 2
    buffer_load_dwordx4 v130, s[84:87], s20 offen offset:2112 lds
    v_exp_f32 v206, v206
    v_exp_f32 v207, v207
    v_cvt_pk_bf16_f32 v228, v200, v201
    v_cvt_pk_bf16_f32 v229, v202, v203
    v_cvt_pk_bf16_f32 v230, v204, v205
    v_cvt_pk_bf16_f32 v231, v206, v207
    v_exp_f32 v208, v208
    s_nop 0
    v_mfma_f32_16x16x32_bf16 a[160:163], v[64:67], v[228:231], a[160:163]
    s_add_u32 s68, s52, s56
    buffer_load_dwordx4 v131, s[84:87], s20 offen offset:3168 lds
    v_mfma_f32_16x16x32_bf16 a[164:167], v[68:71], v[228:231], a[164:167]
    s_add_u32 m0, 112128, s34
    v_exp_f32 v209, v209
    v_mfma_f32_16x16x32_bf16 a[168:171], v[72:75], v[228:231], a[168:171]
    s_and_b32 s95, s68, 1
    v_exp_f32 v210, v210
    v_mfma_f32_16x16x32_bf16 a[172:175], v[76:79], v[228:231], a[172:175]
    s_sub_u32 s68, s68, s95
    buffer_load_dwordx4 v128, s[84:87], s92 offen offset:0 lds
    v_mfma_f32_16x16x32_bf16 a[176:179], v[80:83], v[228:231], a[176:179]
    s_add_u32 s68, s68, s57
    v_exp_f32 v211, v211
    v_mfma_f32_16x16x32_bf16 a[180:183], v[84:87], v[228:231], a[180:183]
    s_mul_i32 s94, s68, 987136
    v_exp_f32 v212, v212
    v_mfma_f32_16x16x32_bf16 a[184:187], v[88:91], v[228:231], a[184:187]
    s_lshl_b32 s68, s68, 1
    buffer_load_dwordx4 v129, s[84:87], s92 offen offset:1056 lds
    v_mfma_f32_16x16x32_bf16 a[188:191], v[92:95], v[228:231], a[188:191]
    s_add_u32 s68, s68, s95
    v_exp_f32 v213, v213
    v_mfma_f32_16x16x32_bf16 v[104:107], v[96:99], v[228:231], v[104:107]
    s_mul_i32 s38, s3, 5120
    v_exp_f32 v214, v214
    v_exp_f32 v215, v215
    buffer_load_dwordx4 v130, s[84:87], s92 offen offset:2112 lds
    v_cvt_pk_bf16_f32 v232, v208, v209
    v_cvt_pk_bf16_f32 v233, v210, v211
    v_cvt_pk_bf16_f32 v234, v212, v213
    v_cvt_pk_bf16_f32 v235, v214, v215
    v_or_b32 v124, v124, v127
    v_lshrrev_b32 v23, 1, v1
    v_mfma_f32_16x16x32_bf16 a[192:195], v[64:67], v[232:235], a[192:195]
    s_mul_i32 s39, s58, 15794176
    v_and_b32 v0, 1, v1
    v_readfirstlane_b32 s100, v124
    v_mfma_f32_16x16x32_bf16 a[196:199], v[68:71], v[232:235], a[196:199]
    s_lshl_b32 s95, s95, 11
    buffer_load_dwordx4 v131, s[84:87], s92 offen offset:3168 lds
    v_mfma_f32_16x16x32_bf16 a[200:203], v[72:75], v[232:235], a[200:203]
    s_or_b32 s64, s100, s3
    v_lshlrev_b32 v23, 10, v23
    v_lshlrev_b32 v0, 7, v0
    v_mfma_f32_16x16x32_bf16 a[204:207], v[76:79], v[232:235], a[204:207]
    s_cmp_eq_u32 s64, 0
    s_cselect_b32 s42, 30720, 0
    v_add3_u32 v23, v23, v0, s60
    v_mfma_f32_16x16x32_bf16 a[208:211], v[80:83], v[232:235], a[208:211]
    s_add_u32 s52, s52, 1
    v_cmp_gt_u32 vcc, 30, v1
    v_mov_b32 v0, 0x100000
    v_mfma_f32_16x16x32_bf16 a[212:215], v[84:87], v[232:235], a[212:215]
    s_mov_b32 s55, 12
    v_mov_b32 v22, s65
    v_cndmask_b32 v23, v0, v23, vcc
    v_mfma_f32_16x16x32_bf16 a[216:219], v[88:91], v[232:235], a[216:219]
    s_mov_b32 s6, 128
    v_rcp_f32 v24, v100
    v_mfma_f32_16x16x32_bf16 a[220:223], v[92:95], v[232:235], a[220:223]
    s_mov_b32 s7, 0x20000
    v_accvgpr_read_b32 v116, a128
    v_accvgpr_read_b32 v117, a129
    v_mfma_f32_16x16x32_bf16 v[108:111], v[96:99], v[232:235], v[108:111]
    s_add_u32 s38, s38, 16896
    v_accvgpr_read_b32 v118, a130
    v_accvgpr_read_b32 v119, a131
    v_accvgpr_read_b32 v120, a132
    v_accvgpr_read_b32 v121, a133
    v_accvgpr_read_b32 v122, a134
    v_accvgpr_read_b32 v123, a135
    v_accvgpr_read_b32 v10, a136
    v_accvgpr_read_b32 v11, a137
    s_waitcnt vmcnt(16) lgkmcnt(0)
    s_barrier
    buffer_store_dword v22, v23, s[40:43], 0 offen sc1
    v_accvgpr_read_b32 v12, a138
    v_accvgpr_read_b32 v13, a139
    v_accvgpr_read_b32 v14, a140
    v_accvgpr_read_b32 v15, a141
    v_accvgpr_read_b32 v16, a142
    v_accvgpr_read_b32 v17, a143
    v_mul_f32 v116, v24, v116
    v_mul_f32 v117, v24, v117
    v_mul_f32 v118, v24, v118
    v_mul_f32 v119, v24, v119
    v_mul_f32 v120, v24, v120
    v_mul_f32 v121, v24, v121
    v_mul_f32 v122, v24, v122
    v_mul_f32 v123, v24, v123
    v_mul_f32 v10, v24, v10
    v_mul_f32 v11, v24, v11
    v_mul_f32 v12, v24, v12
    v_mul_f32 v13, v24, v13
    v_mul_f32 v14, v24, v14
    v_mul_f32 v15, v24, v15
    v_mul_f32 v16, v24, v16
    v_mul_f32 v17, v24, v17
    v_cvt_pk_bf16_f32 v32, v116, v117
    v_cvt_pk_bf16_f32 v33, v118, v119
    v_cvt_pk_bf16_f32 v34, v120, v121
    v_cvt_pk_bf16_f32 v35, v122, v123
    v_cvt_pk_bf16_f32 v36, v10, v11
    buffer_store_dwordx4 v[32:35], v20, s[16:19], s48 offen offset:0 sc1
    v_cvt_pk_bf16_f32 v37, v12, v13
    v_cvt_pk_bf16_f32 v38, v14, v15
    v_cvt_pk_bf16_f32 v39, v16, v17
    v_accvgpr_read_b32 v116, a144
    buffer_store_dwordx4 v[36:39], v20, s[16:19], s48 offen offset:1024 sc1
    v_accvgpr_read_b32 v117, a145
    v_accvgpr_read_b32 v118, a146
    v_accvgpr_read_b32 v119, a147
    v_accvgpr_read_b32 v120, a148
    v_accvgpr_read_b32 v121, a149
    v_accvgpr_read_b32 v122, a150
    v_accvgpr_read_b32 v123, a151
    v_accvgpr_read_b32 v10, a152
    v_accvgpr_read_b32 v11, a153
    v_accvgpr_read_b32 v12, a154
    v_accvgpr_read_b32 v13, a155
    v_accvgpr_read_b32 v14, a156
    v_accvgpr_read_b32 v15, a157
    v_accvgpr_read_b32 v16, a158
    v_accvgpr_read_b32 v17, a159
    v_mul_f32 v116, v24, v116
    v_mul_f32 v117, v24, v117
    v_mul_f32 v118, v24, v118
    v_mul_f32 v119, v24, v119
    v_mul_f32 v120, v24, v120
    v_mul_f32 v121, v24, v121
    v_mul_f32 v122, v24, v122
    v_mul_f32 v123, v24, v123
    v_mul_f32 v10, v24, v10
    v_mul_f32 v11, v24, v11
    v_mul_f32 v12, v24, v12
    v_mul_f32 v13, v24, v13
    v_mul_f32 v14, v24, v14
    v_mul_f32 v15, v24, v15
    v_mul_f32 v16, v24, v16
    v_mul_f32 v17, v24, v17
    v_rcp_f32 v25, v104
    v_cvt_pk_bf16_f32 v40, v116, v117
    v_cvt_pk_bf16_f32 v41, v118, v119
    v_cvt_pk_bf16_f32 v42, v120, v121
    v_cvt_pk_bf16_f32 v43, v122, v123
    v_cvt_pk_bf16_f32 v44, v10, v11
    buffer_store_dwordx4 v[40:43], v20, s[16:19], s48 offen offset:2048 sc1
    v_cvt_pk_bf16_f32 v45, v12, v13
    v_cvt_pk_bf16_f32 v46, v14, v15
    v_cvt_pk_bf16_f32 v47, v16, v17
    v_and_b32 v141, 31, v1
    buffer_store_dwordx4 v[44:47], v20, s[16:19], s48 offen offset:3072 sc1
    v_accvgpr_read_b32 v116, a160
    v_accvgpr_read_b32 v117, a161
    v_accvgpr_read_b32 v118, a162
    v_accvgpr_read_b32 v119, a163
    v_accvgpr_read_b32 v120, a164
    v_accvgpr_read_b32 v121, a165
    v_accvgpr_read_b32 v122, a166
    v_accvgpr_read_b32 v123, a167
    v_accvgpr_read_b32 v10, a168
    v_accvgpr_read_b32 v11, a169
    v_accvgpr_read_b32 v12, a170
    v_accvgpr_read_b32 v13, a171
    v_accvgpr_read_b32 v14, a172
    v_accvgpr_read_b32 v15, a173
    v_accvgpr_read_b32 v16, a174
    v_accvgpr_read_b32 v17, a175
    v_lshlrev_b32 v141, 2, v141
    v_mul_f32 v116, v25, v116
    v_mul_f32 v117, v25, v117
    v_mul_f32 v118, v25, v118
    v_mul_f32 v119, v25, v119
    v_mul_f32 v120, v25, v120
    v_mul_f32 v121, v25, v121
    v_mul_f32 v122, v25, v122
    v_mul_f32 v123, v25, v123
    v_mul_f32 v10, v25, v10
    v_mul_f32 v11, v25, v11
    v_mul_f32 v12, v25, v12
    v_mul_f32 v13, v25, v13
    v_mul_f32 v14, v25, v14
    v_mul_f32 v15, v25, v15
    v_mul_f32 v16, v25, v16
    v_mul_f32 v17, v25, v17
    v_and_b32 v159, s63, v141
    v_cvt_pk_bf16_f32 v48, v116, v117
    v_cvt_pk_bf16_f32 v49, v118, v119
    v_cvt_pk_bf16_f32 v50, v120, v121
    v_cvt_pk_bf16_f32 v51, v122, v123
    v_cvt_pk_bf16_f32 v52, v10, v11
    buffer_store_dwordx4 v[48:51], v20, s[16:19], s49 offen offset:0 sc1
    v_cvt_pk_bf16_f32 v53, v12, v13
    v_cvt_pk_bf16_f32 v54, v14, v15
    v_cvt_pk_bf16_f32 v55, v16, v17
    v_accvgpr_read_b32 v116, a176
    buffer_store_dwordx4 v[52:55], v20, s[16:19], s49 offen offset:1024 sc1
    v_accvgpr_read_b32 v117, a177
    v_accvgpr_read_b32 v118, a178
    v_accvgpr_read_b32 v119, a179
    v_accvgpr_read_b32 v120, a180
    v_accvgpr_read_b32 v121, a181
    v_accvgpr_read_b32 v122, a182
    v_accvgpr_read_b32 v123, a183
    v_accvgpr_read_b32 v10, a184
    v_accvgpr_read_b32 v11, a185
    v_accvgpr_read_b32 v12, a186
    v_accvgpr_read_b32 v13, a187
    v_accvgpr_read_b32 v14, a188
    v_accvgpr_read_b32 v15, a189
    v_accvgpr_read_b32 v16, a190
    v_accvgpr_read_b32 v17, a191
    v_or_b32 v159, s66, v159
    v_mul_f32 v116, v25, v116
    v_mul_f32 v117, v25, v117
    v_mul_f32 v118, v25, v118
    v_mul_f32 v119, v25, v119
    v_mul_f32 v120, v25, v120
    v_mul_f32 v121, v25, v121
    v_mul_f32 v122, v25, v122
    v_mul_f32 v123, v25, v123
    v_mul_f32 v10, v25, v10
    v_mul_f32 v11, v25, v11
    v_mul_f32 v12, v25, v12
    v_mul_f32 v13, v25, v13
    v_mul_f32 v14, v25, v14
    v_mul_f32 v15, v25, v15
    v_mul_f32 v16, v25, v16
    v_mul_f32 v17, v25, v17
    v_or_b32 v141, s62, v159
    s_mul_i32 s66, s96, 40960
    s_and_b32 s62, s3, 1
    s_lshr_b32 s63, s3, 1
    s_add_u32 s8, s28, s66
    s_addc_u32 s9, s29, 0
    v_rcp_f32 v26, v108
    v_cvt_pk_bf16_f32 v56, v116, v117
    v_cvt_pk_bf16_f32 v57, v118, v119
    v_cvt_pk_bf16_f32 v58, v120, v121
    v_cvt_pk_bf16_f32 v59, v122, v123
    v_cvt_pk_bf16_f32 v60, v10, v11
    buffer_store_dwordx4 v[56:59], v20, s[16:19], s49 offen offset:2048 sc1
    v_cvt_pk_bf16_f32 v61, v12, v13
    v_cvt_pk_bf16_f32 v62, v14, v15
    v_cvt_pk_bf16_f32 v63, v16, v17
    s_mul_i32 s66, s62, 20480
    buffer_store_dwordx4 v[60:63], v20, s[16:19], s49 offen offset:3072 sc1
    s_lshl_b32 s67, s63, 10
    v_accvgpr_read_b32 v116, a192
    v_accvgpr_read_b32 v117, a193
    v_accvgpr_read_b32 v118, a194
    v_accvgpr_read_b32 v119, a195
    v_accvgpr_read_b32 v120, a196
    v_accvgpr_read_b32 v121, a197
    v_accvgpr_read_b32 v122, a198
    v_accvgpr_read_b32 v123, a199
    v_accvgpr_read_b32 v10, a200
    v_accvgpr_read_b32 v11, a201
    v_accvgpr_read_b32 v12, a202
    v_accvgpr_read_b32 v13, a203
    v_accvgpr_read_b32 v14, a204
    v_accvgpr_read_b32 v15, a205
    v_accvgpr_read_b32 v16, a206
    v_accvgpr_read_b32 v17, a207
    s_add_u32 s66, s66, s67
    v_add_u32 v132, s66, v20
    v_mul_f32 v116, v26, v116
    v_mul_f32 v117, v26, v117
    v_mul_f32 v118, v26, v118
    v_mul_f32 v119, v26, v119
    v_mul_f32 v120, v26, v120
    v_mul_f32 v121, v26, v121
    v_mul_f32 v122, v26, v122
    v_mul_f32 v123, v26, v123
    v_mul_f32 v10, v26, v10
    v_mul_f32 v11, v26, v11
    v_mul_f32 v12, v26, v12
    v_mul_f32 v13, v26, v13
    v_mul_f32 v14, v26, v14
    v_mul_f32 v15, v26, v15
    v_mul_f32 v16, v26, v16
    v_mul_f32 v17, v26, v17
    s_lshl_b32 s66, s62, 7
    s_mul_i32 s67, s63, 5120
    v_cmp_nlt_f32 s[60:61], v100, s47
    v_cmp_nlt_f32 s[62:63], v104, s47
    v_cvt_pk_bf16_f32 v64, v116, v117
    v_cvt_pk_bf16_f32 v65, v118, v119
    v_cvt_pk_bf16_f32 v66, v120, v121
    v_cvt_pk_bf16_f32 v67, v122, v123
    v_cvt_pk_bf16_f32 v68, v10, v11
    buffer_store_dwordx4 v[64:67], v20, s[16:19], s50 offen offset:0 sc1
    v_cvt_pk_bf16_f32 v69, v12, v13
    v_cvt_pk_bf16_f32 v70, v14, v15
    v_cvt_pk_bf16_f32 v71, v16, v17
    v_cmp_nlt_f32 s[64:65], v108, s47
    buffer_store_dwordx4 v[68:71], v20, s[16:19], s50 offen offset:1024 sc1
    v_accvgpr_read_b32 v116, a208
    v_accvgpr_read_b32 v117, a209
    v_accvgpr_read_b32 v118, a210
    v_accvgpr_read_b32 v119, a211
    v_accvgpr_read_b32 v120, a212
    v_accvgpr_read_b32 v121, a213
    v_accvgpr_read_b32 v122, a214
    v_accvgpr_read_b32 v123, a215
    v_accvgpr_read_b32 v10, a216
    v_accvgpr_read_b32 v11, a217
    v_accvgpr_read_b32 v12, a218
    v_accvgpr_read_b32 v13, a219
    v_accvgpr_read_b32 v14, a220
    v_accvgpr_read_b32 v15, a221
    v_accvgpr_read_b32 v16, a222
    v_accvgpr_read_b32 v17, a223
    v_mul_f32 v116, v26, v116
    v_mul_f32 v117, v26, v117
    v_mul_f32 v118, v26, v118
    v_mul_f32 v119, v26, v119
    v_mul_f32 v120, v26, v120
    v_mul_f32 v121, v26, v121
    v_mul_f32 v122, v26, v122
    v_mul_f32 v123, v26, v123
    v_mul_f32 v10, v26, v10
    v_mul_f32 v11, v26, v11
    v_mul_f32 v12, v26, v12
    v_mul_f32 v13, v26, v13
    v_mul_f32 v14, v26, v14
    v_mul_f32 v15, v26, v15
    v_mul_f32 v16, v26, v16
    v_mul_f32 v17, v26, v17
    s_or_b64 s[60:61], s[60:61], s[62:63]
    v_cvt_pk_bf16_f32 v72, v116, v117
    v_cvt_pk_bf16_f32 v73, v118, v119
    v_cvt_pk_bf16_f32 v74, v120, v121
    v_cvt_pk_bf16_f32 v75, v122, v123
    v_cvt_pk_bf16_f32 v76, v10, v11
    buffer_store_dwordx4 v[72:75], v20, s[16:19], s50 offen offset:2048 sc1
    v_cvt_pk_bf16_f32 v77, v12, v13
    v_cvt_pk_bf16_f32 v78, v14, v15
    v_cvt_pk_bf16_f32 v79, v16, v17
    s_add_u32 s67, s67, 16896
    buffer_store_dwordx4 v[76:79], v20, s[16:19], s50 offen offset:3072 sc1
    s_or_b64 s[60:61], s[60:61], s[64:65]
    s_cselect_b32 s62, 2, 0
    s_mov_b32 s10, 30642176
    s_mov_b32 s11, 0x20000
    v_add_u32 v133, 3072, v132
    v_add_u32 v134, 6144, v132
    v_add_u32 v135, 9216, v132
    v_add_u32 v147, 16384, v132
    v_add_u32 v136, s66, v3
    v_add_u32 v138, s66, v3
    v_add_u32 v137, s67, v20
    v_add_u32 v139, s67, v20
    s_add_u32 s59, s39, 2048
    s_add_u32 s21, s39, 1974272
    s_add_u32 s93, s39, 1976320
    s_mul_i32 s33, s68, 81920
    s_add_u32 s36, s94, s95
    s_cmp_eq_u32 s52, 12
    s_cselect_b32 s57, 1, s57
    s_cselect_b32 s56, s45, s56
    s_mov_b32 s101, 1
    s_or_b32 s99, s99, s62
    s_cmp_lg_u32 s99, 0
    s_cbranch_scc1 L1_fbs
    s_branch L2_start
L1v3_rot:
    s_cmp_ge_u32 s95, 24
    s_cbranch_scc1 L1v3_rotb
    v_mov_b32 v24, v25
    v_mov_b32 v25, v26
    v_mov_b32 v26, v27
    s_branch L1v3_rotb
L1v3_nons:
    s_add_u32 s44, s44, 1
    s_cmp_ge_u32 s44, 0x80000
    s_cbranch_scc1 L1v3_nong
    buffer_load_dword v0, v23, s[64:67], 0 offen sc1
    s_waitcnt vmcnt(0)
    s_branch L1v3_non
L2_start:
    s_cmp_eq_u32 s3, 0
    s_cselect_b32 s42, 30720, 0
    s_mov_b32 s47, 0
    s_cmp_ge_u32 s2, 240
    s_cbranch_scc1 L2_idle
    s_cmp_lg_u32 s100, 0
    s_cbranch_scc1 L2_late
L2_st1:
    s_cmp_eq_u32 s101, 0
    s_cbranch_scc1 L2_redo
L2_wait:
    buffer_load_dword v142, v141, s[4:7], 0 offen sc1
    s_waitcnt vmcnt(0)
L2_w1:
    s_add_u32 s68, s69, 1
    v_subrev_u32 v143, s68, v142
    v_cmp_lt_u32 vcc, 2, v143
    s_nop 3
    s_cmp_lg_u64 vcc, 0
    s_cbranch_scc1 L2_w1s
L2_g1:
    s_add_u32 m0, 0, s38
    s_nop 0
    buffer_load_dwordx4 v132, s[8:11], s39 offen offset:0 sc1 lds
    buffer_load_dwordx4 v133, s[8:11], s39 offen offset:1024 sc1 lds
    buffer_load_dwordx4 v134, s[8:11], s39 offen offset:2048 sc1 lds
    buffer_load_dwordx4 v135, s[8:11], s39 offen offset:3072 sc1 lds
    s_add_u32 m0, m0, 4096
    s_nop 0
    buffer_load_dwordx4 v147, s[8:11], s39 offen offset:0 sc1 lds
    s_add_u32 m0, 37376, s38
    s_nop 0
    buffer_load_dwordx4 v132, s[8:11], s59 offen offset:0 sc1 lds
    buffer_load_dwordx4 v133, s[8:11], s59 offen offset:1024 sc1 lds
    buffer_load_dwordx4 v134, s[8:11], s59 offen offset:2048 sc1 lds
    buffer_load_dwordx4 v135, s[8:11], s59 offen offset:3072 sc1 lds
    s_add_u32 m0, m0, 4096
    s_nop 0
    buffer_load_dwordx4 v147, s[8:11], s59 offen offset:0 sc1 lds
    s_add_u32 m0, 74752, s38
    s_nop 0
    buffer_load_dwordx4 v132, s[8:11], s21 offen offset:0 sc1 lds
    buffer_load_dwordx4 v133, s[8:11], s21 offen offset:1024 sc1 lds
    buffer_load_dwordx4 v134, s[8:11], s21 offen offset:2048 sc1 lds
    buffer_load_dwordx4 v135, s[8:11], s21 offen offset:3072 sc1 lds
    s_add_u32 m0, m0, 4096
    s_nop 0
    buffer_load_dwordx4 v147, s[8:11], s21 offen offset:0 sc1 lds
    s_add_u32 m0, 112128, s38
    s_nop 0
    buffer_load_dwordx4 v132, s[8:11], s93 offen offset:0 sc1 lds
    buffer_load_dwordx4 v133, s[8:11], s93 offen offset:1024 sc1 lds
    buffer_load_dwordx4 v134, s[8:11], s93 offen offset:2048 sc1 lds
    buffer_load_dwordx4 v135, s[8:11], s93 offen offset:3072 sc1 lds
    s_add_u32 m0, m0, 4096
    s_nop 0
    buffer_load_dwordx4 v147, s[8:11], s93 offen offset:0 sc1 lds
L2_pro:
    s_mov_b32 s32, 0
    s_mov_b32 s39, 1
    s_mov_b32 s59, 4
    s_waitcnt vmcnt(15)
    s_barrier
    ds_read_b128 a[0:3], v139 offset:0
    ds_read_b128 a[36:39], v139 offset:10240
    ds_read_b64_tr_b16 a[20:21], v138 offset:0
    ds_read_b64_tr_b16 a[22:23], v138 offset:512
    ds_read_b64_tr_b16 a[56:57], v138 offset:8448
    ds_read_b64_tr_b16 a[58:59], v138 offset:8960
    ds_read_b64_tr_b16 a[24:25], v138 offset:32
    ds_read_b64_tr_b16 a[26:27], v138 offset:544
    ds_read_b64_tr_b16 a[60:61], v138 offset:8480
    ds_read_b64_tr_b16 a[62:63], v138 offset:8992
    ds_read_b128 a[4:7], v139 offset:1024
    ds_read_b128 a[40:43], v139 offset:11264
    ds_read_b128 a[8:11], v139 offset:2048
    ds_read_b128 a[44:47], v139 offset:12288
    ds_read_b128 a[12:15], v139 offset:3072
    ds_read_b128 a[48:51], v139 offset:13312
    ds_read_b128 a[16:19], v139 offset:4096
    ds_read_b128 a[52:55], v139 offset:14336
    s_waitcnt lgkmcnt(14)
    v_mfma_f32_16x16x32_bf16 v[176:179], a[20:23], a[0:3], 0
    s_waitcnt lgkmcnt(12)
    s_lshr_b32 s62, s2, 1
    ds_read_b64_tr_b16 a[28:29], v138 offset:64
    ds_read_b64_tr_b16 a[30:31], v138 offset:576
    v_mfma_f32_16x16x32_bf16 v[176:179], a[56:59], a[36:39], v[176:179]
    s_waitcnt lgkmcnt(10)
    s_lshl_b32 s62, s62, 7
    ds_read_b64_tr_b16 a[64:65], v138 offset:8512
    ds_read_b64_tr_b16 a[66:67], v138 offset:9024
    v_mfma_f32_16x16x32_bf16 v[180:183], a[60:63], a[36:39], 0
    s_and_b32 s60, s3, 1
    ds_read_b64_tr_b16 a[32:33], v138 offset:96
    ds_read_b64_tr_b16 a[34:35], v138 offset:608
    v_mfma_f32_16x16x32_bf16 v[180:183], a[24:27], a[0:3], v[180:183]
    s_waitcnt lgkmcnt(13)
    s_lshr_b32 s61, s3, 1
    ds_read_b64_tr_b16 a[68:69], v138 offset:8544
    ds_read_b64_tr_b16 a[70:71], v138 offset:9056
    v_mfma_f32_16x16x32_bf16 v[192:195], a[20:23], a[4:7], 0
    s_waitcnt lgkmcnt(14)
    s_add_u32 s62, s62, 32538624
    buffer_store_dwordx4 v[80:83], v20, s[16:19], s51 offen offset:0 sc1
    v_mfma_f32_16x16x32_bf16 v[192:195], a[56:59], a[40:43], v[192:195]
    s_lshl_b32 s60, s60, 7
    v_and_b32 v143, 15, v1
    v_lshrrev_b32 v144, 4, v1
    v_mfma_f32_16x16x32_bf16 v[196:199], a[60:63], a[40:43], 0
    s_mul_i32 s61, s61, 102400
    v_and_b32 v146, 1, v143
    v_lshrrev_b32 v145, 2, v143
    v_mfma_f32_16x16x32_bf16 v[196:199], a[24:27], a[4:7], v[196:199]
    s_waitcnt lgkmcnt(13)
    s_add_u32 s64, s28, s62
    s_addc_u32 s65, s29, 0
    v_lshlrev_b32 v146, 4, v146
    v_mfma_f32_16x16x32_bf16 v[208:211], a[20:23], a[8:11], 0
    s_waitcnt lgkmcnt(12)
    s_add_u32 s60, s60, s61
    buffer_store_dwordx4 v[84:87], v20, s[16:19], s51 offen offset:1024 sc1
    v_mfma_f32_16x16x32_bf16 v[208:211], a[56:59], a[44:47], v[208:211]
    s_mul_i32 s62, s96, 5
    v_mov_b32 v148, 0x3f80
    v_cmp_eq_u32 vcc, v145, v144
    v_mfma_f32_16x16x32_bf16 v[212:215], a[60:63], a[44:47], 0
    s_mul_i32 s61, s96, 204800
    v_lshlrev_b32 v146, v146, v148
    v_and_b32 v145, 2, v143
    v_mfma_f32_16x16x32_bf16 v[212:215], a[24:27], a[8:11], v[212:215]
    s_waitcnt lgkmcnt(11)
    s_add_u32 s62, s62, s97
    v_cndmask_b32 v146, 0, v146, vcc
    v_cmp_eq_u32 vcc, 0, v145
    v_mfma_f32_16x16x32_bf16 v[224:227], a[20:23], a[12:15], 0
    s_waitcnt lgkmcnt(10)
    s_add_u32 s60, s60, s61
    s_lshl_b32 s62, s62, 2
    s_lshl_b32 s61, s97, 8
    v_mfma_f32_16x16x32_bf16 v[224:227], a[56:59], a[48:51], v[224:227]
    s_add_u32 s62, s62, s3
    v_cndmask_b32 v148, 0, v146, vcc
    s_add_u32 s60, s60, s61
    v_mfma_f32_16x16x32_bf16 v[228:231], a[60:63], a[48:51], 0
    s_mul_i32 s62, s62, 10368
    s_add_u32 s12, s90, s60
    s_addc_u32 s13, s91, 0
    v_mfma_f32_16x16x32_bf16 v[228:231], a[24:27], a[12:15], v[228:231]
    s_waitcnt lgkmcnt(9)
    s_sub_u32 s14, 4915200, s60
    s_add_u32 s62, s62, 33554432
    v_mul_u32_u24 v140, 1280, v143
    v_mfma_f32_16x16x32_bf16 v[240:243], a[20:23], a[16:19], 0
    s_waitcnt lgkmcnt(8)
    s_mov_b32 s44, s32
    v_sub_u32 v149, v146, v148
    s_add_u32 s32, s32, 37376
    v_mfma_f32_16x16x32_bf16 v[240:243], a[56:59], a[52:55], v[240:243]
    s_add_u32 s60, s28, s62
    s_addc_u32 s61, s29, 0
    s_mov_b32 s15, 0x20000
    v_mfma_f32_16x16x32_bf16 v[244:247], a[60:63], a[52:55], 0
    s_mov_b32 s66, 4
    s_mov_b32 s67, 0x20000
    s_mov_b32 s62, 10240
    v_mfma_f32_16x16x32_bf16 v[244:247], a[24:27], a[16:19], v[244:247]
    s_mov_b32 s63, 0x20000
    v_lshl_add_u32 v140, v144, 4, v140
    v_mov_b32 v150, 0
    v_mov_b32 v151, 0
    v_mov_b32 v152, v148
    v_mov_b32 v153, v149
    v_mov_b32 v146, 0
    s_cmp_ge_u32 s32, 149504
    s_cselect_b32 s32, 0, s32
    s_waitcnt vmcnt(12) lgkmcnt(0)
    v_mfma_f32_16x16x32_bf16 v[184:187], a[28:31], a[0:3], 0
    s_barrier
    v_mfma_f32_16x16x32_bf16 v[184:187], a[64:67], a[36:39], v[184:187]
    s_add_u32 m0, s44, s34
    v_add_u32 v138, s32, v136
    v_add_u32 v139, s32, v137
    v_mfma_f32_16x16x32_bf16 v[188:191], a[68:71], a[36:39], 0
    s_add_u32 s68, s52, s56
    ds_read_b64_tr_b16 a[20:21], v138 offset:0
    ds_read_b64_tr_b16 a[22:23], v138 offset:512
    v_mfma_f32_16x16x32_bf16 v[188:191], a[32:35], a[0:3], v[188:191]
    s_and_b32 s95, s68, 1
    ds_read_b128 a[0:3], v139 offset:0
    s_sub_u32 s68, s68, s95
    v_mfma_f32_16x16x32_bf16 v[200:203], a[28:31], a[4:7], 0
    s_add_u32 s68, s68, s57
    ds_read_b64_tr_b16 a[56:57], v138 offset:8448
    ds_read_b64_tr_b16 a[58:59], v138 offset:8960
    v_mfma_f32_16x16x32_bf16 v[200:203], a[64:67], a[40:43], v[200:203]
    s_mul_i32 s94, s68, 987136
    ds_read_b128 a[36:39], v139 offset:10240
    s_lshl_b32 s68, s68, 1
    v_mfma_f32_16x16x32_bf16 v[204:207], a[68:71], a[40:43], 0
    s_add_u32 s68, s68, s95
    ds_read_b64_tr_b16 a[60:61], v138 offset:8480
    ds_read_b64_tr_b16 a[62:63], v138 offset:8992
    v_mfma_f32_16x16x32_bf16 v[204:207], a[32:35], a[4:7], v[204:207]
    s_lshl_b32 s95, s95, 11
    ds_read_b64_tr_b16 a[24:25], v138 offset:32
    ds_read_b64_tr_b16 a[26:27], v138 offset:544
    v_mfma_f32_16x16x32_bf16 v[216:219], a[28:31], a[8:11], 0
    s_add_u32 s52, s52, 1
    buffer_load_dwordx4 v128, s[84:87], s33 offen offset:0 lds
    v_mfma_f32_16x16x32_bf16 v[216:219], a[64:67], a[44:47], v[216:219]
    s_cmp_eq_u32 s52, 12
    s_cselect_b32 s57, 1, s57
    s_cselect_b32 s56, s45, s56
    v_mfma_f32_16x16x32_bf16 v[220:223], a[68:71], a[44:47], 0
    ds_read_b128 a[4:7], v139 offset:1024
    v_mfma_f32_16x16x32_bf16 v[220:223], a[32:35], a[8:11], v[220:223]
    ds_read_b128 a[40:43], v139 offset:11264
    v_mfma_f32_16x16x32_bf16 v[232:235], a[28:31], a[12:15], 0
    buffer_load_dwordx4 v129, s[84:87], s33 offen offset:1056 lds
    v_mfma_f32_16x16x32_bf16 v[232:235], a[64:67], a[48:51], v[232:235]
    ds_read_b128 a[8:11], v139 offset:2048
    v_mfma_f32_16x16x32_bf16 v[236:239], a[68:71], a[48:51], 0
    ds_read_b128 a[44:47], v139 offset:12288
    v_mfma_f32_16x16x32_bf16 v[236:239], a[32:35], a[12:15], v[236:239]
    buffer_store_dwordx4 v[88:91], v20, s[16:19], s51 offen offset:2048 sc1
    v_mfma_f32_16x16x32_bf16 v[248:251], a[28:31], a[16:19], 0
    ds_read_b128 a[12:15], v139 offset:3072
    v_mfma_f32_16x16x32_bf16 v[248:251], a[64:67], a[52:55], v[248:251]
    ds_read_b128 a[48:51], v139 offset:13312
    v_mfma_f32_16x16x32_bf16 v[252:255], a[68:71], a[52:55], 0
    buffer_load_dwordx4 v130, s[84:87], s33 offen offset:2112 lds
    v_mfma_f32_16x16x32_bf16 v[252:255], a[32:35], a[16:19], v[252:255]
    s_waitcnt lgkmcnt(13)
    ds_read_b128 a[16:19], v139 offset:4096
    v_mfma_f32_16x16x32_bf16 v[176:179], a[20:23], a[0:3], v[176:179]
    s_waitcnt lgkmcnt(11)
    ds_read_b128 a[52:55], v139 offset:14336
    v_mfma_f32_16x16x32_bf16 v[176:179], a[56:59], a[36:39], v[176:179]
    s_waitcnt lgkmcnt(10)
    buffer_load_dwordx4 v131, s[84:87], s33 offen offset:3168 lds
    v_mfma_f32_16x16x32_bf16 v[180:183], a[60:63], a[36:39], v[180:183]
    s_waitcnt lgkmcnt(8)
    s_add_u32 m0, s44, s38
    ds_read_b64_tr_b16 a[28:29], v138 offset:64
    ds_read_b64_tr_b16 a[30:31], v138 offset:576
    v_mfma_f32_16x16x32_bf16 v[180:183], a[24:27], a[0:3], v[180:183]
    s_waitcnt lgkmcnt(9)
    ds_read_b64_tr_b16 a[64:65], v138 offset:8512
    ds_read_b64_tr_b16 a[66:67], v138 offset:9024
    ds_read_b64_tr_b16 a[32:33], v138 offset:96
    s_mov_b32 s44, s32
    buffer_store_dwordx4 v[92:95], v20, s[16:19], s51 offen offset:3072 sc1
    v_mfma_f32_16x16x32_bf16 v[192:195], a[20:23], a[4:7], v[192:195]
    s_waitcnt lgkmcnt(11)
    s_add_u32 s32, s32, 37376
    ds_read_b64_tr_b16 a[34:35], v138 offset:608
    ds_read_b64_tr_b16 a[68:69], v138 offset:8544
    v_mfma_f32_16x16x32_bf16 v[192:195], a[56:59], a[40:43], v[192:195]
    s_cmp_ge_u32 s32, 149504
    s_cselect_b32 s32, 0, s32
    ds_read_b64_tr_b16 a[70:71], v138 offset:9056
    v_mfma_f32_16x16x32_bf16 v[196:199], a[60:63], a[40:43], v[196:199]
    s_mul_i32 s33, s68, 81920
    buffer_load_dwordx4 v132, s[8:11], s36 offen offset:0 sc1 lds
    v_mfma_f32_16x16x32_bf16 v[196:199], a[24:27], a[4:7], v[196:199]
    s_waitcnt lgkmcnt(13)
    v_mfma_f32_16x16x32_bf16 v[208:211], a[20:23], a[8:11], v[208:211]
    s_waitcnt lgkmcnt(12)
    v_mfma_f32_16x16x32_bf16 v[208:211], a[56:59], a[44:47], v[208:211]
    buffer_load_dwordx4 v133, s[8:11], s36 offen offset:1024 sc1 lds
    v_mfma_f32_16x16x32_bf16 v[212:215], a[60:63], a[44:47], v[212:215]
    v_mfma_f32_16x16x32_bf16 v[212:215], a[24:27], a[8:11], v[212:215]
    s_waitcnt lgkmcnt(11)
    v_mfma_f32_16x16x32_bf16 v[224:227], a[20:23], a[12:15], v[224:227]
    s_waitcnt lgkmcnt(10)
    buffer_load_dwordx4 v134, s[8:11], s36 offen offset:2048 sc1 lds
    v_mfma_f32_16x16x32_bf16 v[224:227], a[56:59], a[48:51], v[224:227]
    v_mfma_f32_16x16x32_bf16 v[228:231], a[60:63], a[48:51], v[228:231]
    v_mfma_f32_16x16x32_bf16 v[228:231], a[24:27], a[12:15], v[228:231]
    s_waitcnt lgkmcnt(9)
    buffer_load_dwordx4 v135, s[8:11], s36 offen offset:3072 sc1 lds
    v_mfma_f32_16x16x32_bf16 v[240:243], a[20:23], a[16:19], v[240:243]
    s_waitcnt lgkmcnt(8)
    s_add_u32 m0, m0, 4096
    v_mfma_f32_16x16x32_bf16 v[240:243], a[56:59], a[52:55], v[240:243]
    v_mfma_f32_16x16x32_bf16 v[244:247], a[60:63], a[52:55], v[244:247]
    buffer_load_dwordx4 v147, s[8:11], s36 offen offset:0 sc1 lds
    v_mfma_f32_16x16x32_bf16 v[244:247], a[24:27], a[16:19], v[244:247]
    s_add_u32 s36, s94, s95
    s_waitcnt vmcnt(18) lgkmcnt(0)
.p2align 6
L2_loop:
    v_mfma_f32_16x16x32_bf16 v[184:187], a[28:31], a[0:3], v[184:187]
    s_barrier
    v_mfma_f32_16x16x32_bf16 v[184:187], a[64:67], a[36:39], v[184:187]
    s_add_u32 m0, s44, s34
    v_add_u32 v138, s32, v136
    v_add_u32 v139, s32, v137
    v_mfma_f32_16x16x32_bf16 v[188:191], a[68:71], a[36:39], v[188:191]
    s_add_u32 s68, s52, s56
    ds_read_b64_tr_b16 a[20:21], v138 offset:0
    ds_read_b64_tr_b16 a[22:23], v138 offset:512
    v_mfma_f32_16x16x32_bf16 v[188:191], a[32:35], a[0:3], v[188:191]
    s_and_b32 s95, s68, 1
    ds_read_b128 a[0:3], v139 offset:0
    s_sub_u32 s68, s68, s95
    v_mfma_f32_16x16x32_bf16 v[200:203], a[28:31], a[4:7], v[200:203]
    s_add_u32 s68, s68, s57
    ds_read_b64_tr_b16 a[56:57], v138 offset:8448
    ds_read_b64_tr_b16 a[58:59], v138 offset:8960
    v_mfma_f32_16x16x32_bf16 v[200:203], a[64:67], a[40:43], v[200:203]
    s_mul_i32 s94, s68, 987136
    ds_read_b128 a[36:39], v139 offset:10240
    s_lshl_b32 s68, s68, 1
    v_mfma_f32_16x16x32_bf16 v[204:207], a[68:71], a[40:43], v[204:207]
    s_add_u32 s68, s68, s95
    ds_read_b64_tr_b16 a[60:61], v138 offset:8480
    ds_read_b64_tr_b16 a[62:63], v138 offset:8992
    v_mfma_f32_16x16x32_bf16 v[204:207], a[32:35], a[4:7], v[204:207]
    s_lshl_b32 s95, s95, 11
    ds_read_b64_tr_b16 a[24:25], v138 offset:32
    ds_read_b64_tr_b16 a[26:27], v138 offset:544
    v_mfma_f32_16x16x32_bf16 v[216:219], a[28:31], a[8:11], v[216:219]
    s_add_u32 s52, s52, 1
    ds_read_b128 a[4:7], v139 offset:1024
    s_add_u32 s39, s39, 1
    v_mfma_f32_16x16x32_bf16 v[216:219], a[64:67], a[44:47], v[216:219]
    s_cmp_eq_u32 s52, 12
    s_cselect_b32 s57, 1, s57
    s_cselect_b32 s56, s45, s56
    v_mfma_f32_16x16x32_bf16 v[220:223], a[68:71], a[44:47], v[220:223]
    ds_read_b128 a[40:43], v139 offset:11264
    v_mfma_f32_16x16x32_bf16 v[220:223], a[32:35], a[8:11], v[220:223]
    ds_read_b128 a[8:11], v139 offset:2048
    v_mfma_f32_16x16x32_bf16 v[232:235], a[28:31], a[12:15], v[232:235]
    ds_read_b128 a[44:47], v139 offset:12288
    v_mfma_f32_16x16x32_bf16 v[232:235], a[64:67], a[48:51], v[232:235]
    buffer_load_dwordx4 v128, s[84:87], s33 offen offset:0 lds
    v_mfma_f32_16x16x32_bf16 v[236:239], a[68:71], a[48:51], v[236:239]
    ds_read_b128 a[48:51], v139 offset:13312
    v_mfma_f32_16x16x32_bf16 v[236:239], a[32:35], a[12:15], v[236:239]
    ds_read_b128 a[12:15], v139 offset:3072
    v_mfma_f32_16x16x32_bf16 v[248:251], a[28:31], a[16:19], v[248:251]
    buffer_load_dwordx4 v129, s[84:87], s33 offen offset:1056 lds
    v_mfma_f32_16x16x32_bf16 v[248:251], a[64:67], a[52:55], v[248:251]
    ds_read_b64_tr_b16 a[28:29], v138 offset:64
    ds_read_b64_tr_b16 a[30:31], v138 offset:576
    v_mfma_f32_16x16x32_bf16 v[252:255], a[68:71], a[52:55], v[252:255]
    ds_read_b128 a[52:55], v139 offset:14336
    v_mfma_f32_16x16x32_bf16 v[252:255], a[32:35], a[16:19], v[252:255]
    s_waitcnt lgkmcnt(15)
    ds_read_b128 a[16:19], v139 offset:4096
    v_mfma_f32_16x16x32_bf16 v[176:179], a[20:23], a[0:3], v[176:179]
    s_waitcnt lgkmcnt(14)
    buffer_load_dwordx4 v130, s[84:87], s33 offen offset:2112 lds
    v_mfma_f32_16x16x32_bf16 v[176:179], a[56:59], a[36:39], v[176:179]
    s_waitcnt lgkmcnt(12)
    ds_read_b64_tr_b16 a[64:65], v138 offset:8512
    ds_read_b64_tr_b16 a[66:67], v138 offset:9024
    v_mfma_f32_16x16x32_bf16 v[180:183], a[60:63], a[36:39], v[180:183]
    s_waitcnt lgkmcnt(12)
    ds_read_b64_tr_b16 a[32:33], v138 offset:96
    ds_read_b64_tr_b16 a[34:35], v138 offset:608
    v_mfma_f32_16x16x32_bf16 v[180:183], a[24:27], a[0:3], v[180:183]
    s_waitcnt lgkmcnt(13)
    buffer_load_dwordx4 v131, s[84:87], s33 offen offset:3168 lds
    v_mfma_f32_16x16x32_bf16 v[192:195], a[20:23], a[4:7], v[192:195]
    s_waitcnt lgkmcnt(12)
    s_add_u32 m0, s44, s38
    ds_read_b64_tr_b16 a[68:69], v138 offset:8544
    ds_read_b64_tr_b16 a[70:71], v138 offset:9056
    v_mfma_f32_16x16x32_bf16 v[192:195], a[56:59], a[40:43], v[192:195]
    s_mov_b32 s44, s32
    s_add_u32 s32, s32, 37376
    s_mul_i32 s33, s68, 81920
    v_mfma_f32_16x16x32_bf16 v[196:199], a[60:63], a[40:43], v[196:199]
    s_cmp_ge_u32 s32, 149504
    s_cselect_b32 s32, 0, s32
    v_mfma_f32_16x16x32_bf16 v[196:199], a[24:27], a[4:7], v[196:199]
    s_waitcnt lgkmcnt(13)
    buffer_load_dwordx4 v132, s[8:11], s36 offen offset:0 sc1 lds
    v_mfma_f32_16x16x32_bf16 v[208:211], a[20:23], a[8:11], v[208:211]
    s_waitcnt lgkmcnt(12)
    v_mfma_f32_16x16x32_bf16 v[208:211], a[56:59], a[44:47], v[208:211]
    v_mfma_f32_16x16x32_bf16 v[212:215], a[60:63], a[44:47], v[212:215]
    buffer_load_dwordx4 v133, s[8:11], s36 offen offset:1024 sc1 lds
    v_mfma_f32_16x16x32_bf16 v[212:215], a[24:27], a[8:11], v[212:215]
    s_waitcnt lgkmcnt(10)
    v_mfma_f32_16x16x32_bf16 v[224:227], a[20:23], a[12:15], v[224:227]
    v_mfma_f32_16x16x32_bf16 v[224:227], a[56:59], a[48:51], v[224:227]
    buffer_load_dwordx4 v134, s[8:11], s36 offen offset:2048 sc1 lds
    v_mfma_f32_16x16x32_bf16 v[228:231], a[60:63], a[48:51], v[228:231]
    v_mfma_f32_16x16x32_bf16 v[228:231], a[24:27], a[12:15], v[228:231]
    s_waitcnt lgkmcnt(6)
    v_mfma_f32_16x16x32_bf16 v[240:243], a[20:23], a[16:19], v[240:243]
    buffer_load_dwordx4 v135, s[8:11], s36 offen offset:3072 sc1 lds
    v_mfma_f32_16x16x32_bf16 v[240:243], a[56:59], a[52:55], v[240:243]
    s_add_u32 m0, m0, 4096
    v_mfma_f32_16x16x32_bf16 v[244:247], a[60:63], a[52:55], v[244:247]
    v_mfma_f32_16x16x32_bf16 v[244:247], a[24:27], a[16:19], v[244:247]
    buffer_load_dwordx4 v147, s[8:11], s36 offen offset:0 sc1 lds
    s_add_u32 s36, s94, s95
    s_cmp_lg_u32 s39, s59
    s_waitcnt vmcnt(18) lgkmcnt(0)
    s_cbranch_scc1 L2_loop
    s_cmp_eq_u32 s39, 4
    s_cbranch_scc1 L2_e1
    s_cmp_eq_u32 s39, 10
    s_cbranch_scc1 L2_e2
    s_cmp_eq_u32 s39, 12
    s_cbranch_scc1 L2_w2p
    s_add_u32 s68, s35, 11
    s_cmp_eq_u32 s39, s68
    s_cbranch_scc1 L2_e4
    v_mfma_f32_16x16x32_bf16 v[184:187], a[28:31], a[0:3], v[184:187]
    s_barrier
    v_mfma_f32_16x16x32_bf16 v[184:187], a[64:67], a[36:39], v[184:187]
    s_mov_b32 s44, s32
    v_add_u32 v138, s32, v136
    v_add_u32 v139, s32, v137
    v_mfma_f32_16x16x32_bf16 v[188:191], a[68:71], a[36:39], v[188:191]
    s_add_u32 s32, s32, 37376
    ds_read_b64_tr_b16 a[20:21], v138 offset:0
    ds_read_b64_tr_b16 a[22:23], v138 offset:512
    v_mfma_f32_16x16x32_bf16 v[188:191], a[32:35], a[0:3], v[188:191]
    s_cmp_ge_u32 s32, 149504
    s_cselect_b32 s32, 0, s32
    ds_read_b128 a[0:3], v139 offset:0
    v_mfma_f32_16x16x32_bf16 v[200:203], a[28:31], a[4:7], v[200:203]
    ds_read_b64_tr_b16 a[56:57], v138 offset:8448
    ds_read_b64_tr_b16 a[58:59], v138 offset:8960
    v_mfma_f32_16x16x32_bf16 v[200:203], a[64:67], a[40:43], v[200:203]
    ds_read_b128 a[36:39], v139 offset:10240
    v_mfma_f32_16x16x32_bf16 v[204:207], a[68:71], a[40:43], v[204:207]
    ds_read_b64_tr_b16 a[60:61], v138 offset:8480
    ds_read_b64_tr_b16 a[62:63], v138 offset:8992
    v_mfma_f32_16x16x32_bf16 v[204:207], a[32:35], a[4:7], v[204:207]
    ds_read_b64_tr_b16 a[24:25], v138 offset:32
    ds_read_b64_tr_b16 a[26:27], v138 offset:544
    v_mfma_f32_16x16x32_bf16 v[216:219], a[28:31], a[8:11], v[216:219]
    ds_read_b128 a[4:7], v139 offset:1024
    v_mfma_f32_16x16x32_bf16 v[216:219], a[64:67], a[44:47], v[216:219]
    ds_read_b128 a[40:43], v139 offset:11264
    v_mfma_f32_16x16x32_bf16 v[220:223], a[68:71], a[44:47], v[220:223]
    ds_read_b128 a[44:47], v139 offset:12288
    v_mfma_f32_16x16x32_bf16 v[220:223], a[32:35], a[8:11], v[220:223]
    ds_read_b128 a[8:11], v139 offset:2048
    v_mfma_f32_16x16x32_bf16 v[232:235], a[28:31], a[12:15], v[232:235]
    v_mfma_f32_16x16x32_bf16 v[232:235], a[64:67], a[48:51], v[232:235]
    v_mfma_f32_16x16x32_bf16 v[236:239], a[68:71], a[48:51], v[236:239]
    ds_read_b128 a[48:51], v139 offset:13312
    v_mfma_f32_16x16x32_bf16 v[236:239], a[32:35], a[12:15], v[236:239]
    ds_read_b128 a[12:15], v139 offset:3072
    v_mfma_f32_16x16x32_bf16 v[248:251], a[28:31], a[16:19], v[248:251]
    ds_read_b64_tr_b16 a[28:29], v138 offset:64
    ds_read_b64_tr_b16 a[30:31], v138 offset:576
    v_mfma_f32_16x16x32_bf16 v[248:251], a[64:67], a[52:55], v[248:251]
    ds_read_b64_tr_b16 a[64:65], v138 offset:8512
    ds_read_b64_tr_b16 a[66:67], v138 offset:9024
    v_mfma_f32_16x16x32_bf16 v[252:255], a[68:71], a[52:55], v[252:255]
    ds_read_b128 a[52:55], v139 offset:14336
    v_mfma_f32_16x16x32_bf16 v[252:255], a[32:35], a[16:19], v[252:255]
    s_waitcnt lgkmcnt(15)
    ds_read_b128 a[16:19], v139 offset:4096
    v_mfma_f32_16x16x32_bf16 v[176:179], a[20:23], a[0:3], v[176:179]
    ds_read_b64_tr_b16 a[32:33], v138 offset:96
    ds_read_b64_tr_b16 a[34:35], v138 offset:608
    v_mfma_f32_16x16x32_bf16 v[176:179], a[56:59], a[36:39], v[176:179]
    s_waitcnt lgkmcnt(15)
    ds_read_b64_tr_b16 a[68:69], v138 offset:8544
    ds_read_b64_tr_b16 a[70:71], v138 offset:9056
    v_mfma_f32_16x16x32_bf16 v[180:183], a[60:63], a[36:39], v[180:183]
    s_waitcnt lgkmcnt(15)
    v_mfma_f32_16x16x32_bf16 v[180:183], a[24:27], a[0:3], v[180:183]
    v_mfma_f32_16x16x32_bf16 v[192:195], a[20:23], a[4:7], v[192:195]
    s_waitcnt lgkmcnt(14)
    v_mfma_f32_16x16x32_bf16 v[192:195], a[56:59], a[40:43], v[192:195]
    v_mfma_f32_16x16x32_bf16 v[196:199], a[60:63], a[40:43], v[196:199]
    v_mfma_f32_16x16x32_bf16 v[196:199], a[24:27], a[4:7], v[196:199]
    s_waitcnt lgkmcnt(12)
    v_mfma_f32_16x16x32_bf16 v[208:211], a[20:23], a[8:11], v[208:211]
    v_mfma_f32_16x16x32_bf16 v[208:211], a[56:59], a[44:47], v[208:211]
    v_mfma_f32_16x16x32_bf16 v[212:215], a[60:63], a[44:47], v[212:215]
    s_waitcnt vmcnt(9) lgkmcnt(0)
    v_mfma_f32_16x16x32_bf16 v[212:215], a[24:27], a[8:11], v[212:215]
    v_mfma_f32_16x16x32_bf16 v[224:227], a[20:23], a[12:15], v[224:227]
    v_mfma_f32_16x16x32_bf16 v[224:227], a[56:59], a[48:51], v[224:227]
    v_mfma_f32_16x16x32_bf16 v[228:231], a[60:63], a[48:51], v[228:231]
    v_mfma_f32_16x16x32_bf16 v[228:231], a[24:27], a[12:15], v[228:231]
    v_mfma_f32_16x16x32_bf16 v[240:243], a[20:23], a[16:19], v[240:243]
    v_mfma_f32_16x16x32_bf16 v[240:243], a[56:59], a[52:55], v[240:243]
    v_mfma_f32_16x16x32_bf16 v[244:247], a[60:63], a[52:55], v[244:247]
    v_mfma_f32_16x16x32_bf16 v[244:247], a[24:27], a[16:19], v[244:247]
    s_mov_b32 s49, 4096
    s_mov_b32 s50, 8192
    s_cmp_eq_u32 s58, 0
    s_cbranch_scc1 L2_send
L2_w3:
    s_add_u32 s68, s69, 3
    v_subrev_u32 v143, s68, v142
    v_cmp_lt_u32 vcc, 0, v143
    s_nop 3
    s_cmp_lg_u64 vcc, 0
    s_cbranch_scc1 L2_w3s
L2_g3:
    buffer_load_dwordx4 v[32:35], v20, s[60:63], s48 offen offset:0 sc1
    buffer_load_dwordx4 v[36:39], v20, s[60:63], s48 offen offset:1024 sc1
    buffer_load_dwordx4 v[40:43], v20, s[60:63], s48 offen offset:2048 sc1
    buffer_load_dwordx4 v[44:47], v20, s[60:63], s48 offen offset:3072 sc1
    buffer_load_dwordx4 v[48:51], v20, s[60:63], s49 offen offset:0 sc1
    buffer_load_dwordx4 v[52:55], v20, s[60:63], s49 offen offset:1024 sc1
    buffer_load_dwordx4 v[56:59], v20, s[60:63], s49 offen offset:2048 sc1
    buffer_load_dwordx4 v[60:63], v20, s[60:63], s49 offen offset:3072 sc1
    buffer_load_dwordx4 v[64:67], v20, s[60:63], s50 offen offset:0 sc1
    buffer_load_dwordx4 v[68:71], v20, s[60:63], s50 offen offset:1024 sc1
    v_mfma_f32_16x16x32_bf16 v[184:187], a[28:31], a[0:3], v[184:187]
    s_barrier
    v_mfma_f32_16x16x32_bf16 v[184:187], a[64:67], a[36:39], v[184:187]
    s_mov_b32 s44, s32
    v_add_u32 v138, s32, v136
    v_add_u32 v139, s32, v137
    v_mfma_f32_16x16x32_bf16 v[188:191], a[68:71], a[36:39], v[188:191]
    s_add_u32 s32, s32, 37376
    ds_read_b64_tr_b16 a[20:21], v138 offset:0
    ds_read_b64_tr_b16 a[22:23], v138 offset:512
    v_mfma_f32_16x16x32_bf16 v[188:191], a[32:35], a[0:3], v[188:191]
    s_cmp_ge_u32 s32, 149504
    s_cselect_b32 s32, 0, s32
    ds_read_b128 a[0:3], v139 offset:0
    v_mfma_f32_16x16x32_bf16 v[200:203], a[28:31], a[4:7], v[200:203]
    ds_read_b64_tr_b16 a[56:57], v138 offset:8448
    ds_read_b64_tr_b16 a[58:59], v138 offset:8960
    v_mfma_f32_16x16x32_bf16 v[200:203], a[64:67], a[40:43], v[200:203]
    ds_read_b128 a[36:39], v139 offset:10240
    v_mfma_f32_16x16x32_bf16 v[204:207], a[68:71], a[40:43], v[204:207]
    ds_read_b64_tr_b16 a[60:61], v138 offset:8480
    ds_read_b64_tr_b16 a[62:63], v138 offset:8992
    v_mfma_f32_16x16x32_bf16 v[204:207], a[32:35], a[4:7], v[204:207]
    ds_read_b64_tr_b16 a[24:25], v138 offset:32
    ds_read_b64_tr_b16 a[26:27], v138 offset:544
    v_mfma_f32_16x16x32_bf16 v[216:219], a[28:31], a[8:11], v[216:219]
    ds_read_b128 a[4:7], v139 offset:1024
    v_mfma_f32_16x16x32_bf16 v[216:219], a[64:67], a[44:47], v[216:219]
    ds_read_b128 a[40:43], v139 offset:11264
    v_mfma_f32_16x16x32_bf16 v[220:223], a[68:71], a[44:47], v[220:223]
    ds_read_b128 a[44:47], v139 offset:12288
    v_mfma_f32_16x16x32_bf16 v[220:223], a[32:35], a[8:11], v[220:223]
    ds_read_b128 a[8:11], v139 offset:2048
    v_mfma_f32_16x16x32_bf16 v[232:235], a[28:31], a[12:15], v[232:235]
    v_mfma_f32_16x16x32_bf16 v[232:235], a[64:67], a[48:51], v[232:235]
    v_mfma_f32_16x16x32_bf16 v[236:239], a[68:71], a[48:51], v[236:239]
    ds_read_b128 a[48:51], v139 offset:13312
    v_mfma_f32_16x16x32_bf16 v[236:239], a[32:35], a[12:15], v[236:239]
    ds_read_b128 a[12:15], v139 offset:3072
    v_mfma_f32_16x16x32_bf16 v[248:251], a[28:31], a[16:19], v[248:251]
    ds_read_b64_tr_b16 a[28:29], v138 offset:64
    ds_read_b64_tr_b16 a[30:31], v138 offset:576
    v_mfma_f32_16x16x32_bf16 v[248:251], a[64:67], a[52:55], v[248:251]
    ds_read_b64_tr_b16 a[64:65], v138 offset:8512
    ds_read_b64_tr_b16 a[66:67], v138 offset:9024
    v_mfma_f32_16x16x32_bf16 v[252:255], a[68:71], a[52:55], v[252:255]
    ds_read_b128 a[52:55], v139 offset:14336
    v_mfma_f32_16x16x32_bf16 v[252:255], a[32:35], a[16:19], v[252:255]
    s_waitcnt lgkmcnt(15)
    ds_read_b128 a[16:19], v139 offset:4096
    v_mfma_f32_16x16x32_bf16 v[176:179], a[20:23], a[0:3], v[176:179]
    ds_read_b64_tr_b16 a[32:33], v138 offset:96
    ds_read_b64_tr_b16 a[34:35], v138 offset:608
    v_mfma_f32_16x16x32_bf16 v[176:179], a[56:59], a[36:39], v[176:179]
    s_waitcnt lgkmcnt(15)
    ds_read_b64_tr_b16 a[68:69], v138 offset:8544
    ds_read_b64_tr_b16 a[70:71], v138 offset:9056
    v_mfma_f32_16x16x32_bf16 v[180:183], a[60:63], a[36:39], v[180:183]
    s_waitcnt lgkmcnt(15)
    v_mfma_f32_16x16x32_bf16 v[180:183], a[24:27], a[0:3], v[180:183]
    v_mfma_f32_16x16x32_bf16 v[192:195], a[20:23], a[4:7], v[192:195]
    s_waitcnt lgkmcnt(14)
    v_mfma_f32_16x16x32_bf16 v[192:195], a[56:59], a[40:43], v[192:195]
    v_mfma_f32_16x16x32_bf16 v[196:199], a[60:63], a[40:43], v[196:199]
    v_mfma_f32_16x16x32_bf16 v[196:199], a[24:27], a[4:7], v[196:199]
    s_waitcnt lgkmcnt(12)
    v_mfma_f32_16x16x32_bf16 v[208:211], a[20:23], a[8:11], v[208:211]
    v_mfma_f32_16x16x32_bf16 v[208:211], a[56:59], a[44:47], v[208:211]
    v_mfma_f32_16x16x32_bf16 v[212:215], a[60:63], a[44:47], v[212:215]
    s_waitcnt vmcnt(10) lgkmcnt(0)
    v_mfma_f32_16x16x32_bf16 v[212:215], a[24:27], a[8:11], v[212:215]
    v_mfma_f32_16x16x32_bf16 v[224:227], a[20:23], a[12:15], v[224:227]
    v_mfma_f32_16x16x32_bf16 v[224:227], a[56:59], a[48:51], v[224:227]
    v_mfma_f32_16x16x32_bf16 v[228:231], a[60:63], a[48:51], v[228:231]
    v_mfma_f32_16x16x32_bf16 v[228:231], a[24:27], a[12:15], v[228:231]
    v_mfma_f32_16x16x32_bf16 v[240:243], a[20:23], a[16:19], v[240:243]
    v_mfma_f32_16x16x32_bf16 v[240:243], a[56:59], a[52:55], v[240:243]
    v_mfma_f32_16x16x32_bf16 v[244:247], a[60:63], a[52:55], v[244:247]
    v_mfma_f32_16x16x32_bf16 v[244:247], a[24:27], a[16:19], v[244:247]
    v_mfma_f32_16x16x32_bf16 v[184:187], a[28:31], a[0:3], v[184:187]
    s_barrier
    v_mfma_f32_16x16x32_bf16 v[184:187], a[64:67], a[36:39], v[184:187]
    s_mov_b32 s52, 0
    v_add_u32 v138, s32, v136
    v_add_u32 v139, s32, v137
    v_mfma_f32_16x16x32_bf16 v[188:191], a[68:71], a[36:39], v[188:191]
    s_mov_b32 s53, 20480
    ds_read_b64_tr_b16 a[20:21], v138 offset:0
    ds_read_b64_tr_b16 a[22:23], v138 offset:512
    v_mfma_f32_16x16x32_bf16 v[188:191], a[32:35], a[0:3], v[188:191]
    s_mov_b32 s54, 40960
    ds_read_b128 a[0:3], v139 offset:0
    s_mov_b32 s55, 61440
    v_mfma_f32_16x16x32_bf16 v[200:203], a[28:31], a[4:7], v[200:203]
    s_mov_b32 s56, 81920
    ds_read_b64_tr_b16 a[56:57], v138 offset:8448
    ds_read_b64_tr_b16 a[58:59], v138 offset:8960
    v_mfma_f32_16x16x32_bf16 v[200:203], a[64:67], a[40:43], v[200:203]
    ds_read_b128 a[36:39], v139 offset:10240
    v_mfma_f32_16x16x32_bf16 v[204:207], a[68:71], a[40:43], v[204:207]
    ds_read_b64_tr_b16 a[60:61], v138 offset:8480
    ds_read_b64_tr_b16 a[62:63], v138 offset:8992
    v_mfma_f32_16x16x32_bf16 v[204:207], a[32:35], a[4:7], v[204:207]
    ds_read_b64_tr_b16 a[24:25], v138 offset:32
    ds_read_b64_tr_b16 a[26:27], v138 offset:544
    v_mfma_f32_16x16x32_bf16 v[216:219], a[28:31], a[8:11], v[216:219]
    ds_read_b128 a[4:7], v139 offset:1024
    v_mfma_f32_16x16x32_bf16 v[216:219], a[64:67], a[44:47], v[216:219]
    ds_read_b128 a[40:43], v139 offset:11264
    v_mfma_f32_16x16x32_bf16 v[220:223], a[68:71], a[44:47], v[220:223]
    ds_read_b128 a[44:47], v139 offset:12288
    v_mfma_f32_16x16x32_bf16 v[220:223], a[32:35], a[8:11], v[220:223]
    ds_read_b128 a[8:11], v139 offset:2048
    v_mfma_f32_16x16x32_bf16 v[232:235], a[28:31], a[12:15], v[232:235]
    v_mfma_f32_16x16x32_bf16 v[232:235], a[64:67], a[48:51], v[232:235]
    v_mfma_f32_16x16x32_bf16 v[236:239], a[68:71], a[48:51], v[236:239]
    ds_read_b128 a[48:51], v139 offset:13312
    v_mfma_f32_16x16x32_bf16 v[236:239], a[32:35], a[12:15], v[236:239]
    ds_read_b128 a[12:15], v139 offset:3072
    v_mfma_f32_16x16x32_bf16 v[248:251], a[28:31], a[16:19], v[248:251]
    ds_read_b64_tr_b16 a[28:29], v138 offset:64
    ds_read_b64_tr_b16 a[30:31], v138 offset:576
    v_mfma_f32_16x16x32_bf16 v[248:251], a[64:67], a[52:55], v[248:251]
    ds_read_b64_tr_b16 a[64:65], v138 offset:8512
    ds_read_b64_tr_b16 a[66:67], v138 offset:9024
    v_mfma_f32_16x16x32_bf16 v[252:255], a[68:71], a[52:55], v[252:255]
    ds_read_b128 a[52:55], v139 offset:14336
    v_mfma_f32_16x16x32_bf16 v[252:255], a[32:35], a[16:19], v[252:255]
    s_waitcnt lgkmcnt(15)
    ds_read_b128 a[16:19], v139 offset:4096
    v_mfma_f32_16x16x32_bf16 v[176:179], a[20:23], a[0:3], v[176:179]
    ds_read_b64_tr_b16 a[32:33], v138 offset:96
    ds_read_b64_tr_b16 a[34:35], v138 offset:608
    v_mfma_f32_16x16x32_bf16 v[176:179], a[56:59], a[36:39], v[176:179]
    s_waitcnt lgkmcnt(15)
    ds_read_b64_tr_b16 a[68:69], v138 offset:8544
    ds_read_b64_tr_b16 a[70:71], v138 offset:9056
    v_mfma_f32_16x16x32_bf16 v[180:183], a[60:63], a[36:39], v[180:183]
    s_waitcnt lgkmcnt(15)
    v_mfma_f32_16x16x32_bf16 v[180:183], a[24:27], a[0:3], v[180:183]
    v_mfma_f32_16x16x32_bf16 v[192:195], a[20:23], a[4:7], v[192:195]
    s_waitcnt lgkmcnt(14)
    v_mfma_f32_16x16x32_bf16 v[192:195], a[56:59], a[40:43], v[192:195]
    v_mfma_f32_16x16x32_bf16 v[196:199], a[60:63], a[40:43], v[196:199]
    v_mfma_f32_16x16x32_bf16 v[196:199], a[24:27], a[4:7], v[196:199]
    s_waitcnt lgkmcnt(12)
    v_mfma_f32_16x16x32_bf16 v[208:211], a[20:23], a[8:11], v[208:211]
    v_mfma_f32_16x16x32_bf16 v[208:211], a[56:59], a[44:47], v[208:211]
    v_mfma_f32_16x16x32_bf16 v[212:215], a[60:63], a[44:47], v[212:215]
    v_mfma_f32_16x16x32_bf16 v[212:215], a[24:27], a[8:11], v[212:215]
    s_waitcnt lgkmcnt(10)
    v_mfma_f32_16x16x32_bf16 v[224:227], a[20:23], a[12:15], v[224:227]
    v_mfma_f32_16x16x32_bf16 v[224:227], a[56:59], a[48:51], v[224:227]
    v_mfma_f32_16x16x32_bf16 v[228:231], a[60:63], a[48:51], v[228:231]
    v_mfma_f32_16x16x32_bf16 v[228:231], a[24:27], a[12:15], v[228:231]
    s_waitcnt lgkmcnt(4)
    v_mfma_f32_16x16x32_bf16 v[240:243], a[20:23], a[16:19], v[240:243]
    v_mfma_f32_16x16x32_bf16 v[240:243], a[56:59], a[52:55], v[240:243]
    v_mfma_f32_16x16x32_bf16 v[244:247], a[60:63], a[52:55], v[244:247]
    v_mfma_f32_16x16x32_bf16 v[244:247], a[24:27], a[16:19], v[244:247]
    s_waitcnt vmcnt(0)
    v_mfma_f32_16x16x32_bf16 v[176:179], v[148:151], v[32:35], v[176:179]
    v_mfma_f32_16x16x32_bf16 v[180:183], v[150:153], v[32:35], v[180:183]
    v_mfma_f32_16x16x32_bf16 v[192:195], v[148:151], v[40:43], v[192:195]
    v_mfma_f32_16x16x32_bf16 v[196:199], v[150:153], v[40:43], v[196:199]
    v_mfma_f32_16x16x32_bf16 v[208:211], v[148:151], v[48:51], v[208:211]
    v_mfma_f32_16x16x32_bf16 v[212:215], v[150:153], v[48:51], v[212:215]
    v_mfma_f32_16x16x32_bf16 v[224:227], v[148:151], v[56:59], v[224:227]
    v_mfma_f32_16x16x32_bf16 v[228:231], v[150:153], v[56:59], v[228:231]
    v_mfma_f32_16x16x32_bf16 v[240:243], v[148:151], v[64:67], v[240:243]
    v_cvt_pk_bf16_f32 v72, v176, v177
    v_cvt_pk_bf16_f32 v73, v178, v179
    v_mfma_f32_16x16x32_bf16 v[244:247], v[150:153], v[64:67], v[244:247]
    v_cvt_pk_bf16_f32 v74, v180, v181
    v_cvt_pk_bf16_f32 v75, v182, v183
    v_mfma_f32_16x16x32_bf16 v[184:187], v[148:151], v[36:39], v[184:187]
    v_permlane32_swap_b32 v72, v74
    v_permlane32_swap_b32 v73, v75
    v_mfma_f32_16x16x32_bf16 v[188:191], v[150:153], v[36:39], v[188:191]
    v_cvt_pk_bf16_f32 v80, v192, v193
    v_cvt_pk_bf16_f32 v81, v194, v195
    v_mfma_f32_16x16x32_bf16 v[200:203], v[148:151], v[44:47], v[200:203]
    v_cvt_pk_bf16_f32 v82, v196, v197
    v_cvt_pk_bf16_f32 v83, v198, v199
    v_mfma_f32_16x16x32_bf16 v[204:207], v[150:153], v[44:47], v[204:207]
    v_permlane16_swap_b32 v72, v74
    v_permlane16_swap_b32 v73, v75
    v_mfma_f32_16x16x32_bf16 v[216:219], v[148:151], v[52:55], v[216:219]
    buffer_store_dwordx4 v[72:75], v140, s[12:15], s52 offen offset:0 nt sc1
    v_mfma_f32_16x16x32_bf16 v[220:223], v[150:153], v[52:55], v[220:223]
    v_permlane32_swap_b32 v80, v82
    v_permlane32_swap_b32 v81, v83
    v_mfma_f32_16x16x32_bf16 v[232:235], v[148:151], v[60:63], v[232:235]
    v_cvt_pk_bf16_f32 v88, v208, v209
    v_cvt_pk_bf16_f32 v89, v210, v211
    v_mfma_f32_16x16x32_bf16 v[236:239], v[150:153], v[60:63], v[236:239]
    v_cvt_pk_bf16_f32 v90, v212, v213
    v_cvt_pk_bf16_f32 v91, v214, v215
    v_mfma_f32_16x16x32_bf16 v[248:251], v[148:151], v[68:71], v[248:251]
    v_permlane16_swap_b32 v80, v82
    v_permlane16_swap_b32 v81, v83
    v_mfma_f32_16x16x32_bf16 v[252:255], v[150:153], v[68:71], v[252:255]
    buffer_store_dwordx4 v[80:83], v140, s[12:15], s53 offen offset:0 nt sc1
    v_mfma_f32_16x16x32_bf16 v[184:187], a[28:31], a[0:3], v[184:187]
    v_permlane32_swap_b32 v88, v90
    v_permlane32_swap_b32 v89, v91
    v_mfma_f32_16x16x32_bf16 v[184:187], a[64:67], a[36:39], v[184:187]
    s_waitcnt lgkmcnt(0)
    v_cvt_pk_bf16_f32 v96, v224, v225
    v_cvt_pk_bf16_f32 v97, v226, v227
    v_mfma_f32_16x16x32_bf16 v[188:191], a[68:71], a[36:39], v[188:191]
    v_cvt_pk_bf16_f32 v98, v228, v229
    v_cvt_pk_bf16_f32 v99, v230, v231
    v_mfma_f32_16x16x32_bf16 v[188:191], a[32:35], a[0:3], v[188:191]
    v_permlane16_swap_b32 v88, v90
    v_permlane16_swap_b32 v89, v91
    v_mfma_f32_16x16x32_bf16 v[200:203], a[28:31], a[4:7], v[200:203]
    buffer_store_dwordx4 v[88:91], v140, s[12:15], s54 offen offset:0 nt sc1
    v_mfma_f32_16x16x32_bf16 v[200:203], a[64:67], a[40:43], v[200:203]
    v_permlane32_swap_b32 v96, v98
    v_permlane32_swap_b32 v97, v99
    v_mfma_f32_16x16x32_bf16 v[204:207], a[68:71], a[40:43], v[204:207]
    v_cvt_pk_bf16_f32 v104, v240, v241
    v_cvt_pk_bf16_f32 v105, v242, v243
    v_mfma_f32_16x16x32_bf16 v[204:207], a[32:35], a[4:7], v[204:207]
    v_cvt_pk_bf16_f32 v106, v244, v245
    v_cvt_pk_bf16_f32 v107, v246, v247
    v_mfma_f32_16x16x32_bf16 v[216:219], a[28:31], a[8:11], v[216:219]
    v_permlane16_swap_b32 v96, v98
    v_permlane16_swap_b32 v97, v99
    v_mfma_f32_16x16x32_bf16 v[216:219], a[64:67], a[44:47], v[216:219]
    buffer_store_dwordx4 v[96:99], v140, s[12:15], s55 offen offset:0 nt sc1
    v_mfma_f32_16x16x32_bf16 v[220:223], a[68:71], a[44:47], v[220:223]
    v_permlane32_swap_b32 v104, v106
    v_permlane32_swap_b32 v105, v107
    v_mfma_f32_16x16x32_bf16 v[220:223], a[32:35], a[8:11], v[220:223]
    v_cvt_pk_bf16_f32 v76, v184, v185
    v_cvt_pk_bf16_f32 v77, v186, v187
    v_mfma_f32_16x16x32_bf16 v[232:235], a[28:31], a[12:15], v[232:235]
    v_cvt_pk_bf16_f32 v78, v188, v189
    v_cvt_pk_bf16_f32 v79, v190, v191
    v_mfma_f32_16x16x32_bf16 v[232:235], a[64:67], a[48:51], v[232:235]
    v_permlane16_swap_b32 v104, v106
    v_permlane16_swap_b32 v105, v107
    v_mfma_f32_16x16x32_bf16 v[236:239], a[68:71], a[48:51], v[236:239]
    buffer_store_dwordx4 v[104:107], v140, s[12:15], s56 offen offset:0 nt sc1
    v_mfma_f32_16x16x32_bf16 v[236:239], a[32:35], a[12:15], v[236:239]
    v_permlane32_swap_b32 v76, v78
    v_permlane32_swap_b32 v77, v79
    v_mfma_f32_16x16x32_bf16 v[248:251], a[28:31], a[16:19], v[248:251]
    v_cvt_pk_bf16_f32 v84, v200, v201
    v_cvt_pk_bf16_f32 v85, v202, v203
    v_mfma_f32_16x16x32_bf16 v[248:251], a[64:67], a[52:55], v[248:251]
    v_cvt_pk_bf16_f32 v86, v204, v205
    v_cvt_pk_bf16_f32 v87, v206, v207
    v_mfma_f32_16x16x32_bf16 v[252:255], a[68:71], a[52:55], v[252:255]
    v_permlane16_swap_b32 v76, v78
    v_permlane16_swap_b32 v77, v79
    v_mfma_f32_16x16x32_bf16 v[252:255], a[32:35], a[16:19], v[252:255]
    buffer_store_dwordx4 v[76:79], v140, s[12:15], s52 offen offset:64 nt sc1
    v_permlane32_swap_b32 v84, v86
    v_permlane32_swap_b32 v85, v87
    v_cvt_pk_bf16_f32 v92, v216, v217
    v_cvt_pk_bf16_f32 v93, v218, v219
    v_cvt_pk_bf16_f32 v94, v220, v221
    v_cvt_pk_bf16_f32 v95, v222, v223
    v_permlane16_swap_b32 v84, v86
    v_permlane16_swap_b32 v85, v87
    v_permlane32_swap_b32 v92, v94
    buffer_store_dwordx4 v[84:87], v140, s[12:15], s53 offen offset:64 nt sc1
    v_permlane32_swap_b32 v93, v95
    v_cvt_pk_bf16_f32 v100, v232, v233
    v_cvt_pk_bf16_f32 v101, v234, v235
    v_cvt_pk_bf16_f32 v102, v236, v237
    v_cvt_pk_bf16_f32 v103, v238, v239
    v_permlane16_swap_b32 v92, v94
    v_permlane16_swap_b32 v93, v95
    v_permlane32_swap_b32 v100, v102
    buffer_store_dwordx4 v[92:95], v140, s[12:15], s54 offen offset:64 nt sc1
    v_permlane32_swap_b32 v101, v103
    v_cvt_pk_bf16_f32 v108, v248, v249
    v_cvt_pk_bf16_f32 v109, v250, v251
    v_cvt_pk_bf16_f32 v110, v252, v253
    v_cvt_pk_bf16_f32 v111, v254, v255
    v_permlane16_swap_b32 v100, v102
    v_permlane16_swap_b32 v101, v103
    v_permlane32_swap_b32 v108, v110
    buffer_store_dwordx4 v[100:103], v140, s[12:15], s55 offen offset:64 nt sc1
    v_permlane32_swap_b32 v109, v111
    v_permlane16_swap_b32 v108, v110
    s_nop 0
    v_permlane16_swap_b32 v109, v111
    buffer_store_dwordx4 v[108:111], v140, s[12:15], s56 offen offset:64 nt sc1
    s_branch L2_fin
L2_send:
    v_mfma_f32_16x16x32_bf16 v[184:187], a[28:31], a[0:3], v[184:187]
    s_barrier
    v_mfma_f32_16x16x32_bf16 v[184:187], a[64:67], a[36:39], v[184:187]
    s_mov_b32 s44, s32
    v_add_u32 v138, s32, v136
    v_add_u32 v139, s32, v137
    v_mfma_f32_16x16x32_bf16 v[188:191], a[68:71], a[36:39], v[188:191]
    s_add_u32 s32, s32, 37376
    ds_read_b64_tr_b16 a[20:21], v138 offset:0
    ds_read_b64_tr_b16 a[22:23], v138 offset:512
    v_mfma_f32_16x16x32_bf16 v[188:191], a[32:35], a[0:3], v[188:191]
    s_cmp_ge_u32 s32, 149504
    s_cselect_b32 s32, 0, s32
    ds_read_b128 a[0:3], v139 offset:0
    v_mfma_f32_16x16x32_bf16 v[200:203], a[28:31], a[4:7], v[200:203]
    ds_read_b64_tr_b16 a[56:57], v138 offset:8448
    ds_read_b64_tr_b16 a[58:59], v138 offset:8960
    v_mfma_f32_16x16x32_bf16 v[200:203], a[64:67], a[40:43], v[200:203]
    ds_read_b128 a[36:39], v139 offset:10240
    v_mfma_f32_16x16x32_bf16 v[204:207], a[68:71], a[40:43], v[204:207]
    ds_read_b64_tr_b16 a[60:61], v138 offset:8480
    ds_read_b64_tr_b16 a[62:63], v138 offset:8992
    v_mfma_f32_16x16x32_bf16 v[204:207], a[32:35], a[4:7], v[204:207]
    ds_read_b64_tr_b16 a[24:25], v138 offset:32
    ds_read_b64_tr_b16 a[26:27], v138 offset:544
    v_mfma_f32_16x16x32_bf16 v[216:219], a[28:31], a[8:11], v[216:219]
    ds_read_b128 a[4:7], v139 offset:1024
    v_mfma_f32_16x16x32_bf16 v[216:219], a[64:67], a[44:47], v[216:219]
    ds_read_b128 a[40:43], v139 offset:11264
    v_mfma_f32_16x16x32_bf16 v[220:223], a[68:71], a[44:47], v[220:223]
    ds_read_b128 a[44:47], v139 offset:12288
    v_mfma_f32_16x16x32_bf16 v[220:223], a[32:35], a[8:11], v[220:223]
    ds_read_b128 a[8:11], v139 offset:2048
    v_mfma_f32_16x16x32_bf16 v[232:235], a[28:31], a[12:15], v[232:235]
    v_mfma_f32_16x16x32_bf16 v[232:235], a[64:67], a[48:51], v[232:235]
    v_mfma_f32_16x16x32_bf16 v[236:239], a[68:71], a[48:51], v[236:239]
    ds_read_b128 a[48:51], v139 offset:13312
    v_mfma_f32_16x16x32_bf16 v[236:239], a[32:35], a[12:15], v[236:239]
    ds_read_b128 a[12:15], v139 offset:3072
    v_mfma_f32_16x16x32_bf16 v[248:251], a[28:31], a[16:19], v[248:251]
    ds_read_b64_tr_b16 a[28:29], v138 offset:64
    ds_read_b64_tr_b16 a[30:31], v138 offset:576
    v_mfma_f32_16x16x32_bf16 v[248:251], a[64:67], a[52:55], v[248:251]
    ds_read_b64_tr_b16 a[64:65], v138 offset:8512
    ds_read_b64_tr_b16 a[66:67], v138 offset:9024
    v_mfma_f32_16x16x32_bf16 v[252:255], a[68:71], a[52:55], v[252:255]
    ds_read_b128 a[52:55], v139 offset:14336
    v_mfma_f32_16x16x32_bf16 v[252:255], a[32:35], a[16:19], v[252:255]
    s_waitcnt lgkmcnt(15)
    ds_read_b128 a[16:19], v139 offset:4096
    v_mfma_f32_16x16x32_bf16 v[176:179], a[20:23], a[0:3], v[176:179]
    ds_read_b64_tr_b16 a[32:33], v138 offset:96
    ds_read_b64_tr_b16 a[34:35], v138 offset:608
    v_mfma_f32_16x16x32_bf16 v[176:179], a[56:59], a[36:39], v[176:179]
    s_waitcnt lgkmcnt(15)
    ds_read_b64_tr_b16 a[68:69], v138 offset:8544
    ds_read_b64_tr_b16 a[70:71], v138 offset:9056
    v_mfma_f32_16x16x32_bf16 v[180:183], a[60:63], a[36:39], v[180:183]
    s_waitcnt lgkmcnt(15)
    v_mfma_f32_16x16x32_bf16 v[180:183], a[24:27], a[0:3], v[180:183]
    v_mfma_f32_16x16x32_bf16 v[192:195], a[20:23], a[4:7], v[192:195]
    s_waitcnt lgkmcnt(14)
    v_mfma_f32_16x16x32_bf16 v[192:195], a[56:59], a[40:43], v[192:195]
    v_mfma_f32_16x16x32_bf16 v[196:199], a[60:63], a[40:43], v[196:199]
    v_mfma_f32_16x16x32_bf16 v[196:199], a[24:27], a[4:7], v[196:199]
    s_waitcnt lgkmcnt(12)
    v_mfma_f32_16x16x32_bf16 v[208:211], a[20:23], a[8:11], v[208:211]
    v_mfma_f32_16x16x32_bf16 v[208:211], a[56:59], a[44:47], v[208:211]
    v_mfma_f32_16x16x32_bf16 v[212:215], a[60:63], a[44:47], v[212:215]
    s_waitcnt vmcnt(0) lgkmcnt(0)
    v_mfma_f32_16x16x32_bf16 v[212:215], a[24:27], a[8:11], v[212:215]
    v_mfma_f32_16x16x32_bf16 v[224:227], a[20:23], a[12:15], v[224:227]
    v_mfma_f32_16x16x32_bf16 v[224:227], a[56:59], a[48:51], v[224:227]
    v_mfma_f32_16x16x32_bf16 v[228:231], a[60:63], a[48:51], v[228:231]
    v_mfma_f32_16x16x32_bf16 v[228:231], a[24:27], a[12:15], v[228:231]
    v_mfma_f32_16x16x32_bf16 v[240:243], a[20:23], a[16:19], v[240:243]
    v_mfma_f32_16x16x32_bf16 v[240:243], a[56:59], a[52:55], v[240:243]
    v_mfma_f32_16x16x32_bf16 v[244:247], a[60:63], a[52:55], v[244:247]
    v_mfma_f32_16x16x32_bf16 v[244:247], a[24:27], a[16:19], v[244:247]
    v_mfma_f32_16x16x32_bf16 v[184:187], a[28:31], a[0:3], v[184:187]
    s_barrier
    v_mfma_f32_16x16x32_bf16 v[184:187], a[64:67], a[36:39], v[184:187]
    v_add_u32 v138, s32, v136
    v_add_u32 v139, s32, v137
    v_mfma_f32_16x16x32_bf16 v[188:191], a[68:71], a[36:39], v[188:191]
    ds_read_b64_tr_b16 a[20:21], v138 offset:0
    ds_read_b64_tr_b16 a[22:23], v138 offset:512
    v_mfma_f32_16x16x32_bf16 v[188:191], a[32:35], a[0:3], v[188:191]
    ds_read_b128 a[0:3], v139 offset:0
    v_mfma_f32_16x16x32_bf16 v[200:203], a[28:31], a[4:7], v[200:203]
    ds_read_b64_tr_b16 a[56:57], v138 offset:8448
    ds_read_b64_tr_b16 a[58:59], v138 offset:8960
    v_mfma_f32_16x16x32_bf16 v[200:203], a[64:67], a[40:43], v[200:203]
    ds_read_b128 a[36:39], v139 offset:10240
    v_mfma_f32_16x16x32_bf16 v[204:207], a[68:71], a[40:43], v[204:207]
    ds_read_b64_tr_b16 a[60:61], v138 offset:8480
    ds_read_b64_tr_b16 a[62:63], v138 offset:8992
    v_mfma_f32_16x16x32_bf16 v[204:207], a[32:35], a[4:7], v[204:207]
    ds_read_b64_tr_b16 a[24:25], v138 offset:32
    ds_read_b64_tr_b16 a[26:27], v138 offset:544
    v_mfma_f32_16x16x32_bf16 v[216:219], a[28:31], a[8:11], v[216:219]
    ds_read_b128 a[4:7], v139 offset:1024
    v_mfma_f32_16x16x32_bf16 v[216:219], a[64:67], a[44:47], v[216:219]
    ds_read_b128 a[40:43], v139 offset:11264
    v_mfma_f32_16x16x32_bf16 v[220:223], a[68:71], a[44:47], v[220:223]
    ds_read_b128 a[44:47], v139 offset:12288
    v_mfma_f32_16x16x32_bf16 v[220:223], a[32:35], a[8:11], v[220:223]
    ds_read_b128 a[8:11], v139 offset:2048
    v_mfma_f32_16x16x32_bf16 v[232:235], a[28:31], a[12:15], v[232:235]
    v_mfma_f32_16x16x32_bf16 v[232:235], a[64:67], a[48:51], v[232:235]
    v_mfma_f32_16x16x32_bf16 v[236:239], a[68:71], a[48:51], v[236:239]
    ds_read_b128 a[48:51], v139 offset:13312
    v_mfma_f32_16x16x32_bf16 v[236:239], a[32:35], a[12:15], v[236:239]
    ds_read_b128 a[12:15], v139 offset:3072
    v_mfma_f32_16x16x32_bf16 v[248:251], a[28:31], a[16:19], v[248:251]
    ds_read_b64_tr_b16 a[28:29], v138 offset:64
    ds_read_b64_tr_b16 a[30:31], v138 offset:576
    v_mfma_f32_16x16x32_bf16 v[248:251], a[64:67], a[52:55], v[248:251]
    ds_read_b64_tr_b16 a[64:65], v138 offset:8512
    ds_read_b64_tr_b16 a[66:67], v138 offset:9024
    v_mfma_f32_16x16x32_bf16 v[252:255], a[68:71], a[52:55], v[252:255]
    ds_read_b128 a[52:55], v139 offset:14336
    v_mfma_f32_16x16x32_bf16 v[252:255], a[32:35], a[16:19], v[252:255]
    s_waitcnt lgkmcnt(15)
    ds_read_b128 a[16:19], v139 offset:4096
    v_mfma_f32_16x16x32_bf16 v[176:179], a[20:23], a[0:3], v[176:179]
    ds_read_b64_tr_b16 a[68:69], v138 offset:8544
    ds_read_b64_tr_b16 a[70:71], v138 offset:9056
    v_mfma_f32_16x16x32_bf16 v[176:179], a[56:59], a[36:39], v[176:179]
    s_waitcnt lgkmcnt(15)
    ds_read_b64_tr_b16 a[32:33], v138 offset:96
    ds_read_b64_tr_b16 a[34:35], v138 offset:608
    v_mfma_f32_16x16x32_bf16 v[180:183], a[60:63], a[36:39], v[180:183]
    s_waitcnt lgkmcnt(15)
    v_mfma_f32_16x16x32_bf16 v[180:183], a[24:27], a[0:3], v[180:183]
    v_mfma_f32_16x16x32_bf16 v[192:195], a[20:23], a[4:7], v[192:195]
    s_waitcnt lgkmcnt(14)
    v_mfma_f32_16x16x32_bf16 v[192:195], a[56:59], a[40:43], v[192:195]
    v_mfma_f32_16x16x32_bf16 v[196:199], a[60:63], a[40:43], v[196:199]
    v_mfma_f32_16x16x32_bf16 v[196:199], a[24:27], a[4:7], v[196:199]
    s_waitcnt lgkmcnt(12)
    v_cvt_pk_bf16_f32 v32, v176, v177
    v_cvt_pk_bf16_f32 v33, v178, v179
    v_mfma_f32_16x16x32_bf16 v[208:211], a[20:23], a[8:11], v[208:211]
    v_mfma_f32_16x16x32_bf16 v[208:211], a[56:59], a[44:47], v[208:211]
    v_cvt_pk_bf16_f32 v34, v180, v181
    v_cvt_pk_bf16_f32 v35, v182, v183
    v_mfma_f32_16x16x32_bf16 v[212:215], a[60:63], a[44:47], v[212:215]
    buffer_store_dwordx4 v[32:35], v20, s[60:63], s48 offen offset:0 sc1
    v_mfma_f32_16x16x32_bf16 v[212:215], a[24:27], a[8:11], v[212:215]
    s_waitcnt lgkmcnt(10)
    v_cvt_pk_bf16_f32 v40, v192, v193
    v_cvt_pk_bf16_f32 v41, v194, v195
    v_mfma_f32_16x16x32_bf16 v[224:227], a[20:23], a[12:15], v[224:227]
    v_cvt_pk_bf16_f32 v42, v196, v197
    v_cvt_pk_bf16_f32 v43, v198, v199
    v_mfma_f32_16x16x32_bf16 v[224:227], a[56:59], a[48:51], v[224:227]
    buffer_store_dwordx4 v[40:43], v20, s[60:63], s48 offen offset:2048 sc1
    v_mfma_f32_16x16x32_bf16 v[228:231], a[60:63], a[48:51], v[228:231]
    v_cvt_pk_bf16_f32 v48, v208, v209
    v_cvt_pk_bf16_f32 v49, v210, v211
    v_mfma_f32_16x16x32_bf16 v[228:231], a[24:27], a[12:15], v[228:231]
    s_waitcnt lgkmcnt(4)
    v_cvt_pk_bf16_f32 v50, v212, v213
    v_cvt_pk_bf16_f32 v51, v214, v215
    v_mfma_f32_16x16x32_bf16 v[240:243], a[20:23], a[16:19], v[240:243]
    buffer_store_dwordx4 v[48:51], v20, s[60:63], s49 offen offset:0 sc1
    v_mfma_f32_16x16x32_bf16 v[240:243], a[56:59], a[52:55], v[240:243]
    v_cvt_pk_bf16_f32 v56, v224, v225
    v_cvt_pk_bf16_f32 v57, v226, v227
    v_mfma_f32_16x16x32_bf16 v[244:247], a[60:63], a[52:55], v[244:247]
    v_cvt_pk_bf16_f32 v58, v228, v229
    v_cvt_pk_bf16_f32 v59, v230, v231
    v_mfma_f32_16x16x32_bf16 v[244:247], a[24:27], a[16:19], v[244:247]
    buffer_store_dwordx4 v[56:59], v20, s[60:63], s49 offen offset:2048 sc1
    v_mfma_f32_16x16x32_bf16 v[184:187], a[28:31], a[0:3], v[184:187]
    v_cvt_pk_bf16_f32 v64, v240, v241
    v_cvt_pk_bf16_f32 v65, v242, v243
    v_mfma_f32_16x16x32_bf16 v[184:187], a[64:67], a[36:39], v[184:187]
    s_waitcnt lgkmcnt(2)
    v_mfma_f32_16x16x32_bf16 v[188:191], a[68:71], a[36:39], v[188:191]
    s_waitcnt lgkmcnt(0)
    v_mfma_f32_16x16x32_bf16 v[188:191], a[32:35], a[0:3], v[188:191]
    v_mfma_f32_16x16x32_bf16 v[200:203], a[28:31], a[4:7], v[200:203]
    v_cvt_pk_bf16_f32 v66, v244, v245
    v_cvt_pk_bf16_f32 v67, v246, v247
    v_mfma_f32_16x16x32_bf16 v[200:203], a[64:67], a[40:43], v[200:203]
    buffer_store_dwordx4 v[64:67], v20, s[60:63], s50 offen offset:0 sc1
    v_mfma_f32_16x16x32_bf16 v[204:207], a[68:71], a[40:43], v[204:207]
    v_cvt_pk_bf16_f32 v36, v184, v185
    v_cvt_pk_bf16_f32 v37, v186, v187
    v_mfma_f32_16x16x32_bf16 v[204:207], a[32:35], a[4:7], v[204:207]
    v_cvt_pk_bf16_f32 v38, v188, v189
    v_cvt_pk_bf16_f32 v39, v190, v191
    v_mfma_f32_16x16x32_bf16 v[216:219], a[28:31], a[8:11], v[216:219]
    buffer_store_dwordx4 v[36:39], v20, s[60:63], s48 offen offset:1024 sc1
    v_mfma_f32_16x16x32_bf16 v[216:219], a[64:67], a[44:47], v[216:219]
    v_cvt_pk_bf16_f32 v44, v200, v201
    v_cvt_pk_bf16_f32 v45, v202, v203
    v_mfma_f32_16x16x32_bf16 v[220:223], a[68:71], a[44:47], v[220:223]
    v_cvt_pk_bf16_f32 v46, v204, v205
    v_cvt_pk_bf16_f32 v47, v206, v207
    v_mfma_f32_16x16x32_bf16 v[220:223], a[32:35], a[8:11], v[220:223]
    buffer_store_dwordx4 v[44:47], v20, s[60:63], s48 offen offset:3072 sc1
    v_mfma_f32_16x16x32_bf16 v[232:235], a[28:31], a[12:15], v[232:235]
    v_cvt_pk_bf16_f32 v52, v216, v217
    v_cvt_pk_bf16_f32 v53, v218, v219
    v_mfma_f32_16x16x32_bf16 v[232:235], a[64:67], a[48:51], v[232:235]
    v_mfma_f32_16x16x32_bf16 v[236:239], a[68:71], a[48:51], v[236:239]
    v_mfma_f32_16x16x32_bf16 v[236:239], a[32:35], a[12:15], v[236:239]
    v_mfma_f32_16x16x32_bf16 v[248:251], a[28:31], a[16:19], v[248:251]
    v_cvt_pk_bf16_f32 v54, v220, v221
    v_cvt_pk_bf16_f32 v55, v222, v223
    v_mfma_f32_16x16x32_bf16 v[248:251], a[64:67], a[52:55], v[248:251]
    buffer_store_dwordx4 v[52:55], v20, s[60:63], s49 offen offset:1024 sc1
    v_mfma_f32_16x16x32_bf16 v[252:255], a[68:71], a[52:55], v[252:255]
    v_cvt_pk_bf16_f32 v60, v232, v233
    v_cvt_pk_bf16_f32 v61, v234, v235
    v_mfma_f32_16x16x32_bf16 v[252:255], a[32:35], a[16:19], v[252:255]
    v_cvt_pk_bf16_f32 v62, v236, v237
    v_cvt_pk_bf16_f32 v63, v238, v239
    s_nop 0
    v_cvt_pk_bf16_f32 v68, v248, v249
    buffer_store_dwordx4 v[60:63], v20, s[60:63], s49 offen offset:3072 sc1
    v_cvt_pk_bf16_f32 v69, v250, v251
    s_nop 1
    v_cvt_pk_bf16_f32 v70, v252, v253
    v_cvt_pk_bf16_f32 v71, v254, v255
    buffer_store_dwordx4 v[68:71], v20, s[60:63], s50 offen offset:1024 sc1
    s_waitcnt vmcnt(0)
    s_barrier
    s_add_u32 s68, s69, 3
    v_mov_b32 v143, s68
    s_cmp_eq_u32 s3, 0
    s_cselect_b32 s66, 4, 0
    buffer_store_dword v143, v20, s[64:67], 0 offen sc1
L2_fin:
L1_end:
    s_endpgm
L2_w1s:
    s_add_u32 s47, s47, 1
    s_cmp_ge_u32 s47, 0x80000
    s_cbranch_scc1 L2_g1
    buffer_load_dword v142, v141, s[4:7], 0 offen sc1
    s_waitcnt vmcnt(0)
    s_branch L2_w1
L2_w3s:
    s_add_u32 s47, s47, 1
    s_cmp_ge_u32 s47, 0x80000
    s_cbranch_scc1 L2_g3
    buffer_load_dword v142, v146, s[64:67], 0 offen sc1
    s_waitcnt vmcnt(0)
    s_branch L2_w3
L2_e1:
    s_add_u32 s68, s69, 2
    v_mov_b32 v143, s68
    buffer_store_dword v143, v23, s[40:43], 0 offen sc1
    s_mov_b32 s59, 10
    s_branch L2_loop
L2_e2:
    v_mov_b32 v142, s69
    buffer_load_dword v142, v159, s[4:7], 0 offen sc1
    s_mov_b32 s59, 12
    s_branch L2_loop
L2_w2p:
L2_w2:
    s_add_u32 s68, s69, 2
    v_subrev_u32 v143, s68, v142
    v_cmp_lt_u32 vcc, 1, v143
    s_nop 3
    s_cmp_lg_u64 vcc, 0
    s_cbranch_scc1 L2_w2s
L2_g2:
    s_add_u32 s59, s35, 11
    s_branch L2_loop
L2_e4:
    buffer_load_dword v142, v146, s[64:67], 0 offen sc1
    s_add_u32 s59, s35, 12
    s_branch L2_loop
L2_w2s:
    s_add_u32 s47, s47, 1
    s_cmp_ge_u32 s47, 0x80000
    s_cbranch_scc1 L2_g2
    buffer_load_dword v142, v159, s[4:7], 0 offen sc1
    s_waitcnt vmcnt(0)
    s_branch L2_w2
L2_idle:
    buffer_store_dwordx4 v[80:83], v20, s[16:19], s51 offen offset:0 sc1
    buffer_store_dwordx4 v[84:87], v20, s[16:19], s51 offen offset:1024 sc1
    buffer_store_dwordx4 v[88:91], v20, s[16:19], s51 offen offset:2048 sc1
    buffer_store_dwordx4 v[92:95], v20, s[16:19], s51 offen offset:3072 sc1
    s_waitcnt vmcnt(0)
    s_barrier
    s_add_u32 s68, s69, 2
    v_mov_b32 v143, s68
    buffer_store_dword v143, v23, s[40:43], 0 offen sc1
    s_branch L2_fin
L2_redo:
    s_and_b32 s58, s2, 1
    s_bfe_u32 s94, s2, 0x20001
    s_lshr_b32 s98, s2, 3
    s_mul_i32 s95, s98, 52
    s_lshr_b32 s95, s95, 8
    s_mul_i32 s97, s95, 5
    s_sub_u32 s97, s98, s97
    s_mul_i32 s96, s94, 6
    s_add_u32 s96, s96, s95
    s_mov_b32 s52, 0
    s_mov_b32 s57, 0
    s_cmp_eq_u32 s58, 0
    s_cselect_b32 s56, 4, 20
    s_cselect_b32 s35, 14, 18
    s_cselect_b32 s45, -12, 2
    s_mov_b32 s55, 12
    s_mul_i32 s34, s3, 4224
    s_lshl_b32 s94, s97, 8
    s_add_u32 s84, s88, s94
    s_addc_u32 s85, s89, 0
    s_sub_u32 s86, 5242880, s94
    s_mov_b32 s87, 0x20000
    s_lshr_b32 s94, s3, 1
    s_mul_i32 s94, s94, 30720
    s_mul_i32 s95, s3, 5120
    s_add_u32 s94, s94, s95
    v_lshrrev_b32 v143, 4, v1
    v_mul_u32_u24 v143, 9984, v143
    v_add3_u32 v128, v143, v20, s94
    v_add_u32 v129, 224, v128
    v_add_u32 v130, 448, v128
    v_add_u32 v131, 672, v128
    s_lshl_b32 s66, s2, 7
    s_add_u32 s66, s66, 32505856
    s_add_u32 s4, s28, s66
    s_addc_u32 s5, s29, 0
    s_mov_b32 s6, 128
    s_mov_b32 s7, 0x20000
    v_and_b32 v141, 31, v1
    v_lshlrev_b32 v141, 2, v141
    s_mul_i32 s66, s96, 43
    s_lshr_b32 s66, s66, 7
    s_mul_i32 s66, s66, 3
    s_sub_u32 s66, s96, s66
    s_and_b32 s67, s66, 1
    s_lshl_b32 s67, s67, 6
    s_lshr_b32 s66, s66, 1
    s_lshl_b32 s66, s66, 6
    s_lshl_b32 s62, s58, 5
    s_add_u32 s67, s67, 28
    s_add_u32 s63, s67, s62
    v_and_b32 v159, s63, v141
    v_or_b32 v159, s66, v159
    v_or_b32 v141, s62, v159
    s_and_b32 s62, s3, 1
    s_lshr_b32 s63, s3, 1
    s_mul_i32 s38, s3, 5120
    s_add_u32 s38, s38, 16896
    s_mul_i32 s66, s96, 40960
    s_add_u32 s8, s28, s66
    s_addc_u32 s9, s29, 0
    s_mov_b32 s10, 30642176
    s_mov_b32 s11, 0x20000
    s_mul_i32 s66, s62, 20480
    s_lshl_b32 s67, s63, 10
    s_add_u32 s66, s66, s67
    v_add_u32 v132, s66, v20
    v_add_u32 v133, 3072, v132
    v_add_u32 v134, 6144, v132
    v_add_u32 v135, 9216, v132
    v_add_u32 v147, 16384, v132
    s_lshl_b32 s66, s62, 7
    v_add_u32 v136, s66, v3
    v_add_u32 v138, s66, v3
    s_mul_i32 s67, s63, 5120
    s_add_u32 s67, s67, 16896
    v_add_u32 v137, s67, v20
    v_add_u32 v139, s67, v20
    s_mul_i32 s37, s58, 2621440
    s_mul_i32 s39, s58, 15794176
    s_add_u32 s44, s37, 81920
    s_add_u32 s59, s39, 2048
    s_add_u32 s20, s37, 327680
    s_add_u32 s21, s39, 1974272
    s_add_u32 s92, s37, 409600
    s_add_u32 s93, s39, 1976320
    s_add_u32 s68, s52, s56
    s_and_b32 s95, s68, 1
    s_sub_u32 s68, s68, s95
    s_add_u32 s68, s68, s57
    s_mul_i32 s94, s68, 987136
    s_lshl_b32 s68, s68, 1
    s_add_u32 s68, s68, s95
    s_lshl_b32 s95, s95, 11
    s_mul_i32 s33, s68, 81920
    s_add_u32 s36, s94, s95
    s_add_u32 s52, s52, 1
    s_cmp_eq_u32 s52, 12
    s_cselect_b32 s57, 1, s57
    s_cselect_b32 s56, s45, s56
    s_branch L2_wait
L2_late:
    s_waitcnt vmcnt(0)
    s_barrier
    s_add_u32 s68, s69, 1
    v_mov_b32 v143, s68
    buffer_store_dword v143, v23, s[40:43], 0 offen sc1
    s_branch L2_st1
L1_fbs:
    buffer_store_dwordx4 v[80:83], v20, s[16:19], s51 offen offset:0 sc1
    buffer_store_dwordx4 v[84:87], v20, s[16:19], s51 offen offset:1024 sc1
    buffer_store_dwordx4 v[88:91], v20, s[16:19], s51 offen offset:2048 sc1
    buffer_store_dwordx4 v[92:95], v20, s[16:19], s51 offen offset:3072 sc1
L1_fb:
    s_waitcnt vmcnt(0)
    s_bitcmp1_b32 s99, 0
    s_cselect_b32 s45, 0, 1
    s_lshl_b32 s52, 1, s45
    s_andn2_b32 s99, s99, s52
    s_lshl_b32 s53, s31, 1
    s_add_u32 s53, s53, s45
    s_lshl_b32 s52, s30, 5
    s_add_u32 s52, s52, s53
    s_lshl_b32 s52, s52, 18
    s_add_u32 s60, s22, s52
    s_addc_u32 s61, s23, 0
    s_mov_b32 s62, 0x40000
    s_mov_b32 s63, 0x20000
    s_add_u32 s64, s24, s52
    s_addc_u32 s65, s25, 0
    s_mov_b32 s66, 0x40000
    s_mov_b32 s67, 0x20000
    s_lshl_b32 s53, s53, 8
    s_add_u32 s4, s26, s53
    s_addc_u32 s5, s27, 0
    s_sub_u32 s6, 5242880, s53
    s_mov_b32 s7, 0x20000
    s_xor_b32 s53, s45, 1
    s_mul_i32 s53, s53, 987136
    s_sub_u32 s8, s16, s53
    s_subb_u32 s9, s17, 0
    s_mov_b32 s10, s18
    s_mov_b32 s11, 0x20000
    v_and_b32 v88, 15, v1
    v_lshrrev_b32 v89, 4, v1
    v_lshlrev_b32 v84, 8, v88
    v_lshl_add_u32 v84, v89, 4, v84
    v_lshlrev_b32 v85, 10, v89
    v_lshl_add_u32 v85, v88, 1, v85
    v_mul_u32_u24 v86, 1280, v88
    v_lshl_add_u32 v86, v89, 4, v86
    v_lshlrev_b32 v87, 16, v89
    v_lshl_add_u32 v87, v88, 1, v87
    s_mov_b32 s54, 0
    v_mov_b32 v80, 0
    v_mov_b32 v81, 0
    v_mov_b32 v82, 0
    v_mov_b32 v83, 0
    s_nop 1
    v_mfma_f32_32x32x16_bf16 a[0:15], v[80:83], v[80:83], 0
    v_mfma_f32_32x32x16_bf16 a[16:31], v[80:83], v[80:83], 0
    v_mfma_f32_32x32x16_bf16 a[32:47], v[80:83], v[80:83], 0
    v_mfma_f32_32x32x16_bf16 a[48:63], v[80:83], v[80:83], 0
    v_mfma_f32_32x32x16_bf16 a[64:79], v[80:83], v[80:83], 0
    v_mfma_f32_32x32x16_bf16 a[80:95], v[80:83], v[80:83], 0
    v_mfma_f32_32x32x16_bf16 a[96:111], v[80:83], v[80:83], 0
    v_mfma_f32_32x32x16_bf16 a[112:127], v[80:83], v[80:83], 0
    s_nop 15
L1_fb0:
    s_add_u32 s55, s54, 0
    s_min_u32 s55, s55, s14
    buffer_load_dwordx4 v[32:35], v86, s[12:15], s55 offen
    s_add_u32 s55, s54, 20480
    s_min_u32 s55, s55, s14
    buffer_load_dwordx4 v[36:39], v86, s[12:15], s55 offen
    s_add_u32 s55, s54, 40960
    s_min_u32 s55, s55, s14
    buffer_load_dwordx4 v[40:43], v86, s[12:15], s55 offen
    s_add_u32 s55, s54, 61440
    s_min_u32 s55, s55, s14
    buffer_load_dwordx4 v[44:47], v86, s[12:15], s55 offen
    s_lshl_b32 s32, s54, 12
    s_add_u32 s33, s32, 8192
    s_add_u32 s34, s32, 16384
    s_add_u32 s35, s32, 24576
    s_add_u32 s36, s32, 32768
    s_add_u32 s37, s32, 40960
    s_add_u32 s38, s32, 49152
    s_add_u32 s39, s32, 57344
    buffer_load_ushort v64, v87, s[4:7], s32 offen offset:0
    buffer_load_ushort v65, v87, s[4:7], s33 offen offset:0
    buffer_load_ushort v66, v87, s[4:7], s34 offen offset:0
    buffer_load_ushort v67, v87, s[4:7], s35 offen offset:0
    buffer_load_ushort v68, v87, s[4:7], s36 offen offset:0
    buffer_load_ushort v69, v87, s[4:7], s37 offen offset:0
    buffer_load_ushort v70, v87, s[4:7], s38 offen offset:0
    buffer_load_ushort v71, v87, s[4:7], s39 offen offset:0
    s_waitcnt vmcnt(0)
    v_lshl_or_b32 v80, v65, 16, v64
    v_lshl_or_b32 v81, v67, 16, v66
    v_lshl_or_b32 v82, v69, 16, v68
    v_lshl_or_b32 v83, v71, 16, v70
    s_nop 1
    v_mfma_f32_16x16x32_bf16 a[0:3], v[80:83], v[32:35], a[0:3]
    v_mfma_f32_16x16x32_bf16 a[32:35], v[80:83], v[36:39], a[32:35]
    v_mfma_f32_16x16x32_bf16 a[64:67], v[80:83], v[40:43], a[64:67]
    v_mfma_f32_16x16x32_bf16 a[96:99], v[80:83], v[44:47], a[96:99]
    s_nop 7
    buffer_load_ushort v64, v87, s[4:7], s32 offen offset:32
    buffer_load_ushort v65, v87, s[4:7], s33 offen offset:32
    buffer_load_ushort v66, v87, s[4:7], s34 offen offset:32
    buffer_load_ushort v67, v87, s[4:7], s35 offen offset:32
    buffer_load_ushort v68, v87, s[4:7], s36 offen offset:32
    buffer_load_ushort v69, v87, s[4:7], s37 offen offset:32
    buffer_load_ushort v70, v87, s[4:7], s38 offen offset:32
    buffer_load_ushort v71, v87, s[4:7], s39 offen offset:32
    s_waitcnt vmcnt(0)
    v_lshl_or_b32 v80, v65, 16, v64
    v_lshl_or_b32 v81, v67, 16, v66
    v_lshl_or_b32 v82, v69, 16, v68
    v_lshl_or_b32 v83, v71, 16, v70
    s_nop 1
    v_mfma_f32_16x16x32_bf16 a[4:7], v[80:83], v[32:35], a[4:7]
    v_mfma_f32_16x16x32_bf16 a[36:39], v[80:83], v[36:39], a[36:39]
    v_mfma_f32_16x16x32_bf16 a[68:71], v[80:83], v[40:43], a[68:71]
    v_mfma_f32_16x16x32_bf16 a[100:103], v[80:83], v[44:47], a[100:103]
    s_nop 7
    buffer_load_ushort v64, v87, s[4:7], s32 offen offset:64
    buffer_load_ushort v65, v87, s[4:7], s33 offen offset:64
    buffer_load_ushort v66, v87, s[4:7], s34 offen offset:64
    buffer_load_ushort v67, v87, s[4:7], s35 offen offset:64
    buffer_load_ushort v68, v87, s[4:7], s36 offen offset:64
    buffer_load_ushort v69, v87, s[4:7], s37 offen offset:64
    buffer_load_ushort v70, v87, s[4:7], s38 offen offset:64
    buffer_load_ushort v71, v87, s[4:7], s39 offen offset:64
    s_waitcnt vmcnt(0)
    v_lshl_or_b32 v80, v65, 16, v64
    v_lshl_or_b32 v81, v67, 16, v66
    v_lshl_or_b32 v82, v69, 16, v68
    v_lshl_or_b32 v83, v71, 16, v70
    s_nop 1
    v_mfma_f32_16x16x32_bf16 a[8:11], v[80:83], v[32:35], a[8:11]
    v_mfma_f32_16x16x32_bf16 a[40:43], v[80:83], v[36:39], a[40:43]
    v_mfma_f32_16x16x32_bf16 a[72:75], v[80:83], v[40:43], a[72:75]
    v_mfma_f32_16x16x32_bf16 a[104:107], v[80:83], v[44:47], a[104:107]
    s_nop 7
    buffer_load_ushort v64, v87, s[4:7], s32 offen offset:96
    buffer_load_ushort v65, v87, s[4:7], s33 offen offset:96
    buffer_load_ushort v66, v87, s[4:7], s34 offen offset:96
    buffer_load_ushort v67, v87, s[4:7], s35 offen offset:96
    buffer_load_ushort v68, v87, s[4:7], s36 offen offset:96
    buffer_load_ushort v69, v87, s[4:7], s37 offen offset:96
    buffer_load_ushort v70, v87, s[4:7], s38 offen offset:96
    buffer_load_ushort v71, v87, s[4:7], s39 offen offset:96
    s_waitcnt vmcnt(0)
    v_lshl_or_b32 v80, v65, 16, v64
    v_lshl_or_b32 v81, v67, 16, v66
    v_lshl_or_b32 v82, v69, 16, v68
    v_lshl_or_b32 v83, v71, 16, v70
    s_nop 1
    v_mfma_f32_16x16x32_bf16 a[12:15], v[80:83], v[32:35], a[12:15]
    v_mfma_f32_16x16x32_bf16 a[44:47], v[80:83], v[36:39], a[44:47]
    v_mfma_f32_16x16x32_bf16 a[76:79], v[80:83], v[40:43], a[76:79]
    v_mfma_f32_16x16x32_bf16 a[108:111], v[80:83], v[44:47], a[108:111]
    s_nop 7
    buffer_load_ushort v64, v87, s[4:7], s32 offen offset:128
    buffer_load_ushort v65, v87, s[4:7], s33 offen offset:128
    buffer_load_ushort v66, v87, s[4:7], s34 offen offset:128
    buffer_load_ushort v67, v87, s[4:7], s35 offen offset:128
    buffer_load_ushort v68, v87, s[4:7], s36 offen offset:128
    buffer_load_ushort v69, v87, s[4:7], s37 offen offset:128
    buffer_load_ushort v70, v87, s[4:7], s38 offen offset:128
    buffer_load_ushort v71, v87, s[4:7], s39 offen offset:128
    s_waitcnt vmcnt(0)
    v_lshl_or_b32 v80, v65, 16, v64
    v_lshl_or_b32 v81, v67, 16, v66
    v_lshl_or_b32 v82, v69, 16, v68
    v_lshl_or_b32 v83, v71, 16, v70
    s_nop 1
    v_mfma_f32_16x16x32_bf16 a[16:19], v[80:83], v[32:35], a[16:19]
    v_mfma_f32_16x16x32_bf16 a[48:51], v[80:83], v[36:39], a[48:51]
    v_mfma_f32_16x16x32_bf16 a[80:83], v[80:83], v[40:43], a[80:83]
    v_mfma_f32_16x16x32_bf16 a[112:115], v[80:83], v[44:47], a[112:115]
    s_nop 7
    buffer_load_ushort v64, v87, s[4:7], s32 offen offset:160
    buffer_load_ushort v65, v87, s[4:7], s33 offen offset:160
    buffer_load_ushort v66, v87, s[4:7], s34 offen offset:160
    buffer_load_ushort v67, v87, s[4:7], s35 offen offset:160
    buffer_load_ushort v68, v87, s[4:7], s36 offen offset:160
    buffer_load_ushort v69, v87, s[4:7], s37 offen offset:160
    buffer_load_ushort v70, v87, s[4:7], s38 offen offset:160
    buffer_load_ushort v71, v87, s[4:7], s39 offen offset:160
    s_waitcnt vmcnt(0)
    v_lshl_or_b32 v80, v65, 16, v64
    v_lshl_or_b32 v81, v67, 16, v66
    v_lshl_or_b32 v82, v69, 16, v68
    v_lshl_or_b32 v83, v71, 16, v70
    s_nop 1
    v_mfma_f32_16x16x32_bf16 a[20:23], v[80:83], v[32:35], a[20:23]
    v_mfma_f32_16x16x32_bf16 a[52:55], v[80:83], v[36:39], a[52:55]
    v_mfma_f32_16x16x32_bf16 a[84:87], v[80:83], v[40:43], a[84:87]
    v_mfma_f32_16x16x32_bf16 a[116:119], v[80:83], v[44:47], a[116:119]
    s_nop 7
    buffer_load_ushort v64, v87, s[4:7], s32 offen offset:192
    buffer_load_ushort v65, v87, s[4:7], s33 offen offset:192
    buffer_load_ushort v66, v87, s[4:7], s34 offen offset:192
    buffer_load_ushort v67, v87, s[4:7], s35 offen offset:192
    buffer_load_ushort v68, v87, s[4:7], s36 offen offset:192
    buffer_load_ushort v69, v87, s[4:7], s37 offen offset:192
    buffer_load_ushort v70, v87, s[4:7], s38 offen offset:192
    buffer_load_ushort v71, v87, s[4:7], s39 offen offset:192
    s_waitcnt vmcnt(0)
    v_lshl_or_b32 v80, v65, 16, v64
    v_lshl_or_b32 v81, v67, 16, v66
    v_lshl_or_b32 v82, v69, 16, v68
    v_lshl_or_b32 v83, v71, 16, v70
    s_nop 1
    v_mfma_f32_16x16x32_bf16 a[24:27], v[80:83], v[32:35], a[24:27]
    v_mfma_f32_16x16x32_bf16 a[56:59], v[80:83], v[36:39], a[56:59]
    v_mfma_f32_16x16x32_bf16 a[88:91], v[80:83], v[40:43], a[88:91]
    v_mfma_f32_16x16x32_bf16 a[120:123], v[80:83], v[44:47], a[120:123]
    s_nop 7
    buffer_load_ushort v64, v87, s[4:7], s32 offen offset:224
    buffer_load_ushort v65, v87, s[4:7], s33 offen offset:224
    buffer_load_ushort v66, v87, s[4:7], s34 offen offset:224
    buffer_load_ushort v67, v87, s[4:7], s35 offen offset:224
    buffer_load_ushort v68, v87, s[4:7], s36 offen offset:224
    buffer_load_ushort v69, v87, s[4:7], s37 offen offset:224
    buffer_load_ushort v70, v87, s[4:7], s38 offen offset:224
    buffer_load_ushort v71, v87, s[4:7], s39 offen offset:224
    s_waitcnt vmcnt(0)
    v_lshl_or_b32 v80, v65, 16, v64
    v_lshl_or_b32 v81, v67, 16, v66
    v_lshl_or_b32 v82, v69, 16, v68
    v_lshl_or_b32 v83, v71, 16, v70
    s_nop 1
    v_mfma_f32_16x16x32_bf16 a[28:31], v[80:83], v[32:35], a[28:31]
    v_mfma_f32_16x16x32_bf16 a[60:63], v[80:83], v[36:39], a[60:63]
    v_mfma_f32_16x16x32_bf16 a[92:95], v[80:83], v[40:43], a[92:95]
    v_mfma_f32_16x16x32_bf16 a[124:127], v[80:83], v[44:47], a[124:127]
    s_nop 7
    s_add_u32 s54, s54, 64
    s_cmp_lt_u32 s54, 1280
    s_cbranch_scc1 L1_fb0
    v_accvgpr_read_b32 v116, a0
    v_accvgpr_read_b32 v117, a1
    v_accvgpr_read_b32 v118, a2
    v_accvgpr_read_b32 v119, a3
    v_accvgpr_read_b32 v120, a4
    v_accvgpr_read_b32 v121, a5
    v_accvgpr_read_b32 v122, a6
    v_accvgpr_read_b32 v123, a7
    v_mul_f32 v116, s46, v116
    v_mul_f32 v117, s46, v117
    v_mul_f32 v118, s46, v118
    v_mul_f32 v119, s46, v119
    v_mul_f32 v120, s46, v120
    v_mul_f32 v121, s46, v121
    v_mul_f32 v122, s46, v122
    v_mul_f32 v123, s46, v123
    v_cvt_pk_bf16_f32 v128, v116, v117
    v_cvt_pk_bf16_f32 v129, v118, v119
    v_cvt_pk_bf16_f32 v130, v120, v121
    v_cvt_pk_bf16_f32 v131, v122, v123
    s_nop 0
    v_permlane32_swap_b32 v128, v130
    v_permlane32_swap_b32 v129, v131
    s_nop 0
    v_permlane16_swap_b32 v128, v130
    v_permlane16_swap_b32 v129, v131
    v_accvgpr_read_b32 v10, a8
    v_accvgpr_read_b32 v11, a9
    v_accvgpr_read_b32 v12, a10
    v_accvgpr_read_b32 v13, a11
    v_accvgpr_read_b32 v14, a12
    v_accvgpr_read_b32 v15, a13
    v_accvgpr_read_b32 v16, a14
    v_accvgpr_read_b32 v17, a15
    v_mul_f32 v10, s46, v10
    v_mul_f32 v11, s46, v11
    v_mul_f32 v12, s46, v12
    v_mul_f32 v13, s46, v13
    v_mul_f32 v14, s46, v14
    v_mul_f32 v15, s46, v15
    v_mul_f32 v16, s46, v16
    v_mul_f32 v17, s46, v17
    v_cvt_pk_bf16_f32 v132, v10, v11
    v_cvt_pk_bf16_f32 v133, v12, v13
    v_cvt_pk_bf16_f32 v134, v14, v15
    v_cvt_pk_bf16_f32 v135, v16, v17
    s_nop 0
    v_permlane32_swap_b32 v132, v134
    v_permlane32_swap_b32 v133, v135
    s_nop 0
    v_permlane16_swap_b32 v132, v134
    v_permlane16_swap_b32 v133, v135
    v_accvgpr_read_b32 v116, a16
    v_accvgpr_read_b32 v117, a17
    v_accvgpr_read_b32 v118, a18
    v_accvgpr_read_b32 v119, a19
    v_accvgpr_read_b32 v120, a20
    v_accvgpr_read_b32 v121, a21
    v_accvgpr_read_b32 v122, a22
    v_accvgpr_read_b32 v123, a23
    v_mul_f32 v116, s46, v116
    v_mul_f32 v117, s46, v117
    v_mul_f32 v118, s46, v118
    v_mul_f32 v119, s46, v119
    v_mul_f32 v120, s46, v120
    v_mul_f32 v121, s46, v121
    v_mul_f32 v122, s46, v122
    v_mul_f32 v123, s46, v123
    v_cvt_pk_bf16_f32 v136, v116, v117
    v_cvt_pk_bf16_f32 v137, v118, v119
    v_cvt_pk_bf16_f32 v138, v120, v121
    v_cvt_pk_bf16_f32 v139, v122, v123
    s_nop 0
    v_permlane32_swap_b32 v136, v138
    v_permlane32_swap_b32 v137, v139
    s_nop 0
    v_permlane16_swap_b32 v136, v138
    v_permlane16_swap_b32 v137, v139
    v_accvgpr_read_b32 v10, a24
    v_accvgpr_read_b32 v11, a25
    v_accvgpr_read_b32 v12, a26
    v_accvgpr_read_b32 v13, a27
    v_accvgpr_read_b32 v14, a28
    v_accvgpr_read_b32 v15, a29
    v_accvgpr_read_b32 v16, a30
    v_accvgpr_read_b32 v17, a31
    v_mul_f32 v10, s46, v10
    v_mul_f32 v11, s46, v11
    v_mul_f32 v12, s46, v12
    v_mul_f32 v13, s46, v13
    v_mul_f32 v14, s46, v14
    v_mul_f32 v15, s46, v15
    v_mul_f32 v16, s46, v16
    v_mul_f32 v17, s46, v17
    v_cvt_pk_bf16_f32 v140, v10, v11
    v_cvt_pk_bf16_f32 v141, v12, v13
    v_cvt_pk_bf16_f32 v142, v14, v15
    v_cvt_pk_bf16_f32 v143, v16, v17
    s_nop 0
    v_permlane32_swap_b32 v140, v142
    v_permlane32_swap_b32 v141, v143
    s_nop 0
    v_permlane16_swap_b32 v140, v142
    v_permlane16_swap_b32 v141, v143
    v_accvgpr_read_b32 v116, a32
    v_accvgpr_read_b32 v117, a33
    v_accvgpr_read_b32 v118, a34
    v_accvgpr_read_b32 v119, a35
    v_accvgpr_read_b32 v120, a36
    v_accvgpr_read_b32 v121, a37
    v_accvgpr_read_b32 v122, a38
    v_accvgpr_read_b32 v123, a39
    v_mul_f32 v116, s46, v116
    v_mul_f32 v117, s46, v117
    v_mul_f32 v118, s46, v118
    v_mul_f32 v119, s46, v119
    v_mul_f32 v120, s46, v120
    v_mul_f32 v121, s46, v121
    v_mul_f32 v122, s46, v122
    v_mul_f32 v123, s46, v123
    v_cvt_pk_bf16_f32 v144, v116, v117
    v_cvt_pk_bf16_f32 v145, v118, v119
    v_cvt_pk_bf16_f32 v146, v120, v121
    v_cvt_pk_bf16_f32 v147, v122, v123
    s_nop 0
    v_permlane32_swap_b32 v144, v146
    v_permlane32_swap_b32 v145, v147
    s_nop 0
    v_permlane16_swap_b32 v144, v146
    v_permlane16_swap_b32 v145, v147
    v_accvgpr_read_b32 v10, a40
    v_accvgpr_read_b32 v11, a41
    v_accvgpr_read_b32 v12, a42
    v_accvgpr_read_b32 v13, a43
    v_accvgpr_read_b32 v14, a44
    v_accvgpr_read_b32 v15, a45
    v_accvgpr_read_b32 v16, a46
    v_accvgpr_read_b32 v17, a47
    v_mul_f32 v10, s46, v10
    v_mul_f32 v11, s46, v11
    v_mul_f32 v12, s46, v12
    v_mul_f32 v13, s46, v13
    v_mul_f32 v14, s46, v14
    v_mul_f32 v15, s46, v15
    v_mul_f32 v16, s46, v16
    v_mul_f32 v17, s46, v17
    v_cvt_pk_bf16_f32 v148, v10, v11
    v_cvt_pk_bf16_f32 v149, v12, v13
    v_cvt_pk_bf16_f32 v150, v14, v15
    v_cvt_pk_bf16_f32 v151, v16, v17
    s_nop 0
    v_permlane32_swap_b32 v148, v150
    v_permlane32_swap_b32 v149, v151
    s_nop 0
    v_permlane16_swap_b32 v148, v150
    v_permlane16_swap_b32 v149, v151
    v_accvgpr_read_b32 v116, a48
    v_accvgpr_read_b32 v117, a49
    v_accvgpr_read_b32 v118, a50
    v_accvgpr_read_b32 v119, a51
    v_accvgpr_read_b32 v120, a52
    v_accvgpr_read_b32 v121, a53
    v_accvgpr_read_b32 v122, a54
    v_accvgpr_read_b32 v123, a55
    v_mul_f32 v116, s46, v116
    v_mul_f32 v117, s46, v117
    v_mul_f32 v118, s46, v118
    v_mul_f32 v119, s46, v119
    v_mul_f32 v120, s46, v120
    v_mul_f32 v121, s46, v121
    v_mul_f32 v122, s46, v122
    v_mul_f32 v123, s46, v123
    v_cvt_pk_bf16_f32 v152, v116, v117
    v_cvt_pk_bf16_f32 v153, v118, v119
    v_cvt_pk_bf16_f32 v154, v120, v121
    v_cvt_pk_bf16_f32 v155, v122, v123
    s_nop 0
    v_permlane32_swap_b32 v152, v154
    v_permlane32_swap_b32 v153, v155
    s_nop 0
    v_permlane16_swap_b32 v152, v154
    v_permlane16_swap_b32 v153, v155
    v_accvgpr_read_b32 v10, a56
    v_accvgpr_read_b32 v11, a57
    v_accvgpr_read_b32 v12, a58
    v_accvgpr_read_b32 v13, a59
    v_accvgpr_read_b32 v14, a60
    v_accvgpr_read_b32 v15, a61
    v_accvgpr_read_b32 v16, a62
    v_accvgpr_read_b32 v17, a63
    v_mul_f32 v10, s46, v10
    v_mul_f32 v11, s46, v11
    v_mul_f32 v12, s46, v12
    v_mul_f32 v13, s46, v13
    v_mul_f32 v14, s46, v14
    v_mul_f32 v15, s46, v15
    v_mul_f32 v16, s46, v16
    v_mul_f32 v17, s46, v17
    v_cvt_pk_bf16_f32 v156, v10, v11
    v_cvt_pk_bf16_f32 v157, v12, v13
    v_cvt_pk_bf16_f32 v158, v14, v15
    v_cvt_pk_bf16_f32 v159, v16, v17
    s_nop 0
    v_permlane32_swap_b32 v156, v158
    v_permlane32_swap_b32 v157, v159
    s_nop 0
    v_permlane16_swap_b32 v156, v158
    v_permlane16_swap_b32 v157, v159
    v_accvgpr_read_b32 v116, a64
    v_accvgpr_read_b32 v117, a65
    v_accvgpr_read_b32 v118, a66
    v_accvgpr_read_b32 v119, a67
    v_accvgpr_read_b32 v120, a68
    v_accvgpr_read_b32 v121, a69
    v_accvgpr_read_b32 v122, a70
    v_accvgpr_read_b32 v123, a71
    v_mul_f32 v116, s46, v116
    v_mul_f32 v117, s46, v117
    v_mul_f32 v118, s46, v118
    v_mul_f32 v119, s46, v119
    v_mul_f32 v120, s46, v120
    v_mul_f32 v121, s46, v121
    v_mul_f32 v122, s46, v122
    v_mul_f32 v123, s46, v123
    v_cvt_pk_bf16_f32 v160, v116, v117
    v_cvt_pk_bf16_f32 v161, v118, v119
    v_cvt_pk_bf16_f32 v162, v120, v121
    v_cvt_pk_bf16_f32 v163, v122, v123
    s_nop 0
    v_permlane32_swap_b32 v160, v162
    v_permlane32_swap_b32 v161, v163
    s_nop 0
    v_permlane16_swap_b32 v160, v162
    v_permlane16_swap_b32 v161, v163
    v_accvgpr_read_b32 v10, a72
    v_accvgpr_read_b32 v11, a73
    v_accvgpr_read_b32 v12, a74
    v_accvgpr_read_b32 v13, a75
    v_accvgpr_read_b32 v14, a76
    v_accvgpr_read_b32 v15, a77
    v_accvgpr_read_b32 v16, a78
    v_accvgpr_read_b32 v17, a79
    v_mul_f32 v10, s46, v10
    v_mul_f32 v11, s46, v11
    v_mul_f32 v12, s46, v12
    v_mul_f32 v13, s46, v13
    v_mul_f32 v14, s46, v14
    v_mul_f32 v15, s46, v15
    v_mul_f32 v16, s46, v16
    v_mul_f32 v17, s46, v17
    v_cvt_pk_bf16_f32 v164, v10, v11
    v_cvt_pk_bf16_f32 v165, v12, v13
    v_cvt_pk_bf16_f32 v166, v14, v15
    v_cvt_pk_bf16_f32 v167, v16, v17
    s_nop 0
    v_permlane32_swap_b32 v164, v166
    v_permlane32_swap_b32 v165, v167
    s_nop 0
    v_permlane16_swap_b32 v164, v166
    v_permlane16_swap_b32 v165, v167
    v_accvgpr_read_b32 v116, a80
    v_accvgpr_read_b32 v117, a81
    v_accvgpr_read_b32 v118, a82
    v_accvgpr_read_b32 v119, a83
    v_accvgpr_read_b32 v120, a84
    v_accvgpr_read_b32 v121, a85
    v_accvgpr_read_b32 v122, a86
    v_accvgpr_read_b32 v123, a87
    v_mul_f32 v116, s46, v116
    v_mul_f32 v117, s46, v117
    v_mul_f32 v118, s46, v118
    v_mul_f32 v119, s46, v119
    v_mul_f32 v120, s46, v120
    v_mul_f32 v121, s46, v121
    v_mul_f32 v122, s46, v122
    v_mul_f32 v123, s46, v123
    v_cvt_pk_bf16_f32 v168, v116, v117
    v_cvt_pk_bf16_f32 v169, v118, v119
    v_cvt_pk_bf16_f32 v170, v120, v121
    v_cvt_pk_bf16_f32 v171, v122, v123
    s_nop 0
    v_permlane32_swap_b32 v168, v170
    v_permlane32_swap_b32 v169, v171
    s_nop 0
    v_permlane16_swap_b32 v168, v170
    v_permlane16_swap_b32 v169, v171
    v_accvgpr_read_b32 v10, a88
    v_accvgpr_read_b32 v11, a89
    v_accvgpr_read_b32 v12, a90
    v_accvgpr_read_b32 v13, a91
    v_accvgpr_read_b32 v14, a92
    v_accvgpr_read_b32 v15, a93
    v_accvgpr_read_b32 v16, a94
    v_accvgpr_read_b32 v17, a95
    v_mul_f32 v10, s46, v10
    v_mul_f32 v11, s46, v11
    v_mul_f32 v12, s46, v12
    v_mul_f32 v13, s46, v13
    v_mul_f32 v14, s46, v14
    v_mul_f32 v15, s46, v15
    v_mul_f32 v16, s46, v16
    v_mul_f32 v17, s46, v17
    v_cvt_pk_bf16_f32 v172, v10, v11
    v_cvt_pk_bf16_f32 v173, v12, v13
    v_cvt_pk_bf16_f32 v174, v14, v15
    v_cvt_pk_bf16_f32 v175, v16, v17
    s_nop 0
    v_permlane32_swap_b32 v172, v174
    v_permlane32_swap_b32 v173, v175
    s_nop 0
    v_permlane16_swap_b32 v172, v174
    v_permlane16_swap_b32 v173, v175
    v_accvgpr_read_b32 v116, a96
    v_accvgpr_read_b32 v117, a97
    v_accvgpr_read_b32 v118, a98
    v_accvgpr_read_b32 v119, a99
    v_accvgpr_read_b32 v120, a100
    v_accvgpr_read_b32 v121, a101
    v_accvgpr_read_b32 v122, a102
    v_accvgpr_read_b32 v123, a103
    v_mul_f32 v116, s46, v116
    v_mul_f32 v117, s46, v117
    v_mul_f32 v118, s46, v118
    v_mul_f32 v119, s46, v119
    v_mul_f32 v120, s46, v120
    v_mul_f32 v121, s46, v121
    v_mul_f32 v122, s46, v122
    v_mul_f32 v123, s46, v123
    v_cvt_pk_bf16_f32 v176, v116, v117
    v_cvt_pk_bf16_f32 v177, v118, v119
    v_cvt_pk_bf16_f32 v178, v120, v121
    v_cvt_pk_bf16_f32 v179, v122, v123
    s_nop 0
    v_permlane32_swap_b32 v176, v178
    v_permlane32_swap_b32 v177, v179
    s_nop 0
    v_permlane16_swap_b32 v176, v178
    v_permlane16_swap_b32 v177, v179
    v_accvgpr_read_b32 v10, a104
    v_accvgpr_read_b32 v11, a105
    v_accvgpr_read_b32 v12, a106
    v_accvgpr_read_b32 v13, a107
    v_accvgpr_read_b32 v14, a108
    v_accvgpr_read_b32 v15, a109
    v_accvgpr_read_b32 v16, a110
    v_accvgpr_read_b32 v17, a111
    v_mul_f32 v10, s46, v10
    v_mul_f32 v11, s46, v11
    v_mul_f32 v12, s46, v12
    v_mul_f32 v13, s46, v13
    v_mul_f32 v14, s46, v14
    v_mul_f32 v15, s46, v15
    v_mul_f32 v16, s46, v16
    v_mul_f32 v17, s46, v17
    v_cvt_pk_bf16_f32 v180, v10, v11
    v_cvt_pk_bf16_f32 v181, v12, v13
    v_cvt_pk_bf16_f32 v182, v14, v15
    v_cvt_pk_bf16_f32 v183, v16, v17
    s_nop 0
    v_permlane32_swap_b32 v180, v182
    v_permlane32_swap_b32 v181, v183
    s_nop 0
    v_permlane16_swap_b32 v180, v182
    v_permlane16_swap_b32 v181, v183
    v_accvgpr_read_b32 v116, a112
    v_accvgpr_read_b32 v117, a113
    v_accvgpr_read_b32 v118, a114
    v_accvgpr_read_b32 v119, a115
    v_accvgpr_read_b32 v120, a116
    v_accvgpr_read_b32 v121, a117
    v_accvgpr_read_b32 v122, a118
    v_accvgpr_read_b32 v123, a119
    v_mul_f32 v116, s46, v116
    v_mul_f32 v117, s46, v117
    v_mul_f32 v118, s46, v118
    v_mul_f32 v119, s46, v119
    v_mul_f32 v120, s46, v120
    v_mul_f32 v121, s46, v121
    v_mul_f32 v122, s46, v122
    v_mul_f32 v123, s46, v123
    v_cvt_pk_bf16_f32 v184, v116, v117
    v_cvt_pk_bf16_f32 v185, v118, v119
    v_cvt_pk_bf16_f32 v186, v120, v121
    v_cvt_pk_bf16_f32 v187, v122, v123
    s_nop 0
    v_permlane32_swap_b32 v184, v186
    v_permlane32_swap_b32 v185, v187
    s_nop 0
    v_permlane16_swap_b32 v184, v186
    v_permlane16_swap_b32 v185, v187
    v_accvgpr_read_b32 v10, a120
    v_accvgpr_read_b32 v11, a121
    v_accvgpr_read_b32 v12, a122
    v_accvgpr_read_b32 v13, a123
    v_accvgpr_read_b32 v14, a124
    v_accvgpr_read_b32 v15, a125
    v_accvgpr_read_b32 v16, a126
    v_accvgpr_read_b32 v17, a127
    v_mul_f32 v10, s46, v10
    v_mul_f32 v11, s46, v11
    v_mul_f32 v12, s46, v12
    v_mul_f32 v13, s46, v13
    v_mul_f32 v14, s46, v14
    v_mul_f32 v15, s46, v15
    v_mul_f32 v16, s46, v16
    v_mul_f32 v17, s46, v17
    v_cvt_pk_bf16_f32 v188, v10, v11
    v_cvt_pk_bf16_f32 v189, v12, v13
    v_cvt_pk_bf16_f32 v190, v14, v15
    v_cvt_pk_bf16_f32 v191, v16, v17
    s_nop 0
    v_permlane32_swap_b32 v188, v190
    v_permlane32_swap_b32 v189, v191
    s_nop 0
    v_permlane16_swap_b32 v188, v190
    v_permlane16_swap_b32 v189, v191
    s_mov_b32 s54, 0
    v_mov_b32 v88, 0xff800000
    v_mov_b32 v89, 0xff800000
    v_mov_b32 v90, 0xff800000
    v_mov_b32 v91, 0xff800000
L1_fb1:
    buffer_load_dwordx4 v[64:67], v84, s[60:63], s54 offen offset:0
    buffer_load_dwordx4 v[68:71], v84, s[60:63], s54 offen offset:64
    buffer_load_dwordx4 v[72:75], v84, s[60:63], s54 offen offset:128
    buffer_load_dwordx4 v[76:79], v84, s[60:63], s54 offen offset:192
    s_waitcnt vmcnt(0)
    v_mfma_f32_16x16x32_bf16 v[192:195], v[64:67], v[128:131], 0
    v_mfma_f32_16x16x32_bf16 v[192:195], v[68:71], v[132:135], v[192:195]
    v_mfma_f32_16x16x32_bf16 v[192:195], v[72:75], v[136:139], v[192:195]
    v_mfma_f32_16x16x32_bf16 v[192:195], v[76:79], v[140:143], v[192:195]
    v_mfma_f32_16x16x32_bf16 v[200:203], v[64:67], v[144:147], 0
    v_mfma_f32_16x16x32_bf16 v[200:203], v[68:71], v[148:151], v[200:203]
    v_mfma_f32_16x16x32_bf16 v[200:203], v[72:75], v[152:155], v[200:203]
    v_mfma_f32_16x16x32_bf16 v[200:203], v[76:79], v[156:159], v[200:203]
    v_mfma_f32_16x16x32_bf16 v[208:211], v[64:67], v[160:163], 0
    v_mfma_f32_16x16x32_bf16 v[208:211], v[68:71], v[164:167], v[208:211]
    v_mfma_f32_16x16x32_bf16 v[208:211], v[72:75], v[168:171], v[208:211]
    v_mfma_f32_16x16x32_bf16 v[208:211], v[76:79], v[172:175], v[208:211]
    v_mfma_f32_16x16x32_bf16 v[216:219], v[64:67], v[176:179], 0
    v_mfma_f32_16x16x32_bf16 v[216:219], v[68:71], v[180:183], v[216:219]
    v_mfma_f32_16x16x32_bf16 v[216:219], v[72:75], v[184:187], v[216:219]
    v_mfma_f32_16x16x32_bf16 v[216:219], v[76:79], v[188:191], v[216:219]
    v_max3_f32 v88, v88, v192, v193
    v_max3_f32 v88, v88, v194, v195
    v_max3_f32 v89, v89, v200, v201
    v_max3_f32 v89, v89, v202, v203
    v_max3_f32 v90, v90, v208, v209
    v_max3_f32 v90, v90, v210, v211
    s_nop 1
    v_max3_f32 v91, v91, v216, v217
    v_max3_f32 v91, v91, v218, v219
    s_add_u32 s54, s54, 4096
    s_cmp_lt_u32 s54, 0x40000
    s_cbranch_scc1 L1_fb1
    v_mov_b32 v92, v88
    s_nop 1
    v_permlane32_swap_b32 v88, v92
    v_max_f32 v88, v88, v92
    v_mov_b32 v92, v88
    s_nop 1
    v_permlane16_swap_b32 v88, v92
    v_max_f32 v88, v88, v92
    v_mov_b32 v93, v89
    s_nop 1
    v_permlane32_swap_b32 v89, v93
    v_max_f32 v89, v89, v93
    v_mov_b32 v93, v89
    s_nop 1
    v_permlane16_swap_b32 v89, v93
    v_max_f32 v89, v89, v93
    v_mov_b32 v94, v90
    s_nop 1
    v_permlane32_swap_b32 v90, v94
    v_max_f32 v90, v90, v94
    v_mov_b32 v94, v90
    s_nop 1
    v_permlane16_swap_b32 v90, v94
    v_max_f32 v90, v90, v94
    v_mov_b32 v95, v91
    s_nop 1
    v_permlane32_swap_b32 v91, v95
    v_max_f32 v91, v91, v95
    v_mov_b32 v95, v91
    s_nop 1
    v_permlane16_swap_b32 v91, v95
    v_max_f32 v91, v91, v95
    v_sub_f32 v240, 0, v88
    v_sub_f32 v241, 0, v88
    v_sub_f32 v242, 0, v88
    v_sub_f32 v243, 0, v88
    v_sub_f32 v244, 0, v89
    v_sub_f32 v245, 0, v89
    v_sub_f32 v246, 0, v89
    v_sub_f32 v247, 0, v89
    v_sub_f32 v248, 0, v90
    v_sub_f32 v249, 0, v90
    v_sub_f32 v250, 0, v90
    v_sub_f32 v251, 0, v90
    v_sub_f32 v252, 0, v91
    v_sub_f32 v253, 0, v91
    v_sub_f32 v254, 0, v91
    v_sub_f32 v255, 0, v91
    v_mov_b32 v80, 0
    v_mov_b32 v81, 0
    v_mov_b32 v82, 0
    v_mov_b32 v83, 0
    s_nop 1
    v_mfma_f32_32x32x16_bf16 a[0:15], v[80:83], v[80:83], 0
    v_mfma_f32_32x32x16_bf16 a[16:31], v[80:83], v[80:83], 0
    v_mfma_f32_32x32x16_bf16 a[32:47], v[80:83], v[80:83], 0
    v_mfma_f32_32x32x16_bf16 a[48:63], v[80:83], v[80:83], 0
    v_mfma_f32_32x32x16_bf16 a[64:79], v[80:83], v[80:83], 0
    v_mfma_f32_32x32x16_bf16 a[80:95], v[80:83], v[80:83], 0
    v_mfma_f32_32x32x16_bf16 a[96:111], v[80:83], v[80:83], 0
    v_mfma_f32_32x32x16_bf16 a[112:127], v[80:83], v[80:83], 0
    s_nop 15
    v_mov_b32 v100, 0
    v_mov_b32 v101, 0
    v_mov_b32 v102, 0
    v_mov_b32 v103, 0
    v_mov_b32 v104, 0
    v_mov_b32 v105, 0
    v_mov_b32 v106, 0
    v_mov_b32 v107, 0
    v_mov_b32 v108, 0
    v_mov_b32 v109, 0
    v_mov_b32 v110, 0
    v_mov_b32 v111, 0
    v_mov_b32 v112, 0
    v_mov_b32 v113, 0
    v_mov_b32 v114, 0
    v_mov_b32 v115, 0
    s_mov_b32 s54, 0
L1_fb2:
    s_add_u32 s55, s54, 4096
    buffer_load_dwordx4 v[64:67], v84, s[60:63], s54 offen offset:0
    buffer_load_dwordx4 v[68:71], v84, s[60:63], s54 offen offset:64
    buffer_load_dwordx4 v[72:75], v84, s[60:63], s54 offen offset:128
    buffer_load_dwordx4 v[76:79], v84, s[60:63], s54 offen offset:192
    s_waitcnt vmcnt(0)
    v_mfma_f32_16x16x32_bf16 v[192:195], v[64:67], v[128:131], v[240:243]
    v_mfma_f32_16x16x32_bf16 v[192:195], v[68:71], v[132:135], v[192:195]
    v_mfma_f32_16x16x32_bf16 v[192:195], v[72:75], v[136:139], v[192:195]
    v_mfma_f32_16x16x32_bf16 v[192:195], v[76:79], v[140:143], v[192:195]
    v_mfma_f32_16x16x32_bf16 v[200:203], v[64:67], v[144:147], v[244:247]
    v_mfma_f32_16x16x32_bf16 v[200:203], v[68:71], v[148:151], v[200:203]
    v_mfma_f32_16x16x32_bf16 v[200:203], v[72:75], v[152:155], v[200:203]
    v_mfma_f32_16x16x32_bf16 v[200:203], v[76:79], v[156:159], v[200:203]
    v_mfma_f32_16x16x32_bf16 v[208:211], v[64:67], v[160:163], v[248:251]
    v_mfma_f32_16x16x32_bf16 v[208:211], v[68:71], v[164:167], v[208:211]
    v_mfma_f32_16x16x32_bf16 v[208:211], v[72:75], v[168:171], v[208:211]
    v_mfma_f32_16x16x32_bf16 v[208:211], v[76:79], v[172:175], v[208:211]
    v_mfma_f32_16x16x32_bf16 v[216:219], v[64:67], v[176:179], v[252:255]
    v_mfma_f32_16x16x32_bf16 v[216:219], v[68:71], v[180:183], v[216:219]
    v_mfma_f32_16x16x32_bf16 v[216:219], v[72:75], v[184:187], v[216:219]
    v_mfma_f32_16x16x32_bf16 v[216:219], v[76:79], v[188:191], v[216:219]
    s_nop 7
    buffer_load_dwordx4 v[64:67], v84, s[60:63], s55 offen offset:0
    buffer_load_dwordx4 v[68:71], v84, s[60:63], s55 offen offset:64
    buffer_load_dwordx4 v[72:75], v84, s[60:63], s55 offen offset:128
    buffer_load_dwordx4 v[76:79], v84, s[60:63], s55 offen offset:192
    s_waitcnt vmcnt(0)
    v_mfma_f32_16x16x32_bf16 v[196:199], v[64:67], v[128:131], v[240:243]
    v_mfma_f32_16x16x32_bf16 v[196:199], v[68:71], v[132:135], v[196:199]
    v_mfma_f32_16x16x32_bf16 v[196:199], v[72:75], v[136:139], v[196:199]
    v_mfma_f32_16x16x32_bf16 v[196:199], v[76:79], v[140:143], v[196:199]
    v_mfma_f32_16x16x32_bf16 v[204:207], v[64:67], v[144:147], v[244:247]
    v_mfma_f32_16x16x32_bf16 v[204:207], v[68:71], v[148:151], v[204:207]
    v_mfma_f32_16x16x32_bf16 v[204:207], v[72:75], v[152:155], v[204:207]
    v_mfma_f32_16x16x32_bf16 v[204:207], v[76:79], v[156:159], v[204:207]
    v_mfma_f32_16x16x32_bf16 v[212:215], v[64:67], v[160:163], v[248:251]
    v_mfma_f32_16x16x32_bf16 v[212:215], v[68:71], v[164:167], v[212:215]
    v_mfma_f32_16x16x32_bf16 v[212:215], v[72:75], v[168:171], v[212:215]
    v_mfma_f32_16x16x32_bf16 v[212:215], v[76:79], v[172:175], v[212:215]
    v_mfma_f32_16x16x32_bf16 v[220:223], v[64:67], v[176:179], v[252:255]
    v_mfma_f32_16x16x32_bf16 v[220:223], v[68:71], v[180:183], v[220:223]
    v_mfma_f32_16x16x32_bf16 v[220:223], v[72:75], v[184:187], v[220:223]
    v_mfma_f32_16x16x32_bf16 v[220:223], v[76:79], v[188:191], v[220:223]
    s_nop 7
    v_exp_f32 v192, v192
    v_exp_f32 v193, v193
    v_exp_f32 v194, v194
    v_exp_f32 v195, v195
    v_exp_f32 v196, v196
    v_exp_f32 v197, v197
    v_exp_f32 v198, v198
    v_exp_f32 v199, v199
    v_exp_f32 v200, v200
    v_exp_f32 v201, v201
    v_exp_f32 v202, v202
    v_exp_f32 v203, v203
    v_exp_f32 v204, v204
    v_exp_f32 v205, v205
    v_exp_f32 v206, v206
    v_exp_f32 v207, v207
    v_exp_f32 v208, v208
    v_exp_f32 v209, v209
    v_exp_f32 v210, v210
    v_exp_f32 v211, v211
    v_exp_f32 v212, v212
    v_exp_f32 v213, v213
    v_exp_f32 v214, v214
    v_exp_f32 v215, v215
    v_exp_f32 v216, v216
    v_exp_f32 v217, v217
    v_exp_f32 v218, v218
    v_exp_f32 v219, v219
    v_exp_f32 v220, v220
    v_exp_f32 v221, v221
    v_exp_f32 v222, v222
    v_exp_f32 v223, v223
    v_cvt_pk_bf16_f32 v224, v192, v193
    v_cvt_pk_bf16_f32 v225, v194, v195
    v_cvt_pk_bf16_f32 v226, v196, v197
    v_cvt_pk_bf16_f32 v227, v198, v199
    v_cvt_pk_bf16_f32 v228, v200, v201
    v_cvt_pk_bf16_f32 v229, v202, v203
    v_cvt_pk_bf16_f32 v230, v204, v205
    v_cvt_pk_bf16_f32 v231, v206, v207
    v_cvt_pk_bf16_f32 v232, v208, v209
    v_cvt_pk_bf16_f32 v233, v210, v211
    v_cvt_pk_bf16_f32 v234, v212, v213
    v_cvt_pk_bf16_f32 v235, v214, v215
    v_cvt_pk_bf16_f32 v236, v216, v217
    v_cvt_pk_bf16_f32 v237, v218, v219
    v_cvt_pk_bf16_f32 v238, v220, v221
    v_cvt_pk_bf16_f32 v239, v222, v223
    buffer_load_ushort v64, v85, s[64:67], s54 offen offset:0
    buffer_load_ushort v65, v85, s[64:67], s54 offen offset:256
    buffer_load_ushort v66, v85, s[64:67], s54 offen offset:512
    buffer_load_ushort v67, v85, s[64:67], s54 offen offset:768
    buffer_load_ushort v68, v85, s[64:67], s55 offen offset:0
    buffer_load_ushort v69, v85, s[64:67], s55 offen offset:256
    buffer_load_ushort v70, v85, s[64:67], s55 offen offset:512
    buffer_load_ushort v71, v85, s[64:67], s55 offen offset:768
    s_waitcnt vmcnt(0)
    v_lshl_or_b32 v80, v65, 16, v64
    v_lshl_or_b32 v81, v67, 16, v66
    v_lshl_or_b32 v82, v69, 16, v68
    v_lshl_or_b32 v83, v71, 16, v70
    s_nop 1
    v_mfma_f32_16x16x32_bf16 a[0:3], v[80:83], v[224:227], a[0:3]
    v_mfma_f32_16x16x32_bf16 a[32:35], v[80:83], v[228:231], a[32:35]
    v_mfma_f32_16x16x32_bf16 a[64:67], v[80:83], v[232:235], a[64:67]
    v_mfma_f32_16x16x32_bf16 a[96:99], v[80:83], v[236:239], a[96:99]
    s_nop 7
    buffer_load_ushort v64, v85, s[64:67], s54 offen offset:32
    buffer_load_ushort v65, v85, s[64:67], s54 offen offset:288
    buffer_load_ushort v66, v85, s[64:67], s54 offen offset:544
    buffer_load_ushort v67, v85, s[64:67], s54 offen offset:800
    buffer_load_ushort v68, v85, s[64:67], s55 offen offset:32
    buffer_load_ushort v69, v85, s[64:67], s55 offen offset:288
    buffer_load_ushort v70, v85, s[64:67], s55 offen offset:544
    buffer_load_ushort v71, v85, s[64:67], s55 offen offset:800
    s_waitcnt vmcnt(0)
    v_lshl_or_b32 v80, v65, 16, v64
    v_lshl_or_b32 v81, v67, 16, v66
    v_lshl_or_b32 v82, v69, 16, v68
    v_lshl_or_b32 v83, v71, 16, v70
    s_nop 1
    v_mfma_f32_16x16x32_bf16 a[4:7], v[80:83], v[224:227], a[4:7]
    v_mfma_f32_16x16x32_bf16 a[36:39], v[80:83], v[228:231], a[36:39]
    v_mfma_f32_16x16x32_bf16 a[68:71], v[80:83], v[232:235], a[68:71]
    v_mfma_f32_16x16x32_bf16 a[100:103], v[80:83], v[236:239], a[100:103]
    s_nop 7
    buffer_load_ushort v64, v85, s[64:67], s54 offen offset:64
    buffer_load_ushort v65, v85, s[64:67], s54 offen offset:320
    buffer_load_ushort v66, v85, s[64:67], s54 offen offset:576
    buffer_load_ushort v67, v85, s[64:67], s54 offen offset:832
    buffer_load_ushort v68, v85, s[64:67], s55 offen offset:64
    buffer_load_ushort v69, v85, s[64:67], s55 offen offset:320
    buffer_load_ushort v70, v85, s[64:67], s55 offen offset:576
    buffer_load_ushort v71, v85, s[64:67], s55 offen offset:832
    s_waitcnt vmcnt(0)
    v_lshl_or_b32 v80, v65, 16, v64
    v_lshl_or_b32 v81, v67, 16, v66
    v_lshl_or_b32 v82, v69, 16, v68
    v_lshl_or_b32 v83, v71, 16, v70
    s_nop 1
    v_mfma_f32_16x16x32_bf16 a[8:11], v[80:83], v[224:227], a[8:11]
    v_mfma_f32_16x16x32_bf16 a[40:43], v[80:83], v[228:231], a[40:43]
    v_mfma_f32_16x16x32_bf16 a[72:75], v[80:83], v[232:235], a[72:75]
    v_mfma_f32_16x16x32_bf16 a[104:107], v[80:83], v[236:239], a[104:107]
    s_nop 7
    buffer_load_ushort v64, v85, s[64:67], s54 offen offset:96
    buffer_load_ushort v65, v85, s[64:67], s54 offen offset:352
    buffer_load_ushort v66, v85, s[64:67], s54 offen offset:608
    buffer_load_ushort v67, v85, s[64:67], s54 offen offset:864
    buffer_load_ushort v68, v85, s[64:67], s55 offen offset:96
    buffer_load_ushort v69, v85, s[64:67], s55 offen offset:352
    buffer_load_ushort v70, v85, s[64:67], s55 offen offset:608
    buffer_load_ushort v71, v85, s[64:67], s55 offen offset:864
    s_waitcnt vmcnt(0)
    v_lshl_or_b32 v80, v65, 16, v64
    v_lshl_or_b32 v81, v67, 16, v66
    v_lshl_or_b32 v82, v69, 16, v68
    v_lshl_or_b32 v83, v71, 16, v70
    s_nop 1
    v_mfma_f32_16x16x32_bf16 a[12:15], v[80:83], v[224:227], a[12:15]
    v_mfma_f32_16x16x32_bf16 a[44:47], v[80:83], v[228:231], a[44:47]
    v_mfma_f32_16x16x32_bf16 a[76:79], v[80:83], v[232:235], a[76:79]
    v_mfma_f32_16x16x32_bf16 a[108:111], v[80:83], v[236:239], a[108:111]
    s_nop 7
    buffer_load_ushort v64, v85, s[64:67], s54 offen offset:128
    buffer_load_ushort v65, v85, s[64:67], s54 offen offset:384
    buffer_load_ushort v66, v85, s[64:67], s54 offen offset:640
    buffer_load_ushort v67, v85, s[64:67], s54 offen offset:896
    buffer_load_ushort v68, v85, s[64:67], s55 offen offset:128
    buffer_load_ushort v69, v85, s[64:67], s55 offen offset:384
    buffer_load_ushort v70, v85, s[64:67], s55 offen offset:640
    buffer_load_ushort v71, v85, s[64:67], s55 offen offset:896
    s_waitcnt vmcnt(0)
    v_lshl_or_b32 v80, v65, 16, v64
    v_lshl_or_b32 v81, v67, 16, v66
    v_lshl_or_b32 v82, v69, 16, v68
    v_lshl_or_b32 v83, v71, 16, v70
    s_nop 1
    v_mfma_f32_16x16x32_bf16 a[16:19], v[80:83], v[224:227], a[16:19]
    v_mfma_f32_16x16x32_bf16 a[48:51], v[80:83], v[228:231], a[48:51]
    v_mfma_f32_16x16x32_bf16 a[80:83], v[80:83], v[232:235], a[80:83]
    v_mfma_f32_16x16x32_bf16 a[112:115], v[80:83], v[236:239], a[112:115]
    s_nop 7
    buffer_load_ushort v64, v85, s[64:67], s54 offen offset:160
    buffer_load_ushort v65, v85, s[64:67], s54 offen offset:416
    buffer_load_ushort v66, v85, s[64:67], s54 offen offset:672
    buffer_load_ushort v67, v85, s[64:67], s54 offen offset:928
    buffer_load_ushort v68, v85, s[64:67], s55 offen offset:160
    buffer_load_ushort v69, v85, s[64:67], s55 offen offset:416
    buffer_load_ushort v70, v85, s[64:67], s55 offen offset:672
    buffer_load_ushort v71, v85, s[64:67], s55 offen offset:928
    s_waitcnt vmcnt(0)
    v_lshl_or_b32 v80, v65, 16, v64
    v_lshl_or_b32 v81, v67, 16, v66
    v_lshl_or_b32 v82, v69, 16, v68
    v_lshl_or_b32 v83, v71, 16, v70
    s_nop 1
    v_mfma_f32_16x16x32_bf16 a[20:23], v[80:83], v[224:227], a[20:23]
    v_mfma_f32_16x16x32_bf16 a[52:55], v[80:83], v[228:231], a[52:55]
    v_mfma_f32_16x16x32_bf16 a[84:87], v[80:83], v[232:235], a[84:87]
    v_mfma_f32_16x16x32_bf16 a[116:119], v[80:83], v[236:239], a[116:119]
    s_nop 7
    buffer_load_ushort v64, v85, s[64:67], s54 offen offset:192
    buffer_load_ushort v65, v85, s[64:67], s54 offen offset:448
    buffer_load_ushort v66, v85, s[64:67], s54 offen offset:704
    buffer_load_ushort v67, v85, s[64:67], s54 offen offset:960
    buffer_load_ushort v68, v85, s[64:67], s55 offen offset:192
    buffer_load_ushort v69, v85, s[64:67], s55 offen offset:448
    buffer_load_ushort v70, v85, s[64:67], s55 offen offset:704
    buffer_load_ushort v71, v85, s[64:67], s55 offen offset:960
    s_waitcnt vmcnt(0)
    v_lshl_or_b32 v80, v65, 16, v64
    v_lshl_or_b32 v81, v67, 16, v66
    v_lshl_or_b32 v82, v69, 16, v68
    v_lshl_or_b32 v83, v71, 16, v70
    s_nop 1
    v_mfma_f32_16x16x32_bf16 a[24:27], v[80:83], v[224:227], a[24:27]
    v_mfma_f32_16x16x32_bf16 a[56:59], v[80:83], v[228:231], a[56:59]
    v_mfma_f32_16x16x32_bf16 a[88:91], v[80:83], v[232:235], a[88:91]
    v_mfma_f32_16x16x32_bf16 a[120:123], v[80:83], v[236:239], a[120:123]
    s_nop 7
    buffer_load_ushort v64, v85, s[64:67], s54 offen offset:224
    buffer_load_ushort v65, v85, s[64:67], s54 offen offset:480
    buffer_load_ushort v66, v85, s[64:67], s54 offen offset:736
    buffer_load_ushort v67, v85, s[64:67], s54 offen offset:992
    buffer_load_ushort v68, v85, s[64:67], s55 offen offset:224
    buffer_load_ushort v69, v85, s[64:67], s55 offen offset:480
    buffer_load_ushort v70, v85, s[64:67], s55 offen offset:736
    buffer_load_ushort v71, v85, s[64:67], s55 offen offset:992
    s_waitcnt vmcnt(0)
    v_lshl_or_b32 v80, v65, 16, v64
    v_lshl_or_b32 v81, v67, 16, v66
    v_lshl_or_b32 v82, v69, 16, v68
    v_lshl_or_b32 v83, v71, 16, v70
    s_nop 1
    v_mfma_f32_16x16x32_bf16 a[28:31], v[80:83], v[224:227], a[28:31]
    v_mfma_f32_16x16x32_bf16 a[60:63], v[80:83], v[228:231], a[60:63]
    v_mfma_f32_16x16x32_bf16 a[92:95], v[80:83], v[232:235], a[92:95]
    v_mfma_f32_16x16x32_bf16 a[124:127], v[80:83], v[236:239], a[124:127]
    s_nop 7
    v_mfma_f32_16x16x32_bf16 v[100:103], v[96:99], v[224:227], v[100:103]
    v_mfma_f32_16x16x32_bf16 v[104:107], v[96:99], v[228:231], v[104:107]
    v_mfma_f32_16x16x32_bf16 v[108:111], v[96:99], v[232:235], v[108:111]
    v_mfma_f32_16x16x32_bf16 v[112:115], v[96:99], v[236:239], v[112:115]
    s_add_u32 s54, s54, 8192
    s_cmp_lt_u32 s54, 0x40000
    s_cbranch_scc1 L1_fb2
    s_nop 7
    v_rcp_f32 v24, v100
    v_rcp_f32 v25, v104
    v_rcp_f32 v26, v108
    v_rcp_f32 v27, v112
    v_accvgpr_read_b32 v116, a0
    v_accvgpr_read_b32 v117, a1
    v_accvgpr_read_b32 v118, a2
    v_accvgpr_read_b32 v119, a3
    v_accvgpr_read_b32 v120, a4
    v_accvgpr_read_b32 v121, a5
    v_accvgpr_read_b32 v122, a6
    v_accvgpr_read_b32 v123, a7
    v_mul_f32 v116, v24, v116
    v_mul_f32 v117, v24, v117
    v_mul_f32 v118, v24, v118
    v_mul_f32 v119, v24, v119
    v_mul_f32 v120, v24, v120
    v_mul_f32 v121, v24, v121
    v_mul_f32 v122, v24, v122
    v_mul_f32 v123, v24, v123
    v_cvt_pk_bf16_f32 v124, v116, v117
    v_cvt_pk_bf16_f32 v125, v118, v119
    v_cvt_pk_bf16_f32 v126, v120, v121
    v_cvt_pk_bf16_f32 v127, v122, v123
    buffer_store_dwordx4 v[124:127], v20, s[8:11], s48 offen offset:0 sc1
    v_accvgpr_read_b32 v10, a8
    v_accvgpr_read_b32 v11, a9
    v_accvgpr_read_b32 v12, a10
    v_accvgpr_read_b32 v13, a11
    v_accvgpr_read_b32 v14, a12
    v_accvgpr_read_b32 v15, a13
    v_accvgpr_read_b32 v16, a14
    v_accvgpr_read_b32 v17, a15
    v_mul_f32 v10, v24, v10
    v_mul_f32 v11, v24, v11
    v_mul_f32 v12, v24, v12
    v_mul_f32 v13, v24, v13
    v_mul_f32 v14, v24, v14
    v_mul_f32 v15, v24, v15
    v_mul_f32 v16, v24, v16
    v_mul_f32 v17, v24, v17
    v_cvt_pk_bf16_f32 v28, v10, v11
    v_cvt_pk_bf16_f32 v29, v12, v13
    v_cvt_pk_bf16_f32 v30, v14, v15
    v_cvt_pk_bf16_f32 v31, v16, v17
    buffer_store_dwordx4 v[28:31], v20, s[8:11], s48 offen offset:1024 sc1
    v_accvgpr_read_b32 v116, a16
    v_accvgpr_read_b32 v117, a17
    v_accvgpr_read_b32 v118, a18
    v_accvgpr_read_b32 v119, a19
    v_accvgpr_read_b32 v120, a20
    v_accvgpr_read_b32 v121, a21
    v_accvgpr_read_b32 v122, a22
    v_accvgpr_read_b32 v123, a23
    v_mul_f32 v116, v24, v116
    v_mul_f32 v117, v24, v117
    v_mul_f32 v118, v24, v118
    v_mul_f32 v119, v24, v119
    v_mul_f32 v120, v24, v120
    v_mul_f32 v121, v24, v121
    v_mul_f32 v122, v24, v122
    v_mul_f32 v123, v24, v123
    v_cvt_pk_bf16_f32 v124, v116, v117
    v_cvt_pk_bf16_f32 v125, v118, v119
    v_cvt_pk_bf16_f32 v126, v120, v121
    v_cvt_pk_bf16_f32 v127, v122, v123
    buffer_store_dwordx4 v[124:127], v20, s[8:11], s48 offen offset:2048 sc1
    v_accvgpr_read_b32 v10, a24
    v_accvgpr_read_b32 v11, a25
    v_accvgpr_read_b32 v12, a26
    v_accvgpr_read_b32 v13, a27
    v_accvgpr_read_b32 v14, a28
    v_accvgpr_read_b32 v15, a29
    v_accvgpr_read_b32 v16, a30
    v_accvgpr_read_b32 v17, a31
    v_mul_f32 v10, v24, v10
    v_mul_f32 v11, v24, v11
    v_mul_f32 v12, v24, v12
    v_mul_f32 v13, v24, v13
    v_mul_f32 v14, v24, v14
    v_mul_f32 v15, v24, v15
    v_mul_f32 v16, v24, v16
    v_mul_f32 v17, v24, v17
    v_cvt_pk_bf16_f32 v28, v10, v11
    v_cvt_pk_bf16_f32 v29, v12, v13
    v_cvt_pk_bf16_f32 v30, v14, v15
    v_cvt_pk_bf16_f32 v31, v16, v17
    buffer_store_dwordx4 v[28:31], v20, s[8:11], s48 offen offset:3072 sc1
    v_accvgpr_read_b32 v116, a32
    v_accvgpr_read_b32 v117, a33
    v_accvgpr_read_b32 v118, a34
    v_accvgpr_read_b32 v119, a35
    v_accvgpr_read_b32 v120, a36
    v_accvgpr_read_b32 v121, a37
    v_accvgpr_read_b32 v122, a38
    v_accvgpr_read_b32 v123, a39
    v_mul_f32 v116, v25, v116
    v_mul_f32 v117, v25, v117
    v_mul_f32 v118, v25, v118
    v_mul_f32 v119, v25, v119
    v_mul_f32 v120, v25, v120
    v_mul_f32 v121, v25, v121
    v_mul_f32 v122, v25, v122
    v_mul_f32 v123, v25, v123
    v_cvt_pk_bf16_f32 v124, v116, v117
    v_cvt_pk_bf16_f32 v125, v118, v119
    v_cvt_pk_bf16_f32 v126, v120, v121
    v_cvt_pk_bf16_f32 v127, v122, v123
    buffer_store_dwordx4 v[124:127], v20, s[8:11], s49 offen offset:0 sc1
    v_accvgpr_read_b32 v10, a40
    v_accvgpr_read_b32 v11, a41
    v_accvgpr_read_b32 v12, a42
    v_accvgpr_read_b32 v13, a43
    v_accvgpr_read_b32 v14, a44
    v_accvgpr_read_b32 v15, a45
    v_accvgpr_read_b32 v16, a46
    v_accvgpr_read_b32 v17, a47
    v_mul_f32 v10, v25, v10
    v_mul_f32 v11, v25, v11
    v_mul_f32 v12, v25, v12
    v_mul_f32 v13, v25, v13
    v_mul_f32 v14, v25, v14
    v_mul_f32 v15, v25, v15
    v_mul_f32 v16, v25, v16
    v_mul_f32 v17, v25, v17
    v_cvt_pk_bf16_f32 v28, v10, v11
    v_cvt_pk_bf16_f32 v29, v12, v13
    v_cvt_pk_bf16_f32 v30, v14, v15
    v_cvt_pk_bf16_f32 v31, v16, v17
    buffer_store_dwordx4 v[28:31], v20, s[8:11], s49 offen offset:1024 sc1
    v_accvgpr_read_b32 v116, a48
    v_accvgpr_read_b32 v117, a49
    v_accvgpr_read_b32 v118, a50
    v_accvgpr_read_b32 v119, a51
    v_accvgpr_read_b32 v120, a52
    v_accvgpr_read_b32 v121, a53
    v_accvgpr_read_b32 v122, a54
    v_accvgpr_read_b32 v123, a55
    v_mul_f32 v116, v25, v116
    v_mul_f32 v117, v25, v117
    v_mul_f32 v118, v25, v118
    v_mul_f32 v119, v25, v119
    v_mul_f32 v120, v25, v120
    v_mul_f32 v121, v25, v121
    v_mul_f32 v122, v25, v122
    v_mul_f32 v123, v25, v123
    v_cvt_pk_bf16_f32 v124, v116, v117
    v_cvt_pk_bf16_f32 v125, v118, v119
    v_cvt_pk_bf16_f32 v126, v120, v121
    v_cvt_pk_bf16_f32 v127, v122, v123
    buffer_store_dwordx4 v[124:127], v20, s[8:11], s49 offen offset:2048 sc1
    v_accvgpr_read_b32 v10, a56
    v_accvgpr_read_b32 v11, a57
    v_accvgpr_read_b32 v12, a58
    v_accvgpr_read_b32 v13, a59
    v_accvgpr_read_b32 v14, a60
    v_accvgpr_read_b32 v15, a61
    v_accvgpr_read_b32 v16, a62
    v_accvgpr_read_b32 v17, a63
    v_mul_f32 v10, v25, v10
    v_mul_f32 v11, v25, v11
    v_mul_f32 v12, v25, v12
    v_mul_f32 v13, v25, v13
    v_mul_f32 v14, v25, v14
    v_mul_f32 v15, v25, v15
    v_mul_f32 v16, v25, v16
    v_mul_f32 v17, v25, v17
    v_cvt_pk_bf16_f32 v28, v10, v11
    v_cvt_pk_bf16_f32 v29, v12, v13
    v_cvt_pk_bf16_f32 v30, v14, v15
    v_cvt_pk_bf16_f32 v31, v16, v17
    buffer_store_dwordx4 v[28:31], v20, s[8:11], s49 offen offset:3072 sc1
    v_accvgpr_read_b32 v116, a64
    v_accvgpr_read_b32 v117, a65
    v_accvgpr_read_b32 v118, a66
    v_accvgpr_read_b32 v119, a67
    v_accvgpr_read_b32 v120, a68
    v_accvgpr_read_b32 v121, a69
    v_accvgpr_read_b32 v122, a70
    v_accvgpr_read_b32 v123, a71
    v_mul_f32 v116, v26, v116
    v_mul_f32 v117, v26, v117
    v_mul_f32 v118, v26, v118
    v_mul_f32 v119, v26, v119
    v_mul_f32 v120, v26, v120
    v_mul_f32 v121, v26, v121
    v_mul_f32 v122, v26, v122
    v_mul_f32 v123, v26, v123
    v_cvt_pk_bf16_f32 v124, v116, v117
    v_cvt_pk_bf16_f32 v125, v118, v119
    v_cvt_pk_bf16_f32 v126, v120, v121
    v_cvt_pk_bf16_f32 v127, v122, v123
    buffer_store_dwordx4 v[124:127], v20, s[8:11], s50 offen offset:0 sc1
    v_accvgpr_read_b32 v10, a72
    v_accvgpr_read_b32 v11, a73
    v_accvgpr_read_b32 v12, a74
    v_accvgpr_read_b32 v13, a75
    v_accvgpr_read_b32 v14, a76
    v_accvgpr_read_b32 v15, a77
    v_accvgpr_read_b32 v16, a78
    v_accvgpr_read_b32 v17, a79
    v_mul_f32 v10, v26, v10
    v_mul_f32 v11, v26, v11
    v_mul_f32 v12, v26, v12
    v_mul_f32 v13, v26, v13
    v_mul_f32 v14, v26, v14
    v_mul_f32 v15, v26, v15
    v_mul_f32 v16, v26, v16
    v_mul_f32 v17, v26, v17
    v_cvt_pk_bf16_f32 v28, v10, v11
    v_cvt_pk_bf16_f32 v29, v12, v13
    v_cvt_pk_bf16_f32 v30, v14, v15
    v_cvt_pk_bf16_f32 v31, v16, v17
    buffer_store_dwordx4 v[28:31], v20, s[8:11], s50 offen offset:1024 sc1
    v_accvgpr_read_b32 v116, a80
    v_accvgpr_read_b32 v117, a81
    v_accvgpr_read_b32 v118, a82
    v_accvgpr_read_b32 v119, a83
    v_accvgpr_read_b32 v120, a84
    v_accvgpr_read_b32 v121, a85
    v_accvgpr_read_b32 v122, a86
    v_accvgpr_read_b32 v123, a87
    v_mul_f32 v116, v26, v116
    v_mul_f32 v117, v26, v117
    v_mul_f32 v118, v26, v118
    v_mul_f32 v119, v26, v119
    v_mul_f32 v120, v26, v120
    v_mul_f32 v121, v26, v121
    v_mul_f32 v122, v26, v122
    v_mul_f32 v123, v26, v123
    v_cvt_pk_bf16_f32 v124, v116, v117
    v_cvt_pk_bf16_f32 v125, v118, v119
    v_cvt_pk_bf16_f32 v126, v120, v121
    v_cvt_pk_bf16_f32 v127, v122, v123
    buffer_store_dwordx4 v[124:127], v20, s[8:11], s50 offen offset:2048 sc1
    v_accvgpr_read_b32 v10, a88
    v_accvgpr_read_b32 v11, a89
    v_accvgpr_read_b32 v12, a90
    v_accvgpr_read_b32 v13, a91
    v_accvgpr_read_b32 v14, a92
    v_accvgpr_read_b32 v15, a93
    v_accvgpr_read_b32 v16, a94
    v_accvgpr_read_b32 v17, a95
    v_mul_f32 v10, v26, v10
    v_mul_f32 v11, v26, v11
    v_mul_f32 v12, v26, v12
    v_mul_f32 v13, v26, v13
    v_mul_f32 v14, v26, v14
    v_mul_f32 v15, v26, v15
    v_mul_f32 v16, v26, v16
    v_mul_f32 v17, v26, v17
    v_cvt_pk_bf16_f32 v28, v10, v11
    v_cvt_pk_bf16_f32 v29, v12, v13
    v_cvt_pk_bf16_f32 v30, v14, v15
    v_cvt_pk_bf16_f32 v31, v16, v17
    buffer_store_dwordx4 v[28:31], v20, s[8:11], s50 offen offset:3072 sc1
    v_accvgpr_read_b32 v116, a96
    v_accvgpr_read_b32 v117, a97
    v_accvgpr_read_b32 v118, a98
    v_accvgpr_read_b32 v119, a99
    v_accvgpr_read_b32 v120, a100
    v_accvgpr_read_b32 v121, a101
    v_accvgpr_read_b32 v122, a102
    v_accvgpr_read_b32 v123, a103
    v_mul_f32 v116, v27, v116
    v_mul_f32 v117, v27, v117
    v_mul_f32 v118, v27, v118
    v_mul_f32 v119, v27, v119
    v_mul_f32 v120, v27, v120
    v_mul_f32 v121, v27, v121
    v_mul_f32 v122, v27, v122
    v_mul_f32 v123, v27, v123
    v_cvt_pk_bf16_f32 v124, v116, v117
    v_cvt_pk_bf16_f32 v125, v118, v119
    v_cvt_pk_bf16_f32 v126, v120, v121
    v_cvt_pk_bf16_f32 v127, v122, v123
    buffer_store_dwordx4 v[124:127], v20, s[8:11], s51 offen offset:0 sc1
    v_accvgpr_read_b32 v10, a104
    v_accvgpr_read_b32 v11, a105
    v_accvgpr_read_b32 v12, a106
    v_accvgpr_read_b32 v13, a107
    v_accvgpr_read_b32 v14, a108
    v_accvgpr_read_b32 v15, a109
    v_accvgpr_read_b32 v16, a110
    v_accvgpr_read_b32 v17, a111
    v_mul_f32 v10, v27, v10
    v_mul_f32 v11, v27, v11
    v_mul_f32 v12, v27, v12
    v_mul_f32 v13, v27, v13
    v_mul_f32 v14, v27, v14
    v_mul_f32 v15, v27, v15
    v_mul_f32 v16, v27, v16
    v_mul_f32 v17, v27, v17
    v_cvt_pk_bf16_f32 v28, v10, v11
    v_cvt_pk_bf16_f32 v29, v12, v13
    v_cvt_pk_bf16_f32 v30, v14, v15
    v_cvt_pk_bf16_f32 v31, v16, v17
    buffer_store_dwordx4 v[28:31], v20, s[8:11], s51 offen offset:1024 sc1
    v_accvgpr_read_b32 v116, a112
    v_accvgpr_read_b32 v117, a113
    v_accvgpr_read_b32 v118, a114
    v_accvgpr_read_b32 v119, a115
    v_accvgpr_read_b32 v120, a116
    v_accvgpr_read_b32 v121, a117
    v_accvgpr_read_b32 v122, a118
    v_accvgpr_read_b32 v123, a119
    v_mul_f32 v116, v27, v116
    v_mul_f32 v117, v27, v117
    v_mul_f32 v118, v27, v118
    v_mul_f32 v119, v27, v119
    v_mul_f32 v120, v27, v120
    v_mul_f32 v121, v27, v121
    v_mul_f32 v122, v27, v122
    v_mul_f32 v123, v27, v123
    v_cvt_pk_bf16_f32 v124, v116, v117
    v_cvt_pk_bf16_f32 v125, v118, v119
    v_cvt_pk_bf16_f32 v126, v120, v121
    v_cvt_pk_bf16_f32 v127, v122, v123
    buffer_store_dwordx4 v[124:127], v20, s[8:11], s51 offen offset:2048 sc1
    v_accvgpr_read_b32 v10, a120
    v_accvgpr_read_b32 v11, a121
    v_accvgpr_read_b32 v12, a122
    v_accvgpr_read_b32 v13, a123
    v_accvgpr_read_b32 v14, a124
    v_accvgpr_read_b32 v15, a125
    v_accvgpr_read_b32 v16, a126
    v_accvgpr_read_b32 v17, a127
    v_mul_f32 v10, v27, v10
    v_mul_f32 v11, v27, v11
    v_mul_f32 v12, v27, v12
    v_mul_f32 v13, v27, v13
    v_mul_f32 v14, v27, v14
    v_mul_f32 v15, v27, v15
    v_mul_f32 v16, v27, v16
    v_mul_f32 v17, v27, v17
    v_cvt_pk_bf16_f32 v28, v10, v11
    v_cvt_pk_bf16_f32 v29, v12, v13
    v_cvt_pk_bf16_f32 v30, v14, v15
    v_cvt_pk_bf16_f32 v31, v16, v17
    buffer_store_dwordx4 v[28:31], v20, s[8:11], s51 offen offset:3072 sc1
    s_cmp_lg_u32 s99, 0
    s_cbranch_scc1 L1_fb
    s_mov_b32 s18, 0
    s_mov_b32 s49, 0
    s_mov_b32 s50, 0
    s_mov_b32 s51, 0
    s_mov_b32 s101, 0
    s_branch L2_start
.section .rodata,"a"
.p2align 6
.amdhsa_kernel standalone__gqa_block_cached__near_ridge_kernel
  .amdhsa_next_free_vgpr 512
  .amdhsa_next_free_sgpr 102
  .amdhsa_accum_offset 256
  .amdhsa_group_segment_fixed_size 0
  .amdhsa_kernarg_size 64
  .amdhsa_user_sgpr_count 2
  .amdhsa_user_sgpr_kernarg_segment_ptr 1
  .amdhsa_system_sgpr_workgroup_id_x 1
.end_amdhsa_kernel
```
